```python
import torch

def _softmax(x, axis=-1):
    return torch.softmax(x, dim=axis)
def _gelu(x):
    return torch.nn.functional.gelu(x, approximate="tanh")
def _silu(x):
    return torch.nn.functional.silu(x)
def _sigmoid(x):
    return torch.sigmoid(x)
def _layernorm(x, axis=-1, eps=1e-5):
    m = x.mean(dim=axis, keepdim=True)
    v = x.var(dim=axis, keepdim=True, unbiased=False)
    return (x - m) / torch.sqrt(v + eps)
def _scatter_add(tgt, idx, src, axis=0):
    return tgt.clone().index_add_(axis, idx, src)
def _segment_sum(src, seg, n):
    out = torch.zeros((n,) + src.shape[1:], dtype=src.dtype)
    return out.index_add_(0, seg, src)
def _pad(x, pw):
    flat = tuple(v for pair in reversed(pw) for v in pair)
    return torch.nn.functional.pad(x, flat)

kernel_name = 'concat_heads__compressed_kv_cla__sliding_block__prompt'

def setup_inputs():

    _w = (lambda a: (lambda t: t.to(torch.bfloat16) if t.is_floating_point() else t)(torch.as_tensor(a)))
    def _A_setup():
        B, H, Sq, Sk, D, M = 1, 16, 2048, 2048, 256, 448
        Dc = 4 * D
        return {
            "x": _w((lambda *s: torch.randn(*s, dtype=torch.bfloat16) * 0.2)(B, Sq, M)),
            "c_kv": _w((lambda *s: torch.randn(*s, dtype=torch.bfloat16) * 1.6)(B, Sk, Dc)),
            "w_q": _w((lambda *s: torch.randn(*s, dtype=torch.bfloat16) * 3.2)(M, H, D) * (M ** -0.5)),
            "w_uk": _w((lambda *s: torch.randn(*s, dtype=torch.bfloat16) * 3.2)(Dc, H, D) * (Dc ** -0.5)),
            "w_uv": _w((lambda *s: torch.randn(*s, dtype=torch.bfloat16) * 1.6)(Dc, H, D) * (Dc ** -0.5)),
            "w_o": _w((lambda *s: torch.randn(*s, dtype=torch.bfloat16) * 1.6)(H, D, M) * ((H * D) ** -0.5)),
        }
    _A_in = _A_setup()

    def _B_setup():
        B, S, D = 1, 2048, 448
        return {
            "x": _w((lambda *s: torch.randn(*s, dtype=torch.bfloat16) * 0.4)(B, S, D)),
            "wqkv": _w((lambda *s: torch.randn(*s, dtype=torch.bfloat16) * 0.4)(D, 3 * D)),
            "wo": _w((lambda *s: torch.randn(*s, dtype=torch.bfloat16) * 0.05)(D, D)),
        }
    _B_in = _B_setup()

    return {
        "A_x": _A_in["x"],
        "A_c_kv": _A_in["c_kv"],
        "A_w_q": _A_in["w_q"],
        "A_w_uk": _A_in["w_uk"],
        "A_w_uv": _A_in["w_uv"],
        "A_w_o": _A_in["w_o"],
        "B_x": _B_in["x"],
        "B_wqkv": _B_in["wqkv"],
        "B_wo": _B_in["wo"],
    }

def reference(A_x, A_c_kv, A_w_q, A_w_uk, A_w_uv, A_w_o, B_x, B_wqkv, B_wo):
    def _A_ref(x, c_kv, w_q, w_uk, w_uv, w_o):
        B, Sq, M = x.shape[0], x.shape[1], x.shape[2]
        Sk = c_kv.shape[1]
        H, D = w_q.shape[1], w_q.shape[2]
        q = torch.einsum("bqm,mhd->bhqd", x, w_q)
        k = torch.einsum("bkc,chd->bhkd", c_kv, w_uk)
        v = torch.einsum("bkc,chd->bhkd", c_kv, w_uv)
        scores = torch.einsum("bhqd,bhkd->bhqk", q, k) * (D ** -0.5)
        off = Sk - Sq
        qi = torch.arange(Sq)[:, None]
        kj = torch.arange(Sk)[None, :]
        cmask = kj <= (qi + off)
        scores = torch.where(cmask[None, None], scores, -1e9)
        p = _softmax(scores, axis=-1)
        ctx = torch.einsum("bhqk,bhkd->bhqd", p, v)
        return torch.einsum("bhqd,hdm->bqm", ctx, w_o)

    def _B_ref(x, wqkv, wo):
        B, S, D = x.shape
        H = 16; Dh = D // H; W = 256
        qkv = (lambda x, *d: x.permute(*d))((x @ wqkv).reshape(B, S, 3, H, Dh), 2, 0, 3, 1, 4)
        q, k, v = qkv[0], qkv[1], qkv[2]
        scores = torch.einsum("bhqd,bhkd->bhqk", q, k) * (Dh ** -0.5)
        idx = torch.arange(S)
        mask = (idx[:, None] - idx[None, :] >= 0) & (idx[:, None] - idx[None, :] < W)
        scores = torch.where(mask[None, None], scores, -1e9)
        p = _softmax(scores, axis=-1)
        o = torch.einsum("bhqk,bhkd->bhqd", p, v)
        return (lambda x, *d: x.permute(*d))(o, 0, 2, 1, 3).reshape(B, S, D) @ wo

    a = _A_ref(A_x, A_c_kv, A_w_q, A_w_uk, A_w_uv, A_w_o)
    b = _B_ref(B_x, B_wqkv, B_wo)
    return torch.concatenate([a, b], axis=-1)
```

```asm
; @launch grid=(256,1,1) block=(256,1,1) lds=163840
.amdgcn_target "amdgcn-amd-amdhsa--gfx950"
.text
.globl concat_heads__compressed_kv_cla__sliding_block__prompt_kernel
.p2align 8
.type concat_heads__compressed_kv_cla__sliding_block__prompt_kernel,@function
concat_heads__compressed_kv_cla__sliding_block__prompt_kernel:
s_cmp_ge_u32 s2, 256
s_cbranch_scc1 L_f_end
s_load_dwordx16 s[32:47], s[0:1], 0
s_load_dwordx8 s[48:55], s[0:1], 64
v_lshrrev_b32 v1, 6, v0
s_nop 0
v_readfirstlane_b32 s16, v1
s_mov_b32 s30, 0x7f000000
s_waitcnt lgkmcnt(0)
s_mov_b32 s12, s54
s_mov_b32 s13, s55
s_mov_b32 s14, 268435456
s_mov_b32 s15, 0x20000
s_and_b32 s61, s2, 7
s_lshr_b32 s62, s2, 3
s_lshl_b32 s61, s61, 2
s_and_b32 s63, s62, 3
s_add_u32 s61, s61, s63
s_lshr_b32 s62, s62, 2
s_lshl_b32 s59, s62, 8
s_lshr_b32 s60, s61, 4
s_and_b32 s61, s61, 15
s_mov_b32 s101, s61
s_lshl_b32 s68, s61, 20
s_lshl_b32 s62, s62, 17
s_add_u32 s68, s68, s62
s_lshl_b32 s62, s60, 24
s_add_u32 s68, s68, s62
s_lshl_b32 s61, s61, 9
s_mov_b32 s4, s34
s_mov_b32 s5, s35
s_mov_b32 s6, 4194304
s_mov_b32 s7, 0x20000
s_cmp_eq_u32 s60, 0
s_cselect_b32 s62, s38, s40
s_cselect_b32 s63, s39, s41
s_add_u32 s8, s62, s61
s_addc_u32 s9, s63, 0
s_sub_u32 s10, 8388608, s61
s_mov_b32 s11, 0x20000
s_mov_b32 s56, 2048
s_mov_b32 s57, 8192
s_mov_b32 s58, 0
s_mov_b32 s29, 16
v_and_b32 v28, 63, v0
v_lshlrev_b32 v1, 4, v28
v_and_b32 v29, 15, v28
v_lshrrev_b32 v30, 4, v28
v_lshrrev_b32 v31, 1, v29
v_xor_b32 v31, v31, v30
s_lshr_b32 s61, s16, 1
s_lshl_b32 s61, s61, 14
v_lshlrev_b32 v32, 7, v29
v_add_u32 v32, s61, v32
v_xor_b32 v33, 0, v31
v_lshl_add_u32 v2, v33, 4, v32
v_xor_b32 v33, 4, v31
v_lshl_add_u32 v3, v33, 4, v32
v_bfe_u32 v31, v28, 2, 2
v_and_b32 v32, 3, v28
v_lshlrev_b32 v32, 3, v32
v_lshl_add_u32 v29, v30, 3, v31
v_lshlrev_b32 v29, 9, v29
v_add_u32 v29, 0x10000, v29
v_and_b32 v30, 1, v30
v_lshl_add_u32 v31, v30, 2, v31
v_lshlrev_b32 v31, 5, v31
s_and_b32 s61, s16, 1
s_cmp_eq_u32 s58, 0
s_cselect_b32 s62, 64, 56
s_mul_i32 s61, s61, s62
s_lshl_b32 s61, s61, 2
v_add_u32 v33, s61, v32
v_xor_b32 v33, v33, v31
v_add_u32 v4, v33, v29
v_add_u32 v33, s61, v32
v_add_u32 v33, 32, v33
v_xor_b32 v33, v33, v31
v_add_u32 v5, v33, v29
s_add_u32 s61, s61, s62
v_add_u32 v33, s61, v32
v_xor_b32 v33, v33, v31
v_add_u32 v6, v33, v29
v_add_u32 v33, s61, v32
v_add_u32 v33, 32, v33
v_xor_b32 v33, v33, v31
v_add_u32 v7, v33, v29
s_add_u32 s61, s61, s62
v_add_u32 v33, s61, v32
v_xor_b32 v33, v33, v31
v_add_u32 v8, v33, v29
v_add_u32 v33, s61, v32
v_add_u32 v33, 32, v33
v_xor_b32 v33, v33, v31
v_add_u32 v9, v33, v29
s_add_u32 s61, s61, s62
v_add_u32 v33, s61, v32
v_xor_b32 v33, v33, v31
v_add_u32 v10, v33, v29
v_add_u32 v33, s61, v32
v_add_u32 v33, 32, v33
v_xor_b32 v33, v33, v31
v_add_u32 v11, v33, v29
s_add_u32 s61, s61, s62
v_lshrrev_b32 v29, 3, v28
s_lshl_b32 s61, s16, 6
s_add_u32 s61, s61, s59
v_add_u32 v29, s61, v29
v_mul_lo_u32 v29, v29, s56
v_and_b32 v30, 7, v28
v_lshrrev_b32 v31, 4, v28
v_xor_b32 v30, v30, v31
v_xor_b32 v31, 4, v30
v_lshlrev_b32 v30, 4, v30
v_lshlrev_b32 v31, 4, v31
s_lshl_b32 s62, s56, 3
s_mov_b32 s61, 0
v_add3_u32 v12, v29, v30, s61
s_add_u32 s61, s61, s62
s_sub_u32 s61, s61, 1024
v_add3_u32 v13, v29, v31, s61
s_add_u32 s61, s61, s62
s_sub_u32 s61, s61, 1024
v_add3_u32 v14, v29, v30, s61
s_add_u32 s61, s61, s62
s_sub_u32 s61, s61, 1024
v_add3_u32 v15, v29, v31, s61
s_add_u32 s61, s61, s62
s_add_u32 s61, s61, 3072
v_add3_u32 v16, v29, v30, s61
s_add_u32 s61, s61, s62
s_sub_u32 s61, s61, 1024
v_add3_u32 v17, v29, v31, s61
s_add_u32 s61, s61, s62
s_sub_u32 s61, s61, 1024
v_add3_u32 v18, v29, v30, s61
s_add_u32 s61, s61, s62
s_sub_u32 s61, s61, 1024
v_add3_u32 v19, v29, v31, s61
v_lshrrev_b32 v29, 5, v28
v_and_b32 v30, 31, v28
v_lshlrev_b32 v31, 1, v29
v_xor_b32 v30, v30, v31
s_lshl_b32 s61, s16, 4
v_add_u32 v29, s61, v29
v_mul_lo_u32 v29, v29, s57
s_lshl_b32 s62, s57, 1
s_mov_b32 s61, 0
v_xor_b32 v31, 0, v30
v_lshlrev_b32 v31, 4, v31
v_add3_u32 v20, v29, v31, s61
s_add_u32 s61, s61, s62
s_sub_u32 s61, s61, 1024
v_xor_b32 v31, 4, v30
v_lshlrev_b32 v31, 4, v31
v_add3_u32 v21, v29, v31, s61
s_add_u32 s61, s61, s62
s_sub_u32 s61, s61, 1024
v_xor_b32 v31, 0, v30
v_lshlrev_b32 v31, 4, v31
v_add3_u32 v22, v29, v31, s61
s_add_u32 s61, s61, s62
s_sub_u32 s61, s61, 1024
v_xor_b32 v31, 4, v30
v_lshlrev_b32 v31, 4, v31
v_add3_u32 v23, v29, v31, s61
s_add_u32 s61, s61, s62
s_add_u32 s61, s61, 3072
v_xor_b32 v31, 8, v30
v_lshlrev_b32 v31, 4, v31
v_add3_u32 v24, v29, v31, s61
s_add_u32 s61, s61, s62
s_sub_u32 s61, s61, 1024
v_xor_b32 v31, 12, v30
v_lshlrev_b32 v31, 4, v31
v_add3_u32 v25, v29, v31, s61
s_add_u32 s61, s61, s62
s_sub_u32 s61, s61, 1024
v_xor_b32 v31, 8, v30
v_lshlrev_b32 v31, 4, v31
v_add3_u32 v26, v29, v31, s61
s_add_u32 s61, s61, s62
s_sub_u32 s61, s61, 1024
v_xor_b32 v31, 12, v30
v_lshlrev_b32 v31, 4, v31
v_add3_u32 v27, v29, v31, s61
s_lshl_b32 s19, s57, 6
s_lshl_b32 s61, s16, 13
s_mov_b32 s17, 0
s_mov_b32 s18, 0
s_add_u32 s21, s61, 32768
s_add_u32 s22, s61, 98304
s_add_u32 s86, s61, 36864
s_add_u32 s87, s61, 102400
s_add_u32 m0, s61, 0
s_nop 0
buffer_load_dwordx4 v12, s[4:7], s17 offen offset:0 lds
buffer_load_dwordx4 v13, s[4:7], s17 offen offset:1024 lds
buffer_load_dwordx4 v14, s[4:7], s17 offen offset:2048 lds
buffer_load_dwordx4 v15, s[4:7], s17 offen offset:3072 lds
s_add_u32 m0, s61, 4096
s_nop 0
buffer_load_dwordx4 v16, s[4:7], s17 offen offset:0 lds
buffer_load_dwordx4 v17, s[4:7], s17 offen offset:1024 lds
buffer_load_dwordx4 v18, s[4:7], s17 offen offset:2048 lds
buffer_load_dwordx4 v19, s[4:7], s17 offen offset:3072 lds
s_add_u32 m0, s61, 65536
s_nop 0
buffer_load_dwordx4 v20, s[8:11], s18 offen offset:0 lds
buffer_load_dwordx4 v21, s[8:11], s18 offen offset:1024 lds
buffer_load_dwordx4 v22, s[8:11], s18 offen offset:2048 lds
buffer_load_dwordx4 v23, s[8:11], s18 offen offset:3072 lds
s_add_u32 m0, s61, 69632
s_nop 0
buffer_load_dwordx4 v24, s[8:11], s18 offen offset:0 lds
buffer_load_dwordx4 v25, s[8:11], s18 offen offset:1024 lds
buffer_load_dwordx4 v26, s[8:11], s18 offen offset:2048 lds
buffer_load_dwordx4 v27, s[8:11], s18 offen offset:3072 lds
s_mov_b32 s17, 128
s_mov_b32 s18, s19
s_sub_u32 s70, s29, 1
s_mov_b32 s71, 0
s_mov_b32 s27, 128
s_mov_b32 s28, s19
s_lshr_b32 s61, s2, 3
v_and_b32 v28, 63, v0
s_lshl_b32 s62, s61, 6
v_add_u32 v240, s62, v28
s_mov_b32 m0, s21
s_nop 0
buffer_load_dwordx4 v12, s[4:7], s17 offen offset:0 lds
v_lshlrev_b32 v240, 11, v240
s_lshr_b32 s62, s61, 2
s_lshl_b32 s62, s62, 3
v_bfe_u32 v29, v28, 2, 3
buffer_load_dwordx4 v13, s[4:7], s17 offen offset:1024 lds
v_add_u32 v29, s62, v29
v_lshlrev_b32 v29, 13, v29
v_and_b32 v30, 3, v28
v_lshl_add_u32 v29, v30, 7, v29
buffer_load_dwordx4 v14, s[4:7], s17 offen offset:2048 lds
s_cmp_eq_u32 s16, 1
s_cselect_b64 vcc, -1, 0
s_nop 1
v_cndmask_b32 v240, v240, v29, vcc
buffer_load_dwordx4 v15, s[4:7], s17 offen offset:3072 lds
s_cmp_ge_u32 s16, 2
s_cselect_b64 vcc, -1, 0
v_mov_b32 v29, 0
s_nop 0
s_mov_b32 m0, s86
s_nop 0
buffer_load_dwordx4 v16, s[4:7], s17 offen offset:0 lds
v_cndmask_b32 v240, v240, v29, vcc
v_and_b32 v28, 63, v0
v_lshlrev_b32 v28, 7, v28
s_lshl_b32 s61, s2, 1
buffer_load_dwordx4 v17, s[4:7], s17 offen offset:1024 lds
s_add_u32 s61, s61, s16
s_sub_u32 s61, s61, 2
s_min_u32 s61, s61, 511
s_sub_u32 s62, s61, 448
buffer_load_dwordx4 v18, s[4:7], s17 offen offset:2048 lds
s_min_u32 s62, s62, 48
s_cmp_lt_u32 s61, 448
s_cselect_b32 s62, s61, s62
s_cselect_b32 s63, s36, s48
buffer_load_dwordx4 v19, s[4:7], s17 offen offset:3072 lds
s_cselect_b32 s85, s37, s49
s_lshl_b32 s62, s62, 13
s_add_u32 s63, s63, s62
s_addc_u32 s85, s85, 0
s_mov_b32 m0, s22
s_nop 0
buffer_load_dwordx4 v20, s[8:11], s18 offen offset:0 lds
v_add_co_u32 v242, vcc, s63, v28
v_mov_b32 v243, s85
s_nop 0
v_addc_co_u32 v243, vcc, 0, v243, vcc
buffer_load_dwordx4 v21, s[8:11], s18 offen offset:1024 lds
s_sub_u32 s62, s61, 448
s_min_u32 s62, s62, 0
s_cmp_lt_u32 s61, 448
s_cselect_b32 s62, s61, s62
buffer_load_dwordx4 v22, s[8:11], s18 offen offset:2048 lds
s_cselect_b32 s63, s42, s42
s_cselect_b32 s85, s43, s43
s_lshl_b32 s62, s62, 13
s_add_u32 s63, s63, s62
buffer_load_dwordx4 v23, s[8:11], s18 offen offset:3072 lds
s_addc_u32 s85, s85, 0
v_add_co_u32 v244, vcc, s63, v28
v_mov_b32 v245, s85
s_nop 0
s_mov_b32 m0, s87
s_nop 0
buffer_load_dwordx4 v24, s[8:11], s18 offen offset:0 lds
v_addc_co_u32 v245, vcc, 0, v245, vcc
s_sub_u32 s62, s61, 224
s_min_u32 s62, s62, 223
s_cmp_lt_u32 s61, 224
buffer_load_dwordx4 v25, s[8:11], s18 offen offset:1024 lds
s_cselect_b32 s62, s61, s62
s_cselect_b32 s63, s32, s44
s_cselect_b32 s85, s33, s45
s_lshl_b32 s62, s62, 13
buffer_load_dwordx4 v26, s[8:11], s18 offen offset:2048 lds
s_add_u32 s63, s63, s62
s_addc_u32 s85, s85, 0
v_add_co_u32 v246, vcc, s63, v28
v_mov_b32 v247, s85
buffer_load_dwordx4 v27, s[8:11], s18 offen offset:3072 lds
s_nop 0
v_addc_co_u32 v247, vcc, 0, v247, vcc
s_sub_u32 s62, s61, 147
s_min_u32 s62, s62, 0
s_cmp_lt_u32 s61, 147
s_cselect_b32 s62, s61, s62
s_cselect_b32 s63, s46, s46
s_cselect_b32 s85, s47, s47
s_lshl_b32 s62, s62, 13
s_add_u32 s63, s63, s62
s_addc_u32 s85, s85, 0
v_add_co_u32 v248, vcc, s63, v28
v_mov_b32 v249, s85
s_nop 0
v_addc_co_u32 v249, vcc, 0, v249, vcc
s_cmp_ge_u32 s16, 2
s_cbranch_scc1 L_f_tchg
s_cmp_eq_u32 s16, 0
s_cbranch_scc0 L_f_tch1_1
s_add_u32 s85, s17, 128
buffer_load_dword v241, v240, s[4:7], s85 offen
s_branch L_f_tch2_1
L_f_tch1_1:
s_mul_i32 s85, s19, 1
s_add_u32 s85, s85, s18
buffer_load_dword v241, v240, s[8:11], s85 offen
L_f_tch2_1:
s_cmp_eq_u32 s16, 0
s_cbranch_scc0 L_f_tch1_2
s_add_u32 s85, s17, 256
buffer_load_dword v241, v240, s[4:7], s85 offen
s_branch L_f_tch2_2
L_f_tch1_2:
s_mul_i32 s85, s19, 2
s_add_u32 s85, s85, s18
buffer_load_dword v241, v240, s[8:11], s85 offen
L_f_tch2_2:
s_branch L_f_tchd
L_f_tchg:
buffer_load_dword v241, v1, s[4:7], 0 offen
buffer_load_dword v241, v1, s[4:7], 0 offen
L_f_tchd:
s_getpc_b64 s[64:65]
L_f_pc:
s_lshr_b32 s66, s2, 3
s_lshl_b32 s67, s16, 5
s_add_u32 s66, s66, s67
s_lshl_b32 s66, s66, 13
s_min_u32 s66, s66, L_f_codeend - L_f_pc - 8192
s_add_u32 s64, s64, s66
s_addc_u32 s65, s65, 0
v_and_b32 v250, 63, v0
v_lshlrev_b32 v250, 7, v250
global_load_dword v250, v250, s[64:65]
s_cmp_lg_u32 s16, 0
s_cbranch_scc1 L_f_tok0
s_memrealtime s[62:63]
s_waitcnt lgkmcnt(0)
s_or_b32 s62, s62, 1
v_mov_b32 v252, s62
v_mov_b32 v253, 0
v_mov_b32 v254, 0
s_mov_b64 exec, 1
global_atomic_cmpswap v251, v254, v[252:253], s[52:53] sc0 sc1
s_mov_b64 exec, -1
L_f_tok0:
s_lshr_b32 s24, s2, 4
s_and_b32 s25, s2, 7
s_lshl_b32 s25, s25, 1
s_bfe_u32 s61, s2, 0x10003
s_add_u32 s25, s25, s61
s_and_b32 s61, s2, 7
s_lshr_b32 s62, s2, 3
s_lshl_b32 s26, s61, 1
s_and_b32 s63, s62, 1
s_add_u32 s26, s26, s63
s_lshr_b32 s62, s62, 1
s_and_b32 s31, s62, 1
s_lshr_b32 s65, s62, 1
s_sub_u32 s61, 15, s65
s_cmp_eq_u32 s31, 0
s_cselect_b32 s66, s61, s65
s_mov_b32 s96, s44
s_mov_b32 s97, s45
s_mov_b32 s98, 1835008
s_mov_b32 s99, 0x20000
s_mov_b32 s72, s32
s_mov_b32 s73, s33
s_mov_b32 s74, 1835008
s_mov_b32 s75, 0x20000
s_lshl_b32 s61, s26, 9
s_add_u32 s76, s36, s61
s_addc_u32 s77, s37, 0
s_sub_u32 s78, 3670016, s61
s_mov_b32 s79, 0x20000
s_lshl_b32 s67, s16, 13
s_lshl_b32 s84, s16, 12
v_and_b32 v28, 63, v0
v_and_b32 v29, 15, v28
v_lshrrev_b32 v30, 4, v28
v_bfe_u32 v31, v28, 2, 2
v_and_b32 v32, 3, v28
s_lshl_b32 s62, s25, 7
s_lshl_b32 s61, s16, 5
s_add_u32 s61, s61, s62
v_lshrrev_b32 v33, 3, v28
v_add_u32 v33, s61, v33
v_mul_u32_u24 v33, 896, v33
v_and_b32 v34, 7, v28
v_xor_b32 v34, v34, v30
v_xor_b32 v35, 0, v34
v_lshl_add_u32 v35, v35, 4, v33
v_add_u32 v168, 0, v35
v_xor_b32 v35, 4, v34
v_lshl_add_u32 v35, v35, 4, v33
v_add_u32 v169, 6144, v35
v_xor_b32 v35, 0, v34
v_lshl_add_u32 v35, v35, 4, v33
v_add_u32 v170, 12288, v35
v_xor_b32 v35, 4, v34
v_lshl_add_u32 v35, v35, 4, v33
v_add_u32 v171, 18432, v35
s_lshl_b32 s62, s66, 7
s_lshl_b32 s61, s16, 5
s_add_u32 s61, s61, s62
v_lshrrev_b32 v33, 3, v28
v_add_u32 v33, s61, v33
v_mul_u32_u24 v33, 896, v33
v_and_b32 v34, 7, v28
v_xor_b32 v34, v34, v30
v_xor_b32 v35, 0, v34
v_lshl_add_u32 v35, v35, 4, v33
v_add_u32 v164, 0, v35
v_xor_b32 v35, 4, v34
v_lshl_add_u32 v35, v35, 4, v33
v_add_u32 v165, 6144, v35
v_xor_b32 v35, 0, v34
v_lshl_add_u32 v35, v35, 4, v33
v_add_u32 v166, 12288, v35
v_xor_b32 v35, 4, v34
v_lshl_add_u32 v35, v35, 4, v33
v_add_u32 v167, 18432, v35
v_lshrrev_b32 v33, 1, v29
v_xor_b32 v33, v33, v30
v_lshlrev_b32 v34, 7, v29
v_add_u32 v34, s84, v34
v_xor_b32 v35, 0, v33
v_lshl_add_u32 v176, v35, 4, v34
v_xor_b32 v35, 4, v33
v_lshl_add_u32 v177, v35, 4, v34
s_mul_i32 s62, s24, 56
s_and_b32 s89, s62, 8
s_and_b32 s62, s62, -16
s_lshl_b32 s63, s16, 4
v_add_u32 v35, s63, v30
v_mul_u32_u24 v35, 2688, v35
v_add_u32 v35, s62, v35
v_lshlrev_b32 v33, 1, v30
v_xor_b32 v33, v33, v29
v_cmp_eq_u32 vcc, 15, v33
v_mul_u32_u24 v34, 52, v33
v_lshrrev_b32 v34, 8, v34
v_mul_u32_u24 v34, 816, v34
v_lshl_add_u32 v34, v33, 4, v34
v_add_u32 v34, v34, v35
v_mov_b32 v33, 0x7e000000
v_cndmask_b32 v34, v34, v33, vcc
v_add_u32 v172, 0, v34
v_add_u32 v173, 9728, v34
v_lshlrev_b32 v33, 1, v30
v_xor_b32 v33, 8, v33
v_xor_b32 v33, v33, v29
v_cmp_eq_u32 vcc, 15, v33
v_mul_u32_u24 v34, 52, v33
v_lshrrev_b32 v34, 8, v34
v_mul_u32_u24 v34, 816, v34
v_lshl_add_u32 v34, v33, 4, v34
v_add_u32 v34, v34, v35
v_mov_b32 v33, 0x7e000000
v_cndmask_b32 v34, v34, v33, vcc
v_add_u32 v174, 19456, v34
v_add_u32 v175, 29184, v34
s_cmp_eq_u32 s16, 0
s_cbranch_scc1 L_f_w19
s_waitcnt vmcnt(19)
s_branch L_f_wd
L_f_w19:
s_waitcnt vmcnt(20)
L_f_wd:
s_barrier
ds_read_b128 v[36:39], v2 offset:0
ds_read_b64_tr_b16 v[68:69], v4 offset:0
ds_read_b64_tr_b16 v[70:71], v4 offset:2048
ds_read_b64_tr_b16 v[72:73], v5 offset:0
ds_read_b64_tr_b16 v[74:75], v5 offset:2048
ds_read_b64_tr_b16 v[76:77], v6 offset:0
ds_read_b64_tr_b16 v[78:79], v6 offset:2048
ds_read_b64_tr_b16 v[80:81], v7 offset:0
ds_read_b64_tr_b16 v[82:83], v7 offset:2048
ds_read_b64_tr_b16 v[84:85], v8 offset:0
ds_read_b64_tr_b16 v[86:87], v8 offset:2048
ds_read_b64_tr_b16 v[88:89], v9 offset:0
ds_read_b64_tr_b16 v[90:91], v9 offset:2048
ds_read_b64_tr_b16 v[92:93], v10 offset:0
ds_read_b64_tr_b16 v[94:95], v10 offset:2048
ds_read_b64_tr_b16 v[96:97], v11 offset:0
ds_read_b64_tr_b16 v[98:99], v11 offset:2048
ds_read_b128 v[40:43], v2 offset:2048
ds_read_b128 v[44:47], v2 offset:4096
ds_read_b128 v[48:51], v2 offset:6144
ds_read_b128 v[52:55], v2 offset:8192
ds_read_b128 v[56:59], v2 offset:10240
ds_read_b128 v[60:63], v2 offset:12288
ds_read_b128 v[64:67], v2 offset:14336
s_mov_b32 s20, s29
s_cmp_eq_u32 s60, 0
s_cbranch_scc0 L_f_nx_1_1
s_cmp_eq_u32 s16, 1
s_cbranch_scc1 L_f_go_1_1
L_f_nx_1_1:
s_cmp_eq_u32 s60, 0
s_cbranch_scc0 L_f_nx_1_2
s_cmp_eq_u32 s16, 2
s_cbranch_scc1 L_f_go_1_2
L_f_nx_1_2:
s_cmp_eq_u32 s60, 0
s_cbranch_scc0 L_f_nx_1_3
s_cmp_eq_u32 s16, 3
s_cbranch_scc1 L_f_go_1_3
L_f_nx_1_3:
s_cmp_eq_u32 s60, 1
s_cbranch_scc0 L_f_nx_0_0
s_cmp_eq_u32 s16, 0
s_cbranch_scc1 L_f_go_0_0
L_f_nx_0_0:
s_cmp_eq_u32 s60, 1
s_cbranch_scc0 L_f_nx_0_1
s_cmp_eq_u32 s16, 1
s_cbranch_scc1 L_f_go_0_1
L_f_nx_0_1:
s_cmp_eq_u32 s60, 1
s_cbranch_scc0 L_f_nx_0_2
s_cmp_eq_u32 s16, 2
s_cbranch_scc1 L_f_go_0_2
L_f_nx_0_2:
s_cmp_eq_u32 s60, 1
s_cbranch_scc0 L_f_nx_0_3
s_cmp_eq_u32 s16, 3
s_cbranch_scc1 L_f_go_0_3
L_f_nx_0_3:
L_f_go_1_0:
s_waitcnt lgkmcnt(0)
v_mfma_f32_16x16x32_bf16 a[0:3], v[68:71], v[36:39], 0
ds_read_b128 v[100:103], v3 offset:0
v_mfma_f32_16x16x32_bf16 a[4:7], v[72:75], v[36:39], 0
s_cmp_ge_u32 s2, 128
s_cselect_b32 s80, s48, s42
s_cselect_b32 s81, s49, s43
s_mov_b32 s62, 401408
s_cselect_b32 s82, s62, 3670016
s_mov_b32 s83, 0x20000
v_mfma_f32_16x16x32_bf16 a[8:11], v[76:79], v[36:39], 0
ds_read_b64_tr_b16 v[132:133], v4 offset:16384
v_mfma_f32_16x16x32_bf16 a[12:15], v[80:83], v[36:39], 0
s_sub_u32 s61, s2, 128
s_cselect_b32 s61, s61, s61
s_cmp_ge_u32 s2, 128
s_cselect_b32 s61, s61, s2
s_cselect_b32 s62, 28, 32
v_mfma_f32_16x16x32_bf16 a[16:19], v[84:87], v[36:39], 0
ds_read_b64_tr_b16 v[134:135], v4 offset:18432
v_mfma_f32_16x16x32_bf16 a[20:23], v[88:91], v[36:39], 0
s_mul_i32 s62, s62, s61
s_mul_i32 s62, s62, 896
v_mfma_f32_16x16x32_bf16 a[24:27], v[92:95], v[36:39], 0
ds_read_b64_tr_b16 v[136:137], v5 offset:16384
v_mfma_f32_16x16x32_bf16 a[28:31], v[96:99], v[36:39], 0
s_lshl_b32 s90, s61, 10
s_cmp_ge_u32 s2, 128
s_mov_b32 s63, 79691776
s_cselect_b32 s63, s63, 75497472
v_mfma_f32_16x16x32_bf16 a[32:35], v[68:71], v[40:43], 0
ds_read_b64_tr_b16 v[138:139], v5 offset:18432
v_mfma_f32_16x16x32_bf16 a[36:39], v[72:75], v[40:43], 0
s_add_u32 s90, s90, s63
s_cmp_ge_u32 s2, 128
s_mov_b32 s63, 16384
s_cselect_b32 s100, s63, 131072
v_mfma_f32_16x16x32_bf16 a[40:43], v[76:79], v[40:43], 0
ds_read_b64_tr_b16 v[140:141], v6 offset:16384
v_mfma_f32_16x16x32_bf16 a[44:47], v[80:83], v[40:43], 0
s_cmp_ge_u32 s2, 144
s_cselect_b32 s62, s30, s62
s_cselect_b32 s90, s30, s90
s_cselect_b32 s100, 0, s100
s_mul_i32 s63, s16, 7168
v_mfma_f32_16x16x32_bf16 a[48:51], v[84:87], v[40:43], 0
ds_read_b64_tr_b16 v[142:143], v6 offset:18432
v_mfma_f32_16x16x32_bf16 a[52:55], v[88:91], v[40:43], 0
s_add_u32 s62, s62, s63
s_add_u32 s63, s63, 131072
v_mfma_f32_16x16x32_bf16 a[56:59], v[92:95], v[40:43], 0
ds_read_b64_tr_b16 v[144:145], v7 offset:16384
v_mfma_f32_16x16x32_bf16 a[60:63], v[96:99], v[40:43], 0
s_add_u32 m0, s63, 0
s_add_u32 s61, s62, 0
buffer_load_dwordx4 v1, s[80:83], s61 offen lds
s_add_u32 m0, s63, 1024
s_add_u32 s61, s62, 1024
buffer_load_dwordx4 v1, s[80:83], s61 offen lds
v_mfma_f32_16x16x32_bf16 a[64:67], v[68:71], v[44:47], 0
ds_read_b64_tr_b16 v[146:147], v7 offset:18432
v_mfma_f32_16x16x32_bf16 a[68:71], v[72:75], v[44:47], 0
s_add_u32 m0, s63, 2048
s_add_u32 s61, s62, 2048
buffer_load_dwordx4 v1, s[80:83], s61 offen lds
s_add_u32 m0, s63, 3072
s_add_u32 s61, s62, 3072
buffer_load_dwordx4 v1, s[80:83], s61 offen lds
v_mfma_f32_16x16x32_bf16 a[72:75], v[76:79], v[44:47], 0
ds_read_b64_tr_b16 v[148:149], v8 offset:16384
v_mfma_f32_16x16x32_bf16 a[76:79], v[80:83], v[44:47], 0
s_add_u32 m0, s63, 4096
s_add_u32 s61, s62, 4096
buffer_load_dwordx4 v1, s[80:83], s61 offen lds
s_add_u32 m0, s63, 5120
s_add_u32 s61, s62, 5120
buffer_load_dwordx4 v1, s[80:83], s61 offen lds
v_mfma_f32_16x16x32_bf16 a[80:83], v[84:87], v[44:47], 0
ds_read_b64_tr_b16 v[150:151], v8 offset:18432
v_mfma_f32_16x16x32_bf16 a[84:87], v[88:91], v[44:47], 0
s_add_u32 m0, s63, 6144
s_add_u32 s61, s62, 6144
buffer_load_dwordx4 v1, s[80:83], s61 offen lds
v_and_b32 v28, 63, v0
v_mfma_f32_16x16x32_bf16 a[88:91], v[92:95], v[44:47], 0
ds_read_b64_tr_b16 v[152:153], v9 offset:16384
v_mfma_f32_16x16x32_bf16 a[92:95], v[96:99], v[44:47], 0
v_and_b32 v29, 15, v28
v_lshrrev_b32 v30, 4, v28
v_mfma_f32_16x16x32_bf16 a[96:99], v[68:71], v[48:51], 0
ds_read_b64_tr_b16 v[154:155], v9 offset:18432
v_mfma_f32_16x16x32_bf16 a[100:103], v[72:75], v[48:51], 0
v_bfe_u32 v31, v28, 2, 2
v_and_b32 v32, 3, v28
v_mfma_f32_16x16x32_bf16 a[104:107], v[76:79], v[48:51], 0
ds_read_b64_tr_b16 v[156:157], v10 offset:16384
v_mfma_f32_16x16x32_bf16 a[108:111], v[80:83], v[48:51], 0
v_lshl_add_u32 v33, v30, 2, v31
v_mul_u32_u24 v33, 896, v33
v_mfma_f32_16x16x32_bf16 a[112:115], v[84:87], v[48:51], 0
ds_read_b64_tr_b16 v[158:159], v10 offset:18432
v_mfma_f32_16x16x32_bf16 a[116:119], v[88:91], v[48:51], 0
v_lshl_add_u32 v33, v32, 3, v33
s_mul_i32 s62, s16, 224
v_mfma_f32_16x16x32_bf16 a[120:123], v[92:95], v[48:51], 0
ds_read_b64_tr_b16 v[160:161], v11 offset:16384
v_mfma_f32_16x16x32_bf16 a[124:127], v[96:99], v[48:51], 0
s_add_u32 s85, s17, 384
v_mfma_f32_16x16x32_bf16 a[128:131], v[68:71], v[52:55], 0
ds_read_b64_tr_b16 v[162:163], v11 offset:18432
v_mfma_f32_16x16x32_bf16 a[132:135], v[72:75], v[52:55], 0
buffer_load_dword v241, v240, s[4:7], s85 offen
v_mfma_f32_16x16x32_bf16 a[136:139], v[76:79], v[52:55], 0
ds_read_b128 v[104:107], v3 offset:2048
v_mfma_f32_16x16x32_bf16 a[140:143], v[80:83], v[52:55], 0
s_add_u32 s62, s62, 131072
v_add_u32 v178, s62, v33
v_mfma_f32_16x16x32_bf16 a[144:147], v[84:87], v[52:55], 0
ds_read_b128 v[108:111], v3 offset:4096
v_mfma_f32_16x16x32_bf16 a[148:151], v[88:91], v[52:55], 0
v_mfma_f32_16x16x32_bf16 a[152:155], v[92:95], v[52:55], 0
ds_read_b128 v[112:115], v3 offset:6144
v_mfma_f32_16x16x32_bf16 a[156:159], v[96:99], v[52:55], 0
v_mfma_f32_16x16x32_bf16 a[160:163], v[68:71], v[56:59], 0
ds_read_b128 v[116:119], v3 offset:8192
v_mfma_f32_16x16x32_bf16 a[164:167], v[72:75], v[56:59], 0
v_mfma_f32_16x16x32_bf16 a[168:171], v[76:79], v[56:59], 0
ds_read_b128 v[120:123], v3 offset:10240
v_mfma_f32_16x16x32_bf16 a[172:175], v[80:83], v[56:59], 0
v_mfma_f32_16x16x32_bf16 a[176:179], v[84:87], v[56:59], 0
ds_read_b128 v[124:127], v3 offset:12288
v_mfma_f32_16x16x32_bf16 a[180:183], v[88:91], v[56:59], 0
v_mfma_f32_16x16x32_bf16 a[184:187], v[92:95], v[56:59], 0
ds_read_b128 v[128:131], v3 offset:14336
v_mfma_f32_16x16x32_bf16 a[188:191], v[96:99], v[56:59], 0
v_mfma_f32_16x16x32_bf16 a[192:195], v[68:71], v[60:63], 0
v_mfma_f32_16x16x32_bf16 a[196:199], v[72:75], v[60:63], 0
v_mfma_f32_16x16x32_bf16 a[200:203], v[76:79], v[60:63], 0
v_mfma_f32_16x16x32_bf16 a[204:207], v[80:83], v[60:63], 0
v_mfma_f32_16x16x32_bf16 a[208:211], v[84:87], v[60:63], 0
v_mfma_f32_16x16x32_bf16 a[212:215], v[88:91], v[60:63], 0
v_mfma_f32_16x16x32_bf16 a[216:219], v[92:95], v[60:63], 0
v_mfma_f32_16x16x32_bf16 a[220:223], v[96:99], v[60:63], 0
v_mfma_f32_16x16x32_bf16 a[224:227], v[68:71], v[64:67], 0
v_mfma_f32_16x16x32_bf16 a[228:231], v[72:75], v[64:67], 0
s_waitcnt vmcnt(12) lgkmcnt(0)
s_barrier
v_mfma_f32_16x16x32_bf16 a[232:235], v[76:79], v[64:67], 0
s_add_u32 s27, s27, 128
s_add_u32 s28, s28, s19
v_mfma_f32_16x16x32_bf16 a[236:239], v[80:83], v[64:67], 0
s_sub_u32 s70, s70, 1
s_cmp_gt_i32 s70, 0
v_mfma_f32_16x16x32_bf16 a[240:243], v[84:87], v[64:67], 0
s_cselect_b32 s17, s27, s30
s_cselect_b32 s18, s28, s30
v_mfma_f32_16x16x32_bf16 a[244:247], v[88:91], v[64:67], 0
s_xor_b32 s21, s21, 0x8000
s_xor_b32 s22, s22, 0x8000
v_mfma_f32_16x16x32_bf16 a[248:251], v[92:95], v[64:67], 0
s_mov_b32 m0, s21
v_mfma_f32_16x16x32_bf16 a[252:255], v[96:99], v[64:67], 0
s_waitcnt lgkmcnt(0)
v_mfma_f32_16x16x32_bf16 a[0:3], v[132:135], v[100:103], a[0:3]
v_xor_b32 v2, 0x8000, v2
buffer_load_dwordx4 v12, s[4:7], s17 offen offset:0 lds
v_mfma_f32_16x16x32_bf16 a[4:7], v[136:139], v[100:103], a[4:7]
v_xor_b32 v4, 0x8000, v4
v_mfma_f32_16x16x32_bf16 a[8:11], v[140:143], v[100:103], a[8:11]
ds_read_b128 v[36:39], v2 offset:0
v_mfma_f32_16x16x32_bf16 a[12:15], v[144:147], v[100:103], a[12:15]
v_xor_b32 v5, 0x8000, v5
v_mfma_f32_16x16x32_bf16 a[16:19], v[148:151], v[100:103], a[16:19]
ds_read_b64_tr_b16 v[68:69], v4 offset:0
v_mfma_f32_16x16x32_bf16 a[20:23], v[152:155], v[100:103], a[20:23]
v_xor_b32 v6, 0x8000, v6
v_mfma_f32_16x16x32_bf16 a[24:27], v[156:159], v[100:103], a[24:27]
ds_read_b64_tr_b16 v[70:71], v4 offset:2048
buffer_load_dwordx4 v13, s[4:7], s17 offen offset:1024 lds
v_mfma_f32_16x16x32_bf16 a[28:31], v[160:163], v[100:103], a[28:31]
v_xor_b32 v7, 0x8000, v7
v_mfma_f32_16x16x32_bf16 a[32:35], v[132:135], v[104:107], a[32:35]
ds_read_b64_tr_b16 v[72:73], v5 offset:0
v_mfma_f32_16x16x32_bf16 a[36:39], v[136:139], v[104:107], a[36:39]
v_xor_b32 v8, 0x8000, v8
v_mfma_f32_16x16x32_bf16 a[40:43], v[140:143], v[104:107], a[40:43]
ds_read_b64_tr_b16 v[74:75], v5 offset:2048
v_mfma_f32_16x16x32_bf16 a[44:47], v[144:147], v[104:107], a[44:47]
v_xor_b32 v9, 0x8000, v9
v_mfma_f32_16x16x32_bf16 a[48:51], v[148:151], v[104:107], a[48:51]
ds_read_b64_tr_b16 v[76:77], v6 offset:0
buffer_load_dwordx4 v14, s[4:7], s17 offen offset:2048 lds
v_mfma_f32_16x16x32_bf16 a[52:55], v[152:155], v[104:107], a[52:55]
v_xor_b32 v10, 0x8000, v10
v_mfma_f32_16x16x32_bf16 a[56:59], v[156:159], v[104:107], a[56:59]
ds_read_b64_tr_b16 v[78:79], v6 offset:2048
v_mfma_f32_16x16x32_bf16 a[60:63], v[160:163], v[104:107], a[60:63]
v_xor_b32 v11, 0x8000, v11
v_mfma_f32_16x16x32_bf16 a[64:67], v[132:135], v[108:111], a[64:67]
ds_read_b64_tr_b16 v[80:81], v7 offset:0
v_mfma_f32_16x16x32_bf16 a[68:71], v[136:139], v[108:111], a[68:71]
v_xor_b32 v3, 0x8000, v3
v_mfma_f32_16x16x32_bf16 a[72:75], v[140:143], v[108:111], a[72:75]
ds_read_b64_tr_b16 v[82:83], v7 offset:2048
v_mfma_f32_16x16x32_bf16 a[76:79], v[144:147], v[108:111], a[76:79]
buffer_load_dwordx4 v15, s[4:7], s17 offen offset:3072 lds
v_mfma_f32_16x16x32_bf16 a[80:83], v[148:151], v[108:111], a[80:83]
ds_read_b64_tr_b16 v[84:85], v8 offset:0
v_mfma_f32_16x16x32_bf16 a[84:87], v[152:155], v[108:111], a[84:87]
s_add_u32 m0, s21, 4096
v_mfma_f32_16x16x32_bf16 a[88:91], v[156:159], v[108:111], a[88:91]
ds_read_b64_tr_b16 v[86:87], v8 offset:2048
v_mfma_f32_16x16x32_bf16 a[92:95], v[160:163], v[108:111], a[92:95]
v_mfma_f32_16x16x32_bf16 a[96:99], v[132:135], v[112:115], a[96:99]
ds_read_b64_tr_b16 v[88:89], v9 offset:0
v_mfma_f32_16x16x32_bf16 a[100:103], v[136:139], v[112:115], a[100:103]
buffer_load_dwordx4 v16, s[4:7], s17 offen offset:0 lds
v_mfma_f32_16x16x32_bf16 a[104:107], v[140:143], v[112:115], a[104:107]
ds_read_b64_tr_b16 v[90:91], v9 offset:2048
v_mfma_f32_16x16x32_bf16 a[108:111], v[144:147], v[112:115], a[108:111]
v_mfma_f32_16x16x32_bf16 a[112:115], v[148:151], v[112:115], a[112:115]
ds_read_b64_tr_b16 v[92:93], v10 offset:0
v_mfma_f32_16x16x32_bf16 a[116:119], v[152:155], v[112:115], a[116:119]
v_mfma_f32_16x16x32_bf16 a[120:123], v[156:159], v[112:115], a[120:123]
ds_read_b64_tr_b16 v[94:95], v10 offset:2048
v_mfma_f32_16x16x32_bf16 a[124:127], v[160:163], v[112:115], a[124:127]
buffer_load_dwordx4 v17, s[4:7], s17 offen offset:1024 lds
v_mfma_f32_16x16x32_bf16 a[128:131], v[132:135], v[116:119], a[128:131]
ds_read_b64_tr_b16 v[96:97], v11 offset:0
v_mfma_f32_16x16x32_bf16 a[132:135], v[136:139], v[116:119], a[132:135]
v_mfma_f32_16x16x32_bf16 a[136:139], v[140:143], v[116:119], a[136:139]
ds_read_b64_tr_b16 v[98:99], v11 offset:2048
v_mfma_f32_16x16x32_bf16 a[140:143], v[144:147], v[116:119], a[140:143]
v_mfma_f32_16x16x32_bf16 a[144:147], v[148:151], v[116:119], a[144:147]
ds_read_b128 v[40:43], v2 offset:2048
v_mfma_f32_16x16x32_bf16 a[148:151], v[152:155], v[116:119], a[148:151]
buffer_load_dwordx4 v18, s[4:7], s17 offen offset:2048 lds
v_mfma_f32_16x16x32_bf16 a[152:155], v[156:159], v[116:119], a[152:155]
ds_read_b128 v[44:47], v2 offset:4096
v_mfma_f32_16x16x32_bf16 a[156:159], v[160:163], v[116:119], a[156:159]
v_mfma_f32_16x16x32_bf16 a[160:163], v[132:135], v[120:123], a[160:163]
ds_read_b128 v[48:51], v2 offset:6144
v_mfma_f32_16x16x32_bf16 a[164:167], v[136:139], v[120:123], a[164:167]
v_mfma_f32_16x16x32_bf16 a[168:171], v[140:143], v[120:123], a[168:171]
ds_read_b128 v[52:55], v2 offset:8192
v_mfma_f32_16x16x32_bf16 a[172:175], v[144:147], v[120:123], a[172:175]
buffer_load_dwordx4 v19, s[4:7], s17 offen offset:3072 lds
v_mfma_f32_16x16x32_bf16 a[176:179], v[148:151], v[120:123], a[176:179]
ds_read_b128 v[56:59], v2 offset:10240
v_mfma_f32_16x16x32_bf16 a[180:183], v[152:155], v[120:123], a[180:183]
s_mov_b32 m0, s22
v_mfma_f32_16x16x32_bf16 a[184:187], v[156:159], v[120:123], a[184:187]
ds_read_b128 v[60:63], v2 offset:12288
v_mfma_f32_16x16x32_bf16 a[188:191], v[160:163], v[120:123], a[188:191]
v_mfma_f32_16x16x32_bf16 a[192:195], v[132:135], v[124:127], a[192:195]
ds_read_b128 v[64:67], v2 offset:14336
v_mfma_f32_16x16x32_bf16 a[196:199], v[136:139], v[124:127], a[196:199]
buffer_load_dwordx4 v20, s[8:11], s18 offen offset:0 lds
v_mfma_f32_16x16x32_bf16 a[200:203], v[140:143], v[124:127], a[200:203]
v_mfma_f32_16x16x32_bf16 a[204:207], v[144:147], v[124:127], a[204:207]
v_mfma_f32_16x16x32_bf16 a[208:211], v[148:151], v[124:127], a[208:211]
v_mfma_f32_16x16x32_bf16 a[212:215], v[152:155], v[124:127], a[212:215]
v_mfma_f32_16x16x32_bf16 a[216:219], v[156:159], v[124:127], a[216:219]
v_mfma_f32_16x16x32_bf16 a[220:223], v[160:163], v[124:127], a[220:223]
buffer_load_dwordx4 v21, s[8:11], s18 offen offset:1024 lds
v_mfma_f32_16x16x32_bf16 a[224:227], v[132:135], v[128:131], a[224:227]
v_mfma_f32_16x16x32_bf16 a[228:231], v[136:139], v[128:131], a[228:231]
v_mfma_f32_16x16x32_bf16 a[232:235], v[140:143], v[128:131], a[232:235]
v_mfma_f32_16x16x32_bf16 a[236:239], v[144:147], v[128:131], a[236:239]
v_mfma_f32_16x16x32_bf16 a[240:243], v[148:151], v[128:131], a[240:243]
v_mfma_f32_16x16x32_bf16 a[244:247], v[152:155], v[128:131], a[244:247]
buffer_load_dwordx4 v22, s[8:11], s18 offen offset:2048 lds
v_mfma_f32_16x16x32_bf16 a[248:251], v[156:159], v[128:131], a[248:251]
s_sub_u32 s20, s20, 1
v_mfma_f32_16x16x32_bf16 a[252:255], v[160:163], v[128:131], a[252:255]
s_cmp_lg_u32 s20, 0
.p2align 6
L_f_loop_1_0:
s_waitcnt lgkmcnt(0)
v_mfma_f32_16x16x32_bf16 a[0:3], v[68:71], v[36:39], a[0:3]
ds_read_b128 v[100:103], v3 offset:0
v_mfma_f32_16x16x32_bf16 a[4:7], v[72:75], v[36:39], a[4:7]
v_mfma_f32_16x16x32_bf16 a[8:11], v[76:79], v[36:39], a[8:11]
ds_read_b64_tr_b16 v[132:133], v4 offset:16384
v_mfma_f32_16x16x32_bf16 a[12:15], v[80:83], v[36:39], a[12:15]
buffer_load_dwordx4 v23, s[8:11], s18 offen offset:3072 lds
v_mfma_f32_16x16x32_bf16 a[16:19], v[84:87], v[36:39], a[16:19]
ds_read_b64_tr_b16 v[134:135], v4 offset:18432
v_mfma_f32_16x16x32_bf16 a[20:23], v[88:91], v[36:39], a[20:23]
s_add_u32 m0, s22, 4096
v_mfma_f32_16x16x32_bf16 a[24:27], v[92:95], v[36:39], a[24:27]
ds_read_b64_tr_b16 v[136:137], v5 offset:16384
v_mfma_f32_16x16x32_bf16 a[28:31], v[96:99], v[36:39], a[28:31]
v_mfma_f32_16x16x32_bf16 a[32:35], v[68:71], v[40:43], a[32:35]
ds_read_b64_tr_b16 v[138:139], v5 offset:18432
v_mfma_f32_16x16x32_bf16 a[36:39], v[72:75], v[40:43], a[36:39]
buffer_load_dwordx4 v24, s[8:11], s18 offen offset:0 lds
v_mfma_f32_16x16x32_bf16 a[40:43], v[76:79], v[40:43], a[40:43]
ds_read_b64_tr_b16 v[140:141], v6 offset:16384
v_mfma_f32_16x16x32_bf16 a[44:47], v[80:83], v[40:43], a[44:47]
v_mfma_f32_16x16x32_bf16 a[48:51], v[84:87], v[40:43], a[48:51]
ds_read_b64_tr_b16 v[142:143], v6 offset:18432
v_mfma_f32_16x16x32_bf16 a[52:55], v[88:91], v[40:43], a[52:55]
v_mfma_f32_16x16x32_bf16 a[56:59], v[92:95], v[40:43], a[56:59]
ds_read_b64_tr_b16 v[144:145], v7 offset:16384
v_mfma_f32_16x16x32_bf16 a[60:63], v[96:99], v[40:43], a[60:63]
buffer_load_dwordx4 v25, s[8:11], s18 offen offset:1024 lds
v_mfma_f32_16x16x32_bf16 a[64:67], v[68:71], v[44:47], a[64:67]
ds_read_b64_tr_b16 v[146:147], v7 offset:18432
v_mfma_f32_16x16x32_bf16 a[68:71], v[72:75], v[44:47], a[68:71]
v_mfma_f32_16x16x32_bf16 a[72:75], v[76:79], v[44:47], a[72:75]
ds_read_b64_tr_b16 v[148:149], v8 offset:16384
v_mfma_f32_16x16x32_bf16 a[76:79], v[80:83], v[44:47], a[76:79]
v_mfma_f32_16x16x32_bf16 a[80:83], v[84:87], v[44:47], a[80:83]
ds_read_b64_tr_b16 v[150:151], v8 offset:18432
v_mfma_f32_16x16x32_bf16 a[84:87], v[88:91], v[44:47], a[84:87]
buffer_load_dwordx4 v26, s[8:11], s18 offen offset:2048 lds
v_mfma_f32_16x16x32_bf16 a[88:91], v[92:95], v[44:47], a[88:91]
ds_read_b64_tr_b16 v[152:153], v9 offset:16384
v_mfma_f32_16x16x32_bf16 a[92:95], v[96:99], v[44:47], a[92:95]
v_mfma_f32_16x16x32_bf16 a[96:99], v[68:71], v[48:51], a[96:99]
ds_read_b64_tr_b16 v[154:155], v9 offset:18432
v_mfma_f32_16x16x32_bf16 a[100:103], v[72:75], v[48:51], a[100:103]
v_mfma_f32_16x16x32_bf16 a[104:107], v[76:79], v[48:51], a[104:107]
ds_read_b64_tr_b16 v[156:157], v10 offset:16384
v_mfma_f32_16x16x32_bf16 a[108:111], v[80:83], v[48:51], a[108:111]
buffer_load_dwordx4 v27, s[8:11], s18 offen offset:3072 lds
v_mfma_f32_16x16x32_bf16 a[112:115], v[84:87], v[48:51], a[112:115]
ds_read_b64_tr_b16 v[158:159], v10 offset:18432
v_mfma_f32_16x16x32_bf16 a[116:119], v[88:91], v[48:51], a[116:119]
v_mfma_f32_16x16x32_bf16 a[120:123], v[92:95], v[48:51], a[120:123]
ds_read_b64_tr_b16 v[160:161], v11 offset:16384
v_mfma_f32_16x16x32_bf16 a[124:127], v[96:99], v[48:51], a[124:127]
s_add_u32 s85, s17, 384
v_mfma_f32_16x16x32_bf16 a[128:131], v[68:71], v[52:55], a[128:131]
ds_read_b64_tr_b16 v[162:163], v11 offset:18432
v_mfma_f32_16x16x32_bf16 a[132:135], v[72:75], v[52:55], a[132:135]
buffer_load_dword v241, v240, s[4:7], s85 offen
v_mfma_f32_16x16x32_bf16 a[136:139], v[76:79], v[52:55], a[136:139]
ds_read_b128 v[104:107], v3 offset:2048
v_mfma_f32_16x16x32_bf16 a[140:143], v[80:83], v[52:55], a[140:143]
v_mfma_f32_16x16x32_bf16 a[144:147], v[84:87], v[52:55], a[144:147]
ds_read_b128 v[108:111], v3 offset:4096
v_mfma_f32_16x16x32_bf16 a[148:151], v[88:91], v[52:55], a[148:151]
v_mfma_f32_16x16x32_bf16 a[152:155], v[92:95], v[52:55], a[152:155]
ds_read_b128 v[112:115], v3 offset:6144
v_mfma_f32_16x16x32_bf16 a[156:159], v[96:99], v[52:55], a[156:159]
v_mfma_f32_16x16x32_bf16 a[160:163], v[68:71], v[56:59], a[160:163]
ds_read_b128 v[116:119], v3 offset:8192
v_mfma_f32_16x16x32_bf16 a[164:167], v[72:75], v[56:59], a[164:167]
v_mfma_f32_16x16x32_bf16 a[168:171], v[76:79], v[56:59], a[168:171]
ds_read_b128 v[120:123], v3 offset:10240
v_mfma_f32_16x16x32_bf16 a[172:175], v[80:83], v[56:59], a[172:175]
v_mfma_f32_16x16x32_bf16 a[176:179], v[84:87], v[56:59], a[176:179]
ds_read_b128 v[124:127], v3 offset:12288
v_mfma_f32_16x16x32_bf16 a[180:183], v[88:91], v[56:59], a[180:183]
v_mfma_f32_16x16x32_bf16 a[184:187], v[92:95], v[56:59], a[184:187]
ds_read_b128 v[128:131], v3 offset:14336
v_mfma_f32_16x16x32_bf16 a[188:191], v[96:99], v[56:59], a[188:191]
v_mfma_f32_16x16x32_bf16 a[192:195], v[68:71], v[60:63], a[192:195]
v_mfma_f32_16x16x32_bf16 a[196:199], v[72:75], v[60:63], a[196:199]
v_mfma_f32_16x16x32_bf16 a[200:203], v[76:79], v[60:63], a[200:203]
v_mfma_f32_16x16x32_bf16 a[204:207], v[80:83], v[60:63], a[204:207]
v_mfma_f32_16x16x32_bf16 a[208:211], v[84:87], v[60:63], a[208:211]
v_mfma_f32_16x16x32_bf16 a[212:215], v[88:91], v[60:63], a[212:215]
v_mfma_f32_16x16x32_bf16 a[216:219], v[92:95], v[60:63], a[216:219]
v_mfma_f32_16x16x32_bf16 a[220:223], v[96:99], v[60:63], a[220:223]
v_mfma_f32_16x16x32_bf16 a[224:227], v[68:71], v[64:67], a[224:227]
v_mfma_f32_16x16x32_bf16 a[228:231], v[72:75], v[64:67], a[228:231]
s_waitcnt vmcnt(1) lgkmcnt(0)
s_barrier
v_mfma_f32_16x16x32_bf16 a[232:235], v[76:79], v[64:67], a[232:235]
s_add_u32 s27, s27, 128
s_add_u32 s28, s28, s19
v_mfma_f32_16x16x32_bf16 a[236:239], v[80:83], v[64:67], a[236:239]
s_sub_u32 s70, s70, 1
s_cmp_gt_i32 s70, 0
v_mfma_f32_16x16x32_bf16 a[240:243], v[84:87], v[64:67], a[240:243]
s_cselect_b32 s17, s27, s30
s_cselect_b32 s18, s28, s30
v_mfma_f32_16x16x32_bf16 a[244:247], v[88:91], v[64:67], a[244:247]
s_xor_b32 s21, s21, 0x8000
s_xor_b32 s22, s22, 0x8000
v_mfma_f32_16x16x32_bf16 a[248:251], v[92:95], v[64:67], a[248:251]
s_mov_b32 m0, s21
v_mfma_f32_16x16x32_bf16 a[252:255], v[96:99], v[64:67], a[252:255]
s_waitcnt lgkmcnt(0)
v_mfma_f32_16x16x32_bf16 a[0:3], v[132:135], v[100:103], a[0:3]
v_xor_b32 v2, 0x8000, v2
buffer_load_dwordx4 v12, s[4:7], s17 offen offset:0 lds
v_mfma_f32_16x16x32_bf16 a[4:7], v[136:139], v[100:103], a[4:7]
v_xor_b32 v4, 0x8000, v4
v_mfma_f32_16x16x32_bf16 a[8:11], v[140:143], v[100:103], a[8:11]
ds_read_b128 v[36:39], v2 offset:0
v_mfma_f32_16x16x32_bf16 a[12:15], v[144:147], v[100:103], a[12:15]
v_xor_b32 v5, 0x8000, v5
v_mfma_f32_16x16x32_bf16 a[16:19], v[148:151], v[100:103], a[16:19]
ds_read_b64_tr_b16 v[68:69], v4 offset:0
v_mfma_f32_16x16x32_bf16 a[20:23], v[152:155], v[100:103], a[20:23]
v_xor_b32 v6, 0x8000, v6
v_mfma_f32_16x16x32_bf16 a[24:27], v[156:159], v[100:103], a[24:27]
ds_read_b64_tr_b16 v[70:71], v4 offset:2048
buffer_load_dwordx4 v13, s[4:7], s17 offen offset:1024 lds
v_mfma_f32_16x16x32_bf16 a[28:31], v[160:163], v[100:103], a[28:31]
v_xor_b32 v7, 0x8000, v7
v_mfma_f32_16x16x32_bf16 a[32:35], v[132:135], v[104:107], a[32:35]
ds_read_b64_tr_b16 v[72:73], v5 offset:0
v_mfma_f32_16x16x32_bf16 a[36:39], v[136:139], v[104:107], a[36:39]
v_xor_b32 v8, 0x8000, v8
v_mfma_f32_16x16x32_bf16 a[40:43], v[140:143], v[104:107], a[40:43]
ds_read_b64_tr_b16 v[74:75], v5 offset:2048
v_mfma_f32_16x16x32_bf16 a[44:47], v[144:147], v[104:107], a[44:47]
v_xor_b32 v9, 0x8000, v9
v_mfma_f32_16x16x32_bf16 a[48:51], v[148:151], v[104:107], a[48:51]
ds_read_b64_tr_b16 v[76:77], v6 offset:0
buffer_load_dwordx4 v14, s[4:7], s17 offen offset:2048 lds
v_mfma_f32_16x16x32_bf16 a[52:55], v[152:155], v[104:107], a[52:55]
v_xor_b32 v10, 0x8000, v10
v_mfma_f32_16x16x32_bf16 a[56:59], v[156:159], v[104:107], a[56:59]
ds_read_b64_tr_b16 v[78:79], v6 offset:2048
v_mfma_f32_16x16x32_bf16 a[60:63], v[160:163], v[104:107], a[60:63]
v_xor_b32 v11, 0x8000, v11
v_mfma_f32_16x16x32_bf16 a[64:67], v[132:135], v[108:111], a[64:67]
ds_read_b64_tr_b16 v[80:81], v7 offset:0
v_mfma_f32_16x16x32_bf16 a[68:71], v[136:139], v[108:111], a[68:71]
v_xor_b32 v3, 0x8000, v3
v_mfma_f32_16x16x32_bf16 a[72:75], v[140:143], v[108:111], a[72:75]
ds_read_b64_tr_b16 v[82:83], v7 offset:2048
v_mfma_f32_16x16x32_bf16 a[76:79], v[144:147], v[108:111], a[76:79]
buffer_load_dwordx4 v15, s[4:7], s17 offen offset:3072 lds
v_mfma_f32_16x16x32_bf16 a[80:83], v[148:151], v[108:111], a[80:83]
ds_read_b64_tr_b16 v[84:85], v8 offset:0
v_mfma_f32_16x16x32_bf16 a[84:87], v[152:155], v[108:111], a[84:87]
s_add_u32 m0, s21, 4096
v_mfma_f32_16x16x32_bf16 a[88:91], v[156:159], v[108:111], a[88:91]
ds_read_b64_tr_b16 v[86:87], v8 offset:2048
v_mfma_f32_16x16x32_bf16 a[92:95], v[160:163], v[108:111], a[92:95]
v_mfma_f32_16x16x32_bf16 a[96:99], v[132:135], v[112:115], a[96:99]
ds_read_b64_tr_b16 v[88:89], v9 offset:0
v_mfma_f32_16x16x32_bf16 a[100:103], v[136:139], v[112:115], a[100:103]
buffer_load_dwordx4 v16, s[4:7], s17 offen offset:0 lds
v_mfma_f32_16x16x32_bf16 a[104:107], v[140:143], v[112:115], a[104:107]
ds_read_b64_tr_b16 v[90:91], v9 offset:2048
v_mfma_f32_16x16x32_bf16 a[108:111], v[144:147], v[112:115], a[108:111]
v_mfma_f32_16x16x32_bf16 a[112:115], v[148:151], v[112:115], a[112:115]
ds_read_b64_tr_b16 v[92:93], v10 offset:0
v_mfma_f32_16x16x32_bf16 a[116:119], v[152:155], v[112:115], a[116:119]
v_mfma_f32_16x16x32_bf16 a[120:123], v[156:159], v[112:115], a[120:123]
ds_read_b64_tr_b16 v[94:95], v10 offset:2048
v_mfma_f32_16x16x32_bf16 a[124:127], v[160:163], v[112:115], a[124:127]
buffer_load_dwordx4 v17, s[4:7], s17 offen offset:1024 lds
v_mfma_f32_16x16x32_bf16 a[128:131], v[132:135], v[116:119], a[128:131]
ds_read_b64_tr_b16 v[96:97], v11 offset:0
v_mfma_f32_16x16x32_bf16 a[132:135], v[136:139], v[116:119], a[132:135]
v_mfma_f32_16x16x32_bf16 a[136:139], v[140:143], v[116:119], a[136:139]
ds_read_b64_tr_b16 v[98:99], v11 offset:2048
v_mfma_f32_16x16x32_bf16 a[140:143], v[144:147], v[116:119], a[140:143]
v_mfma_f32_16x16x32_bf16 a[144:147], v[148:151], v[116:119], a[144:147]
ds_read_b128 v[40:43], v2 offset:2048
v_mfma_f32_16x16x32_bf16 a[148:151], v[152:155], v[116:119], a[148:151]
buffer_load_dwordx4 v18, s[4:7], s17 offen offset:2048 lds
v_mfma_f32_16x16x32_bf16 a[152:155], v[156:159], v[116:119], a[152:155]
ds_read_b128 v[44:47], v2 offset:4096
v_mfma_f32_16x16x32_bf16 a[156:159], v[160:163], v[116:119], a[156:159]
v_mfma_f32_16x16x32_bf16 a[160:163], v[132:135], v[120:123], a[160:163]
ds_read_b128 v[48:51], v2 offset:6144
v_mfma_f32_16x16x32_bf16 a[164:167], v[136:139], v[120:123], a[164:167]
v_mfma_f32_16x16x32_bf16 a[168:171], v[140:143], v[120:123], a[168:171]
ds_read_b128 v[52:55], v2 offset:8192
v_mfma_f32_16x16x32_bf16 a[172:175], v[144:147], v[120:123], a[172:175]
buffer_load_dwordx4 v19, s[4:7], s17 offen offset:3072 lds
v_mfma_f32_16x16x32_bf16 a[176:179], v[148:151], v[120:123], a[176:179]
ds_read_b128 v[56:59], v2 offset:10240
v_mfma_f32_16x16x32_bf16 a[180:183], v[152:155], v[120:123], a[180:183]
s_mov_b32 m0, s22
v_mfma_f32_16x16x32_bf16 a[184:187], v[156:159], v[120:123], a[184:187]
ds_read_b128 v[60:63], v2 offset:12288
v_mfma_f32_16x16x32_bf16 a[188:191], v[160:163], v[120:123], a[188:191]
v_mfma_f32_16x16x32_bf16 a[192:195], v[132:135], v[124:127], a[192:195]
ds_read_b128 v[64:67], v2 offset:14336
v_mfma_f32_16x16x32_bf16 a[196:199], v[136:139], v[124:127], a[196:199]
buffer_load_dwordx4 v20, s[8:11], s18 offen offset:0 lds
v_mfma_f32_16x16x32_bf16 a[200:203], v[140:143], v[124:127], a[200:203]
v_mfma_f32_16x16x32_bf16 a[204:207], v[144:147], v[124:127], a[204:207]
v_mfma_f32_16x16x32_bf16 a[208:211], v[148:151], v[124:127], a[208:211]
v_mfma_f32_16x16x32_bf16 a[212:215], v[152:155], v[124:127], a[212:215]
v_mfma_f32_16x16x32_bf16 a[216:219], v[156:159], v[124:127], a[216:219]
v_mfma_f32_16x16x32_bf16 a[220:223], v[160:163], v[124:127], a[220:223]
buffer_load_dwordx4 v21, s[8:11], s18 offen offset:1024 lds
v_mfma_f32_16x16x32_bf16 a[224:227], v[132:135], v[128:131], a[224:227]
v_mfma_f32_16x16x32_bf16 a[228:231], v[136:139], v[128:131], a[228:231]
v_mfma_f32_16x16x32_bf16 a[232:235], v[140:143], v[128:131], a[232:235]
v_mfma_f32_16x16x32_bf16 a[236:239], v[144:147], v[128:131], a[236:239]
v_mfma_f32_16x16x32_bf16 a[240:243], v[148:151], v[128:131], a[240:243]
v_mfma_f32_16x16x32_bf16 a[244:247], v[152:155], v[128:131], a[244:247]
buffer_load_dwordx4 v22, s[8:11], s18 offen offset:2048 lds
v_mfma_f32_16x16x32_bf16 a[248:251], v[156:159], v[128:131], a[248:251]
s_sub_u32 s20, s20, 1
v_mfma_f32_16x16x32_bf16 a[252:255], v[160:163], v[128:131], a[252:255]
s_cmp_lg_u32 s20, 0
s_cbranch_scc1 L_f_loop_1_0
s_branch L_f_kvdone
L_f_go_1_1:
s_waitcnt lgkmcnt(0)
v_mfma_f32_16x16x32_bf16 a[0:3], v[68:71], v[36:39], 0
ds_read_b128 v[100:103], v3 offset:0
v_mfma_f32_16x16x32_bf16 a[4:7], v[72:75], v[36:39], 0
s_cmp_ge_u32 s2, 128
s_cselect_b32 s80, s48, s42
s_cselect_b32 s81, s49, s43
s_mov_b32 s62, 401408
s_cselect_b32 s82, s62, 3670016
s_mov_b32 s83, 0x20000
v_mfma_f32_16x16x32_bf16 a[8:11], v[76:79], v[36:39], 0
ds_read_b64_tr_b16 v[132:133], v4 offset:16384
v_mfma_f32_16x16x32_bf16 a[12:15], v[80:83], v[36:39], 0
s_sub_u32 s61, s2, 128
s_cselect_b32 s61, s61, s61
s_cmp_ge_u32 s2, 128
s_cselect_b32 s61, s61, s2
s_cselect_b32 s62, 28, 32
v_mfma_f32_16x16x32_bf16 a[16:19], v[84:87], v[36:39], 0
ds_read_b64_tr_b16 v[134:135], v4 offset:18432
v_mfma_f32_16x16x32_bf16 a[20:23], v[88:91], v[36:39], 0
s_mul_i32 s62, s62, s61
s_mul_i32 s62, s62, 896
v_mfma_f32_16x16x32_bf16 a[24:27], v[92:95], v[36:39], 0
ds_read_b64_tr_b16 v[136:137], v5 offset:16384
v_mfma_f32_16x16x32_bf16 a[28:31], v[96:99], v[36:39], 0
s_lshl_b32 s90, s61, 10
s_cmp_ge_u32 s2, 128
s_mov_b32 s63, 79691776
s_cselect_b32 s63, s63, 75497472
v_mfma_f32_16x16x32_bf16 a[32:35], v[68:71], v[40:43], 0
ds_read_b64_tr_b16 v[138:139], v5 offset:18432
v_mfma_f32_16x16x32_bf16 a[36:39], v[72:75], v[40:43], 0
s_add_u32 s90, s90, s63
s_cmp_ge_u32 s2, 128
s_mov_b32 s63, 16384
s_cselect_b32 s100, s63, 131072
v_mfma_f32_16x16x32_bf16 a[40:43], v[76:79], v[40:43], 0
ds_read_b64_tr_b16 v[140:141], v6 offset:16384
v_mfma_f32_16x16x32_bf16 a[44:47], v[80:83], v[40:43], 0
s_cmp_ge_u32 s2, 144
s_cselect_b32 s62, s30, s62
s_cselect_b32 s90, s30, s90
s_cselect_b32 s100, 0, s100
s_mul_i32 s63, s16, 7168
v_mfma_f32_16x16x32_bf16 a[48:51], v[84:87], v[40:43], 0
ds_read_b64_tr_b16 v[142:143], v6 offset:18432
v_mfma_f32_16x16x32_bf16 a[52:55], v[88:91], v[40:43], 0
s_add_u32 s62, s62, s63
s_add_u32 s63, s63, 131072
v_mfma_f32_16x16x32_bf16 a[56:59], v[92:95], v[40:43], 0
ds_read_b64_tr_b16 v[144:145], v7 offset:16384
v_mfma_f32_16x16x32_bf16 a[60:63], v[96:99], v[40:43], 0
s_add_u32 m0, s63, 0
s_add_u32 s61, s62, 0
buffer_load_dwordx4 v1, s[80:83], s61 offen lds
s_add_u32 m0, s63, 1024
s_add_u32 s61, s62, 1024
buffer_load_dwordx4 v1, s[80:83], s61 offen lds
v_mfma_f32_16x16x32_bf16 a[64:67], v[68:71], v[44:47], 0
ds_read_b64_tr_b16 v[146:147], v7 offset:18432
v_mfma_f32_16x16x32_bf16 a[68:71], v[72:75], v[44:47], 0
s_add_u32 m0, s63, 2048
s_add_u32 s61, s62, 2048
buffer_load_dwordx4 v1, s[80:83], s61 offen lds
s_add_u32 m0, s63, 3072
s_add_u32 s61, s62, 3072
buffer_load_dwordx4 v1, s[80:83], s61 offen lds
v_mfma_f32_16x16x32_bf16 a[72:75], v[76:79], v[44:47], 0
ds_read_b64_tr_b16 v[148:149], v8 offset:16384
v_mfma_f32_16x16x32_bf16 a[76:79], v[80:83], v[44:47], 0
s_add_u32 m0, s63, 4096
s_add_u32 s61, s62, 4096
buffer_load_dwordx4 v1, s[80:83], s61 offen lds
s_add_u32 m0, s63, 5120
s_add_u32 s61, s62, 5120
buffer_load_dwordx4 v1, s[80:83], s61 offen lds
v_mfma_f32_16x16x32_bf16 a[80:83], v[84:87], v[44:47], 0
ds_read_b64_tr_b16 v[150:151], v8 offset:18432
v_mfma_f32_16x16x32_bf16 a[84:87], v[88:91], v[44:47], 0
s_add_u32 m0, s63, 6144
s_add_u32 s61, s62, 6144
buffer_load_dwordx4 v1, s[80:83], s61 offen lds
v_and_b32 v28, 63, v0
v_mfma_f32_16x16x32_bf16 a[88:91], v[92:95], v[44:47], 0
ds_read_b64_tr_b16 v[152:153], v9 offset:16384
v_mfma_f32_16x16x32_bf16 a[92:95], v[96:99], v[44:47], 0
v_and_b32 v29, 15, v28
v_lshrrev_b32 v30, 4, v28
v_mfma_f32_16x16x32_bf16 a[96:99], v[68:71], v[48:51], 0
ds_read_b64_tr_b16 v[154:155], v9 offset:18432
v_mfma_f32_16x16x32_bf16 a[100:103], v[72:75], v[48:51], 0
v_bfe_u32 v31, v28, 2, 2
v_and_b32 v32, 3, v28
v_mfma_f32_16x16x32_bf16 a[104:107], v[76:79], v[48:51], 0
ds_read_b64_tr_b16 v[156:157], v10 offset:16384
v_mfma_f32_16x16x32_bf16 a[108:111], v[80:83], v[48:51], 0
v_lshl_add_u32 v33, v30, 2, v31
v_mul_u32_u24 v33, 896, v33
v_mfma_f32_16x16x32_bf16 a[112:115], v[84:87], v[48:51], 0
ds_read_b64_tr_b16 v[158:159], v10 offset:18432
v_mfma_f32_16x16x32_bf16 a[116:119], v[88:91], v[48:51], 0
v_lshl_add_u32 v33, v32, 3, v33
s_mul_i32 s62, s16, 224
v_mfma_f32_16x16x32_bf16 a[120:123], v[92:95], v[48:51], 0
ds_read_b64_tr_b16 v[160:161], v11 offset:16384
v_mfma_f32_16x16x32_bf16 a[124:127], v[96:99], v[48:51], 0
s_mul_i32 s85, s19, 3
s_add_u32 s85, s85, s18
v_mfma_f32_16x16x32_bf16 a[128:131], v[68:71], v[52:55], 0
ds_read_b64_tr_b16 v[162:163], v11 offset:18432
v_mfma_f32_16x16x32_bf16 a[132:135], v[72:75], v[52:55], 0
buffer_load_dword v241, v240, s[8:11], s85 offen
v_mfma_f32_16x16x32_bf16 a[136:139], v[76:79], v[52:55], 0
ds_read_b128 v[104:107], v3 offset:2048
v_mfma_f32_16x16x32_bf16 a[140:143], v[80:83], v[52:55], 0
s_add_u32 s62, s62, 131072
v_add_u32 v178, s62, v33
v_mfma_f32_16x16x32_bf16 a[144:147], v[84:87], v[52:55], 0
ds_read_b128 v[108:111], v3 offset:4096
v_mfma_f32_16x16x32_bf16 a[148:151], v[88:91], v[52:55], 0
v_mfma_f32_16x16x32_bf16 a[152:155], v[92:95], v[52:55], 0
ds_read_b128 v[112:115], v3 offset:6144
v_mfma_f32_16x16x32_bf16 a[156:159], v[96:99], v[52:55], 0
v_mfma_f32_16x16x32_bf16 a[160:163], v[68:71], v[56:59], 0
ds_read_b128 v[116:119], v3 offset:8192
v_mfma_f32_16x16x32_bf16 a[164:167], v[72:75], v[56:59], 0
v_mfma_f32_16x16x32_bf16 a[168:171], v[76:79], v[56:59], 0
ds_read_b128 v[120:123], v3 offset:10240
v_mfma_f32_16x16x32_bf16 a[172:175], v[80:83], v[56:59], 0
v_mfma_f32_16x16x32_bf16 a[176:179], v[84:87], v[56:59], 0
ds_read_b128 v[124:127], v3 offset:12288
v_mfma_f32_16x16x32_bf16 a[180:183], v[88:91], v[56:59], 0
v_mfma_f32_16x16x32_bf16 a[184:187], v[92:95], v[56:59], 0
ds_read_b128 v[128:131], v3 offset:14336
v_mfma_f32_16x16x32_bf16 a[188:191], v[96:99], v[56:59], 0
v_mfma_f32_16x16x32_bf16 a[192:195], v[68:71], v[60:63], 0
v_mfma_f32_16x16x32_bf16 a[196:199], v[72:75], v[60:63], 0
v_mfma_f32_16x16x32_bf16 a[200:203], v[76:79], v[60:63], 0
v_mfma_f32_16x16x32_bf16 a[204:207], v[80:83], v[60:63], 0
v_mfma_f32_16x16x32_bf16 a[208:211], v[84:87], v[60:63], 0
v_mfma_f32_16x16x32_bf16 a[212:215], v[88:91], v[60:63], 0
v_mfma_f32_16x16x32_bf16 a[216:219], v[92:95], v[60:63], 0
v_mfma_f32_16x16x32_bf16 a[220:223], v[96:99], v[60:63], 0
v_mfma_f32_16x16x32_bf16 a[224:227], v[68:71], v[64:67], 0
v_mfma_f32_16x16x32_bf16 a[228:231], v[72:75], v[64:67], 0
s_waitcnt vmcnt(11) lgkmcnt(0)
s_barrier
s_nop 1
v_mfma_f32_16x16x32_bf16 a[232:235], v[76:79], v[64:67], 0
s_add_u32 s27, s27, 128
s_add_u32 s28, s28, s19
v_mfma_f32_16x16x32_bf16 a[236:239], v[80:83], v[64:67], 0
s_sub_u32 s70, s70, 1
s_cmp_gt_i32 s70, 0
v_mfma_f32_16x16x32_bf16 a[240:243], v[84:87], v[64:67], 0
s_cselect_b32 s17, s27, s30
s_cselect_b32 s18, s28, s30
v_mfma_f32_16x16x32_bf16 a[244:247], v[88:91], v[64:67], 0
s_xor_b32 s21, s21, 0x8000
s_xor_b32 s22, s22, 0x8000
v_mfma_f32_16x16x32_bf16 a[248:251], v[92:95], v[64:67], 0
s_mov_b32 m0, s21
v_mfma_f32_16x16x32_bf16 a[252:255], v[96:99], v[64:67], 0
s_waitcnt lgkmcnt(0)
v_mfma_f32_16x16x32_bf16 a[0:3], v[132:135], v[100:103], a[0:3]
v_xor_b32 v2, 0x8000, v2
buffer_load_dwordx4 v12, s[4:7], s17 offen offset:0 lds
v_mfma_f32_16x16x32_bf16 a[4:7], v[136:139], v[100:103], a[4:7]
v_xor_b32 v4, 0x8000, v4
v_mfma_f32_16x16x32_bf16 a[8:11], v[140:143], v[100:103], a[8:11]
ds_read_b128 v[36:39], v2 offset:0
v_mfma_f32_16x16x32_bf16 a[12:15], v[144:147], v[100:103], a[12:15]
v_xor_b32 v5, 0x8000, v5
v_mfma_f32_16x16x32_bf16 a[16:19], v[148:151], v[100:103], a[16:19]
ds_read_b64_tr_b16 v[68:69], v4 offset:0
v_mfma_f32_16x16x32_bf16 a[20:23], v[152:155], v[100:103], a[20:23]
v_xor_b32 v6, 0x8000, v6
v_mfma_f32_16x16x32_bf16 a[24:27], v[156:159], v[100:103], a[24:27]
ds_read_b64_tr_b16 v[70:71], v4 offset:2048
buffer_load_dwordx4 v13, s[4:7], s17 offen offset:1024 lds
v_mfma_f32_16x16x32_bf16 a[28:31], v[160:163], v[100:103], a[28:31]
v_xor_b32 v7, 0x8000, v7
v_mfma_f32_16x16x32_bf16 a[32:35], v[132:135], v[104:107], a[32:35]
ds_read_b64_tr_b16 v[72:73], v5 offset:0
v_mfma_f32_16x16x32_bf16 a[36:39], v[136:139], v[104:107], a[36:39]
v_xor_b32 v8, 0x8000, v8
v_mfma_f32_16x16x32_bf16 a[40:43], v[140:143], v[104:107], a[40:43]
ds_read_b64_tr_b16 v[74:75], v5 offset:2048
v_mfma_f32_16x16x32_bf16 a[44:47], v[144:147], v[104:107], a[44:47]
v_xor_b32 v9, 0x8000, v9
v_mfma_f32_16x16x32_bf16 a[48:51], v[148:151], v[104:107], a[48:51]
ds_read_b64_tr_b16 v[76:77], v6 offset:0
buffer_load_dwordx4 v14, s[4:7], s17 offen offset:2048 lds
v_mfma_f32_16x16x32_bf16 a[52:55], v[152:155], v[104:107], a[52:55]
v_xor_b32 v10, 0x8000, v10
v_mfma_f32_16x16x32_bf16 a[56:59], v[156:159], v[104:107], a[56:59]
ds_read_b64_tr_b16 v[78:79], v6 offset:2048
v_mfma_f32_16x16x32_bf16 a[60:63], v[160:163], v[104:107], a[60:63]
v_xor_b32 v11, 0x8000, v11
v_mfma_f32_16x16x32_bf16 a[64:67], v[132:135], v[108:111], a[64:67]
ds_read_b64_tr_b16 v[80:81], v7 offset:0
v_mfma_f32_16x16x32_bf16 a[68:71], v[136:139], v[108:111], a[68:71]
v_xor_b32 v3, 0x8000, v3
v_mfma_f32_16x16x32_bf16 a[72:75], v[140:143], v[108:111], a[72:75]
ds_read_b64_tr_b16 v[82:83], v7 offset:2048
v_mfma_f32_16x16x32_bf16 a[76:79], v[144:147], v[108:111], a[76:79]
buffer_load_dwordx4 v15, s[4:7], s17 offen offset:3072 lds
v_mfma_f32_16x16x32_bf16 a[80:83], v[148:151], v[108:111], a[80:83]
ds_read_b64_tr_b16 v[84:85], v8 offset:0
v_mfma_f32_16x16x32_bf16 a[84:87], v[152:155], v[108:111], a[84:87]
s_add_u32 m0, s21, 4096
v_mfma_f32_16x16x32_bf16 a[88:91], v[156:159], v[108:111], a[88:91]
ds_read_b64_tr_b16 v[86:87], v8 offset:2048
v_mfma_f32_16x16x32_bf16 a[92:95], v[160:163], v[108:111], a[92:95]
v_mfma_f32_16x16x32_bf16 a[96:99], v[132:135], v[112:115], a[96:99]
ds_read_b64_tr_b16 v[88:89], v9 offset:0
v_mfma_f32_16x16x32_bf16 a[100:103], v[136:139], v[112:115], a[100:103]
buffer_load_dwordx4 v16, s[4:7], s17 offen offset:0 lds
v_mfma_f32_16x16x32_bf16 a[104:107], v[140:143], v[112:115], a[104:107]
ds_read_b64_tr_b16 v[90:91], v9 offset:2048
v_mfma_f32_16x16x32_bf16 a[108:111], v[144:147], v[112:115], a[108:111]
v_mfma_f32_16x16x32_bf16 a[112:115], v[148:151], v[112:115], a[112:115]
ds_read_b64_tr_b16 v[92:93], v10 offset:0
v_mfma_f32_16x16x32_bf16 a[116:119], v[152:155], v[112:115], a[116:119]
v_mfma_f32_16x16x32_bf16 a[120:123], v[156:159], v[112:115], a[120:123]
ds_read_b64_tr_b16 v[94:95], v10 offset:2048
v_mfma_f32_16x16x32_bf16 a[124:127], v[160:163], v[112:115], a[124:127]
buffer_load_dwordx4 v17, s[4:7], s17 offen offset:1024 lds
v_mfma_f32_16x16x32_bf16 a[128:131], v[132:135], v[116:119], a[128:131]
ds_read_b64_tr_b16 v[96:97], v11 offset:0
v_mfma_f32_16x16x32_bf16 a[132:135], v[136:139], v[116:119], a[132:135]
v_mfma_f32_16x16x32_bf16 a[136:139], v[140:143], v[116:119], a[136:139]
ds_read_b64_tr_b16 v[98:99], v11 offset:2048
v_mfma_f32_16x16x32_bf16 a[140:143], v[144:147], v[116:119], a[140:143]
v_mfma_f32_16x16x32_bf16 a[144:147], v[148:151], v[116:119], a[144:147]
ds_read_b128 v[40:43], v2 offset:2048
v_mfma_f32_16x16x32_bf16 a[148:151], v[152:155], v[116:119], a[148:151]
buffer_load_dwordx4 v18, s[4:7], s17 offen offset:2048 lds
v_mfma_f32_16x16x32_bf16 a[152:155], v[156:159], v[116:119], a[152:155]
ds_read_b128 v[44:47], v2 offset:4096
v_mfma_f32_16x16x32_bf16 a[156:159], v[160:163], v[116:119], a[156:159]
v_mfma_f32_16x16x32_bf16 a[160:163], v[132:135], v[120:123], a[160:163]
ds_read_b128 v[48:51], v2 offset:6144
v_mfma_f32_16x16x32_bf16 a[164:167], v[136:139], v[120:123], a[164:167]
v_mfma_f32_16x16x32_bf16 a[168:171], v[140:143], v[120:123], a[168:171]
ds_read_b128 v[52:55], v2 offset:8192
v_mfma_f32_16x16x32_bf16 a[172:175], v[144:147], v[120:123], a[172:175]
buffer_load_dwordx4 v19, s[4:7], s17 offen offset:3072 lds
v_mfma_f32_16x16x32_bf16 a[176:179], v[148:151], v[120:123], a[176:179]
ds_read_b128 v[56:59], v2 offset:10240
v_mfma_f32_16x16x32_bf16 a[180:183], v[152:155], v[120:123], a[180:183]
s_mov_b32 m0, s22
v_mfma_f32_16x16x32_bf16 a[184:187], v[156:159], v[120:123], a[184:187]
ds_read_b128 v[60:63], v2 offset:12288
v_mfma_f32_16x16x32_bf16 a[188:191], v[160:163], v[120:123], a[188:191]
v_mfma_f32_16x16x32_bf16 a[192:195], v[132:135], v[124:127], a[192:195]
ds_read_b128 v[64:67], v2 offset:14336
v_mfma_f32_16x16x32_bf16 a[196:199], v[136:139], v[124:127], a[196:199]
buffer_load_dwordx4 v20, s[8:11], s18 offen offset:0 lds
v_mfma_f32_16x16x32_bf16 a[200:203], v[140:143], v[124:127], a[200:203]
v_mfma_f32_16x16x32_bf16 a[204:207], v[144:147], v[124:127], a[204:207]
v_mfma_f32_16x16x32_bf16 a[208:211], v[148:151], v[124:127], a[208:211]
v_mfma_f32_16x16x32_bf16 a[212:215], v[152:155], v[124:127], a[212:215]
v_mfma_f32_16x16x32_bf16 a[216:219], v[156:159], v[124:127], a[216:219]
v_mfma_f32_16x16x32_bf16 a[220:223], v[160:163], v[124:127], a[220:223]
buffer_load_dwordx4 v21, s[8:11], s18 offen offset:1024 lds
v_mfma_f32_16x16x32_bf16 a[224:227], v[132:135], v[128:131], a[224:227]
v_mfma_f32_16x16x32_bf16 a[228:231], v[136:139], v[128:131], a[228:231]
v_mfma_f32_16x16x32_bf16 a[232:235], v[140:143], v[128:131], a[232:235]
v_mfma_f32_16x16x32_bf16 a[236:239], v[144:147], v[128:131], a[236:239]
v_mfma_f32_16x16x32_bf16 a[240:243], v[148:151], v[128:131], a[240:243]
v_mfma_f32_16x16x32_bf16 a[244:247], v[152:155], v[128:131], a[244:247]
buffer_load_dwordx4 v22, s[8:11], s18 offen offset:2048 lds
v_mfma_f32_16x16x32_bf16 a[248:251], v[156:159], v[128:131], a[248:251]
s_sub_u32 s20, s20, 1
v_mfma_f32_16x16x32_bf16 a[252:255], v[160:163], v[128:131], a[252:255]
s_cmp_lg_u32 s20, 0
.p2align 6
L_f_loop_1_1:
s_waitcnt lgkmcnt(0)
v_mfma_f32_16x16x32_bf16 a[0:3], v[68:71], v[36:39], a[0:3]
ds_read_b128 v[100:103], v3 offset:0
v_mfma_f32_16x16x32_bf16 a[4:7], v[72:75], v[36:39], a[4:7]
v_mfma_f32_16x16x32_bf16 a[8:11], v[76:79], v[36:39], a[8:11]
ds_read_b64_tr_b16 v[132:133], v4 offset:16384
v_mfma_f32_16x16x32_bf16 a[12:15], v[80:83], v[36:39], a[12:15]
buffer_load_dwordx4 v23, s[8:11], s18 offen offset:3072 lds
v_mfma_f32_16x16x32_bf16 a[16:19], v[84:87], v[36:39], a[16:19]
ds_read_b64_tr_b16 v[134:135], v4 offset:18432
v_mfma_f32_16x16x32_bf16 a[20:23], v[88:91], v[36:39], a[20:23]
s_add_u32 m0, s22, 4096
v_mfma_f32_16x16x32_bf16 a[24:27], v[92:95], v[36:39], a[24:27]
ds_read_b64_tr_b16 v[136:137], v5 offset:16384
v_mfma_f32_16x16x32_bf16 a[28:31], v[96:99], v[36:39], a[28:31]
v_mfma_f32_16x16x32_bf16 a[32:35], v[68:71], v[40:43], a[32:35]
ds_read_b64_tr_b16 v[138:139], v5 offset:18432
v_mfma_f32_16x16x32_bf16 a[36:39], v[72:75], v[40:43], a[36:39]
buffer_load_dwordx4 v24, s[8:11], s18 offen offset:0 lds
v_mfma_f32_16x16x32_bf16 a[40:43], v[76:79], v[40:43], a[40:43]
ds_read_b64_tr_b16 v[140:141], v6 offset:16384
v_mfma_f32_16x16x32_bf16 a[44:47], v[80:83], v[40:43], a[44:47]
v_mfma_f32_16x16x32_bf16 a[48:51], v[84:87], v[40:43], a[48:51]
ds_read_b64_tr_b16 v[142:143], v6 offset:18432
v_mfma_f32_16x16x32_bf16 a[52:55], v[88:91], v[40:43], a[52:55]
v_mfma_f32_16x16x32_bf16 a[56:59], v[92:95], v[40:43], a[56:59]
ds_read_b64_tr_b16 v[144:145], v7 offset:16384
v_mfma_f32_16x16x32_bf16 a[60:63], v[96:99], v[40:43], a[60:63]
buffer_load_dwordx4 v25, s[8:11], s18 offen offset:1024 lds
v_mfma_f32_16x16x32_bf16 a[64:67], v[68:71], v[44:47], a[64:67]
ds_read_b64_tr_b16 v[146:147], v7 offset:18432
v_mfma_f32_16x16x32_bf16 a[68:71], v[72:75], v[44:47], a[68:71]
v_mfma_f32_16x16x32_bf16 a[72:75], v[76:79], v[44:47], a[72:75]
ds_read_b64_tr_b16 v[148:149], v8 offset:16384
v_mfma_f32_16x16x32_bf16 a[76:79], v[80:83], v[44:47], a[76:79]
v_mfma_f32_16x16x32_bf16 a[80:83], v[84:87], v[44:47], a[80:83]
ds_read_b64_tr_b16 v[150:151], v8 offset:18432
v_mfma_f32_16x16x32_bf16 a[84:87], v[88:91], v[44:47], a[84:87]
buffer_load_dwordx4 v26, s[8:11], s18 offen offset:2048 lds
v_mfma_f32_16x16x32_bf16 a[88:91], v[92:95], v[44:47], a[88:91]
ds_read_b64_tr_b16 v[152:153], v9 offset:16384
v_mfma_f32_16x16x32_bf16 a[92:95], v[96:99], v[44:47], a[92:95]
v_mfma_f32_16x16x32_bf16 a[96:99], v[68:71], v[48:51], a[96:99]
ds_read_b64_tr_b16 v[154:155], v9 offset:18432
v_mfma_f32_16x16x32_bf16 a[100:103], v[72:75], v[48:51], a[100:103]
v_mfma_f32_16x16x32_bf16 a[104:107], v[76:79], v[48:51], a[104:107]
ds_read_b64_tr_b16 v[156:157], v10 offset:16384
v_mfma_f32_16x16x32_bf16 a[108:111], v[80:83], v[48:51], a[108:111]
buffer_load_dwordx4 v27, s[8:11], s18 offen offset:3072 lds
v_mfma_f32_16x16x32_bf16 a[112:115], v[84:87], v[48:51], a[112:115]
ds_read_b64_tr_b16 v[158:159], v10 offset:18432
v_mfma_f32_16x16x32_bf16 a[116:119], v[88:91], v[48:51], a[116:119]
v_mfma_f32_16x16x32_bf16 a[120:123], v[92:95], v[48:51], a[120:123]
ds_read_b64_tr_b16 v[160:161], v11 offset:16384
v_mfma_f32_16x16x32_bf16 a[124:127], v[96:99], v[48:51], a[124:127]
s_mul_i32 s85, s19, 3
s_add_u32 s85, s85, s18
v_mfma_f32_16x16x32_bf16 a[128:131], v[68:71], v[52:55], a[128:131]
ds_read_b64_tr_b16 v[162:163], v11 offset:18432
v_mfma_f32_16x16x32_bf16 a[132:135], v[72:75], v[52:55], a[132:135]
buffer_load_dword v241, v240, s[8:11], s85 offen
v_mfma_f32_16x16x32_bf16 a[136:139], v[76:79], v[52:55], a[136:139]
ds_read_b128 v[104:107], v3 offset:2048
v_mfma_f32_16x16x32_bf16 a[140:143], v[80:83], v[52:55], a[140:143]
v_mfma_f32_16x16x32_bf16 a[144:147], v[84:87], v[52:55], a[144:147]
ds_read_b128 v[108:111], v3 offset:4096
v_mfma_f32_16x16x32_bf16 a[148:151], v[88:91], v[52:55], a[148:151]
v_mfma_f32_16x16x32_bf16 a[152:155], v[92:95], v[52:55], a[152:155]
ds_read_b128 v[112:115], v3 offset:6144
v_mfma_f32_16x16x32_bf16 a[156:159], v[96:99], v[52:55], a[156:159]
v_mfma_f32_16x16x32_bf16 a[160:163], v[68:71], v[56:59], a[160:163]
ds_read_b128 v[116:119], v3 offset:8192
v_mfma_f32_16x16x32_bf16 a[164:167], v[72:75], v[56:59], a[164:167]
v_mfma_f32_16x16x32_bf16 a[168:171], v[76:79], v[56:59], a[168:171]
ds_read_b128 v[120:123], v3 offset:10240
v_mfma_f32_16x16x32_bf16 a[172:175], v[80:83], v[56:59], a[172:175]
v_mfma_f32_16x16x32_bf16 a[176:179], v[84:87], v[56:59], a[176:179]
ds_read_b128 v[124:127], v3 offset:12288
v_mfma_f32_16x16x32_bf16 a[180:183], v[88:91], v[56:59], a[180:183]
v_mfma_f32_16x16x32_bf16 a[184:187], v[92:95], v[56:59], a[184:187]
ds_read_b128 v[128:131], v3 offset:14336
v_mfma_f32_16x16x32_bf16 a[188:191], v[96:99], v[56:59], a[188:191]
v_mfma_f32_16x16x32_bf16 a[192:195], v[68:71], v[60:63], a[192:195]
v_mfma_f32_16x16x32_bf16 a[196:199], v[72:75], v[60:63], a[196:199]
v_mfma_f32_16x16x32_bf16 a[200:203], v[76:79], v[60:63], a[200:203]
v_mfma_f32_16x16x32_bf16 a[204:207], v[80:83], v[60:63], a[204:207]
v_mfma_f32_16x16x32_bf16 a[208:211], v[84:87], v[60:63], a[208:211]
v_mfma_f32_16x16x32_bf16 a[212:215], v[88:91], v[60:63], a[212:215]
v_mfma_f32_16x16x32_bf16 a[216:219], v[92:95], v[60:63], a[216:219]
v_mfma_f32_16x16x32_bf16 a[220:223], v[96:99], v[60:63], a[220:223]
v_mfma_f32_16x16x32_bf16 a[224:227], v[68:71], v[64:67], a[224:227]
v_mfma_f32_16x16x32_bf16 a[228:231], v[72:75], v[64:67], a[228:231]
s_waitcnt vmcnt(1) lgkmcnt(0)
s_barrier
s_nop 1
v_mfma_f32_16x16x32_bf16 a[232:235], v[76:79], v[64:67], a[232:235]
s_add_u32 s27, s27, 128
s_add_u32 s28, s28, s19
v_mfma_f32_16x16x32_bf16 a[236:239], v[80:83], v[64:67], a[236:239]
s_sub_u32 s70, s70, 1
s_cmp_gt_i32 s70, 0
v_mfma_f32_16x16x32_bf16 a[240:243], v[84:87], v[64:67], a[240:243]
s_cselect_b32 s17, s27, s30
s_cselect_b32 s18, s28, s30
v_mfma_f32_16x16x32_bf16 a[244:247], v[88:91], v[64:67], a[244:247]
s_xor_b32 s21, s21, 0x8000
s_xor_b32 s22, s22, 0x8000
v_mfma_f32_16x16x32_bf16 a[248:251], v[92:95], v[64:67], a[248:251]
s_mov_b32 m0, s21
v_mfma_f32_16x16x32_bf16 a[252:255], v[96:99], v[64:67], a[252:255]
s_waitcnt lgkmcnt(0)
v_mfma_f32_16x16x32_bf16 a[0:3], v[132:135], v[100:103], a[0:3]
v_xor_b32 v2, 0x8000, v2
buffer_load_dwordx4 v12, s[4:7], s17 offen offset:0 lds
v_mfma_f32_16x16x32_bf16 a[4:7], v[136:139], v[100:103], a[4:7]
v_xor_b32 v4, 0x8000, v4
v_mfma_f32_16x16x32_bf16 a[8:11], v[140:143], v[100:103], a[8:11]
ds_read_b128 v[36:39], v2 offset:0
v_mfma_f32_16x16x32_bf16 a[12:15], v[144:147], v[100:103], a[12:15]
v_xor_b32 v5, 0x8000, v5
v_mfma_f32_16x16x32_bf16 a[16:19], v[148:151], v[100:103], a[16:19]
ds_read_b64_tr_b16 v[68:69], v4 offset:0
v_mfma_f32_16x16x32_bf16 a[20:23], v[152:155], v[100:103], a[20:23]
v_xor_b32 v6, 0x8000, v6
v_mfma_f32_16x16x32_bf16 a[24:27], v[156:159], v[100:103], a[24:27]
ds_read_b64_tr_b16 v[70:71], v4 offset:2048
buffer_load_dwordx4 v13, s[4:7], s17 offen offset:1024 lds
v_mfma_f32_16x16x32_bf16 a[28:31], v[160:163], v[100:103], a[28:31]
v_xor_b32 v7, 0x8000, v7
v_mfma_f32_16x16x32_bf16 a[32:35], v[132:135], v[104:107], a[32:35]
ds_read_b64_tr_b16 v[72:73], v5 offset:0
v_mfma_f32_16x16x32_bf16 a[36:39], v[136:139], v[104:107], a[36:39]
v_xor_b32 v8, 0x8000, v8
v_mfma_f32_16x16x32_bf16 a[40:43], v[140:143], v[104:107], a[40:43]
ds_read_b64_tr_b16 v[74:75], v5 offset:2048
v_mfma_f32_16x16x32_bf16 a[44:47], v[144:147], v[104:107], a[44:47]
v_xor_b32 v9, 0x8000, v9
v_mfma_f32_16x16x32_bf16 a[48:51], v[148:151], v[104:107], a[48:51]
ds_read_b64_tr_b16 v[76:77], v6 offset:0
buffer_load_dwordx4 v14, s[4:7], s17 offen offset:2048 lds
v_mfma_f32_16x16x32_bf16 a[52:55], v[152:155], v[104:107], a[52:55]
v_xor_b32 v10, 0x8000, v10
v_mfma_f32_16x16x32_bf16 a[56:59], v[156:159], v[104:107], a[56:59]
ds_read_b64_tr_b16 v[78:79], v6 offset:2048
v_mfma_f32_16x16x32_bf16 a[60:63], v[160:163], v[104:107], a[60:63]
v_xor_b32 v11, 0x8000, v11
v_mfma_f32_16x16x32_bf16 a[64:67], v[132:135], v[108:111], a[64:67]
ds_read_b64_tr_b16 v[80:81], v7 offset:0
v_mfma_f32_16x16x32_bf16 a[68:71], v[136:139], v[108:111], a[68:71]
v_xor_b32 v3, 0x8000, v3
v_mfma_f32_16x16x32_bf16 a[72:75], v[140:143], v[108:111], a[72:75]
ds_read_b64_tr_b16 v[82:83], v7 offset:2048
v_mfma_f32_16x16x32_bf16 a[76:79], v[144:147], v[108:111], a[76:79]
buffer_load_dwordx4 v15, s[4:7], s17 offen offset:3072 lds
v_mfma_f32_16x16x32_bf16 a[80:83], v[148:151], v[108:111], a[80:83]
ds_read_b64_tr_b16 v[84:85], v8 offset:0
v_mfma_f32_16x16x32_bf16 a[84:87], v[152:155], v[108:111], a[84:87]
s_add_u32 m0, s21, 4096
v_mfma_f32_16x16x32_bf16 a[88:91], v[156:159], v[108:111], a[88:91]
ds_read_b64_tr_b16 v[86:87], v8 offset:2048
v_mfma_f32_16x16x32_bf16 a[92:95], v[160:163], v[108:111], a[92:95]
v_mfma_f32_16x16x32_bf16 a[96:99], v[132:135], v[112:115], a[96:99]
ds_read_b64_tr_b16 v[88:89], v9 offset:0
v_mfma_f32_16x16x32_bf16 a[100:103], v[136:139], v[112:115], a[100:103]
buffer_load_dwordx4 v16, s[4:7], s17 offen offset:0 lds
v_mfma_f32_16x16x32_bf16 a[104:107], v[140:143], v[112:115], a[104:107]
ds_read_b64_tr_b16 v[90:91], v9 offset:2048
v_mfma_f32_16x16x32_bf16 a[108:111], v[144:147], v[112:115], a[108:111]
v_mfma_f32_16x16x32_bf16 a[112:115], v[148:151], v[112:115], a[112:115]
ds_read_b64_tr_b16 v[92:93], v10 offset:0
v_mfma_f32_16x16x32_bf16 a[116:119], v[152:155], v[112:115], a[116:119]
v_mfma_f32_16x16x32_bf16 a[120:123], v[156:159], v[112:115], a[120:123]
ds_read_b64_tr_b16 v[94:95], v10 offset:2048
v_mfma_f32_16x16x32_bf16 a[124:127], v[160:163], v[112:115], a[124:127]
buffer_load_dwordx4 v17, s[4:7], s17 offen offset:1024 lds
v_mfma_f32_16x16x32_bf16 a[128:131], v[132:135], v[116:119], a[128:131]
ds_read_b64_tr_b16 v[96:97], v11 offset:0
v_mfma_f32_16x16x32_bf16 a[132:135], v[136:139], v[116:119], a[132:135]
v_mfma_f32_16x16x32_bf16 a[136:139], v[140:143], v[116:119], a[136:139]
ds_read_b64_tr_b16 v[98:99], v11 offset:2048
v_mfma_f32_16x16x32_bf16 a[140:143], v[144:147], v[116:119], a[140:143]
v_mfma_f32_16x16x32_bf16 a[144:147], v[148:151], v[116:119], a[144:147]
ds_read_b128 v[40:43], v2 offset:2048
v_mfma_f32_16x16x32_bf16 a[148:151], v[152:155], v[116:119], a[148:151]
buffer_load_dwordx4 v18, s[4:7], s17 offen offset:2048 lds
v_mfma_f32_16x16x32_bf16 a[152:155], v[156:159], v[116:119], a[152:155]
ds_read_b128 v[44:47], v2 offset:4096
v_mfma_f32_16x16x32_bf16 a[156:159], v[160:163], v[116:119], a[156:159]
v_mfma_f32_16x16x32_bf16 a[160:163], v[132:135], v[120:123], a[160:163]
ds_read_b128 v[48:51], v2 offset:6144
v_mfma_f32_16x16x32_bf16 a[164:167], v[136:139], v[120:123], a[164:167]
v_mfma_f32_16x16x32_bf16 a[168:171], v[140:143], v[120:123], a[168:171]
ds_read_b128 v[52:55], v2 offset:8192
v_mfma_f32_16x16x32_bf16 a[172:175], v[144:147], v[120:123], a[172:175]
buffer_load_dwordx4 v19, s[4:7], s17 offen offset:3072 lds
v_mfma_f32_16x16x32_bf16 a[176:179], v[148:151], v[120:123], a[176:179]
ds_read_b128 v[56:59], v2 offset:10240
v_mfma_f32_16x16x32_bf16 a[180:183], v[152:155], v[120:123], a[180:183]
s_mov_b32 m0, s22
v_mfma_f32_16x16x32_bf16 a[184:187], v[156:159], v[120:123], a[184:187]
ds_read_b128 v[60:63], v2 offset:12288
v_mfma_f32_16x16x32_bf16 a[188:191], v[160:163], v[120:123], a[188:191]
v_mfma_f32_16x16x32_bf16 a[192:195], v[132:135], v[124:127], a[192:195]
ds_read_b128 v[64:67], v2 offset:14336
v_mfma_f32_16x16x32_bf16 a[196:199], v[136:139], v[124:127], a[196:199]
buffer_load_dwordx4 v20, s[8:11], s18 offen offset:0 lds
v_mfma_f32_16x16x32_bf16 a[200:203], v[140:143], v[124:127], a[200:203]
v_mfma_f32_16x16x32_bf16 a[204:207], v[144:147], v[124:127], a[204:207]
v_mfma_f32_16x16x32_bf16 a[208:211], v[148:151], v[124:127], a[208:211]
v_mfma_f32_16x16x32_bf16 a[212:215], v[152:155], v[124:127], a[212:215]
v_mfma_f32_16x16x32_bf16 a[216:219], v[156:159], v[124:127], a[216:219]
v_mfma_f32_16x16x32_bf16 a[220:223], v[160:163], v[124:127], a[220:223]
buffer_load_dwordx4 v21, s[8:11], s18 offen offset:1024 lds
v_mfma_f32_16x16x32_bf16 a[224:227], v[132:135], v[128:131], a[224:227]
v_mfma_f32_16x16x32_bf16 a[228:231], v[136:139], v[128:131], a[228:231]
v_mfma_f32_16x16x32_bf16 a[232:235], v[140:143], v[128:131], a[232:235]
v_mfma_f32_16x16x32_bf16 a[236:239], v[144:147], v[128:131], a[236:239]
v_mfma_f32_16x16x32_bf16 a[240:243], v[148:151], v[128:131], a[240:243]
v_mfma_f32_16x16x32_bf16 a[244:247], v[152:155], v[128:131], a[244:247]
buffer_load_dwordx4 v22, s[8:11], s18 offen offset:2048 lds
v_mfma_f32_16x16x32_bf16 a[248:251], v[156:159], v[128:131], a[248:251]
s_sub_u32 s20, s20, 1
v_mfma_f32_16x16x32_bf16 a[252:255], v[160:163], v[128:131], a[252:255]
s_cmp_lg_u32 s20, 0
s_cbranch_scc1 L_f_loop_1_1
s_branch L_f_kvdone
L_f_go_1_2:
s_waitcnt lgkmcnt(0)
v_mfma_f32_16x16x32_bf16 a[0:3], v[68:71], v[36:39], 0
ds_read_b128 v[100:103], v3 offset:0
v_mfma_f32_16x16x32_bf16 a[4:7], v[72:75], v[36:39], 0
s_cmp_ge_u32 s2, 128
s_cselect_b32 s80, s48, s42
s_cselect_b32 s81, s49, s43
s_mov_b32 s62, 401408
s_cselect_b32 s82, s62, 3670016
s_mov_b32 s83, 0x20000
v_mfma_f32_16x16x32_bf16 a[8:11], v[76:79], v[36:39], 0
ds_read_b64_tr_b16 v[132:133], v4 offset:16384
v_mfma_f32_16x16x32_bf16 a[12:15], v[80:83], v[36:39], 0
s_sub_u32 s61, s2, 128
s_cselect_b32 s61, s61, s61
s_cmp_ge_u32 s2, 128
s_cselect_b32 s61, s61, s2
s_cselect_b32 s62, 28, 32
v_mfma_f32_16x16x32_bf16 a[16:19], v[84:87], v[36:39], 0
ds_read_b64_tr_b16 v[134:135], v4 offset:18432
v_mfma_f32_16x16x32_bf16 a[20:23], v[88:91], v[36:39], 0
s_mul_i32 s62, s62, s61
s_mul_i32 s62, s62, 896
v_mfma_f32_16x16x32_bf16 a[24:27], v[92:95], v[36:39], 0
ds_read_b64_tr_b16 v[136:137], v5 offset:16384
v_mfma_f32_16x16x32_bf16 a[28:31], v[96:99], v[36:39], 0
s_lshl_b32 s90, s61, 10
s_cmp_ge_u32 s2, 128
s_mov_b32 s63, 79691776
s_cselect_b32 s63, s63, 75497472
v_mfma_f32_16x16x32_bf16 a[32:35], v[68:71], v[40:43], 0
ds_read_b64_tr_b16 v[138:139], v5 offset:18432
v_mfma_f32_16x16x32_bf16 a[36:39], v[72:75], v[40:43], 0
s_add_u32 s90, s90, s63
s_cmp_ge_u32 s2, 128
s_mov_b32 s63, 16384
s_cselect_b32 s100, s63, 131072
v_mfma_f32_16x16x32_bf16 a[40:43], v[76:79], v[40:43], 0
ds_read_b64_tr_b16 v[140:141], v6 offset:16384
v_mfma_f32_16x16x32_bf16 a[44:47], v[80:83], v[40:43], 0
s_cmp_ge_u32 s2, 144
s_cselect_b32 s62, s30, s62
s_cselect_b32 s90, s30, s90
s_cselect_b32 s100, 0, s100
s_mul_i32 s63, s16, 7168
v_mfma_f32_16x16x32_bf16 a[48:51], v[84:87], v[40:43], 0
ds_read_b64_tr_b16 v[142:143], v6 offset:18432
v_mfma_f32_16x16x32_bf16 a[52:55], v[88:91], v[40:43], 0
s_add_u32 s62, s62, s63
s_add_u32 s63, s63, 131072
v_mfma_f32_16x16x32_bf16 a[56:59], v[92:95], v[40:43], 0
ds_read_b64_tr_b16 v[144:145], v7 offset:16384
v_mfma_f32_16x16x32_bf16 a[60:63], v[96:99], v[40:43], 0
s_add_u32 m0, s63, 0
s_add_u32 s61, s62, 0
buffer_load_dwordx4 v1, s[80:83], s61 offen lds
s_add_u32 m0, s63, 1024
s_add_u32 s61, s62, 1024
buffer_load_dwordx4 v1, s[80:83], s61 offen lds
v_mfma_f32_16x16x32_bf16 a[64:67], v[68:71], v[44:47], 0
ds_read_b64_tr_b16 v[146:147], v7 offset:18432
v_mfma_f32_16x16x32_bf16 a[68:71], v[72:75], v[44:47], 0
s_add_u32 m0, s63, 2048
s_add_u32 s61, s62, 2048
buffer_load_dwordx4 v1, s[80:83], s61 offen lds
s_add_u32 m0, s63, 3072
s_add_u32 s61, s62, 3072
buffer_load_dwordx4 v1, s[80:83], s61 offen lds
v_mfma_f32_16x16x32_bf16 a[72:75], v[76:79], v[44:47], 0
ds_read_b64_tr_b16 v[148:149], v8 offset:16384
v_mfma_f32_16x16x32_bf16 a[76:79], v[80:83], v[44:47], 0
s_add_u32 m0, s63, 4096
s_add_u32 s61, s62, 4096
buffer_load_dwordx4 v1, s[80:83], s61 offen lds
s_add_u32 m0, s63, 5120
s_add_u32 s61, s62, 5120
buffer_load_dwordx4 v1, s[80:83], s61 offen lds
v_mfma_f32_16x16x32_bf16 a[80:83], v[84:87], v[44:47], 0
ds_read_b64_tr_b16 v[150:151], v8 offset:18432
v_mfma_f32_16x16x32_bf16 a[84:87], v[88:91], v[44:47], 0
s_add_u32 m0, s63, 6144
s_add_u32 s61, s62, 6144
buffer_load_dwordx4 v1, s[80:83], s61 offen lds
v_and_b32 v28, 63, v0
v_mfma_f32_16x16x32_bf16 a[88:91], v[92:95], v[44:47], 0
ds_read_b64_tr_b16 v[152:153], v9 offset:16384
v_mfma_f32_16x16x32_bf16 a[92:95], v[96:99], v[44:47], 0
v_and_b32 v29, 15, v28
v_lshrrev_b32 v30, 4, v28
v_mfma_f32_16x16x32_bf16 a[96:99], v[68:71], v[48:51], 0
ds_read_b64_tr_b16 v[154:155], v9 offset:18432
v_mfma_f32_16x16x32_bf16 a[100:103], v[72:75], v[48:51], 0
v_bfe_u32 v31, v28, 2, 2
v_and_b32 v32, 3, v28
v_mfma_f32_16x16x32_bf16 a[104:107], v[76:79], v[48:51], 0
ds_read_b64_tr_b16 v[156:157], v10 offset:16384
v_mfma_f32_16x16x32_bf16 a[108:111], v[80:83], v[48:51], 0
v_lshl_add_u32 v33, v30, 2, v31
v_mul_u32_u24 v33, 896, v33
v_mfma_f32_16x16x32_bf16 a[112:115], v[84:87], v[48:51], 0
ds_read_b64_tr_b16 v[158:159], v10 offset:18432
v_mfma_f32_16x16x32_bf16 a[116:119], v[88:91], v[48:51], 0
v_lshl_add_u32 v33, v32, 3, v33
s_mul_i32 s62, s16, 224
v_mfma_f32_16x16x32_bf16 a[120:123], v[92:95], v[48:51], 0
ds_read_b64_tr_b16 v[160:161], v11 offset:16384
v_mfma_f32_16x16x32_bf16 a[124:127], v[96:99], v[48:51], 0
s_mov_b32 s85, 7736
v_mfma_f32_16x16x32_bf16 a[128:131], v[68:71], v[52:55], 0
ds_read_b64_tr_b16 v[162:163], v11 offset:18432
v_mfma_f32_16x16x32_bf16 a[132:135], v[72:75], v[52:55], 0
s_bitcmp1_b32 s85, s20
s_cbranch_scc1 L_k1_gr_1_2_1_0
buffer_load_dword v241, v240, s[4:7], 0 offen
s_branch L_k1_gd_1_2_1_0
L_k1_gr_1_2_1_0:
global_load_dword v241, v[242:243], off
v_mov_b32 v242, v244
v_mov_b32 v243, v245
v_mov_b32 v244, v246
v_mov_b32 v245, v247
v_mov_b32 v246, v248
v_mov_b32 v247, v249
L_k1_gd_1_2_1_0:
v_mfma_f32_16x16x32_bf16 a[136:139], v[76:79], v[52:55], 0
ds_read_b128 v[104:107], v3 offset:2048
v_mfma_f32_16x16x32_bf16 a[140:143], v[80:83], v[52:55], 0
s_add_u32 s62, s62, 131072
v_add_u32 v178, s62, v33
v_mfma_f32_16x16x32_bf16 a[144:147], v[84:87], v[52:55], 0
ds_read_b128 v[108:111], v3 offset:4096
v_mfma_f32_16x16x32_bf16 a[148:151], v[88:91], v[52:55], 0
v_mfma_f32_16x16x32_bf16 a[152:155], v[92:95], v[52:55], 0
ds_read_b128 v[112:115], v3 offset:6144
v_mfma_f32_16x16x32_bf16 a[156:159], v[96:99], v[52:55], 0
v_mfma_f32_16x16x32_bf16 a[160:163], v[68:71], v[56:59], 0
ds_read_b128 v[116:119], v3 offset:8192
v_mfma_f32_16x16x32_bf16 a[164:167], v[72:75], v[56:59], 0
v_mfma_f32_16x16x32_bf16 a[168:171], v[76:79], v[56:59], 0
ds_read_b128 v[120:123], v3 offset:10240
v_mfma_f32_16x16x32_bf16 a[172:175], v[80:83], v[56:59], 0
v_mfma_f32_16x16x32_bf16 a[176:179], v[84:87], v[56:59], 0
ds_read_b128 v[124:127], v3 offset:12288
v_mfma_f32_16x16x32_bf16 a[180:183], v[88:91], v[56:59], 0
v_mfma_f32_16x16x32_bf16 a[184:187], v[92:95], v[56:59], 0
ds_read_b128 v[128:131], v3 offset:14336
v_mfma_f32_16x16x32_bf16 a[188:191], v[96:99], v[56:59], 0
v_mfma_f32_16x16x32_bf16 a[192:195], v[68:71], v[60:63], 0
v_mfma_f32_16x16x32_bf16 a[196:199], v[72:75], v[60:63], 0
v_mfma_f32_16x16x32_bf16 a[200:203], v[76:79], v[60:63], 0
v_mfma_f32_16x16x32_bf16 a[204:207], v[80:83], v[60:63], 0
v_mfma_f32_16x16x32_bf16 a[208:211], v[84:87], v[60:63], 0
v_mfma_f32_16x16x32_bf16 a[212:215], v[88:91], v[60:63], 0
v_mfma_f32_16x16x32_bf16 a[216:219], v[92:95], v[60:63], 0
v_mfma_f32_16x16x32_bf16 a[220:223], v[96:99], v[60:63], 0
v_mfma_f32_16x16x32_bf16 a[224:227], v[68:71], v[64:67], 0
v_mfma_f32_16x16x32_bf16 a[228:231], v[72:75], v[64:67], 0
s_waitcnt vmcnt(11) lgkmcnt(0)
s_barrier
s_nop 3
v_mfma_f32_16x16x32_bf16 a[232:235], v[76:79], v[64:67], 0
s_add_u32 s27, s27, 128
s_add_u32 s28, s28, s19
v_mfma_f32_16x16x32_bf16 a[236:239], v[80:83], v[64:67], 0
s_sub_u32 s70, s70, 1
s_cmp_gt_i32 s70, 0
v_mfma_f32_16x16x32_bf16 a[240:243], v[84:87], v[64:67], 0
s_cselect_b32 s17, s27, s30
s_cselect_b32 s18, s28, s30
v_mfma_f32_16x16x32_bf16 a[244:247], v[88:91], v[64:67], 0
s_xor_b32 s21, s21, 0x8000
s_xor_b32 s22, s22, 0x8000
v_mfma_f32_16x16x32_bf16 a[248:251], v[92:95], v[64:67], 0
s_mov_b32 m0, s21
v_mfma_f32_16x16x32_bf16 a[252:255], v[96:99], v[64:67], 0
s_waitcnt lgkmcnt(0)
v_mfma_f32_16x16x32_bf16 a[0:3], v[132:135], v[100:103], a[0:3]
v_xor_b32 v2, 0x8000, v2
buffer_load_dwordx4 v12, s[4:7], s17 offen offset:0 lds
v_mfma_f32_16x16x32_bf16 a[4:7], v[136:139], v[100:103], a[4:7]
v_xor_b32 v4, 0x8000, v4
v_mfma_f32_16x16x32_bf16 a[8:11], v[140:143], v[100:103], a[8:11]
ds_read_b128 v[36:39], v2 offset:0
v_mfma_f32_16x16x32_bf16 a[12:15], v[144:147], v[100:103], a[12:15]
v_xor_b32 v5, 0x8000, v5
v_mfma_f32_16x16x32_bf16 a[16:19], v[148:151], v[100:103], a[16:19]
ds_read_b64_tr_b16 v[68:69], v4 offset:0
v_mfma_f32_16x16x32_bf16 a[20:23], v[152:155], v[100:103], a[20:23]
v_xor_b32 v6, 0x8000, v6
v_mfma_f32_16x16x32_bf16 a[24:27], v[156:159], v[100:103], a[24:27]
ds_read_b64_tr_b16 v[70:71], v4 offset:2048
buffer_load_dwordx4 v13, s[4:7], s17 offen offset:1024 lds
v_mfma_f32_16x16x32_bf16 a[28:31], v[160:163], v[100:103], a[28:31]
v_xor_b32 v7, 0x8000, v7
v_mfma_f32_16x16x32_bf16 a[32:35], v[132:135], v[104:107], a[32:35]
ds_read_b64_tr_b16 v[72:73], v5 offset:0
v_mfma_f32_16x16x32_bf16 a[36:39], v[136:139], v[104:107], a[36:39]
v_xor_b32 v8, 0x8000, v8
v_mfma_f32_16x16x32_bf16 a[40:43], v[140:143], v[104:107], a[40:43]
ds_read_b64_tr_b16 v[74:75], v5 offset:2048
v_mfma_f32_16x16x32_bf16 a[44:47], v[144:147], v[104:107], a[44:47]
v_xor_b32 v9, 0x8000, v9
v_mfma_f32_16x16x32_bf16 a[48:51], v[148:151], v[104:107], a[48:51]
ds_read_b64_tr_b16 v[76:77], v6 offset:0
buffer_load_dwordx4 v14, s[4:7], s17 offen offset:2048 lds
v_mfma_f32_16x16x32_bf16 a[52:55], v[152:155], v[104:107], a[52:55]
v_xor_b32 v10, 0x8000, v10
v_mfma_f32_16x16x32_bf16 a[56:59], v[156:159], v[104:107], a[56:59]
ds_read_b64_tr_b16 v[78:79], v6 offset:2048
v_mfma_f32_16x16x32_bf16 a[60:63], v[160:163], v[104:107], a[60:63]
v_xor_b32 v11, 0x8000, v11
v_mfma_f32_16x16x32_bf16 a[64:67], v[132:135], v[108:111], a[64:67]
ds_read_b64_tr_b16 v[80:81], v7 offset:0
v_mfma_f32_16x16x32_bf16 a[68:71], v[136:139], v[108:111], a[68:71]
v_xor_b32 v3, 0x8000, v3
v_mfma_f32_16x16x32_bf16 a[72:75], v[140:143], v[108:111], a[72:75]
ds_read_b64_tr_b16 v[82:83], v7 offset:2048
v_mfma_f32_16x16x32_bf16 a[76:79], v[144:147], v[108:111], a[76:79]
buffer_load_dwordx4 v15, s[4:7], s17 offen offset:3072 lds
v_mfma_f32_16x16x32_bf16 a[80:83], v[148:151], v[108:111], a[80:83]
ds_read_b64_tr_b16 v[84:85], v8 offset:0
v_mfma_f32_16x16x32_bf16 a[84:87], v[152:155], v[108:111], a[84:87]
s_add_u32 m0, s21, 4096
v_mfma_f32_16x16x32_bf16 a[88:91], v[156:159], v[108:111], a[88:91]
ds_read_b64_tr_b16 v[86:87], v8 offset:2048
v_mfma_f32_16x16x32_bf16 a[92:95], v[160:163], v[108:111], a[92:95]
v_mfma_f32_16x16x32_bf16 a[96:99], v[132:135], v[112:115], a[96:99]
ds_read_b64_tr_b16 v[88:89], v9 offset:0
v_mfma_f32_16x16x32_bf16 a[100:103], v[136:139], v[112:115], a[100:103]
buffer_load_dwordx4 v16, s[4:7], s17 offen offset:0 lds
v_mfma_f32_16x16x32_bf16 a[104:107], v[140:143], v[112:115], a[104:107]
ds_read_b64_tr_b16 v[90:91], v9 offset:2048
v_mfma_f32_16x16x32_bf16 a[108:111], v[144:147], v[112:115], a[108:111]
v_mfma_f32_16x16x32_bf16 a[112:115], v[148:151], v[112:115], a[112:115]
ds_read_b64_tr_b16 v[92:93], v10 offset:0
v_mfma_f32_16x16x32_bf16 a[116:119], v[152:155], v[112:115], a[116:119]
v_mfma_f32_16x16x32_bf16 a[120:123], v[156:159], v[112:115], a[120:123]
ds_read_b64_tr_b16 v[94:95], v10 offset:2048
v_mfma_f32_16x16x32_bf16 a[124:127], v[160:163], v[112:115], a[124:127]
buffer_load_dwordx4 v17, s[4:7], s17 offen offset:1024 lds
v_mfma_f32_16x16x32_bf16 a[128:131], v[132:135], v[116:119], a[128:131]
ds_read_b64_tr_b16 v[96:97], v11 offset:0
v_mfma_f32_16x16x32_bf16 a[132:135], v[136:139], v[116:119], a[132:135]
v_mfma_f32_16x16x32_bf16 a[136:139], v[140:143], v[116:119], a[136:139]
ds_read_b64_tr_b16 v[98:99], v11 offset:2048
v_mfma_f32_16x16x32_bf16 a[140:143], v[144:147], v[116:119], a[140:143]
v_mfma_f32_16x16x32_bf16 a[144:147], v[148:151], v[116:119], a[144:147]
ds_read_b128 v[40:43], v2 offset:2048
v_mfma_f32_16x16x32_bf16 a[148:151], v[152:155], v[116:119], a[148:151]
buffer_load_dwordx4 v18, s[4:7], s17 offen offset:2048 lds
v_mfma_f32_16x16x32_bf16 a[152:155], v[156:159], v[116:119], a[152:155]
ds_read_b128 v[44:47], v2 offset:4096
v_mfma_f32_16x16x32_bf16 a[156:159], v[160:163], v[116:119], a[156:159]
v_mfma_f32_16x16x32_bf16 a[160:163], v[132:135], v[120:123], a[160:163]
ds_read_b128 v[48:51], v2 offset:6144
v_mfma_f32_16x16x32_bf16 a[164:167], v[136:139], v[120:123], a[164:167]
v_mfma_f32_16x16x32_bf16 a[168:171], v[140:143], v[120:123], a[168:171]
ds_read_b128 v[52:55], v2 offset:8192
v_mfma_f32_16x16x32_bf16 a[172:175], v[144:147], v[120:123], a[172:175]
buffer_load_dwordx4 v19, s[4:7], s17 offen offset:3072 lds
v_mfma_f32_16x16x32_bf16 a[176:179], v[148:151], v[120:123], a[176:179]
ds_read_b128 v[56:59], v2 offset:10240
v_mfma_f32_16x16x32_bf16 a[180:183], v[152:155], v[120:123], a[180:183]
s_mov_b32 m0, s22
v_mfma_f32_16x16x32_bf16 a[184:187], v[156:159], v[120:123], a[184:187]
ds_read_b128 v[60:63], v2 offset:12288
v_mfma_f32_16x16x32_bf16 a[188:191], v[160:163], v[120:123], a[188:191]
v_mfma_f32_16x16x32_bf16 a[192:195], v[132:135], v[124:127], a[192:195]
ds_read_b128 v[64:67], v2 offset:14336
v_mfma_f32_16x16x32_bf16 a[196:199], v[136:139], v[124:127], a[196:199]
buffer_load_dwordx4 v20, s[8:11], s18 offen offset:0 lds
v_mfma_f32_16x16x32_bf16 a[200:203], v[140:143], v[124:127], a[200:203]
v_mfma_f32_16x16x32_bf16 a[204:207], v[144:147], v[124:127], a[204:207]
v_mfma_f32_16x16x32_bf16 a[208:211], v[148:151], v[124:127], a[208:211]
v_mfma_f32_16x16x32_bf16 a[212:215], v[152:155], v[124:127], a[212:215]
v_mfma_f32_16x16x32_bf16 a[216:219], v[156:159], v[124:127], a[216:219]
v_mfma_f32_16x16x32_bf16 a[220:223], v[160:163], v[124:127], a[220:223]
buffer_load_dwordx4 v21, s[8:11], s18 offen offset:1024 lds
v_mfma_f32_16x16x32_bf16 a[224:227], v[132:135], v[128:131], a[224:227]
v_mfma_f32_16x16x32_bf16 a[228:231], v[136:139], v[128:131], a[228:231]
v_mfma_f32_16x16x32_bf16 a[232:235], v[140:143], v[128:131], a[232:235]
v_mfma_f32_16x16x32_bf16 a[236:239], v[144:147], v[128:131], a[236:239]
v_mfma_f32_16x16x32_bf16 a[240:243], v[148:151], v[128:131], a[240:243]
v_mfma_f32_16x16x32_bf16 a[244:247], v[152:155], v[128:131], a[244:247]
buffer_load_dwordx4 v22, s[8:11], s18 offen offset:2048 lds
v_mfma_f32_16x16x32_bf16 a[248:251], v[156:159], v[128:131], a[248:251]
s_sub_u32 s20, s20, 1
v_mfma_f32_16x16x32_bf16 a[252:255], v[160:163], v[128:131], a[252:255]
s_cmp_lg_u32 s20, 0
.p2align 6
L_f_loop_1_2:
s_waitcnt lgkmcnt(0)
v_mfma_f32_16x16x32_bf16 a[0:3], v[68:71], v[36:39], a[0:3]
ds_read_b128 v[100:103], v3 offset:0
v_mfma_f32_16x16x32_bf16 a[4:7], v[72:75], v[36:39], a[4:7]
v_mfma_f32_16x16x32_bf16 a[8:11], v[76:79], v[36:39], a[8:11]
ds_read_b64_tr_b16 v[132:133], v4 offset:16384
v_mfma_f32_16x16x32_bf16 a[12:15], v[80:83], v[36:39], a[12:15]
buffer_load_dwordx4 v23, s[8:11], s18 offen offset:3072 lds
v_mfma_f32_16x16x32_bf16 a[16:19], v[84:87], v[36:39], a[16:19]
ds_read_b64_tr_b16 v[134:135], v4 offset:18432
v_mfma_f32_16x16x32_bf16 a[20:23], v[88:91], v[36:39], a[20:23]
s_add_u32 m0, s22, 4096
v_mfma_f32_16x16x32_bf16 a[24:27], v[92:95], v[36:39], a[24:27]
ds_read_b64_tr_b16 v[136:137], v5 offset:16384
v_mfma_f32_16x16x32_bf16 a[28:31], v[96:99], v[36:39], a[28:31]
v_mfma_f32_16x16x32_bf16 a[32:35], v[68:71], v[40:43], a[32:35]
ds_read_b64_tr_b16 v[138:139], v5 offset:18432
v_mfma_f32_16x16x32_bf16 a[36:39], v[72:75], v[40:43], a[36:39]
buffer_load_dwordx4 v24, s[8:11], s18 offen offset:0 lds
v_mfma_f32_16x16x32_bf16 a[40:43], v[76:79], v[40:43], a[40:43]
ds_read_b64_tr_b16 v[140:141], v6 offset:16384
v_mfma_f32_16x16x32_bf16 a[44:47], v[80:83], v[40:43], a[44:47]
v_mfma_f32_16x16x32_bf16 a[48:51], v[84:87], v[40:43], a[48:51]
ds_read_b64_tr_b16 v[142:143], v6 offset:18432
v_mfma_f32_16x16x32_bf16 a[52:55], v[88:91], v[40:43], a[52:55]
v_mfma_f32_16x16x32_bf16 a[56:59], v[92:95], v[40:43], a[56:59]
ds_read_b64_tr_b16 v[144:145], v7 offset:16384
v_mfma_f32_16x16x32_bf16 a[60:63], v[96:99], v[40:43], a[60:63]
buffer_load_dwordx4 v25, s[8:11], s18 offen offset:1024 lds
v_mfma_f32_16x16x32_bf16 a[64:67], v[68:71], v[44:47], a[64:67]
ds_read_b64_tr_b16 v[146:147], v7 offset:18432
v_mfma_f32_16x16x32_bf16 a[68:71], v[72:75], v[44:47], a[68:71]
v_mfma_f32_16x16x32_bf16 a[72:75], v[76:79], v[44:47], a[72:75]
ds_read_b64_tr_b16 v[148:149], v8 offset:16384
v_mfma_f32_16x16x32_bf16 a[76:79], v[80:83], v[44:47], a[76:79]
v_mfma_f32_16x16x32_bf16 a[80:83], v[84:87], v[44:47], a[80:83]
ds_read_b64_tr_b16 v[150:151], v8 offset:18432
v_mfma_f32_16x16x32_bf16 a[84:87], v[88:91], v[44:47], a[84:87]
buffer_load_dwordx4 v26, s[8:11], s18 offen offset:2048 lds
v_mfma_f32_16x16x32_bf16 a[88:91], v[92:95], v[44:47], a[88:91]
ds_read_b64_tr_b16 v[152:153], v9 offset:16384
v_mfma_f32_16x16x32_bf16 a[92:95], v[96:99], v[44:47], a[92:95]
v_mfma_f32_16x16x32_bf16 a[96:99], v[68:71], v[48:51], a[96:99]
ds_read_b64_tr_b16 v[154:155], v9 offset:18432
v_mfma_f32_16x16x32_bf16 a[100:103], v[72:75], v[48:51], a[100:103]
v_mfma_f32_16x16x32_bf16 a[104:107], v[76:79], v[48:51], a[104:107]
ds_read_b64_tr_b16 v[156:157], v10 offset:16384
v_mfma_f32_16x16x32_bf16 a[108:111], v[80:83], v[48:51], a[108:111]
buffer_load_dwordx4 v27, s[8:11], s18 offen offset:3072 lds
v_mfma_f32_16x16x32_bf16 a[112:115], v[84:87], v[48:51], a[112:115]
ds_read_b64_tr_b16 v[158:159], v10 offset:18432
v_mfma_f32_16x16x32_bf16 a[116:119], v[88:91], v[48:51], a[116:119]
v_mfma_f32_16x16x32_bf16 a[120:123], v[92:95], v[48:51], a[120:123]
ds_read_b64_tr_b16 v[160:161], v11 offset:16384
v_mfma_f32_16x16x32_bf16 a[124:127], v[96:99], v[48:51], a[124:127]
s_mov_b32 s85, 7736
v_mfma_f32_16x16x32_bf16 a[128:131], v[68:71], v[52:55], a[128:131]
ds_read_b64_tr_b16 v[162:163], v11 offset:18432
v_mfma_f32_16x16x32_bf16 a[132:135], v[72:75], v[52:55], a[132:135]
s_bitcmp1_b32 s85, s20
s_cbranch_scc1 L_k1_gr_1_2_0_0
buffer_load_dword v241, v240, s[4:7], 0 offen
s_branch L_k1_gd_1_2_0_0
L_k1_gr_1_2_0_0:
global_load_dword v241, v[242:243], off
v_mov_b32 v242, v244
v_mov_b32 v243, v245
v_mov_b32 v244, v246
v_mov_b32 v245, v247
v_mov_b32 v246, v248
v_mov_b32 v247, v249
L_k1_gd_1_2_0_0:
v_mfma_f32_16x16x32_bf16 a[136:139], v[76:79], v[52:55], a[136:139]
ds_read_b128 v[104:107], v3 offset:2048
v_mfma_f32_16x16x32_bf16 a[140:143], v[80:83], v[52:55], a[140:143]
v_mfma_f32_16x16x32_bf16 a[144:147], v[84:87], v[52:55], a[144:147]
ds_read_b128 v[108:111], v3 offset:4096
v_mfma_f32_16x16x32_bf16 a[148:151], v[88:91], v[52:55], a[148:151]
s_cmp_eq_u32 s20, 7
s_cbranch_scc1 L_f_loc_1_2_0
L_f_locret_1_2_0:
v_mfma_f32_16x16x32_bf16 a[152:155], v[92:95], v[52:55], a[152:155]
ds_read_b128 v[112:115], v3 offset:6144
v_mfma_f32_16x16x32_bf16 a[156:159], v[96:99], v[52:55], a[156:159]
v_mfma_f32_16x16x32_bf16 a[160:163], v[68:71], v[56:59], a[160:163]
ds_read_b128 v[116:119], v3 offset:8192
v_mfma_f32_16x16x32_bf16 a[164:167], v[72:75], v[56:59], a[164:167]
v_mfma_f32_16x16x32_bf16 a[168:171], v[76:79], v[56:59], a[168:171]
ds_read_b128 v[120:123], v3 offset:10240
v_mfma_f32_16x16x32_bf16 a[172:175], v[80:83], v[56:59], a[172:175]
v_mfma_f32_16x16x32_bf16 a[176:179], v[84:87], v[56:59], a[176:179]
ds_read_b128 v[124:127], v3 offset:12288
v_mfma_f32_16x16x32_bf16 a[180:183], v[88:91], v[56:59], a[180:183]
v_mfma_f32_16x16x32_bf16 a[184:187], v[92:95], v[56:59], a[184:187]
ds_read_b128 v[128:131], v3 offset:14336
v_mfma_f32_16x16x32_bf16 a[188:191], v[96:99], v[56:59], a[188:191]
v_mfma_f32_16x16x32_bf16 a[192:195], v[68:71], v[60:63], a[192:195]
v_mfma_f32_16x16x32_bf16 a[196:199], v[72:75], v[60:63], a[196:199]
v_mfma_f32_16x16x32_bf16 a[200:203], v[76:79], v[60:63], a[200:203]
v_mfma_f32_16x16x32_bf16 a[204:207], v[80:83], v[60:63], a[204:207]
v_mfma_f32_16x16x32_bf16 a[208:211], v[84:87], v[60:63], a[208:211]
v_mfma_f32_16x16x32_bf16 a[212:215], v[88:91], v[60:63], a[212:215]
v_mfma_f32_16x16x32_bf16 a[216:219], v[92:95], v[60:63], a[216:219]
v_mfma_f32_16x16x32_bf16 a[220:223], v[96:99], v[60:63], a[220:223]
v_mfma_f32_16x16x32_bf16 a[224:227], v[68:71], v[64:67], a[224:227]
v_mfma_f32_16x16x32_bf16 a[228:231], v[72:75], v[64:67], a[228:231]
s_waitcnt vmcnt(1) lgkmcnt(0)
s_barrier
s_nop 3
v_mfma_f32_16x16x32_bf16 a[232:235], v[76:79], v[64:67], a[232:235]
s_add_u32 s27, s27, 128
s_add_u32 s28, s28, s19
v_mfma_f32_16x16x32_bf16 a[236:239], v[80:83], v[64:67], a[236:239]
s_sub_u32 s70, s70, 1
s_cmp_gt_i32 s70, 0
v_mfma_f32_16x16x32_bf16 a[240:243], v[84:87], v[64:67], a[240:243]
s_cselect_b32 s17, s27, s30
s_cselect_b32 s18, s28, s30
v_mfma_f32_16x16x32_bf16 a[244:247], v[88:91], v[64:67], a[244:247]
s_xor_b32 s21, s21, 0x8000
s_xor_b32 s22, s22, 0x8000
v_mfma_f32_16x16x32_bf16 a[248:251], v[92:95], v[64:67], a[248:251]
s_mov_b32 m0, s21
v_mfma_f32_16x16x32_bf16 a[252:255], v[96:99], v[64:67], a[252:255]
s_waitcnt lgkmcnt(0)
v_mfma_f32_16x16x32_bf16 a[0:3], v[132:135], v[100:103], a[0:3]
v_xor_b32 v2, 0x8000, v2
buffer_load_dwordx4 v12, s[4:7], s17 offen offset:0 lds
v_mfma_f32_16x16x32_bf16 a[4:7], v[136:139], v[100:103], a[4:7]
v_xor_b32 v4, 0x8000, v4
v_mfma_f32_16x16x32_bf16 a[8:11], v[140:143], v[100:103], a[8:11]
ds_read_b128 v[36:39], v2 offset:0
v_mfma_f32_16x16x32_bf16 a[12:15], v[144:147], v[100:103], a[12:15]
v_xor_b32 v5, 0x8000, v5
v_mfma_f32_16x16x32_bf16 a[16:19], v[148:151], v[100:103], a[16:19]
ds_read_b64_tr_b16 v[68:69], v4 offset:0
v_mfma_f32_16x16x32_bf16 a[20:23], v[152:155], v[100:103], a[20:23]
v_xor_b32 v6, 0x8000, v6
v_mfma_f32_16x16x32_bf16 a[24:27], v[156:159], v[100:103], a[24:27]
ds_read_b64_tr_b16 v[70:71], v4 offset:2048
buffer_load_dwordx4 v13, s[4:7], s17 offen offset:1024 lds
v_mfma_f32_16x16x32_bf16 a[28:31], v[160:163], v[100:103], a[28:31]
v_xor_b32 v7, 0x8000, v7
v_mfma_f32_16x16x32_bf16 a[32:35], v[132:135], v[104:107], a[32:35]
ds_read_b64_tr_b16 v[72:73], v5 offset:0
v_mfma_f32_16x16x32_bf16 a[36:39], v[136:139], v[104:107], a[36:39]
v_xor_b32 v8, 0x8000, v8
v_mfma_f32_16x16x32_bf16 a[40:43], v[140:143], v[104:107], a[40:43]
ds_read_b64_tr_b16 v[74:75], v5 offset:2048
v_mfma_f32_16x16x32_bf16 a[44:47], v[144:147], v[104:107], a[44:47]
v_xor_b32 v9, 0x8000, v9
v_mfma_f32_16x16x32_bf16 a[48:51], v[148:151], v[104:107], a[48:51]
ds_read_b64_tr_b16 v[76:77], v6 offset:0
buffer_load_dwordx4 v14, s[4:7], s17 offen offset:2048 lds
v_mfma_f32_16x16x32_bf16 a[52:55], v[152:155], v[104:107], a[52:55]
v_xor_b32 v10, 0x8000, v10
v_mfma_f32_16x16x32_bf16 a[56:59], v[156:159], v[104:107], a[56:59]
ds_read_b64_tr_b16 v[78:79], v6 offset:2048
v_mfma_f32_16x16x32_bf16 a[60:63], v[160:163], v[104:107], a[60:63]
v_xor_b32 v11, 0x8000, v11
v_mfma_f32_16x16x32_bf16 a[64:67], v[132:135], v[108:111], a[64:67]
ds_read_b64_tr_b16 v[80:81], v7 offset:0
v_mfma_f32_16x16x32_bf16 a[68:71], v[136:139], v[108:111], a[68:71]
v_xor_b32 v3, 0x8000, v3
v_mfma_f32_16x16x32_bf16 a[72:75], v[140:143], v[108:111], a[72:75]
ds_read_b64_tr_b16 v[82:83], v7 offset:2048
v_mfma_f32_16x16x32_bf16 a[76:79], v[144:147], v[108:111], a[76:79]
buffer_load_dwordx4 v15, s[4:7], s17 offen offset:3072 lds
v_mfma_f32_16x16x32_bf16 a[80:83], v[148:151], v[108:111], a[80:83]
ds_read_b64_tr_b16 v[84:85], v8 offset:0
v_mfma_f32_16x16x32_bf16 a[84:87], v[152:155], v[108:111], a[84:87]
s_add_u32 m0, s21, 4096
v_mfma_f32_16x16x32_bf16 a[88:91], v[156:159], v[108:111], a[88:91]
ds_read_b64_tr_b16 v[86:87], v8 offset:2048
v_mfma_f32_16x16x32_bf16 a[92:95], v[160:163], v[108:111], a[92:95]
v_mfma_f32_16x16x32_bf16 a[96:99], v[132:135], v[112:115], a[96:99]
ds_read_b64_tr_b16 v[88:89], v9 offset:0
v_mfma_f32_16x16x32_bf16 a[100:103], v[136:139], v[112:115], a[100:103]
buffer_load_dwordx4 v16, s[4:7], s17 offen offset:0 lds
v_mfma_f32_16x16x32_bf16 a[104:107], v[140:143], v[112:115], a[104:107]
ds_read_b64_tr_b16 v[90:91], v9 offset:2048
v_mfma_f32_16x16x32_bf16 a[108:111], v[144:147], v[112:115], a[108:111]
v_mfma_f32_16x16x32_bf16 a[112:115], v[148:151], v[112:115], a[112:115]
ds_read_b64_tr_b16 v[92:93], v10 offset:0
v_mfma_f32_16x16x32_bf16 a[116:119], v[152:155], v[112:115], a[116:119]
v_mfma_f32_16x16x32_bf16 a[120:123], v[156:159], v[112:115], a[120:123]
ds_read_b64_tr_b16 v[94:95], v10 offset:2048
v_mfma_f32_16x16x32_bf16 a[124:127], v[160:163], v[112:115], a[124:127]
buffer_load_dwordx4 v17, s[4:7], s17 offen offset:1024 lds
v_mfma_f32_16x16x32_bf16 a[128:131], v[132:135], v[116:119], a[128:131]
ds_read_b64_tr_b16 v[96:97], v11 offset:0
v_mfma_f32_16x16x32_bf16 a[132:135], v[136:139], v[116:119], a[132:135]
v_mfma_f32_16x16x32_bf16 a[136:139], v[140:143], v[116:119], a[136:139]
ds_read_b64_tr_b16 v[98:99], v11 offset:2048
v_mfma_f32_16x16x32_bf16 a[140:143], v[144:147], v[116:119], a[140:143]
v_mfma_f32_16x16x32_bf16 a[144:147], v[148:151], v[116:119], a[144:147]
ds_read_b128 v[40:43], v2 offset:2048
v_mfma_f32_16x16x32_bf16 a[148:151], v[152:155], v[116:119], a[148:151]
buffer_load_dwordx4 v18, s[4:7], s17 offen offset:2048 lds
v_mfma_f32_16x16x32_bf16 a[152:155], v[156:159], v[116:119], a[152:155]
ds_read_b128 v[44:47], v2 offset:4096
v_mfma_f32_16x16x32_bf16 a[156:159], v[160:163], v[116:119], a[156:159]
v_mfma_f32_16x16x32_bf16 a[160:163], v[132:135], v[120:123], a[160:163]
ds_read_b128 v[48:51], v2 offset:6144
v_mfma_f32_16x16x32_bf16 a[164:167], v[136:139], v[120:123], a[164:167]
v_mfma_f32_16x16x32_bf16 a[168:171], v[140:143], v[120:123], a[168:171]
ds_read_b128 v[52:55], v2 offset:8192
v_mfma_f32_16x16x32_bf16 a[172:175], v[144:147], v[120:123], a[172:175]
buffer_load_dwordx4 v19, s[4:7], s17 offen offset:3072 lds
v_mfma_f32_16x16x32_bf16 a[176:179], v[148:151], v[120:123], a[176:179]
ds_read_b128 v[56:59], v2 offset:10240
v_mfma_f32_16x16x32_bf16 a[180:183], v[152:155], v[120:123], a[180:183]
s_mov_b32 m0, s22
v_mfma_f32_16x16x32_bf16 a[184:187], v[156:159], v[120:123], a[184:187]
ds_read_b128 v[60:63], v2 offset:12288
v_mfma_f32_16x16x32_bf16 a[188:191], v[160:163], v[120:123], a[188:191]
v_mfma_f32_16x16x32_bf16 a[192:195], v[132:135], v[124:127], a[192:195]
ds_read_b128 v[64:67], v2 offset:14336
v_mfma_f32_16x16x32_bf16 a[196:199], v[136:139], v[124:127], a[196:199]
buffer_load_dwordx4 v20, s[8:11], s18 offen offset:0 lds
v_mfma_f32_16x16x32_bf16 a[200:203], v[140:143], v[124:127], a[200:203]
v_mfma_f32_16x16x32_bf16 a[204:207], v[144:147], v[124:127], a[204:207]
v_mfma_f32_16x16x32_bf16 a[208:211], v[148:151], v[124:127], a[208:211]
v_mfma_f32_16x16x32_bf16 a[212:215], v[152:155], v[124:127], a[212:215]
v_mfma_f32_16x16x32_bf16 a[216:219], v[156:159], v[124:127], a[216:219]
v_mfma_f32_16x16x32_bf16 a[220:223], v[160:163], v[124:127], a[220:223]
buffer_load_dwordx4 v21, s[8:11], s18 offen offset:1024 lds
v_mfma_f32_16x16x32_bf16 a[224:227], v[132:135], v[128:131], a[224:227]
v_mfma_f32_16x16x32_bf16 a[228:231], v[136:139], v[128:131], a[228:231]
v_mfma_f32_16x16x32_bf16 a[232:235], v[140:143], v[128:131], a[232:235]
v_mfma_f32_16x16x32_bf16 a[236:239], v[144:147], v[128:131], a[236:239]
v_mfma_f32_16x16x32_bf16 a[240:243], v[148:151], v[128:131], a[240:243]
v_mfma_f32_16x16x32_bf16 a[244:247], v[152:155], v[128:131], a[244:247]
buffer_load_dwordx4 v22, s[8:11], s18 offen offset:2048 lds
v_mfma_f32_16x16x32_bf16 a[248:251], v[156:159], v[128:131], a[248:251]
s_sub_u32 s20, s20, 1
v_mfma_f32_16x16x32_bf16 a[252:255], v[160:163], v[128:131], a[252:255]
s_cmp_lg_u32 s20, 0
s_cbranch_scc1 L_f_loop_1_2
s_branch L_f_kvdone
L_f_go_1_3:
s_waitcnt lgkmcnt(0)
v_mfma_f32_16x16x32_bf16 a[0:3], v[68:71], v[36:39], 0
ds_read_b128 v[100:103], v3 offset:0
v_mfma_f32_16x16x32_bf16 a[4:7], v[72:75], v[36:39], 0
s_cmp_ge_u32 s2, 128
s_cselect_b32 s80, s48, s42
s_cselect_b32 s81, s49, s43
s_mov_b32 s62, 401408
s_cselect_b32 s82, s62, 3670016
s_mov_b32 s83, 0x20000
v_mfma_f32_16x16x32_bf16 a[8:11], v[76:79], v[36:39], 0
ds_read_b64_tr_b16 v[132:133], v4 offset:16384
v_mfma_f32_16x16x32_bf16 a[12:15], v[80:83], v[36:39], 0
s_sub_u32 s61, s2, 128
s_cselect_b32 s61, s61, s61
s_cmp_ge_u32 s2, 128
s_cselect_b32 s61, s61, s2
s_cselect_b32 s62, 28, 32
v_mfma_f32_16x16x32_bf16 a[16:19], v[84:87], v[36:39], 0
ds_read_b64_tr_b16 v[134:135], v4 offset:18432
v_mfma_f32_16x16x32_bf16 a[20:23], v[88:91], v[36:39], 0
s_mul_i32 s62, s62, s61
s_mul_i32 s62, s62, 896
v_mfma_f32_16x16x32_bf16 a[24:27], v[92:95], v[36:39], 0
ds_read_b64_tr_b16 v[136:137], v5 offset:16384
v_mfma_f32_16x16x32_bf16 a[28:31], v[96:99], v[36:39], 0
s_lshl_b32 s90, s61, 10
s_cmp_ge_u32 s2, 128
s_mov_b32 s63, 79691776
s_cselect_b32 s63, s63, 75497472
v_mfma_f32_16x16x32_bf16 a[32:35], v[68:71], v[40:43], 0
ds_read_b64_tr_b16 v[138:139], v5 offset:18432
v_mfma_f32_16x16x32_bf16 a[36:39], v[72:75], v[40:43], 0
s_add_u32 s90, s90, s63
s_cmp_ge_u32 s2, 128
s_mov_b32 s63, 16384
s_cselect_b32 s100, s63, 131072
v_mfma_f32_16x16x32_bf16 a[40:43], v[76:79], v[40:43], 0
ds_read_b64_tr_b16 v[140:141], v6 offset:16384
v_mfma_f32_16x16x32_bf16 a[44:47], v[80:83], v[40:43], 0
s_cmp_ge_u32 s2, 144
s_cselect_b32 s62, s30, s62
s_cselect_b32 s90, s30, s90
s_cselect_b32 s100, 0, s100
s_mul_i32 s63, s16, 7168
v_mfma_f32_16x16x32_bf16 a[48:51], v[84:87], v[40:43], 0
ds_read_b64_tr_b16 v[142:143], v6 offset:18432
v_mfma_f32_16x16x32_bf16 a[52:55], v[88:91], v[40:43], 0
s_add_u32 s62, s62, s63
s_add_u32 s63, s63, 131072
v_mfma_f32_16x16x32_bf16 a[56:59], v[92:95], v[40:43], 0
ds_read_b64_tr_b16 v[144:145], v7 offset:16384
v_mfma_f32_16x16x32_bf16 a[60:63], v[96:99], v[40:43], 0
s_add_u32 m0, s63, 0
s_add_u32 s61, s62, 0
buffer_load_dwordx4 v1, s[80:83], s61 offen lds
s_add_u32 m0, s63, 1024
s_add_u32 s61, s62, 1024
buffer_load_dwordx4 v1, s[80:83], s61 offen lds
v_mfma_f32_16x16x32_bf16 a[64:67], v[68:71], v[44:47], 0
ds_read_b64_tr_b16 v[146:147], v7 offset:18432
v_mfma_f32_16x16x32_bf16 a[68:71], v[72:75], v[44:47], 0
s_add_u32 m0, s63, 2048
s_add_u32 s61, s62, 2048
buffer_load_dwordx4 v1, s[80:83], s61 offen lds
s_add_u32 m0, s63, 3072
s_add_u32 s61, s62, 3072
buffer_load_dwordx4 v1, s[80:83], s61 offen lds
v_mfma_f32_16x16x32_bf16 a[72:75], v[76:79], v[44:47], 0
ds_read_b64_tr_b16 v[148:149], v8 offset:16384
v_mfma_f32_16x16x32_bf16 a[76:79], v[80:83], v[44:47], 0
s_add_u32 m0, s63, 4096
s_add_u32 s61, s62, 4096
buffer_load_dwordx4 v1, s[80:83], s61 offen lds
s_add_u32 m0, s63, 5120
s_add_u32 s61, s62, 5120
buffer_load_dwordx4 v1, s[80:83], s61 offen lds
v_mfma_f32_16x16x32_bf16 a[80:83], v[84:87], v[44:47], 0
ds_read_b64_tr_b16 v[150:151], v8 offset:18432
v_mfma_f32_16x16x32_bf16 a[84:87], v[88:91], v[44:47], 0
s_add_u32 m0, s63, 6144
s_add_u32 s61, s62, 6144
buffer_load_dwordx4 v1, s[80:83], s61 offen lds
v_and_b32 v28, 63, v0
v_mfma_f32_16x16x32_bf16 a[88:91], v[92:95], v[44:47], 0
ds_read_b64_tr_b16 v[152:153], v9 offset:16384
v_mfma_f32_16x16x32_bf16 a[92:95], v[96:99], v[44:47], 0
v_and_b32 v29, 15, v28
v_lshrrev_b32 v30, 4, v28
v_mfma_f32_16x16x32_bf16 a[96:99], v[68:71], v[48:51], 0
ds_read_b64_tr_b16 v[154:155], v9 offset:18432
v_mfma_f32_16x16x32_bf16 a[100:103], v[72:75], v[48:51], 0
v_bfe_u32 v31, v28, 2, 2
v_and_b32 v32, 3, v28
v_mfma_f32_16x16x32_bf16 a[104:107], v[76:79], v[48:51], 0
ds_read_b64_tr_b16 v[156:157], v10 offset:16384
v_mfma_f32_16x16x32_bf16 a[108:111], v[80:83], v[48:51], 0
v_lshl_add_u32 v33, v30, 2, v31
v_mul_u32_u24 v33, 896, v33
v_mfma_f32_16x16x32_bf16 a[112:115], v[84:87], v[48:51], 0
ds_read_b64_tr_b16 v[158:159], v10 offset:18432
v_mfma_f32_16x16x32_bf16 a[116:119], v[88:91], v[48:51], 0
v_lshl_add_u32 v33, v32, 3, v33
s_mul_i32 s62, s16, 224
v_mfma_f32_16x16x32_bf16 a[120:123], v[92:95], v[48:51], 0
ds_read_b64_tr_b16 v[160:161], v11 offset:16384
v_mfma_f32_16x16x32_bf16 a[124:127], v[96:99], v[48:51], 0
s_mov_b32 s85, 7736
v_mfma_f32_16x16x32_bf16 a[128:131], v[68:71], v[52:55], 0
ds_read_b64_tr_b16 v[162:163], v11 offset:18432
v_mfma_f32_16x16x32_bf16 a[132:135], v[72:75], v[52:55], 0
s_bitcmp1_b32 s85, s20
s_cbranch_scc1 L_k1_gr_1_3_1_0
buffer_load_dword v241, v240, s[4:7], 0 offen
s_branch L_k1_gd_1_3_1_0
L_k1_gr_1_3_1_0:
global_load_dword v241, v[242:243], off
v_mov_b32 v242, v244
v_mov_b32 v243, v245
v_mov_b32 v244, v246
v_mov_b32 v245, v247
v_mov_b32 v246, v248
v_mov_b32 v247, v249
L_k1_gd_1_3_1_0:
v_mfma_f32_16x16x32_bf16 a[136:139], v[76:79], v[52:55], 0
ds_read_b128 v[104:107], v3 offset:2048
v_mfma_f32_16x16x32_bf16 a[140:143], v[80:83], v[52:55], 0
s_add_u32 s62, s62, 131072
v_add_u32 v178, s62, v33
v_mfma_f32_16x16x32_bf16 a[144:147], v[84:87], v[52:55], 0
ds_read_b128 v[108:111], v3 offset:4096
v_mfma_f32_16x16x32_bf16 a[148:151], v[88:91], v[52:55], 0
v_mfma_f32_16x16x32_bf16 a[152:155], v[92:95], v[52:55], 0
ds_read_b128 v[112:115], v3 offset:6144
v_mfma_f32_16x16x32_bf16 a[156:159], v[96:99], v[52:55], 0
v_mfma_f32_16x16x32_bf16 a[160:163], v[68:71], v[56:59], 0
ds_read_b128 v[116:119], v3 offset:8192
v_mfma_f32_16x16x32_bf16 a[164:167], v[72:75], v[56:59], 0
v_mfma_f32_16x16x32_bf16 a[168:171], v[76:79], v[56:59], 0
ds_read_b128 v[120:123], v3 offset:10240
v_mfma_f32_16x16x32_bf16 a[172:175], v[80:83], v[56:59], 0
v_mfma_f32_16x16x32_bf16 a[176:179], v[84:87], v[56:59], 0
ds_read_b128 v[124:127], v3 offset:12288
v_mfma_f32_16x16x32_bf16 a[180:183], v[88:91], v[56:59], 0
v_mfma_f32_16x16x32_bf16 a[184:187], v[92:95], v[56:59], 0
ds_read_b128 v[128:131], v3 offset:14336
v_mfma_f32_16x16x32_bf16 a[188:191], v[96:99], v[56:59], 0
v_mfma_f32_16x16x32_bf16 a[192:195], v[68:71], v[60:63], 0
v_mfma_f32_16x16x32_bf16 a[196:199], v[72:75], v[60:63], 0
v_mfma_f32_16x16x32_bf16 a[200:203], v[76:79], v[60:63], 0
v_mfma_f32_16x16x32_bf16 a[204:207], v[80:83], v[60:63], 0
v_mfma_f32_16x16x32_bf16 a[208:211], v[84:87], v[60:63], 0
v_mfma_f32_16x16x32_bf16 a[212:215], v[88:91], v[60:63], 0
v_mfma_f32_16x16x32_bf16 a[216:219], v[92:95], v[60:63], 0
v_mfma_f32_16x16x32_bf16 a[220:223], v[96:99], v[60:63], 0
v_mfma_f32_16x16x32_bf16 a[224:227], v[68:71], v[64:67], 0
v_mfma_f32_16x16x32_bf16 a[228:231], v[72:75], v[64:67], 0
s_waitcnt vmcnt(11) lgkmcnt(0)
s_barrier
s_nop 5
v_mfma_f32_16x16x32_bf16 a[232:235], v[76:79], v[64:67], 0
s_add_u32 s27, s27, 128
s_add_u32 s28, s28, s19
v_mfma_f32_16x16x32_bf16 a[236:239], v[80:83], v[64:67], 0
s_sub_u32 s70, s70, 1
s_cmp_gt_i32 s70, 0
v_mfma_f32_16x16x32_bf16 a[240:243], v[84:87], v[64:67], 0
s_cselect_b32 s17, s27, s30
s_cselect_b32 s18, s28, s30
v_mfma_f32_16x16x32_bf16 a[244:247], v[88:91], v[64:67], 0
s_xor_b32 s21, s21, 0x8000
s_xor_b32 s22, s22, 0x8000
v_mfma_f32_16x16x32_bf16 a[248:251], v[92:95], v[64:67], 0
s_mov_b32 m0, s21
v_mfma_f32_16x16x32_bf16 a[252:255], v[96:99], v[64:67], 0
s_waitcnt lgkmcnt(0)
v_mfma_f32_16x16x32_bf16 a[0:3], v[132:135], v[100:103], a[0:3]
v_xor_b32 v2, 0x8000, v2
buffer_load_dwordx4 v12, s[4:7], s17 offen offset:0 lds
v_mfma_f32_16x16x32_bf16 a[4:7], v[136:139], v[100:103], a[4:7]
v_xor_b32 v4, 0x8000, v4
v_mfma_f32_16x16x32_bf16 a[8:11], v[140:143], v[100:103], a[8:11]
ds_read_b128 v[36:39], v2 offset:0
v_mfma_f32_16x16x32_bf16 a[12:15], v[144:147], v[100:103], a[12:15]
v_xor_b32 v5, 0x8000, v5
v_mfma_f32_16x16x32_bf16 a[16:19], v[148:151], v[100:103], a[16:19]
ds_read_b64_tr_b16 v[68:69], v4 offset:0
v_mfma_f32_16x16x32_bf16 a[20:23], v[152:155], v[100:103], a[20:23]
v_xor_b32 v6, 0x8000, v6
v_mfma_f32_16x16x32_bf16 a[24:27], v[156:159], v[100:103], a[24:27]
ds_read_b64_tr_b16 v[70:71], v4 offset:2048
buffer_load_dwordx4 v13, s[4:7], s17 offen offset:1024 lds
v_mfma_f32_16x16x32_bf16 a[28:31], v[160:163], v[100:103], a[28:31]
v_xor_b32 v7, 0x8000, v7
v_mfma_f32_16x16x32_bf16 a[32:35], v[132:135], v[104:107], a[32:35]
ds_read_b64_tr_b16 v[72:73], v5 offset:0
v_mfma_f32_16x16x32_bf16 a[36:39], v[136:139], v[104:107], a[36:39]
v_xor_b32 v8, 0x8000, v8
v_mfma_f32_16x16x32_bf16 a[40:43], v[140:143], v[104:107], a[40:43]
ds_read_b64_tr_b16 v[74:75], v5 offset:2048
v_mfma_f32_16x16x32_bf16 a[44:47], v[144:147], v[104:107], a[44:47]
v_xor_b32 v9, 0x8000, v9
v_mfma_f32_16x16x32_bf16 a[48:51], v[148:151], v[104:107], a[48:51]
ds_read_b64_tr_b16 v[76:77], v6 offset:0
buffer_load_dwordx4 v14, s[4:7], s17 offen offset:2048 lds
v_mfma_f32_16x16x32_bf16 a[52:55], v[152:155], v[104:107], a[52:55]
v_xor_b32 v10, 0x8000, v10
v_mfma_f32_16x16x32_bf16 a[56:59], v[156:159], v[104:107], a[56:59]
ds_read_b64_tr_b16 v[78:79], v6 offset:2048
v_mfma_f32_16x16x32_bf16 a[60:63], v[160:163], v[104:107], a[60:63]
v_xor_b32 v11, 0x8000, v11
v_mfma_f32_16x16x32_bf16 a[64:67], v[132:135], v[108:111], a[64:67]
ds_read_b64_tr_b16 v[80:81], v7 offset:0
v_mfma_f32_16x16x32_bf16 a[68:71], v[136:139], v[108:111], a[68:71]
v_xor_b32 v3, 0x8000, v3
v_mfma_f32_16x16x32_bf16 a[72:75], v[140:143], v[108:111], a[72:75]
ds_read_b64_tr_b16 v[82:83], v7 offset:2048
v_mfma_f32_16x16x32_bf16 a[76:79], v[144:147], v[108:111], a[76:79]
buffer_load_dwordx4 v15, s[4:7], s17 offen offset:3072 lds
v_mfma_f32_16x16x32_bf16 a[80:83], v[148:151], v[108:111], a[80:83]
ds_read_b64_tr_b16 v[84:85], v8 offset:0
v_mfma_f32_16x16x32_bf16 a[84:87], v[152:155], v[108:111], a[84:87]
s_add_u32 m0, s21, 4096
v_mfma_f32_16x16x32_bf16 a[88:91], v[156:159], v[108:111], a[88:91]
ds_read_b64_tr_b16 v[86:87], v8 offset:2048
v_mfma_f32_16x16x32_bf16 a[92:95], v[160:163], v[108:111], a[92:95]
v_mfma_f32_16x16x32_bf16 a[96:99], v[132:135], v[112:115], a[96:99]
ds_read_b64_tr_b16 v[88:89], v9 offset:0
v_mfma_f32_16x16x32_bf16 a[100:103], v[136:139], v[112:115], a[100:103]
buffer_load_dwordx4 v16, s[4:7], s17 offen offset:0 lds
v_mfma_f32_16x16x32_bf16 a[104:107], v[140:143], v[112:115], a[104:107]
ds_read_b64_tr_b16 v[90:91], v9 offset:2048
v_mfma_f32_16x16x32_bf16 a[108:111], v[144:147], v[112:115], a[108:111]
v_mfma_f32_16x16x32_bf16 a[112:115], v[148:151], v[112:115], a[112:115]
ds_read_b64_tr_b16 v[92:93], v10 offset:0
v_mfma_f32_16x16x32_bf16 a[116:119], v[152:155], v[112:115], a[116:119]
v_mfma_f32_16x16x32_bf16 a[120:123], v[156:159], v[112:115], a[120:123]
ds_read_b64_tr_b16 v[94:95], v10 offset:2048
v_mfma_f32_16x16x32_bf16 a[124:127], v[160:163], v[112:115], a[124:127]
buffer_load_dwordx4 v17, s[4:7], s17 offen offset:1024 lds
v_mfma_f32_16x16x32_bf16 a[128:131], v[132:135], v[116:119], a[128:131]
ds_read_b64_tr_b16 v[96:97], v11 offset:0
v_mfma_f32_16x16x32_bf16 a[132:135], v[136:139], v[116:119], a[132:135]
v_mfma_f32_16x16x32_bf16 a[136:139], v[140:143], v[116:119], a[136:139]
ds_read_b64_tr_b16 v[98:99], v11 offset:2048
v_mfma_f32_16x16x32_bf16 a[140:143], v[144:147], v[116:119], a[140:143]
v_mfma_f32_16x16x32_bf16 a[144:147], v[148:151], v[116:119], a[144:147]
ds_read_b128 v[40:43], v2 offset:2048
v_mfma_f32_16x16x32_bf16 a[148:151], v[152:155], v[116:119], a[148:151]
buffer_load_dwordx4 v18, s[4:7], s17 offen offset:2048 lds
v_mfma_f32_16x16x32_bf16 a[152:155], v[156:159], v[116:119], a[152:155]
ds_read_b128 v[44:47], v2 offset:4096
v_mfma_f32_16x16x32_bf16 a[156:159], v[160:163], v[116:119], a[156:159]
v_mfma_f32_16x16x32_bf16 a[160:163], v[132:135], v[120:123], a[160:163]
ds_read_b128 v[48:51], v2 offset:6144
v_mfma_f32_16x16x32_bf16 a[164:167], v[136:139], v[120:123], a[164:167]
v_mfma_f32_16x16x32_bf16 a[168:171], v[140:143], v[120:123], a[168:171]
ds_read_b128 v[52:55], v2 offset:8192
v_mfma_f32_16x16x32_bf16 a[172:175], v[144:147], v[120:123], a[172:175]
buffer_load_dwordx4 v19, s[4:7], s17 offen offset:3072 lds
v_mfma_f32_16x16x32_bf16 a[176:179], v[148:151], v[120:123], a[176:179]
ds_read_b128 v[56:59], v2 offset:10240
v_mfma_f32_16x16x32_bf16 a[180:183], v[152:155], v[120:123], a[180:183]
s_mov_b32 m0, s22
v_mfma_f32_16x16x32_bf16 a[184:187], v[156:159], v[120:123], a[184:187]
ds_read_b128 v[60:63], v2 offset:12288
v_mfma_f32_16x16x32_bf16 a[188:191], v[160:163], v[120:123], a[188:191]
v_mfma_f32_16x16x32_bf16 a[192:195], v[132:135], v[124:127], a[192:195]
ds_read_b128 v[64:67], v2 offset:14336
v_mfma_f32_16x16x32_bf16 a[196:199], v[136:139], v[124:127], a[196:199]
buffer_load_dwordx4 v20, s[8:11], s18 offen offset:0 lds
v_mfma_f32_16x16x32_bf16 a[200:203], v[140:143], v[124:127], a[200:203]
v_mfma_f32_16x16x32_bf16 a[204:207], v[144:147], v[124:127], a[204:207]
v_mfma_f32_16x16x32_bf16 a[208:211], v[148:151], v[124:127], a[208:211]
v_mfma_f32_16x16x32_bf16 a[212:215], v[152:155], v[124:127], a[212:215]
v_mfma_f32_16x16x32_bf16 a[216:219], v[156:159], v[124:127], a[216:219]
v_mfma_f32_16x16x32_bf16 a[220:223], v[160:163], v[124:127], a[220:223]
buffer_load_dwordx4 v21, s[8:11], s18 offen offset:1024 lds
v_mfma_f32_16x16x32_bf16 a[224:227], v[132:135], v[128:131], a[224:227]
v_mfma_f32_16x16x32_bf16 a[228:231], v[136:139], v[128:131], a[228:231]
v_mfma_f32_16x16x32_bf16 a[232:235], v[140:143], v[128:131], a[232:235]
v_mfma_f32_16x16x32_bf16 a[236:239], v[144:147], v[128:131], a[236:239]
v_mfma_f32_16x16x32_bf16 a[240:243], v[148:151], v[128:131], a[240:243]
v_mfma_f32_16x16x32_bf16 a[244:247], v[152:155], v[128:131], a[244:247]
buffer_load_dwordx4 v22, s[8:11], s18 offen offset:2048 lds
v_mfma_f32_16x16x32_bf16 a[248:251], v[156:159], v[128:131], a[248:251]
s_sub_u32 s20, s20, 1
v_mfma_f32_16x16x32_bf16 a[252:255], v[160:163], v[128:131], a[252:255]
s_cmp_lg_u32 s20, 0
.p2align 6
L_f_loop_1_3:
s_waitcnt lgkmcnt(0)
v_mfma_f32_16x16x32_bf16 a[0:3], v[68:71], v[36:39], a[0:3]
ds_read_b128 v[100:103], v3 offset:0
v_mfma_f32_16x16x32_bf16 a[4:7], v[72:75], v[36:39], a[4:7]
v_mfma_f32_16x16x32_bf16 a[8:11], v[76:79], v[36:39], a[8:11]
ds_read_b64_tr_b16 v[132:133], v4 offset:16384
v_mfma_f32_16x16x32_bf16 a[12:15], v[80:83], v[36:39], a[12:15]
buffer_load_dwordx4 v23, s[8:11], s18 offen offset:3072 lds
v_mfma_f32_16x16x32_bf16 a[16:19], v[84:87], v[36:39], a[16:19]
ds_read_b64_tr_b16 v[134:135], v4 offset:18432
v_mfma_f32_16x16x32_bf16 a[20:23], v[88:91], v[36:39], a[20:23]
s_add_u32 m0, s22, 4096
v_mfma_f32_16x16x32_bf16 a[24:27], v[92:95], v[36:39], a[24:27]
ds_read_b64_tr_b16 v[136:137], v5 offset:16384
v_mfma_f32_16x16x32_bf16 a[28:31], v[96:99], v[36:39], a[28:31]
v_mfma_f32_16x16x32_bf16 a[32:35], v[68:71], v[40:43], a[32:35]
ds_read_b64_tr_b16 v[138:139], v5 offset:18432
v_mfma_f32_16x16x32_bf16 a[36:39], v[72:75], v[40:43], a[36:39]
buffer_load_dwordx4 v24, s[8:11], s18 offen offset:0 lds
v_mfma_f32_16x16x32_bf16 a[40:43], v[76:79], v[40:43], a[40:43]
ds_read_b64_tr_b16 v[140:141], v6 offset:16384
v_mfma_f32_16x16x32_bf16 a[44:47], v[80:83], v[40:43], a[44:47]
v_mfma_f32_16x16x32_bf16 a[48:51], v[84:87], v[40:43], a[48:51]
ds_read_b64_tr_b16 v[142:143], v6 offset:18432
v_mfma_f32_16x16x32_bf16 a[52:55], v[88:91], v[40:43], a[52:55]
v_mfma_f32_16x16x32_bf16 a[56:59], v[92:95], v[40:43], a[56:59]
ds_read_b64_tr_b16 v[144:145], v7 offset:16384
v_mfma_f32_16x16x32_bf16 a[60:63], v[96:99], v[40:43], a[60:63]
buffer_load_dwordx4 v25, s[8:11], s18 offen offset:1024 lds
v_mfma_f32_16x16x32_bf16 a[64:67], v[68:71], v[44:47], a[64:67]
ds_read_b64_tr_b16 v[146:147], v7 offset:18432
v_mfma_f32_16x16x32_bf16 a[68:71], v[72:75], v[44:47], a[68:71]
v_mfma_f32_16x16x32_bf16 a[72:75], v[76:79], v[44:47], a[72:75]
ds_read_b64_tr_b16 v[148:149], v8 offset:16384
v_mfma_f32_16x16x32_bf16 a[76:79], v[80:83], v[44:47], a[76:79]
v_mfma_f32_16x16x32_bf16 a[80:83], v[84:87], v[44:47], a[80:83]
ds_read_b64_tr_b16 v[150:151], v8 offset:18432
v_mfma_f32_16x16x32_bf16 a[84:87], v[88:91], v[44:47], a[84:87]
buffer_load_dwordx4 v26, s[8:11], s18 offen offset:2048 lds
v_mfma_f32_16x16x32_bf16 a[88:91], v[92:95], v[44:47], a[88:91]
ds_read_b64_tr_b16 v[152:153], v9 offset:16384
v_mfma_f32_16x16x32_bf16 a[92:95], v[96:99], v[44:47], a[92:95]
v_mfma_f32_16x16x32_bf16 a[96:99], v[68:71], v[48:51], a[96:99]
ds_read_b64_tr_b16 v[154:155], v9 offset:18432
v_mfma_f32_16x16x32_bf16 a[100:103], v[72:75], v[48:51], a[100:103]
v_mfma_f32_16x16x32_bf16 a[104:107], v[76:79], v[48:51], a[104:107]
ds_read_b64_tr_b16 v[156:157], v10 offset:16384
v_mfma_f32_16x16x32_bf16 a[108:111], v[80:83], v[48:51], a[108:111]
buffer_load_dwordx4 v27, s[8:11], s18 offen offset:3072 lds
v_mfma_f32_16x16x32_bf16 a[112:115], v[84:87], v[48:51], a[112:115]
ds_read_b64_tr_b16 v[158:159], v10 offset:18432
v_mfma_f32_16x16x32_bf16 a[116:119], v[88:91], v[48:51], a[116:119]
v_mfma_f32_16x16x32_bf16 a[120:123], v[92:95], v[48:51], a[120:123]
ds_read_b64_tr_b16 v[160:161], v11 offset:16384
v_mfma_f32_16x16x32_bf16 a[124:127], v[96:99], v[48:51], a[124:127]
s_mov_b32 s85, 7736
v_mfma_f32_16x16x32_bf16 a[128:131], v[68:71], v[52:55], a[128:131]
ds_read_b64_tr_b16 v[162:163], v11 offset:18432
v_mfma_f32_16x16x32_bf16 a[132:135], v[72:75], v[52:55], a[132:135]
s_bitcmp1_b32 s85, s20
s_cbranch_scc1 L_k1_gr_1_3_0_0
buffer_load_dword v241, v240, s[4:7], 0 offen
s_branch L_k1_gd_1_3_0_0
L_k1_gr_1_3_0_0:
global_load_dword v241, v[242:243], off
v_mov_b32 v242, v244
v_mov_b32 v243, v245
v_mov_b32 v244, v246
v_mov_b32 v245, v247
v_mov_b32 v246, v248
v_mov_b32 v247, v249
L_k1_gd_1_3_0_0:
v_mfma_f32_16x16x32_bf16 a[136:139], v[76:79], v[52:55], a[136:139]
ds_read_b128 v[104:107], v3 offset:2048
v_mfma_f32_16x16x32_bf16 a[140:143], v[80:83], v[52:55], a[140:143]
v_mfma_f32_16x16x32_bf16 a[144:147], v[84:87], v[52:55], a[144:147]
ds_read_b128 v[108:111], v3 offset:4096
v_mfma_f32_16x16x32_bf16 a[148:151], v[88:91], v[52:55], a[148:151]
s_cmp_eq_u32 s20, 7
s_cbranch_scc1 L_f_loc_1_3_0
L_f_locret_1_3_0:
v_mfma_f32_16x16x32_bf16 a[152:155], v[92:95], v[52:55], a[152:155]
ds_read_b128 v[112:115], v3 offset:6144
v_mfma_f32_16x16x32_bf16 a[156:159], v[96:99], v[52:55], a[156:159]
v_mfma_f32_16x16x32_bf16 a[160:163], v[68:71], v[56:59], a[160:163]
ds_read_b128 v[116:119], v3 offset:8192
v_mfma_f32_16x16x32_bf16 a[164:167], v[72:75], v[56:59], a[164:167]
v_mfma_f32_16x16x32_bf16 a[168:171], v[76:79], v[56:59], a[168:171]
ds_read_b128 v[120:123], v3 offset:10240
v_mfma_f32_16x16x32_bf16 a[172:175], v[80:83], v[56:59], a[172:175]
v_mfma_f32_16x16x32_bf16 a[176:179], v[84:87], v[56:59], a[176:179]
ds_read_b128 v[124:127], v3 offset:12288
v_mfma_f32_16x16x32_bf16 a[180:183], v[88:91], v[56:59], a[180:183]
v_mfma_f32_16x16x32_bf16 a[184:187], v[92:95], v[56:59], a[184:187]
ds_read_b128 v[128:131], v3 offset:14336
v_mfma_f32_16x16x32_bf16 a[188:191], v[96:99], v[56:59], a[188:191]
v_mfma_f32_16x16x32_bf16 a[192:195], v[68:71], v[60:63], a[192:195]
v_mfma_f32_16x16x32_bf16 a[196:199], v[72:75], v[60:63], a[196:199]
v_mfma_f32_16x16x32_bf16 a[200:203], v[76:79], v[60:63], a[200:203]
v_mfma_f32_16x16x32_bf16 a[204:207], v[80:83], v[60:63], a[204:207]
v_mfma_f32_16x16x32_bf16 a[208:211], v[84:87], v[60:63], a[208:211]
v_mfma_f32_16x16x32_bf16 a[212:215], v[88:91], v[60:63], a[212:215]
v_mfma_f32_16x16x32_bf16 a[216:219], v[92:95], v[60:63], a[216:219]
v_mfma_f32_16x16x32_bf16 a[220:223], v[96:99], v[60:63], a[220:223]
v_mfma_f32_16x16x32_bf16 a[224:227], v[68:71], v[64:67], a[224:227]
v_mfma_f32_16x16x32_bf16 a[228:231], v[72:75], v[64:67], a[228:231]
s_waitcnt vmcnt(1) lgkmcnt(0)
s_barrier
s_nop 5
v_mfma_f32_16x16x32_bf16 a[232:235], v[76:79], v[64:67], a[232:235]
s_add_u32 s27, s27, 128
s_add_u32 s28, s28, s19
v_mfma_f32_16x16x32_bf16 a[236:239], v[80:83], v[64:67], a[236:239]
s_sub_u32 s70, s70, 1
s_cmp_gt_i32 s70, 0
v_mfma_f32_16x16x32_bf16 a[240:243], v[84:87], v[64:67], a[240:243]
s_cselect_b32 s17, s27, s30
s_cselect_b32 s18, s28, s30
v_mfma_f32_16x16x32_bf16 a[244:247], v[88:91], v[64:67], a[244:247]
s_xor_b32 s21, s21, 0x8000
s_xor_b32 s22, s22, 0x8000
v_mfma_f32_16x16x32_bf16 a[248:251], v[92:95], v[64:67], a[248:251]
s_mov_b32 m0, s21
v_mfma_f32_16x16x32_bf16 a[252:255], v[96:99], v[64:67], a[252:255]
s_waitcnt lgkmcnt(0)
v_mfma_f32_16x16x32_bf16 a[0:3], v[132:135], v[100:103], a[0:3]
v_xor_b32 v2, 0x8000, v2
buffer_load_dwordx4 v12, s[4:7], s17 offen offset:0 lds
v_mfma_f32_16x16x32_bf16 a[4:7], v[136:139], v[100:103], a[4:7]
v_xor_b32 v4, 0x8000, v4
v_mfma_f32_16x16x32_bf16 a[8:11], v[140:143], v[100:103], a[8:11]
ds_read_b128 v[36:39], v2 offset:0
v_mfma_f32_16x16x32_bf16 a[12:15], v[144:147], v[100:103], a[12:15]
v_xor_b32 v5, 0x8000, v5
v_mfma_f32_16x16x32_bf16 a[16:19], v[148:151], v[100:103], a[16:19]
ds_read_b64_tr_b16 v[68:69], v4 offset:0
v_mfma_f32_16x16x32_bf16 a[20:23], v[152:155], v[100:103], a[20:23]
v_xor_b32 v6, 0x8000, v6
v_mfma_f32_16x16x32_bf16 a[24:27], v[156:159], v[100:103], a[24:27]
ds_read_b64_tr_b16 v[70:71], v4 offset:2048
buffer_load_dwordx4 v13, s[4:7], s17 offen offset:1024 lds
v_mfma_f32_16x16x32_bf16 a[28:31], v[160:163], v[100:103], a[28:31]
v_xor_b32 v7, 0x8000, v7
v_mfma_f32_16x16x32_bf16 a[32:35], v[132:135], v[104:107], a[32:35]
ds_read_b64_tr_b16 v[72:73], v5 offset:0
v_mfma_f32_16x16x32_bf16 a[36:39], v[136:139], v[104:107], a[36:39]
v_xor_b32 v8, 0x8000, v8
v_mfma_f32_16x16x32_bf16 a[40:43], v[140:143], v[104:107], a[40:43]
ds_read_b64_tr_b16 v[74:75], v5 offset:2048
v_mfma_f32_16x16x32_bf16 a[44:47], v[144:147], v[104:107], a[44:47]
v_xor_b32 v9, 0x8000, v9
v_mfma_f32_16x16x32_bf16 a[48:51], v[148:151], v[104:107], a[48:51]
ds_read_b64_tr_b16 v[76:77], v6 offset:0
buffer_load_dwordx4 v14, s[4:7], s17 offen offset:2048 lds
v_mfma_f32_16x16x32_bf16 a[52:55], v[152:155], v[104:107], a[52:55]
v_xor_b32 v10, 0x8000, v10
v_mfma_f32_16x16x32_bf16 a[56:59], v[156:159], v[104:107], a[56:59]
ds_read_b64_tr_b16 v[78:79], v6 offset:2048
v_mfma_f32_16x16x32_bf16 a[60:63], v[160:163], v[104:107], a[60:63]
v_xor_b32 v11, 0x8000, v11
v_mfma_f32_16x16x32_bf16 a[64:67], v[132:135], v[108:111], a[64:67]
ds_read_b64_tr_b16 v[80:81], v7 offset:0
v_mfma_f32_16x16x32_bf16 a[68:71], v[136:139], v[108:111], a[68:71]
v_xor_b32 v3, 0x8000, v3
v_mfma_f32_16x16x32_bf16 a[72:75], v[140:143], v[108:111], a[72:75]
ds_read_b64_tr_b16 v[82:83], v7 offset:2048
v_mfma_f32_16x16x32_bf16 a[76:79], v[144:147], v[108:111], a[76:79]
buffer_load_dwordx4 v15, s[4:7], s17 offen offset:3072 lds
v_mfma_f32_16x16x32_bf16 a[80:83], v[148:151], v[108:111], a[80:83]
ds_read_b64_tr_b16 v[84:85], v8 offset:0
v_mfma_f32_16x16x32_bf16 a[84:87], v[152:155], v[108:111], a[84:87]
s_add_u32 m0, s21, 4096
v_mfma_f32_16x16x32_bf16 a[88:91], v[156:159], v[108:111], a[88:91]
ds_read_b64_tr_b16 v[86:87], v8 offset:2048
v_mfma_f32_16x16x32_bf16 a[92:95], v[160:163], v[108:111], a[92:95]
v_mfma_f32_16x16x32_bf16 a[96:99], v[132:135], v[112:115], a[96:99]
ds_read_b64_tr_b16 v[88:89], v9 offset:0
v_mfma_f32_16x16x32_bf16 a[100:103], v[136:139], v[112:115], a[100:103]
buffer_load_dwordx4 v16, s[4:7], s17 offen offset:0 lds
v_mfma_f32_16x16x32_bf16 a[104:107], v[140:143], v[112:115], a[104:107]
ds_read_b64_tr_b16 v[90:91], v9 offset:2048
v_mfma_f32_16x16x32_bf16 a[108:111], v[144:147], v[112:115], a[108:111]
v_mfma_f32_16x16x32_bf16 a[112:115], v[148:151], v[112:115], a[112:115]
ds_read_b64_tr_b16 v[92:93], v10 offset:0
v_mfma_f32_16x16x32_bf16 a[116:119], v[152:155], v[112:115], a[116:119]
v_mfma_f32_16x16x32_bf16 a[120:123], v[156:159], v[112:115], a[120:123]
ds_read_b64_tr_b16 v[94:95], v10 offset:2048
v_mfma_f32_16x16x32_bf16 a[124:127], v[160:163], v[112:115], a[124:127]
buffer_load_dwordx4 v17, s[4:7], s17 offen offset:1024 lds
v_mfma_f32_16x16x32_bf16 a[128:131], v[132:135], v[116:119], a[128:131]
ds_read_b64_tr_b16 v[96:97], v11 offset:0
v_mfma_f32_16x16x32_bf16 a[132:135], v[136:139], v[116:119], a[132:135]
v_mfma_f32_16x16x32_bf16 a[136:139], v[140:143], v[116:119], a[136:139]
ds_read_b64_tr_b16 v[98:99], v11 offset:2048
v_mfma_f32_16x16x32_bf16 a[140:143], v[144:147], v[116:119], a[140:143]
v_mfma_f32_16x16x32_bf16 a[144:147], v[148:151], v[116:119], a[144:147]
ds_read_b128 v[40:43], v2 offset:2048
v_mfma_f32_16x16x32_bf16 a[148:151], v[152:155], v[116:119], a[148:151]
buffer_load_dwordx4 v18, s[4:7], s17 offen offset:2048 lds
v_mfma_f32_16x16x32_bf16 a[152:155], v[156:159], v[116:119], a[152:155]
ds_read_b128 v[44:47], v2 offset:4096
v_mfma_f32_16x16x32_bf16 a[156:159], v[160:163], v[116:119], a[156:159]
v_mfma_f32_16x16x32_bf16 a[160:163], v[132:135], v[120:123], a[160:163]
ds_read_b128 v[48:51], v2 offset:6144
v_mfma_f32_16x16x32_bf16 a[164:167], v[136:139], v[120:123], a[164:167]
v_mfma_f32_16x16x32_bf16 a[168:171], v[140:143], v[120:123], a[168:171]
ds_read_b128 v[52:55], v2 offset:8192
v_mfma_f32_16x16x32_bf16 a[172:175], v[144:147], v[120:123], a[172:175]
buffer_load_dwordx4 v19, s[4:7], s17 offen offset:3072 lds
v_mfma_f32_16x16x32_bf16 a[176:179], v[148:151], v[120:123], a[176:179]
ds_read_b128 v[56:59], v2 offset:10240
v_mfma_f32_16x16x32_bf16 a[180:183], v[152:155], v[120:123], a[180:183]
s_mov_b32 m0, s22
v_mfma_f32_16x16x32_bf16 a[184:187], v[156:159], v[120:123], a[184:187]
ds_read_b128 v[60:63], v2 offset:12288
v_mfma_f32_16x16x32_bf16 a[188:191], v[160:163], v[120:123], a[188:191]
v_mfma_f32_16x16x32_bf16 a[192:195], v[132:135], v[124:127], a[192:195]
ds_read_b128 v[64:67], v2 offset:14336
v_mfma_f32_16x16x32_bf16 a[196:199], v[136:139], v[124:127], a[196:199]
buffer_load_dwordx4 v20, s[8:11], s18 offen offset:0 lds
v_mfma_f32_16x16x32_bf16 a[200:203], v[140:143], v[124:127], a[200:203]
v_mfma_f32_16x16x32_bf16 a[204:207], v[144:147], v[124:127], a[204:207]
v_mfma_f32_16x16x32_bf16 a[208:211], v[148:151], v[124:127], a[208:211]
v_mfma_f32_16x16x32_bf16 a[212:215], v[152:155], v[124:127], a[212:215]
v_mfma_f32_16x16x32_bf16 a[216:219], v[156:159], v[124:127], a[216:219]
v_mfma_f32_16x16x32_bf16 a[220:223], v[160:163], v[124:127], a[220:223]
buffer_load_dwordx4 v21, s[8:11], s18 offen offset:1024 lds
v_mfma_f32_16x16x32_bf16 a[224:227], v[132:135], v[128:131], a[224:227]
v_mfma_f32_16x16x32_bf16 a[228:231], v[136:139], v[128:131], a[228:231]
v_mfma_f32_16x16x32_bf16 a[232:235], v[140:143], v[128:131], a[232:235]
v_mfma_f32_16x16x32_bf16 a[236:239], v[144:147], v[128:131], a[236:239]
v_mfma_f32_16x16x32_bf16 a[240:243], v[148:151], v[128:131], a[240:243]
v_mfma_f32_16x16x32_bf16 a[244:247], v[152:155], v[128:131], a[244:247]
buffer_load_dwordx4 v22, s[8:11], s18 offen offset:2048 lds
v_mfma_f32_16x16x32_bf16 a[248:251], v[156:159], v[128:131], a[248:251]
s_sub_u32 s20, s20, 1
v_mfma_f32_16x16x32_bf16 a[252:255], v[160:163], v[128:131], a[252:255]
s_cmp_lg_u32 s20, 0
s_cbranch_scc1 L_f_loop_1_3
s_branch L_f_kvdone
L_f_go_0_0:
s_waitcnt lgkmcnt(0)
v_mfma_f32_16x16x32_bf16 a[0:3], v[36:39], v[68:71], 0
ds_read_b128 v[100:103], v3 offset:0
v_mfma_f32_16x16x32_bf16 a[8:11], v[36:39], v[72:75], 0
s_cmp_ge_u32 s2, 128
s_cselect_b32 s80, s48, s42
s_cselect_b32 s81, s49, s43
s_mov_b32 s62, 401408
s_cselect_b32 s82, s62, 3670016
s_mov_b32 s83, 0x20000
v_mfma_f32_16x16x32_bf16 a[16:19], v[36:39], v[76:79], 0
ds_read_b64_tr_b16 v[132:133], v4 offset:16384
v_mfma_f32_16x16x32_bf16 a[24:27], v[36:39], v[80:83], 0
s_sub_u32 s61, s2, 128
s_cselect_b32 s61, s61, s61
s_cmp_ge_u32 s2, 128
s_cselect_b32 s61, s61, s2
s_cselect_b32 s62, 28, 32
v_mfma_f32_16x16x32_bf16 a[32:35], v[36:39], v[84:87], 0
ds_read_b64_tr_b16 v[134:135], v4 offset:18432
v_mfma_f32_16x16x32_bf16 a[40:43], v[36:39], v[88:91], 0
s_mul_i32 s62, s62, s61
s_mul_i32 s62, s62, 896
v_mfma_f32_16x16x32_bf16 a[48:51], v[36:39], v[92:95], 0
ds_read_b64_tr_b16 v[136:137], v5 offset:16384
v_mfma_f32_16x16x32_bf16 a[56:59], v[36:39], v[96:99], 0
s_lshl_b32 s90, s61, 10
s_cmp_ge_u32 s2, 128
s_mov_b32 s63, 79691776
s_cselect_b32 s63, s63, 75497472
v_mfma_f32_16x16x32_bf16 a[4:7], v[40:43], v[68:71], 0
ds_read_b64_tr_b16 v[138:139], v5 offset:18432
v_mfma_f32_16x16x32_bf16 a[12:15], v[40:43], v[72:75], 0
s_add_u32 s90, s90, s63
s_cmp_ge_u32 s2, 128
s_mov_b32 s63, 16384
s_cselect_b32 s100, s63, 131072
v_mfma_f32_16x16x32_bf16 a[20:23], v[40:43], v[76:79], 0
ds_read_b64_tr_b16 v[140:141], v6 offset:16384
v_mfma_f32_16x16x32_bf16 a[28:31], v[40:43], v[80:83], 0
s_cmp_ge_u32 s2, 144
s_cselect_b32 s62, s30, s62
s_cselect_b32 s90, s30, s90
s_cselect_b32 s100, 0, s100
s_mul_i32 s63, s16, 7168
v_mfma_f32_16x16x32_bf16 a[36:39], v[40:43], v[84:87], 0
ds_read_b64_tr_b16 v[142:143], v6 offset:18432
v_mfma_f32_16x16x32_bf16 a[44:47], v[40:43], v[88:91], 0
s_add_u32 s62, s62, s63
s_add_u32 s63, s63, 131072
v_mfma_f32_16x16x32_bf16 a[52:55], v[40:43], v[92:95], 0
ds_read_b64_tr_b16 v[144:145], v7 offset:16384
v_mfma_f32_16x16x32_bf16 a[60:63], v[40:43], v[96:99], 0
s_add_u32 m0, s63, 0
s_add_u32 s61, s62, 0
buffer_load_dwordx4 v1, s[80:83], s61 offen lds
s_add_u32 m0, s63, 1024
s_add_u32 s61, s62, 1024
buffer_load_dwordx4 v1, s[80:83], s61 offen lds
v_mfma_f32_16x16x32_bf16 a[64:67], v[44:47], v[68:71], 0
ds_read_b64_tr_b16 v[146:147], v7 offset:18432
v_mfma_f32_16x16x32_bf16 a[72:75], v[44:47], v[72:75], 0
s_add_u32 m0, s63, 2048
s_add_u32 s61, s62, 2048
buffer_load_dwordx4 v1, s[80:83], s61 offen lds
s_add_u32 m0, s63, 3072
s_add_u32 s61, s62, 3072
buffer_load_dwordx4 v1, s[80:83], s61 offen lds
v_mfma_f32_16x16x32_bf16 a[80:83], v[44:47], v[76:79], 0
ds_read_b64_tr_b16 v[148:149], v8 offset:16384
v_mfma_f32_16x16x32_bf16 a[88:91], v[44:47], v[80:83], 0
s_add_u32 m0, s63, 4096
s_add_u32 s61, s62, 4096
buffer_load_dwordx4 v1, s[80:83], s61 offen lds
s_add_u32 m0, s63, 5120
s_add_u32 s61, s62, 5120
buffer_load_dwordx4 v1, s[80:83], s61 offen lds
v_mfma_f32_16x16x32_bf16 a[96:99], v[44:47], v[84:87], 0
ds_read_b64_tr_b16 v[150:151], v8 offset:18432
v_mfma_f32_16x16x32_bf16 a[104:107], v[44:47], v[88:91], 0
s_add_u32 m0, s63, 6144
s_add_u32 s61, s62, 6144
buffer_load_dwordx4 v1, s[80:83], s61 offen lds
v_and_b32 v28, 63, v0
v_mfma_f32_16x16x32_bf16 a[112:115], v[44:47], v[92:95], 0
ds_read_b64_tr_b16 v[152:153], v9 offset:16384
v_mfma_f32_16x16x32_bf16 a[120:123], v[44:47], v[96:99], 0
v_and_b32 v29, 15, v28
v_lshrrev_b32 v30, 4, v28
v_mfma_f32_16x16x32_bf16 a[68:71], v[48:51], v[68:71], 0
ds_read_b64_tr_b16 v[154:155], v9 offset:18432
v_mfma_f32_16x16x32_bf16 a[76:79], v[48:51], v[72:75], 0
v_bfe_u32 v31, v28, 2, 2
v_and_b32 v32, 3, v28
v_mfma_f32_16x16x32_bf16 a[84:87], v[48:51], v[76:79], 0
ds_read_b64_tr_b16 v[156:157], v10 offset:16384
v_mfma_f32_16x16x32_bf16 a[92:95], v[48:51], v[80:83], 0
v_lshl_add_u32 v33, v30, 2, v31
v_mul_u32_u24 v33, 896, v33
v_mfma_f32_16x16x32_bf16 a[100:103], v[48:51], v[84:87], 0
ds_read_b64_tr_b16 v[158:159], v10 offset:18432
v_mfma_f32_16x16x32_bf16 a[108:111], v[48:51], v[88:91], 0
v_lshl_add_u32 v33, v32, 3, v33
s_mul_i32 s62, s16, 224
v_mfma_f32_16x16x32_bf16 a[116:119], v[48:51], v[92:95], 0
ds_read_b64_tr_b16 v[160:161], v11 offset:16384
v_mfma_f32_16x16x32_bf16 a[124:127], v[48:51], v[96:99], 0
s_add_u32 s85, s17, 384
v_mfma_f32_16x16x32_bf16 a[128:131], v[52:55], v[68:71], 0
ds_read_b64_tr_b16 v[162:163], v11 offset:18432
v_mfma_f32_16x16x32_bf16 a[136:139], v[52:55], v[72:75], 0
buffer_load_dword v241, v240, s[4:7], s85 offen
v_mfma_f32_16x16x32_bf16 a[144:147], v[52:55], v[76:79], 0
ds_read_b128 v[104:107], v3 offset:2048
v_mfma_f32_16x16x32_bf16 a[152:155], v[52:55], v[80:83], 0
s_add_u32 s62, s62, 131072
v_add_u32 v178, s62, v33
v_mfma_f32_16x16x32_bf16 a[160:163], v[52:55], v[84:87], 0
ds_read_b128 v[108:111], v3 offset:4096
v_mfma_f32_16x16x32_bf16 a[168:171], v[52:55], v[88:91], 0
v_mfma_f32_16x16x32_bf16 a[176:179], v[52:55], v[92:95], 0
ds_read_b128 v[112:115], v3 offset:6144
v_mfma_f32_16x16x32_bf16 a[184:187], v[52:55], v[96:99], 0
v_mfma_f32_16x16x32_bf16 a[132:135], v[56:59], v[68:71], 0
ds_read_b128 v[116:119], v3 offset:8192
v_mfma_f32_16x16x32_bf16 a[140:143], v[56:59], v[72:75], 0
v_mfma_f32_16x16x32_bf16 a[148:151], v[56:59], v[76:79], 0
ds_read_b128 v[120:123], v3 offset:10240
v_mfma_f32_16x16x32_bf16 a[156:159], v[56:59], v[80:83], 0
v_mfma_f32_16x16x32_bf16 a[164:167], v[56:59], v[84:87], 0
ds_read_b128 v[124:127], v3 offset:12288
v_mfma_f32_16x16x32_bf16 a[172:175], v[56:59], v[88:91], 0
v_mfma_f32_16x16x32_bf16 a[180:183], v[56:59], v[92:95], 0
ds_read_b128 v[128:131], v3 offset:14336
v_mfma_f32_16x16x32_bf16 a[188:191], v[56:59], v[96:99], 0
v_mfma_f32_16x16x32_bf16 a[192:195], v[60:63], v[68:71], 0
v_mfma_f32_16x16x32_bf16 a[200:203], v[60:63], v[72:75], 0
v_mfma_f32_16x16x32_bf16 a[208:211], v[60:63], v[76:79], 0
v_mfma_f32_16x16x32_bf16 a[216:219], v[60:63], v[80:83], 0
v_mfma_f32_16x16x32_bf16 a[224:227], v[60:63], v[84:87], 0
v_mfma_f32_16x16x32_bf16 a[232:235], v[60:63], v[88:91], 0
v_mfma_f32_16x16x32_bf16 a[240:243], v[60:63], v[92:95], 0
v_mfma_f32_16x16x32_bf16 a[248:251], v[60:63], v[96:99], 0
v_mfma_f32_16x16x32_bf16 a[196:199], v[64:67], v[68:71], 0
v_mfma_f32_16x16x32_bf16 a[204:207], v[64:67], v[72:75], 0
s_waitcnt vmcnt(12) lgkmcnt(0)
s_barrier
v_mfma_f32_16x16x32_bf16 a[212:215], v[64:67], v[76:79], 0
s_add_u32 s27, s27, 128
s_add_u32 s28, s28, s19
v_mfma_f32_16x16x32_bf16 a[220:223], v[64:67], v[80:83], 0
s_sub_u32 s70, s70, 1
s_cmp_gt_i32 s70, 0
v_mfma_f32_16x16x32_bf16 a[228:231], v[64:67], v[84:87], 0
s_cselect_b32 s17, s27, s30
s_cselect_b32 s18, s28, s30
v_mfma_f32_16x16x32_bf16 a[236:239], v[64:67], v[88:91], 0
s_xor_b32 s21, s21, 0x8000
s_xor_b32 s22, s22, 0x8000
v_mfma_f32_16x16x32_bf16 a[244:247], v[64:67], v[92:95], 0
s_mov_b32 m0, s21
v_mfma_f32_16x16x32_bf16 a[252:255], v[64:67], v[96:99], 0
s_waitcnt lgkmcnt(0)
v_mfma_f32_16x16x32_bf16 a[0:3], v[100:103], v[132:135], a[0:3]
v_xor_b32 v2, 0x8000, v2
buffer_load_dwordx4 v12, s[4:7], s17 offen offset:0 lds
v_mfma_f32_16x16x32_bf16 a[8:11], v[100:103], v[136:139], a[8:11]
v_xor_b32 v4, 0x8000, v4
v_mfma_f32_16x16x32_bf16 a[16:19], v[100:103], v[140:143], a[16:19]
ds_read_b128 v[36:39], v2 offset:0
v_mfma_f32_16x16x32_bf16 a[24:27], v[100:103], v[144:147], a[24:27]
v_xor_b32 v5, 0x8000, v5
v_mfma_f32_16x16x32_bf16 a[32:35], v[100:103], v[148:151], a[32:35]
ds_read_b64_tr_b16 v[68:69], v4 offset:0
v_mfma_f32_16x16x32_bf16 a[40:43], v[100:103], v[152:155], a[40:43]
v_xor_b32 v6, 0x8000, v6
v_mfma_f32_16x16x32_bf16 a[48:51], v[100:103], v[156:159], a[48:51]
ds_read_b64_tr_b16 v[70:71], v4 offset:2048
buffer_load_dwordx4 v13, s[4:7], s17 offen offset:1024 lds
v_mfma_f32_16x16x32_bf16 a[56:59], v[100:103], v[160:163], a[56:59]
v_xor_b32 v7, 0x8000, v7
v_mfma_f32_16x16x32_bf16 a[4:7], v[104:107], v[132:135], a[4:7]
ds_read_b64_tr_b16 v[72:73], v5 offset:0
v_mfma_f32_16x16x32_bf16 a[12:15], v[104:107], v[136:139], a[12:15]
v_xor_b32 v8, 0x8000, v8
v_mfma_f32_16x16x32_bf16 a[20:23], v[104:107], v[140:143], a[20:23]
ds_read_b64_tr_b16 v[74:75], v5 offset:2048
v_mfma_f32_16x16x32_bf16 a[28:31], v[104:107], v[144:147], a[28:31]
v_xor_b32 v9, 0x8000, v9
v_mfma_f32_16x16x32_bf16 a[36:39], v[104:107], v[148:151], a[36:39]
ds_read_b64_tr_b16 v[76:77], v6 offset:0
buffer_load_dwordx4 v14, s[4:7], s17 offen offset:2048 lds
v_mfma_f32_16x16x32_bf16 a[44:47], v[104:107], v[152:155], a[44:47]
v_xor_b32 v10, 0x8000, v10
v_mfma_f32_16x16x32_bf16 a[52:55], v[104:107], v[156:159], a[52:55]
ds_read_b64_tr_b16 v[78:79], v6 offset:2048
v_mfma_f32_16x16x32_bf16 a[60:63], v[104:107], v[160:163], a[60:63]
v_xor_b32 v11, 0x8000, v11
v_mfma_f32_16x16x32_bf16 a[64:67], v[108:111], v[132:135], a[64:67]
ds_read_b64_tr_b16 v[80:81], v7 offset:0
v_mfma_f32_16x16x32_bf16 a[72:75], v[108:111], v[136:139], a[72:75]
v_xor_b32 v3, 0x8000, v3
v_mfma_f32_16x16x32_bf16 a[80:83], v[108:111], v[140:143], a[80:83]
ds_read_b64_tr_b16 v[82:83], v7 offset:2048
v_mfma_f32_16x16x32_bf16 a[88:91], v[108:111], v[144:147], a[88:91]
buffer_load_dwordx4 v15, s[4:7], s17 offen offset:3072 lds
v_mfma_f32_16x16x32_bf16 a[96:99], v[108:111], v[148:151], a[96:99]
ds_read_b64_tr_b16 v[84:85], v8 offset:0
v_mfma_f32_16x16x32_bf16 a[104:107], v[108:111], v[152:155], a[104:107]
s_add_u32 m0, s21, 4096
v_mfma_f32_16x16x32_bf16 a[112:115], v[108:111], v[156:159], a[112:115]
ds_read_b64_tr_b16 v[86:87], v8 offset:2048
v_mfma_f32_16x16x32_bf16 a[120:123], v[108:111], v[160:163], a[120:123]
v_mfma_f32_16x16x32_bf16 a[68:71], v[112:115], v[132:135], a[68:71]
ds_read_b64_tr_b16 v[88:89], v9 offset:0
v_mfma_f32_16x16x32_bf16 a[76:79], v[112:115], v[136:139], a[76:79]
buffer_load_dwordx4 v16, s[4:7], s17 offen offset:0 lds
v_mfma_f32_16x16x32_bf16 a[84:87], v[112:115], v[140:143], a[84:87]
ds_read_b64_tr_b16 v[90:91], v9 offset:2048
v_mfma_f32_16x16x32_bf16 a[92:95], v[112:115], v[144:147], a[92:95]
v_mfma_f32_16x16x32_bf16 a[100:103], v[112:115], v[148:151], a[100:103]
ds_read_b64_tr_b16 v[92:93], v10 offset:0
v_mfma_f32_16x16x32_bf16 a[108:111], v[112:115], v[152:155], a[108:111]
v_mfma_f32_16x16x32_bf16 a[116:119], v[112:115], v[156:159], a[116:119]
ds_read_b64_tr_b16 v[94:95], v10 offset:2048
v_mfma_f32_16x16x32_bf16 a[124:127], v[112:115], v[160:163], a[124:127]
buffer_load_dwordx4 v17, s[4:7], s17 offen offset:1024 lds
v_mfma_f32_16x16x32_bf16 a[128:131], v[116:119], v[132:135], a[128:131]
ds_read_b64_tr_b16 v[96:97], v11 offset:0
v_mfma_f32_16x16x32_bf16 a[136:139], v[116:119], v[136:139], a[136:139]
v_mfma_f32_16x16x32_bf16 a[144:147], v[116:119], v[140:143], a[144:147]
ds_read_b64_tr_b16 v[98:99], v11 offset:2048
v_mfma_f32_16x16x32_bf16 a[152:155], v[116:119], v[144:147], a[152:155]
v_mfma_f32_16x16x32_bf16 a[160:163], v[116:119], v[148:151], a[160:163]
ds_read_b128 v[40:43], v2 offset:2048
v_mfma_f32_16x16x32_bf16 a[168:171], v[116:119], v[152:155], a[168:171]
buffer_load_dwordx4 v18, s[4:7], s17 offen offset:2048 lds
v_mfma_f32_16x16x32_bf16 a[176:179], v[116:119], v[156:159], a[176:179]
ds_read_b128 v[44:47], v2 offset:4096
v_mfma_f32_16x16x32_bf16 a[184:187], v[116:119], v[160:163], a[184:187]
v_mfma_f32_16x16x32_bf16 a[132:135], v[120:123], v[132:135], a[132:135]
ds_read_b128 v[48:51], v2 offset:6144
v_mfma_f32_16x16x32_bf16 a[140:143], v[120:123], v[136:139], a[140:143]
v_mfma_f32_16x16x32_bf16 a[148:151], v[120:123], v[140:143], a[148:151]
ds_read_b128 v[52:55], v2 offset:8192
v_mfma_f32_16x16x32_bf16 a[156:159], v[120:123], v[144:147], a[156:159]
buffer_load_dwordx4 v19, s[4:7], s17 offen offset:3072 lds
v_mfma_f32_16x16x32_bf16 a[164:167], v[120:123], v[148:151], a[164:167]
ds_read_b128 v[56:59], v2 offset:10240
v_mfma_f32_16x16x32_bf16 a[172:175], v[120:123], v[152:155], a[172:175]
s_mov_b32 m0, s22
v_mfma_f32_16x16x32_bf16 a[180:183], v[120:123], v[156:159], a[180:183]
ds_read_b128 v[60:63], v2 offset:12288
v_mfma_f32_16x16x32_bf16 a[188:191], v[120:123], v[160:163], a[188:191]
v_mfma_f32_16x16x32_bf16 a[192:195], v[124:127], v[132:135], a[192:195]
ds_read_b128 v[64:67], v2 offset:14336
v_mfma_f32_16x16x32_bf16 a[200:203], v[124:127], v[136:139], a[200:203]
buffer_load_dwordx4 v20, s[8:11], s18 offen offset:0 lds
v_mfma_f32_16x16x32_bf16 a[208:211], v[124:127], v[140:143], a[208:211]
v_mfma_f32_16x16x32_bf16 a[216:219], v[124:127], v[144:147], a[216:219]
v_mfma_f32_16x16x32_bf16 a[224:227], v[124:127], v[148:151], a[224:227]
v_mfma_f32_16x16x32_bf16 a[232:235], v[124:127], v[152:155], a[232:235]
v_mfma_f32_16x16x32_bf16 a[240:243], v[124:127], v[156:159], a[240:243]
v_mfma_f32_16x16x32_bf16 a[248:251], v[124:127], v[160:163], a[248:251]
buffer_load_dwordx4 v21, s[8:11], s18 offen offset:1024 lds
v_mfma_f32_16x16x32_bf16 a[196:199], v[128:131], v[132:135], a[196:199]
v_mfma_f32_16x16x32_bf16 a[204:207], v[128:131], v[136:139], a[204:207]
v_mfma_f32_16x16x32_bf16 a[212:215], v[128:131], v[140:143], a[212:215]
v_mfma_f32_16x16x32_bf16 a[220:223], v[128:131], v[144:147], a[220:223]
v_mfma_f32_16x16x32_bf16 a[228:231], v[128:131], v[148:151], a[228:231]
v_mfma_f32_16x16x32_bf16 a[236:239], v[128:131], v[152:155], a[236:239]
buffer_load_dwordx4 v22, s[8:11], s18 offen offset:2048 lds
v_mfma_f32_16x16x32_bf16 a[244:247], v[128:131], v[156:159], a[244:247]
s_sub_u32 s20, s20, 1
v_mfma_f32_16x16x32_bf16 a[252:255], v[128:131], v[160:163], a[252:255]
s_cmp_lg_u32 s20, 0
.p2align 6
L_f_loop_0_0:
s_waitcnt lgkmcnt(0)
v_mfma_f32_16x16x32_bf16 a[0:3], v[36:39], v[68:71], a[0:3]
ds_read_b128 v[100:103], v3 offset:0
v_mfma_f32_16x16x32_bf16 a[8:11], v[36:39], v[72:75], a[8:11]
v_mfma_f32_16x16x32_bf16 a[16:19], v[36:39], v[76:79], a[16:19]
ds_read_b64_tr_b16 v[132:133], v4 offset:16384
v_mfma_f32_16x16x32_bf16 a[24:27], v[36:39], v[80:83], a[24:27]
buffer_load_dwordx4 v23, s[8:11], s18 offen offset:3072 lds
v_mfma_f32_16x16x32_bf16 a[32:35], v[36:39], v[84:87], a[32:35]
ds_read_b64_tr_b16 v[134:135], v4 offset:18432
v_mfma_f32_16x16x32_bf16 a[40:43], v[36:39], v[88:91], a[40:43]
s_add_u32 m0, s22, 4096
v_mfma_f32_16x16x32_bf16 a[48:51], v[36:39], v[92:95], a[48:51]
ds_read_b64_tr_b16 v[136:137], v5 offset:16384
v_mfma_f32_16x16x32_bf16 a[56:59], v[36:39], v[96:99], a[56:59]
v_mfma_f32_16x16x32_bf16 a[4:7], v[40:43], v[68:71], a[4:7]
ds_read_b64_tr_b16 v[138:139], v5 offset:18432
v_mfma_f32_16x16x32_bf16 a[12:15], v[40:43], v[72:75], a[12:15]
buffer_load_dwordx4 v24, s[8:11], s18 offen offset:0 lds
v_mfma_f32_16x16x32_bf16 a[20:23], v[40:43], v[76:79], a[20:23]
ds_read_b64_tr_b16 v[140:141], v6 offset:16384
v_mfma_f32_16x16x32_bf16 a[28:31], v[40:43], v[80:83], a[28:31]
v_mfma_f32_16x16x32_bf16 a[36:39], v[40:43], v[84:87], a[36:39]
ds_read_b64_tr_b16 v[142:143], v6 offset:18432
v_mfma_f32_16x16x32_bf16 a[44:47], v[40:43], v[88:91], a[44:47]
v_mfma_f32_16x16x32_bf16 a[52:55], v[40:43], v[92:95], a[52:55]
ds_read_b64_tr_b16 v[144:145], v7 offset:16384
v_mfma_f32_16x16x32_bf16 a[60:63], v[40:43], v[96:99], a[60:63]
buffer_load_dwordx4 v25, s[8:11], s18 offen offset:1024 lds
v_mfma_f32_16x16x32_bf16 a[64:67], v[44:47], v[68:71], a[64:67]
ds_read_b64_tr_b16 v[146:147], v7 offset:18432
v_mfma_f32_16x16x32_bf16 a[72:75], v[44:47], v[72:75], a[72:75]
v_mfma_f32_16x16x32_bf16 a[80:83], v[44:47], v[76:79], a[80:83]
ds_read_b64_tr_b16 v[148:149], v8 offset:16384
v_mfma_f32_16x16x32_bf16 a[88:91], v[44:47], v[80:83], a[88:91]
v_mfma_f32_16x16x32_bf16 a[96:99], v[44:47], v[84:87], a[96:99]
ds_read_b64_tr_b16 v[150:151], v8 offset:18432
v_mfma_f32_16x16x32_bf16 a[104:107], v[44:47], v[88:91], a[104:107]
buffer_load_dwordx4 v26, s[8:11], s18 offen offset:2048 lds
v_mfma_f32_16x16x32_bf16 a[112:115], v[44:47], v[92:95], a[112:115]
ds_read_b64_tr_b16 v[152:153], v9 offset:16384
v_mfma_f32_16x16x32_bf16 a[120:123], v[44:47], v[96:99], a[120:123]
v_mfma_f32_16x16x32_bf16 a[68:71], v[48:51], v[68:71], a[68:71]
ds_read_b64_tr_b16 v[154:155], v9 offset:18432
v_mfma_f32_16x16x32_bf16 a[76:79], v[48:51], v[72:75], a[76:79]
v_mfma_f32_16x16x32_bf16 a[84:87], v[48:51], v[76:79], a[84:87]
ds_read_b64_tr_b16 v[156:157], v10 offset:16384
v_mfma_f32_16x16x32_bf16 a[92:95], v[48:51], v[80:83], a[92:95]
buffer_load_dwordx4 v27, s[8:11], s18 offen offset:3072 lds
v_mfma_f32_16x16x32_bf16 a[100:103], v[48:51], v[84:87], a[100:103]
ds_read_b64_tr_b16 v[158:159], v10 offset:18432
v_mfma_f32_16x16x32_bf16 a[108:111], v[48:51], v[88:91], a[108:111]
v_mfma_f32_16x16x32_bf16 a[116:119], v[48:51], v[92:95], a[116:119]
ds_read_b64_tr_b16 v[160:161], v11 offset:16384
v_mfma_f32_16x16x32_bf16 a[124:127], v[48:51], v[96:99], a[124:127]
s_add_u32 s85, s17, 384
v_mfma_f32_16x16x32_bf16 a[128:131], v[52:55], v[68:71], a[128:131]
ds_read_b64_tr_b16 v[162:163], v11 offset:18432
v_mfma_f32_16x16x32_bf16 a[136:139], v[52:55], v[72:75], a[136:139]
buffer_load_dword v241, v240, s[4:7], s85 offen
v_mfma_f32_16x16x32_bf16 a[144:147], v[52:55], v[76:79], a[144:147]
ds_read_b128 v[104:107], v3 offset:2048
v_mfma_f32_16x16x32_bf16 a[152:155], v[52:55], v[80:83], a[152:155]
v_mfma_f32_16x16x32_bf16 a[160:163], v[52:55], v[84:87], a[160:163]
ds_read_b128 v[108:111], v3 offset:4096
v_mfma_f32_16x16x32_bf16 a[168:171], v[52:55], v[88:91], a[168:171]
v_mfma_f32_16x16x32_bf16 a[176:179], v[52:55], v[92:95], a[176:179]
ds_read_b128 v[112:115], v3 offset:6144
v_mfma_f32_16x16x32_bf16 a[184:187], v[52:55], v[96:99], a[184:187]
v_mfma_f32_16x16x32_bf16 a[132:135], v[56:59], v[68:71], a[132:135]
ds_read_b128 v[116:119], v3 offset:8192
v_mfma_f32_16x16x32_bf16 a[140:143], v[56:59], v[72:75], a[140:143]
v_mfma_f32_16x16x32_bf16 a[148:151], v[56:59], v[76:79], a[148:151]
ds_read_b128 v[120:123], v3 offset:10240
v_mfma_f32_16x16x32_bf16 a[156:159], v[56:59], v[80:83], a[156:159]
v_mfma_f32_16x16x32_bf16 a[164:167], v[56:59], v[84:87], a[164:167]
ds_read_b128 v[124:127], v3 offset:12288
v_mfma_f32_16x16x32_bf16 a[172:175], v[56:59], v[88:91], a[172:175]
v_mfma_f32_16x16x32_bf16 a[180:183], v[56:59], v[92:95], a[180:183]
ds_read_b128 v[128:131], v3 offset:14336
v_mfma_f32_16x16x32_bf16 a[188:191], v[56:59], v[96:99], a[188:191]
v_mfma_f32_16x16x32_bf16 a[192:195], v[60:63], v[68:71], a[192:195]
v_mfma_f32_16x16x32_bf16 a[200:203], v[60:63], v[72:75], a[200:203]
v_mfma_f32_16x16x32_bf16 a[208:211], v[60:63], v[76:79], a[208:211]
v_mfma_f32_16x16x32_bf16 a[216:219], v[60:63], v[80:83], a[216:219]
v_mfma_f32_16x16x32_bf16 a[224:227], v[60:63], v[84:87], a[224:227]
v_mfma_f32_16x16x32_bf16 a[232:235], v[60:63], v[88:91], a[232:235]
v_mfma_f32_16x16x32_bf16 a[240:243], v[60:63], v[92:95], a[240:243]
v_mfma_f32_16x16x32_bf16 a[248:251], v[60:63], v[96:99], a[248:251]
v_mfma_f32_16x16x32_bf16 a[196:199], v[64:67], v[68:71], a[196:199]
v_mfma_f32_16x16x32_bf16 a[204:207], v[64:67], v[72:75], a[204:207]
s_waitcnt vmcnt(1) lgkmcnt(0)
s_barrier
v_mfma_f32_16x16x32_bf16 a[212:215], v[64:67], v[76:79], a[212:215]
s_add_u32 s27, s27, 128
s_add_u32 s28, s28, s19
v_mfma_f32_16x16x32_bf16 a[220:223], v[64:67], v[80:83], a[220:223]
s_sub_u32 s70, s70, 1
s_cmp_gt_i32 s70, 0
v_mfma_f32_16x16x32_bf16 a[228:231], v[64:67], v[84:87], a[228:231]
s_cselect_b32 s17, s27, s30
s_cselect_b32 s18, s28, s30
v_mfma_f32_16x16x32_bf16 a[236:239], v[64:67], v[88:91], a[236:239]
s_xor_b32 s21, s21, 0x8000
s_xor_b32 s22, s22, 0x8000
v_mfma_f32_16x16x32_bf16 a[244:247], v[64:67], v[92:95], a[244:247]
s_mov_b32 m0, s21
v_mfma_f32_16x16x32_bf16 a[252:255], v[64:67], v[96:99], a[252:255]
s_waitcnt lgkmcnt(0)
v_mfma_f32_16x16x32_bf16 a[0:3], v[100:103], v[132:135], a[0:3]
v_xor_b32 v2, 0x8000, v2
buffer_load_dwordx4 v12, s[4:7], s17 offen offset:0 lds
v_mfma_f32_16x16x32_bf16 a[8:11], v[100:103], v[136:139], a[8:11]
v_xor_b32 v4, 0x8000, v4
v_mfma_f32_16x16x32_bf16 a[16:19], v[100:103], v[140:143], a[16:19]
ds_read_b128 v[36:39], v2 offset:0
v_mfma_f32_16x16x32_bf16 a[24:27], v[100:103], v[144:147], a[24:27]
v_xor_b32 v5, 0x8000, v5
v_mfma_f32_16x16x32_bf16 a[32:35], v[100:103], v[148:151], a[32:35]
ds_read_b64_tr_b16 v[68:69], v4 offset:0
v_mfma_f32_16x16x32_bf16 a[40:43], v[100:103], v[152:155], a[40:43]
v_xor_b32 v6, 0x8000, v6
v_mfma_f32_16x16x32_bf16 a[48:51], v[100:103], v[156:159], a[48:51]
ds_read_b64_tr_b16 v[70:71], v4 offset:2048
buffer_load_dwordx4 v13, s[4:7], s17 offen offset:1024 lds
v_mfma_f32_16x16x32_bf16 a[56:59], v[100:103], v[160:163], a[56:59]
v_xor_b32 v7, 0x8000, v7
v_mfma_f32_16x16x32_bf16 a[4:7], v[104:107], v[132:135], a[4:7]
ds_read_b64_tr_b16 v[72:73], v5 offset:0
v_mfma_f32_16x16x32_bf16 a[12:15], v[104:107], v[136:139], a[12:15]
v_xor_b32 v8, 0x8000, v8
v_mfma_f32_16x16x32_bf16 a[20:23], v[104:107], v[140:143], a[20:23]
ds_read_b64_tr_b16 v[74:75], v5 offset:2048
v_mfma_f32_16x16x32_bf16 a[28:31], v[104:107], v[144:147], a[28:31]
v_xor_b32 v9, 0x8000, v9
v_mfma_f32_16x16x32_bf16 a[36:39], v[104:107], v[148:151], a[36:39]
ds_read_b64_tr_b16 v[76:77], v6 offset:0
buffer_load_dwordx4 v14, s[4:7], s17 offen offset:2048 lds
v_mfma_f32_16x16x32_bf16 a[44:47], v[104:107], v[152:155], a[44:47]
v_xor_b32 v10, 0x8000, v10
v_mfma_f32_16x16x32_bf16 a[52:55], v[104:107], v[156:159], a[52:55]
ds_read_b64_tr_b16 v[78:79], v6 offset:2048
v_mfma_f32_16x16x32_bf16 a[60:63], v[104:107], v[160:163], a[60:63]
v_xor_b32 v11, 0x8000, v11
v_mfma_f32_16x16x32_bf16 a[64:67], v[108:111], v[132:135], a[64:67]
ds_read_b64_tr_b16 v[80:81], v7 offset:0
v_mfma_f32_16x16x32_bf16 a[72:75], v[108:111], v[136:139], a[72:75]
v_xor_b32 v3, 0x8000, v3
v_mfma_f32_16x16x32_bf16 a[80:83], v[108:111], v[140:143], a[80:83]
ds_read_b64_tr_b16 v[82:83], v7 offset:2048
v_mfma_f32_16x16x32_bf16 a[88:91], v[108:111], v[144:147], a[88:91]
buffer_load_dwordx4 v15, s[4:7], s17 offen offset:3072 lds
v_mfma_f32_16x16x32_bf16 a[96:99], v[108:111], v[148:151], a[96:99]
ds_read_b64_tr_b16 v[84:85], v8 offset:0
v_mfma_f32_16x16x32_bf16 a[104:107], v[108:111], v[152:155], a[104:107]
s_add_u32 m0, s21, 4096
v_mfma_f32_16x16x32_bf16 a[112:115], v[108:111], v[156:159], a[112:115]
ds_read_b64_tr_b16 v[86:87], v8 offset:2048
v_mfma_f32_16x16x32_bf16 a[120:123], v[108:111], v[160:163], a[120:123]
v_mfma_f32_16x16x32_bf16 a[68:71], v[112:115], v[132:135], a[68:71]
ds_read_b64_tr_b16 v[88:89], v9 offset:0
v_mfma_f32_16x16x32_bf16 a[76:79], v[112:115], v[136:139], a[76:79]
buffer_load_dwordx4 v16, s[4:7], s17 offen offset:0 lds
v_mfma_f32_16x16x32_bf16 a[84:87], v[112:115], v[140:143], a[84:87]
ds_read_b64_tr_b16 v[90:91], v9 offset:2048
v_mfma_f32_16x16x32_bf16 a[92:95], v[112:115], v[144:147], a[92:95]
v_mfma_f32_16x16x32_bf16 a[100:103], v[112:115], v[148:151], a[100:103]
ds_read_b64_tr_b16 v[92:93], v10 offset:0
v_mfma_f32_16x16x32_bf16 a[108:111], v[112:115], v[152:155], a[108:111]
v_mfma_f32_16x16x32_bf16 a[116:119], v[112:115], v[156:159], a[116:119]
ds_read_b64_tr_b16 v[94:95], v10 offset:2048
v_mfma_f32_16x16x32_bf16 a[124:127], v[112:115], v[160:163], a[124:127]
buffer_load_dwordx4 v17, s[4:7], s17 offen offset:1024 lds
v_mfma_f32_16x16x32_bf16 a[128:131], v[116:119], v[132:135], a[128:131]
ds_read_b64_tr_b16 v[96:97], v11 offset:0
v_mfma_f32_16x16x32_bf16 a[136:139], v[116:119], v[136:139], a[136:139]
v_mfma_f32_16x16x32_bf16 a[144:147], v[116:119], v[140:143], a[144:147]
ds_read_b64_tr_b16 v[98:99], v11 offset:2048
v_mfma_f32_16x16x32_bf16 a[152:155], v[116:119], v[144:147], a[152:155]
v_mfma_f32_16x16x32_bf16 a[160:163], v[116:119], v[148:151], a[160:163]
ds_read_b128 v[40:43], v2 offset:2048
v_mfma_f32_16x16x32_bf16 a[168:171], v[116:119], v[152:155], a[168:171]
buffer_load_dwordx4 v18, s[4:7], s17 offen offset:2048 lds
v_mfma_f32_16x16x32_bf16 a[176:179], v[116:119], v[156:159], a[176:179]
ds_read_b128 v[44:47], v2 offset:4096
v_mfma_f32_16x16x32_bf16 a[184:187], v[116:119], v[160:163], a[184:187]
v_mfma_f32_16x16x32_bf16 a[132:135], v[120:123], v[132:135], a[132:135]
ds_read_b128 v[48:51], v2 offset:6144
v_mfma_f32_16x16x32_bf16 a[140:143], v[120:123], v[136:139], a[140:143]
v_mfma_f32_16x16x32_bf16 a[148:151], v[120:123], v[140:143], a[148:151]
ds_read_b128 v[52:55], v2 offset:8192
v_mfma_f32_16x16x32_bf16 a[156:159], v[120:123], v[144:147], a[156:159]
buffer_load_dwordx4 v19, s[4:7], s17 offen offset:3072 lds
v_mfma_f32_16x16x32_bf16 a[164:167], v[120:123], v[148:151], a[164:167]
ds_read_b128 v[56:59], v2 offset:10240
v_mfma_f32_16x16x32_bf16 a[172:175], v[120:123], v[152:155], a[172:175]
s_mov_b32 m0, s22
v_mfma_f32_16x16x32_bf16 a[180:183], v[120:123], v[156:159], a[180:183]
ds_read_b128 v[60:63], v2 offset:12288
v_mfma_f32_16x16x32_bf16 a[188:191], v[120:123], v[160:163], a[188:191]
v_mfma_f32_16x16x32_bf16 a[192:195], v[124:127], v[132:135], a[192:195]
ds_read_b128 v[64:67], v2 offset:14336
v_mfma_f32_16x16x32_bf16 a[200:203], v[124:127], v[136:139], a[200:203]
buffer_load_dwordx4 v20, s[8:11], s18 offen offset:0 lds
v_mfma_f32_16x16x32_bf16 a[208:211], v[124:127], v[140:143], a[208:211]
v_mfma_f32_16x16x32_bf16 a[216:219], v[124:127], v[144:147], a[216:219]
v_mfma_f32_16x16x32_bf16 a[224:227], v[124:127], v[148:151], a[224:227]
v_mfma_f32_16x16x32_bf16 a[232:235], v[124:127], v[152:155], a[232:235]
v_mfma_f32_16x16x32_bf16 a[240:243], v[124:127], v[156:159], a[240:243]
v_mfma_f32_16x16x32_bf16 a[248:251], v[124:127], v[160:163], a[248:251]
buffer_load_dwordx4 v21, s[8:11], s18 offen offset:1024 lds
v_mfma_f32_16x16x32_bf16 a[196:199], v[128:131], v[132:135], a[196:199]
v_mfma_f32_16x16x32_bf16 a[204:207], v[128:131], v[136:139], a[204:207]
v_mfma_f32_16x16x32_bf16 a[212:215], v[128:131], v[140:143], a[212:215]
v_mfma_f32_16x16x32_bf16 a[220:223], v[128:131], v[144:147], a[220:223]
v_mfma_f32_16x16x32_bf16 a[228:231], v[128:131], v[148:151], a[228:231]
v_mfma_f32_16x16x32_bf16 a[236:239], v[128:131], v[152:155], a[236:239]
buffer_load_dwordx4 v22, s[8:11], s18 offen offset:2048 lds
v_mfma_f32_16x16x32_bf16 a[244:247], v[128:131], v[156:159], a[244:247]
s_sub_u32 s20, s20, 1
v_mfma_f32_16x16x32_bf16 a[252:255], v[128:131], v[160:163], a[252:255]
s_cmp_lg_u32 s20, 0
s_cbranch_scc1 L_f_loop_0_0
s_branch L_f_kvdone
L_f_go_0_1:
s_waitcnt lgkmcnt(0)
v_mfma_f32_16x16x32_bf16 a[0:3], v[36:39], v[68:71], 0
ds_read_b128 v[100:103], v3 offset:0
v_mfma_f32_16x16x32_bf16 a[8:11], v[36:39], v[72:75], 0
s_cmp_ge_u32 s2, 128
s_cselect_b32 s80, s48, s42
s_cselect_b32 s81, s49, s43
s_mov_b32 s62, 401408
s_cselect_b32 s82, s62, 3670016
s_mov_b32 s83, 0x20000
v_mfma_f32_16x16x32_bf16 a[16:19], v[36:39], v[76:79], 0
ds_read_b64_tr_b16 v[132:133], v4 offset:16384
v_mfma_f32_16x16x32_bf16 a[24:27], v[36:39], v[80:83], 0
s_sub_u32 s61, s2, 128
s_cselect_b32 s61, s61, s61
s_cmp_ge_u32 s2, 128
s_cselect_b32 s61, s61, s2
s_cselect_b32 s62, 28, 32
v_mfma_f32_16x16x32_bf16 a[32:35], v[36:39], v[84:87], 0
ds_read_b64_tr_b16 v[134:135], v4 offset:18432
v_mfma_f32_16x16x32_bf16 a[40:43], v[36:39], v[88:91], 0
s_mul_i32 s62, s62, s61
s_mul_i32 s62, s62, 896
v_mfma_f32_16x16x32_bf16 a[48:51], v[36:39], v[92:95], 0
ds_read_b64_tr_b16 v[136:137], v5 offset:16384
v_mfma_f32_16x16x32_bf16 a[56:59], v[36:39], v[96:99], 0
s_lshl_b32 s90, s61, 10
s_cmp_ge_u32 s2, 128
s_mov_b32 s63, 79691776
s_cselect_b32 s63, s63, 75497472
v_mfma_f32_16x16x32_bf16 a[4:7], v[40:43], v[68:71], 0
ds_read_b64_tr_b16 v[138:139], v5 offset:18432
v_mfma_f32_16x16x32_bf16 a[12:15], v[40:43], v[72:75], 0
s_add_u32 s90, s90, s63
s_cmp_ge_u32 s2, 128
s_mov_b32 s63, 16384
s_cselect_b32 s100, s63, 131072
v_mfma_f32_16x16x32_bf16 a[20:23], v[40:43], v[76:79], 0
ds_read_b64_tr_b16 v[140:141], v6 offset:16384
v_mfma_f32_16x16x32_bf16 a[28:31], v[40:43], v[80:83], 0
s_cmp_ge_u32 s2, 144
s_cselect_b32 s62, s30, s62
s_cselect_b32 s90, s30, s90
s_cselect_b32 s100, 0, s100
s_mul_i32 s63, s16, 7168
v_mfma_f32_16x16x32_bf16 a[36:39], v[40:43], v[84:87], 0
ds_read_b64_tr_b16 v[142:143], v6 offset:18432
v_mfma_f32_16x16x32_bf16 a[44:47], v[40:43], v[88:91], 0
s_add_u32 s62, s62, s63
s_add_u32 s63, s63, 131072
v_mfma_f32_16x16x32_bf16 a[52:55], v[40:43], v[92:95], 0
ds_read_b64_tr_b16 v[144:145], v7 offset:16384
v_mfma_f32_16x16x32_bf16 a[60:63], v[40:43], v[96:99], 0
s_add_u32 m0, s63, 0
s_add_u32 s61, s62, 0
buffer_load_dwordx4 v1, s[80:83], s61 offen lds
s_add_u32 m0, s63, 1024
s_add_u32 s61, s62, 1024
buffer_load_dwordx4 v1, s[80:83], s61 offen lds
v_mfma_f32_16x16x32_bf16 a[64:67], v[44:47], v[68:71], 0
ds_read_b64_tr_b16 v[146:147], v7 offset:18432
v_mfma_f32_16x16x32_bf16 a[72:75], v[44:47], v[72:75], 0
s_add_u32 m0, s63, 2048
s_add_u32 s61, s62, 2048
buffer_load_dwordx4 v1, s[80:83], s61 offen lds
s_add_u32 m0, s63, 3072
s_add_u32 s61, s62, 3072
buffer_load_dwordx4 v1, s[80:83], s61 offen lds
v_mfma_f32_16x16x32_bf16 a[80:83], v[44:47], v[76:79], 0
ds_read_b64_tr_b16 v[148:149], v8 offset:16384
v_mfma_f32_16x16x32_bf16 a[88:91], v[44:47], v[80:83], 0
s_add_u32 m0, s63, 4096
s_add_u32 s61, s62, 4096
buffer_load_dwordx4 v1, s[80:83], s61 offen lds
s_add_u32 m0, s63, 5120
s_add_u32 s61, s62, 5120
buffer_load_dwordx4 v1, s[80:83], s61 offen lds
v_mfma_f32_16x16x32_bf16 a[96:99], v[44:47], v[84:87], 0
ds_read_b64_tr_b16 v[150:151], v8 offset:18432
v_mfma_f32_16x16x32_bf16 a[104:107], v[44:47], v[88:91], 0
s_add_u32 m0, s63, 6144
s_add_u32 s61, s62, 6144
buffer_load_dwordx4 v1, s[80:83], s61 offen lds
v_and_b32 v28, 63, v0
v_mfma_f32_16x16x32_bf16 a[112:115], v[44:47], v[92:95], 0
ds_read_b64_tr_b16 v[152:153], v9 offset:16384
v_mfma_f32_16x16x32_bf16 a[120:123], v[44:47], v[96:99], 0
v_and_b32 v29, 15, v28
v_lshrrev_b32 v30, 4, v28
v_mfma_f32_16x16x32_bf16 a[68:71], v[48:51], v[68:71], 0
ds_read_b64_tr_b16 v[154:155], v9 offset:18432
v_mfma_f32_16x16x32_bf16 a[76:79], v[48:51], v[72:75], 0
v_bfe_u32 v31, v28, 2, 2
v_and_b32 v32, 3, v28
v_mfma_f32_16x16x32_bf16 a[84:87], v[48:51], v[76:79], 0
ds_read_b64_tr_b16 v[156:157], v10 offset:16384
v_mfma_f32_16x16x32_bf16 a[92:95], v[48:51], v[80:83], 0
v_lshl_add_u32 v33, v30, 2, v31
v_mul_u32_u24 v33, 896, v33
v_mfma_f32_16x16x32_bf16 a[100:103], v[48:51], v[84:87], 0
ds_read_b64_tr_b16 v[158:159], v10 offset:18432
v_mfma_f32_16x16x32_bf16 a[108:111], v[48:51], v[88:91], 0
v_lshl_add_u32 v33, v32, 3, v33
s_mul_i32 s62, s16, 224
v_mfma_f32_16x16x32_bf16 a[116:119], v[48:51], v[92:95], 0
ds_read_b64_tr_b16 v[160:161], v11 offset:16384
v_mfma_f32_16x16x32_bf16 a[124:127], v[48:51], v[96:99], 0
s_mul_i32 s85, s19, 3
s_add_u32 s85, s85, s18
v_mfma_f32_16x16x32_bf16 a[128:131], v[52:55], v[68:71], 0
ds_read_b64_tr_b16 v[162:163], v11 offset:18432
v_mfma_f32_16x16x32_bf16 a[136:139], v[52:55], v[72:75], 0
buffer_load_dword v241, v240, s[8:11], s85 offen
v_mfma_f32_16x16x32_bf16 a[144:147], v[52:55], v[76:79], 0
ds_read_b128 v[104:107], v3 offset:2048
v_mfma_f32_16x16x32_bf16 a[152:155], v[52:55], v[80:83], 0
s_add_u32 s62, s62, 131072
v_add_u32 v178, s62, v33
v_mfma_f32_16x16x32_bf16 a[160:163], v[52:55], v[84:87], 0
ds_read_b128 v[108:111], v3 offset:4096
v_mfma_f32_16x16x32_bf16 a[168:171], v[52:55], v[88:91], 0
v_mfma_f32_16x16x32_bf16 a[176:179], v[52:55], v[92:95], 0
ds_read_b128 v[112:115], v3 offset:6144
v_mfma_f32_16x16x32_bf16 a[184:187], v[52:55], v[96:99], 0
v_mfma_f32_16x16x32_bf16 a[132:135], v[56:59], v[68:71], 0
ds_read_b128 v[116:119], v3 offset:8192
v_mfma_f32_16x16x32_bf16 a[140:143], v[56:59], v[72:75], 0
v_mfma_f32_16x16x32_bf16 a[148:151], v[56:59], v[76:79], 0
ds_read_b128 v[120:123], v3 offset:10240
v_mfma_f32_16x16x32_bf16 a[156:159], v[56:59], v[80:83], 0
v_mfma_f32_16x16x32_bf16 a[164:167], v[56:59], v[84:87], 0
ds_read_b128 v[124:127], v3 offset:12288
v_mfma_f32_16x16x32_bf16 a[172:175], v[56:59], v[88:91], 0
v_mfma_f32_16x16x32_bf16 a[180:183], v[56:59], v[92:95], 0
ds_read_b128 v[128:131], v3 offset:14336
v_mfma_f32_16x16x32_bf16 a[188:191], v[56:59], v[96:99], 0
v_mfma_f32_16x16x32_bf16 a[192:195], v[60:63], v[68:71], 0
v_mfma_f32_16x16x32_bf16 a[200:203], v[60:63], v[72:75], 0
v_mfma_f32_16x16x32_bf16 a[208:211], v[60:63], v[76:79], 0
v_mfma_f32_16x16x32_bf16 a[216:219], v[60:63], v[80:83], 0
v_mfma_f32_16x16x32_bf16 a[224:227], v[60:63], v[84:87], 0
v_mfma_f32_16x16x32_bf16 a[232:235], v[60:63], v[88:91], 0
v_mfma_f32_16x16x32_bf16 a[240:243], v[60:63], v[92:95], 0
v_mfma_f32_16x16x32_bf16 a[248:251], v[60:63], v[96:99], 0
v_mfma_f32_16x16x32_bf16 a[196:199], v[64:67], v[68:71], 0
v_mfma_f32_16x16x32_bf16 a[204:207], v[64:67], v[72:75], 0
s_waitcnt vmcnt(11) lgkmcnt(0)
s_barrier
s_nop 1
v_mfma_f32_16x16x32_bf16 a[212:215], v[64:67], v[76:79], 0
s_add_u32 s27, s27, 128
s_add_u32 s28, s28, s19
v_mfma_f32_16x16x32_bf16 a[220:223], v[64:67], v[80:83], 0
s_sub_u32 s70, s70, 1
s_cmp_gt_i32 s70, 0
v_mfma_f32_16x16x32_bf16 a[228:231], v[64:67], v[84:87], 0
s_cselect_b32 s17, s27, s30
s_cselect_b32 s18, s28, s30
v_mfma_f32_16x16x32_bf16 a[236:239], v[64:67], v[88:91], 0
s_xor_b32 s21, s21, 0x8000
s_xor_b32 s22, s22, 0x8000
v_mfma_f32_16x16x32_bf16 a[244:247], v[64:67], v[92:95], 0
s_mov_b32 m0, s21
v_mfma_f32_16x16x32_bf16 a[252:255], v[64:67], v[96:99], 0
s_waitcnt lgkmcnt(0)
v_mfma_f32_16x16x32_bf16 a[0:3], v[100:103], v[132:135], a[0:3]
v_xor_b32 v2, 0x8000, v2
buffer_load_dwordx4 v12, s[4:7], s17 offen offset:0 lds
v_mfma_f32_16x16x32_bf16 a[8:11], v[100:103], v[136:139], a[8:11]
v_xor_b32 v4, 0x8000, v4
v_mfma_f32_16x16x32_bf16 a[16:19], v[100:103], v[140:143], a[16:19]
ds_read_b128 v[36:39], v2 offset:0
v_mfma_f32_16x16x32_bf16 a[24:27], v[100:103], v[144:147], a[24:27]
v_xor_b32 v5, 0x8000, v5
v_mfma_f32_16x16x32_bf16 a[32:35], v[100:103], v[148:151], a[32:35]
ds_read_b64_tr_b16 v[68:69], v4 offset:0
v_mfma_f32_16x16x32_bf16 a[40:43], v[100:103], v[152:155], a[40:43]
v_xor_b32 v6, 0x8000, v6
v_mfma_f32_16x16x32_bf16 a[48:51], v[100:103], v[156:159], a[48:51]
ds_read_b64_tr_b16 v[70:71], v4 offset:2048
buffer_load_dwordx4 v13, s[4:7], s17 offen offset:1024 lds
v_mfma_f32_16x16x32_bf16 a[56:59], v[100:103], v[160:163], a[56:59]
v_xor_b32 v7, 0x8000, v7
v_mfma_f32_16x16x32_bf16 a[4:7], v[104:107], v[132:135], a[4:7]
ds_read_b64_tr_b16 v[72:73], v5 offset:0
v_mfma_f32_16x16x32_bf16 a[12:15], v[104:107], v[136:139], a[12:15]
v_xor_b32 v8, 0x8000, v8
v_mfma_f32_16x16x32_bf16 a[20:23], v[104:107], v[140:143], a[20:23]
ds_read_b64_tr_b16 v[74:75], v5 offset:2048
v_mfma_f32_16x16x32_bf16 a[28:31], v[104:107], v[144:147], a[28:31]
v_xor_b32 v9, 0x8000, v9
v_mfma_f32_16x16x32_bf16 a[36:39], v[104:107], v[148:151], a[36:39]
ds_read_b64_tr_b16 v[76:77], v6 offset:0
buffer_load_dwordx4 v14, s[4:7], s17 offen offset:2048 lds
v_mfma_f32_16x16x32_bf16 a[44:47], v[104:107], v[152:155], a[44:47]
v_xor_b32 v10, 0x8000, v10
v_mfma_f32_16x16x32_bf16 a[52:55], v[104:107], v[156:159], a[52:55]
ds_read_b64_tr_b16 v[78:79], v6 offset:2048
v_mfma_f32_16x16x32_bf16 a[60:63], v[104:107], v[160:163], a[60:63]
v_xor_b32 v11, 0x8000, v11
v_mfma_f32_16x16x32_bf16 a[64:67], v[108:111], v[132:135], a[64:67]
ds_read_b64_tr_b16 v[80:81], v7 offset:0
v_mfma_f32_16x16x32_bf16 a[72:75], v[108:111], v[136:139], a[72:75]
v_xor_b32 v3, 0x8000, v3
v_mfma_f32_16x16x32_bf16 a[80:83], v[108:111], v[140:143], a[80:83]
ds_read_b64_tr_b16 v[82:83], v7 offset:2048
v_mfma_f32_16x16x32_bf16 a[88:91], v[108:111], v[144:147], a[88:91]
buffer_load_dwordx4 v15, s[4:7], s17 offen offset:3072 lds
v_mfma_f32_16x16x32_bf16 a[96:99], v[108:111], v[148:151], a[96:99]
ds_read_b64_tr_b16 v[84:85], v8 offset:0
v_mfma_f32_16x16x32_bf16 a[104:107], v[108:111], v[152:155], a[104:107]
s_add_u32 m0, s21, 4096
v_mfma_f32_16x16x32_bf16 a[112:115], v[108:111], v[156:159], a[112:115]
ds_read_b64_tr_b16 v[86:87], v8 offset:2048
v_mfma_f32_16x16x32_bf16 a[120:123], v[108:111], v[160:163], a[120:123]
v_mfma_f32_16x16x32_bf16 a[68:71], v[112:115], v[132:135], a[68:71]
ds_read_b64_tr_b16 v[88:89], v9 offset:0
v_mfma_f32_16x16x32_bf16 a[76:79], v[112:115], v[136:139], a[76:79]
buffer_load_dwordx4 v16, s[4:7], s17 offen offset:0 lds
v_mfma_f32_16x16x32_bf16 a[84:87], v[112:115], v[140:143], a[84:87]
ds_read_b64_tr_b16 v[90:91], v9 offset:2048
v_mfma_f32_16x16x32_bf16 a[92:95], v[112:115], v[144:147], a[92:95]
v_mfma_f32_16x16x32_bf16 a[100:103], v[112:115], v[148:151], a[100:103]
ds_read_b64_tr_b16 v[92:93], v10 offset:0
v_mfma_f32_16x16x32_bf16 a[108:111], v[112:115], v[152:155], a[108:111]
v_mfma_f32_16x16x32_bf16 a[116:119], v[112:115], v[156:159], a[116:119]
ds_read_b64_tr_b16 v[94:95], v10 offset:2048
v_mfma_f32_16x16x32_bf16 a[124:127], v[112:115], v[160:163], a[124:127]
buffer_load_dwordx4 v17, s[4:7], s17 offen offset:1024 lds
v_mfma_f32_16x16x32_bf16 a[128:131], v[116:119], v[132:135], a[128:131]
ds_read_b64_tr_b16 v[96:97], v11 offset:0
v_mfma_f32_16x16x32_bf16 a[136:139], v[116:119], v[136:139], a[136:139]
v_mfma_f32_16x16x32_bf16 a[144:147], v[116:119], v[140:143], a[144:147]
ds_read_b64_tr_b16 v[98:99], v11 offset:2048
v_mfma_f32_16x16x32_bf16 a[152:155], v[116:119], v[144:147], a[152:155]
v_mfma_f32_16x16x32_bf16 a[160:163], v[116:119], v[148:151], a[160:163]
ds_read_b128 v[40:43], v2 offset:2048
v_mfma_f32_16x16x32_bf16 a[168:171], v[116:119], v[152:155], a[168:171]
buffer_load_dwordx4 v18, s[4:7], s17 offen offset:2048 lds
v_mfma_f32_16x16x32_bf16 a[176:179], v[116:119], v[156:159], a[176:179]
ds_read_b128 v[44:47], v2 offset:4096
v_mfma_f32_16x16x32_bf16 a[184:187], v[116:119], v[160:163], a[184:187]
v_mfma_f32_16x16x32_bf16 a[132:135], v[120:123], v[132:135], a[132:135]
ds_read_b128 v[48:51], v2 offset:6144
v_mfma_f32_16x16x32_bf16 a[140:143], v[120:123], v[136:139], a[140:143]
v_mfma_f32_16x16x32_bf16 a[148:151], v[120:123], v[140:143], a[148:151]
ds_read_b128 v[52:55], v2 offset:8192
v_mfma_f32_16x16x32_bf16 a[156:159], v[120:123], v[144:147], a[156:159]
buffer_load_dwordx4 v19, s[4:7], s17 offen offset:3072 lds
v_mfma_f32_16x16x32_bf16 a[164:167], v[120:123], v[148:151], a[164:167]
ds_read_b128 v[56:59], v2 offset:10240
v_mfma_f32_16x16x32_bf16 a[172:175], v[120:123], v[152:155], a[172:175]
s_mov_b32 m0, s22
v_mfma_f32_16x16x32_bf16 a[180:183], v[120:123], v[156:159], a[180:183]
ds_read_b128 v[60:63], v2 offset:12288
v_mfma_f32_16x16x32_bf16 a[188:191], v[120:123], v[160:163], a[188:191]
v_mfma_f32_16x16x32_bf16 a[192:195], v[124:127], v[132:135], a[192:195]
ds_read_b128 v[64:67], v2 offset:14336
v_mfma_f32_16x16x32_bf16 a[200:203], v[124:127], v[136:139], a[200:203]
buffer_load_dwordx4 v20, s[8:11], s18 offen offset:0 lds
v_mfma_f32_16x16x32_bf16 a[208:211], v[124:127], v[140:143], a[208:211]
v_mfma_f32_16x16x32_bf16 a[216:219], v[124:127], v[144:147], a[216:219]
v_mfma_f32_16x16x32_bf16 a[224:227], v[124:127], v[148:151], a[224:227]
v_mfma_f32_16x16x32_bf16 a[232:235], v[124:127], v[152:155], a[232:235]
v_mfma_f32_16x16x32_bf16 a[240:243], v[124:127], v[156:159], a[240:243]
v_mfma_f32_16x16x32_bf16 a[248:251], v[124:127], v[160:163], a[248:251]
buffer_load_dwordx4 v21, s[8:11], s18 offen offset:1024 lds
v_mfma_f32_16x16x32_bf16 a[196:199], v[128:131], v[132:135], a[196:199]
v_mfma_f32_16x16x32_bf16 a[204:207], v[128:131], v[136:139], a[204:207]
v_mfma_f32_16x16x32_bf16 a[212:215], v[128:131], v[140:143], a[212:215]
v_mfma_f32_16x16x32_bf16 a[220:223], v[128:131], v[144:147], a[220:223]
v_mfma_f32_16x16x32_bf16 a[228:231], v[128:131], v[148:151], a[228:231]
v_mfma_f32_16x16x32_bf16 a[236:239], v[128:131], v[152:155], a[236:239]
buffer_load_dwordx4 v22, s[8:11], s18 offen offset:2048 lds
v_mfma_f32_16x16x32_bf16 a[244:247], v[128:131], v[156:159], a[244:247]
s_sub_u32 s20, s20, 1
v_mfma_f32_16x16x32_bf16 a[252:255], v[128:131], v[160:163], a[252:255]
s_cmp_lg_u32 s20, 0
.p2align 6
L_f_loop_0_1:
s_waitcnt lgkmcnt(0)
v_mfma_f32_16x16x32_bf16 a[0:3], v[36:39], v[68:71], a[0:3]
ds_read_b128 v[100:103], v3 offset:0
v_mfma_f32_16x16x32_bf16 a[8:11], v[36:39], v[72:75], a[8:11]
v_mfma_f32_16x16x32_bf16 a[16:19], v[36:39], v[76:79], a[16:19]
ds_read_b64_tr_b16 v[132:133], v4 offset:16384
v_mfma_f32_16x16x32_bf16 a[24:27], v[36:39], v[80:83], a[24:27]
buffer_load_dwordx4 v23, s[8:11], s18 offen offset:3072 lds
v_mfma_f32_16x16x32_bf16 a[32:35], v[36:39], v[84:87], a[32:35]
ds_read_b64_tr_b16 v[134:135], v4 offset:18432
v_mfma_f32_16x16x32_bf16 a[40:43], v[36:39], v[88:91], a[40:43]
s_add_u32 m0, s22, 4096
v_mfma_f32_16x16x32_bf16 a[48:51], v[36:39], v[92:95], a[48:51]
ds_read_b64_tr_b16 v[136:137], v5 offset:16384
v_mfma_f32_16x16x32_bf16 a[56:59], v[36:39], v[96:99], a[56:59]
v_mfma_f32_16x16x32_bf16 a[4:7], v[40:43], v[68:71], a[4:7]
ds_read_b64_tr_b16 v[138:139], v5 offset:18432
v_mfma_f32_16x16x32_bf16 a[12:15], v[40:43], v[72:75], a[12:15]
buffer_load_dwordx4 v24, s[8:11], s18 offen offset:0 lds
v_mfma_f32_16x16x32_bf16 a[20:23], v[40:43], v[76:79], a[20:23]
ds_read_b64_tr_b16 v[140:141], v6 offset:16384
v_mfma_f32_16x16x32_bf16 a[28:31], v[40:43], v[80:83], a[28:31]
v_mfma_f32_16x16x32_bf16 a[36:39], v[40:43], v[84:87], a[36:39]
ds_read_b64_tr_b16 v[142:143], v6 offset:18432
v_mfma_f32_16x16x32_bf16 a[44:47], v[40:43], v[88:91], a[44:47]
v_mfma_f32_16x16x32_bf16 a[52:55], v[40:43], v[92:95], a[52:55]
ds_read_b64_tr_b16 v[144:145], v7 offset:16384
v_mfma_f32_16x16x32_bf16 a[60:63], v[40:43], v[96:99], a[60:63]
buffer_load_dwordx4 v25, s[8:11], s18 offen offset:1024 lds
v_mfma_f32_16x16x32_bf16 a[64:67], v[44:47], v[68:71], a[64:67]
ds_read_b64_tr_b16 v[146:147], v7 offset:18432
v_mfma_f32_16x16x32_bf16 a[72:75], v[44:47], v[72:75], a[72:75]
v_mfma_f32_16x16x32_bf16 a[80:83], v[44:47], v[76:79], a[80:83]
ds_read_b64_tr_b16 v[148:149], v8 offset:16384
v_mfma_f32_16x16x32_bf16 a[88:91], v[44:47], v[80:83], a[88:91]
v_mfma_f32_16x16x32_bf16 a[96:99], v[44:47], v[84:87], a[96:99]
ds_read_b64_tr_b16 v[150:151], v8 offset:18432
v_mfma_f32_16x16x32_bf16 a[104:107], v[44:47], v[88:91], a[104:107]
buffer_load_dwordx4 v26, s[8:11], s18 offen offset:2048 lds
v_mfma_f32_16x16x32_bf16 a[112:115], v[44:47], v[92:95], a[112:115]
ds_read_b64_tr_b16 v[152:153], v9 offset:16384
v_mfma_f32_16x16x32_bf16 a[120:123], v[44:47], v[96:99], a[120:123]
v_mfma_f32_16x16x32_bf16 a[68:71], v[48:51], v[68:71], a[68:71]
ds_read_b64_tr_b16 v[154:155], v9 offset:18432
v_mfma_f32_16x16x32_bf16 a[76:79], v[48:51], v[72:75], a[76:79]
v_mfma_f32_16x16x32_bf16 a[84:87], v[48:51], v[76:79], a[84:87]
ds_read_b64_tr_b16 v[156:157], v10 offset:16384
v_mfma_f32_16x16x32_bf16 a[92:95], v[48:51], v[80:83], a[92:95]
buffer_load_dwordx4 v27, s[8:11], s18 offen offset:3072 lds
v_mfma_f32_16x16x32_bf16 a[100:103], v[48:51], v[84:87], a[100:103]
ds_read_b64_tr_b16 v[158:159], v10 offset:18432
v_mfma_f32_16x16x32_bf16 a[108:111], v[48:51], v[88:91], a[108:111]
v_mfma_f32_16x16x32_bf16 a[116:119], v[48:51], v[92:95], a[116:119]
ds_read_b64_tr_b16 v[160:161], v11 offset:16384
v_mfma_f32_16x16x32_bf16 a[124:127], v[48:51], v[96:99], a[124:127]
s_mul_i32 s85, s19, 3
s_add_u32 s85, s85, s18
v_mfma_f32_16x16x32_bf16 a[128:131], v[52:55], v[68:71], a[128:131]
ds_read_b64_tr_b16 v[162:163], v11 offset:18432
v_mfma_f32_16x16x32_bf16 a[136:139], v[52:55], v[72:75], a[136:139]
buffer_load_dword v241, v240, s[8:11], s85 offen
v_mfma_f32_16x16x32_bf16 a[144:147], v[52:55], v[76:79], a[144:147]
ds_read_b128 v[104:107], v3 offset:2048
v_mfma_f32_16x16x32_bf16 a[152:155], v[52:55], v[80:83], a[152:155]
v_mfma_f32_16x16x32_bf16 a[160:163], v[52:55], v[84:87], a[160:163]
ds_read_b128 v[108:111], v3 offset:4096
v_mfma_f32_16x16x32_bf16 a[168:171], v[52:55], v[88:91], a[168:171]
v_mfma_f32_16x16x32_bf16 a[176:179], v[52:55], v[92:95], a[176:179]
ds_read_b128 v[112:115], v3 offset:6144
v_mfma_f32_16x16x32_bf16 a[184:187], v[52:55], v[96:99], a[184:187]
v_mfma_f32_16x16x32_bf16 a[132:135], v[56:59], v[68:71], a[132:135]
ds_read_b128 v[116:119], v3 offset:8192
v_mfma_f32_16x16x32_bf16 a[140:143], v[56:59], v[72:75], a[140:143]
v_mfma_f32_16x16x32_bf16 a[148:151], v[56:59], v[76:79], a[148:151]
ds_read_b128 v[120:123], v3 offset:10240
v_mfma_f32_16x16x32_bf16 a[156:159], v[56:59], v[80:83], a[156:159]
v_mfma_f32_16x16x32_bf16 a[164:167], v[56:59], v[84:87], a[164:167]
ds_read_b128 v[124:127], v3 offset:12288
v_mfma_f32_16x16x32_bf16 a[172:175], v[56:59], v[88:91], a[172:175]
v_mfma_f32_16x16x32_bf16 a[180:183], v[56:59], v[92:95], a[180:183]
ds_read_b128 v[128:131], v3 offset:14336
v_mfma_f32_16x16x32_bf16 a[188:191], v[56:59], v[96:99], a[188:191]
v_mfma_f32_16x16x32_bf16 a[192:195], v[60:63], v[68:71], a[192:195]
v_mfma_f32_16x16x32_bf16 a[200:203], v[60:63], v[72:75], a[200:203]
v_mfma_f32_16x16x32_bf16 a[208:211], v[60:63], v[76:79], a[208:211]
v_mfma_f32_16x16x32_bf16 a[216:219], v[60:63], v[80:83], a[216:219]
v_mfma_f32_16x16x32_bf16 a[224:227], v[60:63], v[84:87], a[224:227]
v_mfma_f32_16x16x32_bf16 a[232:235], v[60:63], v[88:91], a[232:235]
v_mfma_f32_16x16x32_bf16 a[240:243], v[60:63], v[92:95], a[240:243]
v_mfma_f32_16x16x32_bf16 a[248:251], v[60:63], v[96:99], a[248:251]
v_mfma_f32_16x16x32_bf16 a[196:199], v[64:67], v[68:71], a[196:199]
v_mfma_f32_16x16x32_bf16 a[204:207], v[64:67], v[72:75], a[204:207]
s_waitcnt vmcnt(1) lgkmcnt(0)
s_barrier
s_nop 1
v_mfma_f32_16x16x32_bf16 a[212:215], v[64:67], v[76:79], a[212:215]
s_add_u32 s27, s27, 128
s_add_u32 s28, s28, s19
v_mfma_f32_16x16x32_bf16 a[220:223], v[64:67], v[80:83], a[220:223]
s_sub_u32 s70, s70, 1
s_cmp_gt_i32 s70, 0
v_mfma_f32_16x16x32_bf16 a[228:231], v[64:67], v[84:87], a[228:231]
s_cselect_b32 s17, s27, s30
s_cselect_b32 s18, s28, s30
v_mfma_f32_16x16x32_bf16 a[236:239], v[64:67], v[88:91], a[236:239]
s_xor_b32 s21, s21, 0x8000
s_xor_b32 s22, s22, 0x8000
v_mfma_f32_16x16x32_bf16 a[244:247], v[64:67], v[92:95], a[244:247]
s_mov_b32 m0, s21
v_mfma_f32_16x16x32_bf16 a[252:255], v[64:67], v[96:99], a[252:255]
s_waitcnt lgkmcnt(0)
v_mfma_f32_16x16x32_bf16 a[0:3], v[100:103], v[132:135], a[0:3]
v_xor_b32 v2, 0x8000, v2
buffer_load_dwordx4 v12, s[4:7], s17 offen offset:0 lds
v_mfma_f32_16x16x32_bf16 a[8:11], v[100:103], v[136:139], a[8:11]
v_xor_b32 v4, 0x8000, v4
v_mfma_f32_16x16x32_bf16 a[16:19], v[100:103], v[140:143], a[16:19]
ds_read_b128 v[36:39], v2 offset:0
v_mfma_f32_16x16x32_bf16 a[24:27], v[100:103], v[144:147], a[24:27]
v_xor_b32 v5, 0x8000, v5
v_mfma_f32_16x16x32_bf16 a[32:35], v[100:103], v[148:151], a[32:35]
ds_read_b64_tr_b16 v[68:69], v4 offset:0
v_mfma_f32_16x16x32_bf16 a[40:43], v[100:103], v[152:155], a[40:43]
v_xor_b32 v6, 0x8000, v6
v_mfma_f32_16x16x32_bf16 a[48:51], v[100:103], v[156:159], a[48:51]
ds_read_b64_tr_b16 v[70:71], v4 offset:2048
buffer_load_dwordx4 v13, s[4:7], s17 offen offset:1024 lds
v_mfma_f32_16x16x32_bf16 a[56:59], v[100:103], v[160:163], a[56:59]
v_xor_b32 v7, 0x8000, v7
v_mfma_f32_16x16x32_bf16 a[4:7], v[104:107], v[132:135], a[4:7]
ds_read_b64_tr_b16 v[72:73], v5 offset:0
v_mfma_f32_16x16x32_bf16 a[12:15], v[104:107], v[136:139], a[12:15]
v_xor_b32 v8, 0x8000, v8
v_mfma_f32_16x16x32_bf16 a[20:23], v[104:107], v[140:143], a[20:23]
ds_read_b64_tr_b16 v[74:75], v5 offset:2048
v_mfma_f32_16x16x32_bf16 a[28:31], v[104:107], v[144:147], a[28:31]
v_xor_b32 v9, 0x8000, v9
v_mfma_f32_16x16x32_bf16 a[36:39], v[104:107], v[148:151], a[36:39]
ds_read_b64_tr_b16 v[76:77], v6 offset:0
buffer_load_dwordx4 v14, s[4:7], s17 offen offset:2048 lds
v_mfma_f32_16x16x32_bf16 a[44:47], v[104:107], v[152:155], a[44:47]
v_xor_b32 v10, 0x8000, v10
v_mfma_f32_16x16x32_bf16 a[52:55], v[104:107], v[156:159], a[52:55]
ds_read_b64_tr_b16 v[78:79], v6 offset:2048
v_mfma_f32_16x16x32_bf16 a[60:63], v[104:107], v[160:163], a[60:63]
v_xor_b32 v11, 0x8000, v11
v_mfma_f32_16x16x32_bf16 a[64:67], v[108:111], v[132:135], a[64:67]
ds_read_b64_tr_b16 v[80:81], v7 offset:0
v_mfma_f32_16x16x32_bf16 a[72:75], v[108:111], v[136:139], a[72:75]
v_xor_b32 v3, 0x8000, v3
v_mfma_f32_16x16x32_bf16 a[80:83], v[108:111], v[140:143], a[80:83]
ds_read_b64_tr_b16 v[82:83], v7 offset:2048
v_mfma_f32_16x16x32_bf16 a[88:91], v[108:111], v[144:147], a[88:91]
buffer_load_dwordx4 v15, s[4:7], s17 offen offset:3072 lds
v_mfma_f32_16x16x32_bf16 a[96:99], v[108:111], v[148:151], a[96:99]
ds_read_b64_tr_b16 v[84:85], v8 offset:0
v_mfma_f32_16x16x32_bf16 a[104:107], v[108:111], v[152:155], a[104:107]
s_add_u32 m0, s21, 4096
v_mfma_f32_16x16x32_bf16 a[112:115], v[108:111], v[156:159], a[112:115]
ds_read_b64_tr_b16 v[86:87], v8 offset:2048
v_mfma_f32_16x16x32_bf16 a[120:123], v[108:111], v[160:163], a[120:123]
v_mfma_f32_16x16x32_bf16 a[68:71], v[112:115], v[132:135], a[68:71]
ds_read_b64_tr_b16 v[88:89], v9 offset:0
v_mfma_f32_16x16x32_bf16 a[76:79], v[112:115], v[136:139], a[76:79]
buffer_load_dwordx4 v16, s[4:7], s17 offen offset:0 lds
v_mfma_f32_16x16x32_bf16 a[84:87], v[112:115], v[140:143], a[84:87]
ds_read_b64_tr_b16 v[90:91], v9 offset:2048
v_mfma_f32_16x16x32_bf16 a[92:95], v[112:115], v[144:147], a[92:95]
v_mfma_f32_16x16x32_bf16 a[100:103], v[112:115], v[148:151], a[100:103]
ds_read_b64_tr_b16 v[92:93], v10 offset:0
v_mfma_f32_16x16x32_bf16 a[108:111], v[112:115], v[152:155], a[108:111]
v_mfma_f32_16x16x32_bf16 a[116:119], v[112:115], v[156:159], a[116:119]
ds_read_b64_tr_b16 v[94:95], v10 offset:2048
v_mfma_f32_16x16x32_bf16 a[124:127], v[112:115], v[160:163], a[124:127]
buffer_load_dwordx4 v17, s[4:7], s17 offen offset:1024 lds
v_mfma_f32_16x16x32_bf16 a[128:131], v[116:119], v[132:135], a[128:131]
ds_read_b64_tr_b16 v[96:97], v11 offset:0
v_mfma_f32_16x16x32_bf16 a[136:139], v[116:119], v[136:139], a[136:139]
v_mfma_f32_16x16x32_bf16 a[144:147], v[116:119], v[140:143], a[144:147]
ds_read_b64_tr_b16 v[98:99], v11 offset:2048
v_mfma_f32_16x16x32_bf16 a[152:155], v[116:119], v[144:147], a[152:155]
v_mfma_f32_16x16x32_bf16 a[160:163], v[116:119], v[148:151], a[160:163]
ds_read_b128 v[40:43], v2 offset:2048
v_mfma_f32_16x16x32_bf16 a[168:171], v[116:119], v[152:155], a[168:171]
buffer_load_dwordx4 v18, s[4:7], s17 offen offset:2048 lds
v_mfma_f32_16x16x32_bf16 a[176:179], v[116:119], v[156:159], a[176:179]
ds_read_b128 v[44:47], v2 offset:4096
v_mfma_f32_16x16x32_bf16 a[184:187], v[116:119], v[160:163], a[184:187]
v_mfma_f32_16x16x32_bf16 a[132:135], v[120:123], v[132:135], a[132:135]
ds_read_b128 v[48:51], v2 offset:6144
v_mfma_f32_16x16x32_bf16 a[140:143], v[120:123], v[136:139], a[140:143]
v_mfma_f32_16x16x32_bf16 a[148:151], v[120:123], v[140:143], a[148:151]
ds_read_b128 v[52:55], v2 offset:8192
v_mfma_f32_16x16x32_bf16 a[156:159], v[120:123], v[144:147], a[156:159]
buffer_load_dwordx4 v19, s[4:7], s17 offen offset:3072 lds
v_mfma_f32_16x16x32_bf16 a[164:167], v[120:123], v[148:151], a[164:167]
ds_read_b128 v[56:59], v2 offset:10240
v_mfma_f32_16x16x32_bf16 a[172:175], v[120:123], v[152:155], a[172:175]
s_mov_b32 m0, s22
v_mfma_f32_16x16x32_bf16 a[180:183], v[120:123], v[156:159], a[180:183]
ds_read_b128 v[60:63], v2 offset:12288
v_mfma_f32_16x16x32_bf16 a[188:191], v[120:123], v[160:163], a[188:191]
v_mfma_f32_16x16x32_bf16 a[192:195], v[124:127], v[132:135], a[192:195]
ds_read_b128 v[64:67], v2 offset:14336
v_mfma_f32_16x16x32_bf16 a[200:203], v[124:127], v[136:139], a[200:203]
buffer_load_dwordx4 v20, s[8:11], s18 offen offset:0 lds
v_mfma_f32_16x16x32_bf16 a[208:211], v[124:127], v[140:143], a[208:211]
v_mfma_f32_16x16x32_bf16 a[216:219], v[124:127], v[144:147], a[216:219]
v_mfma_f32_16x16x32_bf16 a[224:227], v[124:127], v[148:151], a[224:227]
v_mfma_f32_16x16x32_bf16 a[232:235], v[124:127], v[152:155], a[232:235]
v_mfma_f32_16x16x32_bf16 a[240:243], v[124:127], v[156:159], a[240:243]
v_mfma_f32_16x16x32_bf16 a[248:251], v[124:127], v[160:163], a[248:251]
buffer_load_dwordx4 v21, s[8:11], s18 offen offset:1024 lds
v_mfma_f32_16x16x32_bf16 a[196:199], v[128:131], v[132:135], a[196:199]
v_mfma_f32_16x16x32_bf16 a[204:207], v[128:131], v[136:139], a[204:207]
v_mfma_f32_16x16x32_bf16 a[212:215], v[128:131], v[140:143], a[212:215]
v_mfma_f32_16x16x32_bf16 a[220:223], v[128:131], v[144:147], a[220:223]
v_mfma_f32_16x16x32_bf16 a[228:231], v[128:131], v[148:151], a[228:231]
v_mfma_f32_16x16x32_bf16 a[236:239], v[128:131], v[152:155], a[236:239]
buffer_load_dwordx4 v22, s[8:11], s18 offen offset:2048 lds
v_mfma_f32_16x16x32_bf16 a[244:247], v[128:131], v[156:159], a[244:247]
s_sub_u32 s20, s20, 1
v_mfma_f32_16x16x32_bf16 a[252:255], v[128:131], v[160:163], a[252:255]
s_cmp_lg_u32 s20, 0
s_cbranch_scc1 L_f_loop_0_1
s_branch L_f_kvdone
L_f_go_0_2:
s_waitcnt lgkmcnt(0)
v_mfma_f32_16x16x32_bf16 a[0:3], v[36:39], v[68:71], 0
ds_read_b128 v[100:103], v3 offset:0
v_mfma_f32_16x16x32_bf16 a[8:11], v[36:39], v[72:75], 0
s_cmp_ge_u32 s2, 128
s_cselect_b32 s80, s48, s42
s_cselect_b32 s81, s49, s43
s_mov_b32 s62, 401408
s_cselect_b32 s82, s62, 3670016
s_mov_b32 s83, 0x20000
v_mfma_f32_16x16x32_bf16 a[16:19], v[36:39], v[76:79], 0
ds_read_b64_tr_b16 v[132:133], v4 offset:16384
v_mfma_f32_16x16x32_bf16 a[24:27], v[36:39], v[80:83], 0
s_sub_u32 s61, s2, 128
s_cselect_b32 s61, s61, s61
s_cmp_ge_u32 s2, 128
s_cselect_b32 s61, s61, s2
s_cselect_b32 s62, 28, 32
v_mfma_f32_16x16x32_bf16 a[32:35], v[36:39], v[84:87], 0
ds_read_b64_tr_b16 v[134:135], v4 offset:18432
v_mfma_f32_16x16x32_bf16 a[40:43], v[36:39], v[88:91], 0
s_mul_i32 s62, s62, s61
s_mul_i32 s62, s62, 896
v_mfma_f32_16x16x32_bf16 a[48:51], v[36:39], v[92:95], 0
ds_read_b64_tr_b16 v[136:137], v5 offset:16384
v_mfma_f32_16x16x32_bf16 a[56:59], v[36:39], v[96:99], 0
s_lshl_b32 s90, s61, 10
s_cmp_ge_u32 s2, 128
s_mov_b32 s63, 79691776
s_cselect_b32 s63, s63, 75497472
v_mfma_f32_16x16x32_bf16 a[4:7], v[40:43], v[68:71], 0
ds_read_b64_tr_b16 v[138:139], v5 offset:18432
v_mfma_f32_16x16x32_bf16 a[12:15], v[40:43], v[72:75], 0
s_add_u32 s90, s90, s63
s_cmp_ge_u32 s2, 128
s_mov_b32 s63, 16384
s_cselect_b32 s100, s63, 131072
v_mfma_f32_16x16x32_bf16 a[20:23], v[40:43], v[76:79], 0
ds_read_b64_tr_b16 v[140:141], v6 offset:16384
v_mfma_f32_16x16x32_bf16 a[28:31], v[40:43], v[80:83], 0
s_cmp_ge_u32 s2, 144
s_cselect_b32 s62, s30, s62
s_cselect_b32 s90, s30, s90
s_cselect_b32 s100, 0, s100
s_mul_i32 s63, s16, 7168
v_mfma_f32_16x16x32_bf16 a[36:39], v[40:43], v[84:87], 0
ds_read_b64_tr_b16 v[142:143], v6 offset:18432
v_mfma_f32_16x16x32_bf16 a[44:47], v[40:43], v[88:91], 0
s_add_u32 s62, s62, s63
s_add_u32 s63, s63, 131072
v_mfma_f32_16x16x32_bf16 a[52:55], v[40:43], v[92:95], 0
ds_read_b64_tr_b16 v[144:145], v7 offset:16384
v_mfma_f32_16x16x32_bf16 a[60:63], v[40:43], v[96:99], 0
s_add_u32 m0, s63, 0
s_add_u32 s61, s62, 0
buffer_load_dwordx4 v1, s[80:83], s61 offen lds
s_add_u32 m0, s63, 1024
s_add_u32 s61, s62, 1024
buffer_load_dwordx4 v1, s[80:83], s61 offen lds
v_mfma_f32_16x16x32_bf16 a[64:67], v[44:47], v[68:71], 0
ds_read_b64_tr_b16 v[146:147], v7 offset:18432
v_mfma_f32_16x16x32_bf16 a[72:75], v[44:47], v[72:75], 0
s_add_u32 m0, s63, 2048
s_add_u32 s61, s62, 2048
buffer_load_dwordx4 v1, s[80:83], s61 offen lds
s_add_u32 m0, s63, 3072
s_add_u32 s61, s62, 3072
buffer_load_dwordx4 v1, s[80:83], s61 offen lds
v_mfma_f32_16x16x32_bf16 a[80:83], v[44:47], v[76:79], 0
ds_read_b64_tr_b16 v[148:149], v8 offset:16384
v_mfma_f32_16x16x32_bf16 a[88:91], v[44:47], v[80:83], 0
s_add_u32 m0, s63, 4096
s_add_u32 s61, s62, 4096
buffer_load_dwordx4 v1, s[80:83], s61 offen lds
s_add_u32 m0, s63, 5120
s_add_u32 s61, s62, 5120
buffer_load_dwordx4 v1, s[80:83], s61 offen lds
v_mfma_f32_16x16x32_bf16 a[96:99], v[44:47], v[84:87], 0
ds_read_b64_tr_b16 v[150:151], v8 offset:18432
v_mfma_f32_16x16x32_bf16 a[104:107], v[44:47], v[88:91], 0
s_add_u32 m0, s63, 6144
s_add_u32 s61, s62, 6144
buffer_load_dwordx4 v1, s[80:83], s61 offen lds
v_and_b32 v28, 63, v0
v_mfma_f32_16x16x32_bf16 a[112:115], v[44:47], v[92:95], 0
ds_read_b64_tr_b16 v[152:153], v9 offset:16384
v_mfma_f32_16x16x32_bf16 a[120:123], v[44:47], v[96:99], 0
v_and_b32 v29, 15, v28
v_lshrrev_b32 v30, 4, v28
v_mfma_f32_16x16x32_bf16 a[68:71], v[48:51], v[68:71], 0
ds_read_b64_tr_b16 v[154:155], v9 offset:18432
v_mfma_f32_16x16x32_bf16 a[76:79], v[48:51], v[72:75], 0
v_bfe_u32 v31, v28, 2, 2
v_and_b32 v32, 3, v28
v_mfma_f32_16x16x32_bf16 a[84:87], v[48:51], v[76:79], 0
ds_read_b64_tr_b16 v[156:157], v10 offset:16384
v_mfma_f32_16x16x32_bf16 a[92:95], v[48:51], v[80:83], 0
v_lshl_add_u32 v33, v30, 2, v31
v_mul_u32_u24 v33, 896, v33
v_mfma_f32_16x16x32_bf16 a[100:103], v[48:51], v[84:87], 0
ds_read_b64_tr_b16 v[158:159], v10 offset:18432
v_mfma_f32_16x16x32_bf16 a[108:111], v[48:51], v[88:91], 0
v_lshl_add_u32 v33, v32, 3, v33
s_mul_i32 s62, s16, 224
v_mfma_f32_16x16x32_bf16 a[116:119], v[48:51], v[92:95], 0
ds_read_b64_tr_b16 v[160:161], v11 offset:16384
v_mfma_f32_16x16x32_bf16 a[124:127], v[48:51], v[96:99], 0
s_mov_b32 s85, 7736
v_mfma_f32_16x16x32_bf16 a[128:131], v[52:55], v[68:71], 0
ds_read_b64_tr_b16 v[162:163], v11 offset:18432
v_mfma_f32_16x16x32_bf16 a[136:139], v[52:55], v[72:75], 0
s_bitcmp1_b32 s85, s20
s_cbranch_scc1 L_k1_gr_0_2_1_0
buffer_load_dword v241, v240, s[4:7], 0 offen
s_branch L_k1_gd_0_2_1_0
L_k1_gr_0_2_1_0:
global_load_dword v241, v[242:243], off
v_mov_b32 v242, v244
v_mov_b32 v243, v245
v_mov_b32 v244, v246
v_mov_b32 v245, v247
v_mov_b32 v246, v248
v_mov_b32 v247, v249
L_k1_gd_0_2_1_0:
v_mfma_f32_16x16x32_bf16 a[144:147], v[52:55], v[76:79], 0
ds_read_b128 v[104:107], v3 offset:2048
v_mfma_f32_16x16x32_bf16 a[152:155], v[52:55], v[80:83], 0
s_add_u32 s62, s62, 131072
v_add_u32 v178, s62, v33
v_mfma_f32_16x16x32_bf16 a[160:163], v[52:55], v[84:87], 0
ds_read_b128 v[108:111], v3 offset:4096
v_mfma_f32_16x16x32_bf16 a[168:171], v[52:55], v[88:91], 0
v_mfma_f32_16x16x32_bf16 a[176:179], v[52:55], v[92:95], 0
ds_read_b128 v[112:115], v3 offset:6144
v_mfma_f32_16x16x32_bf16 a[184:187], v[52:55], v[96:99], 0
v_mfma_f32_16x16x32_bf16 a[132:135], v[56:59], v[68:71], 0
ds_read_b128 v[116:119], v3 offset:8192
v_mfma_f32_16x16x32_bf16 a[140:143], v[56:59], v[72:75], 0
v_mfma_f32_16x16x32_bf16 a[148:151], v[56:59], v[76:79], 0
ds_read_b128 v[120:123], v3 offset:10240
v_mfma_f32_16x16x32_bf16 a[156:159], v[56:59], v[80:83], 0
v_mfma_f32_16x16x32_bf16 a[164:167], v[56:59], v[84:87], 0
ds_read_b128 v[124:127], v3 offset:12288
v_mfma_f32_16x16x32_bf16 a[172:175], v[56:59], v[88:91], 0
v_mfma_f32_16x16x32_bf16 a[180:183], v[56:59], v[92:95], 0
ds_read_b128 v[128:131], v3 offset:14336
v_mfma_f32_16x16x32_bf16 a[188:191], v[56:59], v[96:99], 0
v_mfma_f32_16x16x32_bf16 a[192:195], v[60:63], v[68:71], 0
v_mfma_f32_16x16x32_bf16 a[200:203], v[60:63], v[72:75], 0
v_mfma_f32_16x16x32_bf16 a[208:211], v[60:63], v[76:79], 0
v_mfma_f32_16x16x32_bf16 a[216:219], v[60:63], v[80:83], 0
v_mfma_f32_16x16x32_bf16 a[224:227], v[60:63], v[84:87], 0
v_mfma_f32_16x16x32_bf16 a[232:235], v[60:63], v[88:91], 0
v_mfma_f32_16x16x32_bf16 a[240:243], v[60:63], v[92:95], 0
v_mfma_f32_16x16x32_bf16 a[248:251], v[60:63], v[96:99], 0
v_mfma_f32_16x16x32_bf16 a[196:199], v[64:67], v[68:71], 0
v_mfma_f32_16x16x32_bf16 a[204:207], v[64:67], v[72:75], 0
s_waitcnt vmcnt(11) lgkmcnt(0)
s_barrier
s_nop 3
v_mfma_f32_16x16x32_bf16 a[212:215], v[64:67], v[76:79], 0
s_add_u32 s27, s27, 128
s_add_u32 s28, s28, s19
v_mfma_f32_16x16x32_bf16 a[220:223], v[64:67], v[80:83], 0
s_sub_u32 s70, s70, 1
s_cmp_gt_i32 s70, 0
v_mfma_f32_16x16x32_bf16 a[228:231], v[64:67], v[84:87], 0
s_cselect_b32 s17, s27, s30
s_cselect_b32 s18, s28, s30
v_mfma_f32_16x16x32_bf16 a[236:239], v[64:67], v[88:91], 0
s_xor_b32 s21, s21, 0x8000
s_xor_b32 s22, s22, 0x8000
v_mfma_f32_16x16x32_bf16 a[244:247], v[64:67], v[92:95], 0
s_mov_b32 m0, s21
v_mfma_f32_16x16x32_bf16 a[252:255], v[64:67], v[96:99], 0
s_waitcnt lgkmcnt(0)
v_mfma_f32_16x16x32_bf16 a[0:3], v[100:103], v[132:135], a[0:3]
v_xor_b32 v2, 0x8000, v2
buffer_load_dwordx4 v12, s[4:7], s17 offen offset:0 lds
v_mfma_f32_16x16x32_bf16 a[8:11], v[100:103], v[136:139], a[8:11]
v_xor_b32 v4, 0x8000, v4
v_mfma_f32_16x16x32_bf16 a[16:19], v[100:103], v[140:143], a[16:19]
ds_read_b128 v[36:39], v2 offset:0
v_mfma_f32_16x16x32_bf16 a[24:27], v[100:103], v[144:147], a[24:27]
v_xor_b32 v5, 0x8000, v5
v_mfma_f32_16x16x32_bf16 a[32:35], v[100:103], v[148:151], a[32:35]
ds_read_b64_tr_b16 v[68:69], v4 offset:0
v_mfma_f32_16x16x32_bf16 a[40:43], v[100:103], v[152:155], a[40:43]
v_xor_b32 v6, 0x8000, v6
v_mfma_f32_16x16x32_bf16 a[48:51], v[100:103], v[156:159], a[48:51]
ds_read_b64_tr_b16 v[70:71], v4 offset:2048
buffer_load_dwordx4 v13, s[4:7], s17 offen offset:1024 lds
v_mfma_f32_16x16x32_bf16 a[56:59], v[100:103], v[160:163], a[56:59]
v_xor_b32 v7, 0x8000, v7
v_mfma_f32_16x16x32_bf16 a[4:7], v[104:107], v[132:135], a[4:7]
ds_read_b64_tr_b16 v[72:73], v5 offset:0
v_mfma_f32_16x16x32_bf16 a[12:15], v[104:107], v[136:139], a[12:15]
v_xor_b32 v8, 0x8000, v8
v_mfma_f32_16x16x32_bf16 a[20:23], v[104:107], v[140:143], a[20:23]
ds_read_b64_tr_b16 v[74:75], v5 offset:2048
v_mfma_f32_16x16x32_bf16 a[28:31], v[104:107], v[144:147], a[28:31]
v_xor_b32 v9, 0x8000, v9
v_mfma_f32_16x16x32_bf16 a[36:39], v[104:107], v[148:151], a[36:39]
ds_read_b64_tr_b16 v[76:77], v6 offset:0
buffer_load_dwordx4 v14, s[4:7], s17 offen offset:2048 lds
v_mfma_f32_16x16x32_bf16 a[44:47], v[104:107], v[152:155], a[44:47]
v_xor_b32 v10, 0x8000, v10
v_mfma_f32_16x16x32_bf16 a[52:55], v[104:107], v[156:159], a[52:55]
ds_read_b64_tr_b16 v[78:79], v6 offset:2048
v_mfma_f32_16x16x32_bf16 a[60:63], v[104:107], v[160:163], a[60:63]
v_xor_b32 v11, 0x8000, v11
v_mfma_f32_16x16x32_bf16 a[64:67], v[108:111], v[132:135], a[64:67]
ds_read_b64_tr_b16 v[80:81], v7 offset:0
v_mfma_f32_16x16x32_bf16 a[72:75], v[108:111], v[136:139], a[72:75]
v_xor_b32 v3, 0x8000, v3
v_mfma_f32_16x16x32_bf16 a[80:83], v[108:111], v[140:143], a[80:83]
ds_read_b64_tr_b16 v[82:83], v7 offset:2048
v_mfma_f32_16x16x32_bf16 a[88:91], v[108:111], v[144:147], a[88:91]
buffer_load_dwordx4 v15, s[4:7], s17 offen offset:3072 lds
v_mfma_f32_16x16x32_bf16 a[96:99], v[108:111], v[148:151], a[96:99]
ds_read_b64_tr_b16 v[84:85], v8 offset:0
v_mfma_f32_16x16x32_bf16 a[104:107], v[108:111], v[152:155], a[104:107]
s_add_u32 m0, s21, 4096
v_mfma_f32_16x16x32_bf16 a[112:115], v[108:111], v[156:159], a[112:115]
ds_read_b64_tr_b16 v[86:87], v8 offset:2048
v_mfma_f32_16x16x32_bf16 a[120:123], v[108:111], v[160:163], a[120:123]
v_mfma_f32_16x16x32_bf16 a[68:71], v[112:115], v[132:135], a[68:71]
ds_read_b64_tr_b16 v[88:89], v9 offset:0
v_mfma_f32_16x16x32_bf16 a[76:79], v[112:115], v[136:139], a[76:79]
buffer_load_dwordx4 v16, s[4:7], s17 offen offset:0 lds
v_mfma_f32_16x16x32_bf16 a[84:87], v[112:115], v[140:143], a[84:87]
ds_read_b64_tr_b16 v[90:91], v9 offset:2048
v_mfma_f32_16x16x32_bf16 a[92:95], v[112:115], v[144:147], a[92:95]
v_mfma_f32_16x16x32_bf16 a[100:103], v[112:115], v[148:151], a[100:103]
ds_read_b64_tr_b16 v[92:93], v10 offset:0
v_mfma_f32_16x16x32_bf16 a[108:111], v[112:115], v[152:155], a[108:111]
v_mfma_f32_16x16x32_bf16 a[116:119], v[112:115], v[156:159], a[116:119]
ds_read_b64_tr_b16 v[94:95], v10 offset:2048
v_mfma_f32_16x16x32_bf16 a[124:127], v[112:115], v[160:163], a[124:127]
buffer_load_dwordx4 v17, s[4:7], s17 offen offset:1024 lds
v_mfma_f32_16x16x32_bf16 a[128:131], v[116:119], v[132:135], a[128:131]
ds_read_b64_tr_b16 v[96:97], v11 offset:0
v_mfma_f32_16x16x32_bf16 a[136:139], v[116:119], v[136:139], a[136:139]
v_mfma_f32_16x16x32_bf16 a[144:147], v[116:119], v[140:143], a[144:147]
ds_read_b64_tr_b16 v[98:99], v11 offset:2048
v_mfma_f32_16x16x32_bf16 a[152:155], v[116:119], v[144:147], a[152:155]
v_mfma_f32_16x16x32_bf16 a[160:163], v[116:119], v[148:151], a[160:163]
ds_read_b128 v[40:43], v2 offset:2048
v_mfma_f32_16x16x32_bf16 a[168:171], v[116:119], v[152:155], a[168:171]
buffer_load_dwordx4 v18, s[4:7], s17 offen offset:2048 lds
v_mfma_f32_16x16x32_bf16 a[176:179], v[116:119], v[156:159], a[176:179]
ds_read_b128 v[44:47], v2 offset:4096
v_mfma_f32_16x16x32_bf16 a[184:187], v[116:119], v[160:163], a[184:187]
v_mfma_f32_16x16x32_bf16 a[132:135], v[120:123], v[132:135], a[132:135]
ds_read_b128 v[48:51], v2 offset:6144
v_mfma_f32_16x16x32_bf16 a[140:143], v[120:123], v[136:139], a[140:143]
v_mfma_f32_16x16x32_bf16 a[148:151], v[120:123], v[140:143], a[148:151]
ds_read_b128 v[52:55], v2 offset:8192
v_mfma_f32_16x16x32_bf16 a[156:159], v[120:123], v[144:147], a[156:159]
buffer_load_dwordx4 v19, s[4:7], s17 offen offset:3072 lds
v_mfma_f32_16x16x32_bf16 a[164:167], v[120:123], v[148:151], a[164:167]
ds_read_b128 v[56:59], v2 offset:10240
v_mfma_f32_16x16x32_bf16 a[172:175], v[120:123], v[152:155], a[172:175]
s_mov_b32 m0, s22
v_mfma_f32_16x16x32_bf16 a[180:183], v[120:123], v[156:159], a[180:183]
ds_read_b128 v[60:63], v2 offset:12288
v_mfma_f32_16x16x32_bf16 a[188:191], v[120:123], v[160:163], a[188:191]
v_mfma_f32_16x16x32_bf16 a[192:195], v[124:127], v[132:135], a[192:195]
ds_read_b128 v[64:67], v2 offset:14336
v_mfma_f32_16x16x32_bf16 a[200:203], v[124:127], v[136:139], a[200:203]
buffer_load_dwordx4 v20, s[8:11], s18 offen offset:0 lds
v_mfma_f32_16x16x32_bf16 a[208:211], v[124:127], v[140:143], a[208:211]
v_mfma_f32_16x16x32_bf16 a[216:219], v[124:127], v[144:147], a[216:219]
v_mfma_f32_16x16x32_bf16 a[224:227], v[124:127], v[148:151], a[224:227]
v_mfma_f32_16x16x32_bf16 a[232:235], v[124:127], v[152:155], a[232:235]
v_mfma_f32_16x16x32_bf16 a[240:243], v[124:127], v[156:159], a[240:243]
v_mfma_f32_16x16x32_bf16 a[248:251], v[124:127], v[160:163], a[248:251]
buffer_load_dwordx4 v21, s[8:11], s18 offen offset:1024 lds
v_mfma_f32_16x16x32_bf16 a[196:199], v[128:131], v[132:135], a[196:199]
v_mfma_f32_16x16x32_bf16 a[204:207], v[128:131], v[136:139], a[204:207]
v_mfma_f32_16x16x32_bf16 a[212:215], v[128:131], v[140:143], a[212:215]
v_mfma_f32_16x16x32_bf16 a[220:223], v[128:131], v[144:147], a[220:223]
v_mfma_f32_16x16x32_bf16 a[228:231], v[128:131], v[148:151], a[228:231]
v_mfma_f32_16x16x32_bf16 a[236:239], v[128:131], v[152:155], a[236:239]
buffer_load_dwordx4 v22, s[8:11], s18 offen offset:2048 lds
v_mfma_f32_16x16x32_bf16 a[244:247], v[128:131], v[156:159], a[244:247]
s_sub_u32 s20, s20, 1
v_mfma_f32_16x16x32_bf16 a[252:255], v[128:131], v[160:163], a[252:255]
s_cmp_lg_u32 s20, 0
.p2align 6
L_f_loop_0_2:
s_waitcnt lgkmcnt(0)
v_mfma_f32_16x16x32_bf16 a[0:3], v[36:39], v[68:71], a[0:3]
ds_read_b128 v[100:103], v3 offset:0
v_mfma_f32_16x16x32_bf16 a[8:11], v[36:39], v[72:75], a[8:11]
v_mfma_f32_16x16x32_bf16 a[16:19], v[36:39], v[76:79], a[16:19]
ds_read_b64_tr_b16 v[132:133], v4 offset:16384
v_mfma_f32_16x16x32_bf16 a[24:27], v[36:39], v[80:83], a[24:27]
buffer_load_dwordx4 v23, s[8:11], s18 offen offset:3072 lds
v_mfma_f32_16x16x32_bf16 a[32:35], v[36:39], v[84:87], a[32:35]
ds_read_b64_tr_b16 v[134:135], v4 offset:18432
v_mfma_f32_16x16x32_bf16 a[40:43], v[36:39], v[88:91], a[40:43]
s_add_u32 m0, s22, 4096
v_mfma_f32_16x16x32_bf16 a[48:51], v[36:39], v[92:95], a[48:51]
ds_read_b64_tr_b16 v[136:137], v5 offset:16384
v_mfma_f32_16x16x32_bf16 a[56:59], v[36:39], v[96:99], a[56:59]
v_mfma_f32_16x16x32_bf16 a[4:7], v[40:43], v[68:71], a[4:7]
ds_read_b64_tr_b16 v[138:139], v5 offset:18432
v_mfma_f32_16x16x32_bf16 a[12:15], v[40:43], v[72:75], a[12:15]
buffer_load_dwordx4 v24, s[8:11], s18 offen offset:0 lds
v_mfma_f32_16x16x32_bf16 a[20:23], v[40:43], v[76:79], a[20:23]
ds_read_b64_tr_b16 v[140:141], v6 offset:16384
v_mfma_f32_16x16x32_bf16 a[28:31], v[40:43], v[80:83], a[28:31]
v_mfma_f32_16x16x32_bf16 a[36:39], v[40:43], v[84:87], a[36:39]
ds_read_b64_tr_b16 v[142:143], v6 offset:18432
v_mfma_f32_16x16x32_bf16 a[44:47], v[40:43], v[88:91], a[44:47]
v_mfma_f32_16x16x32_bf16 a[52:55], v[40:43], v[92:95], a[52:55]
ds_read_b64_tr_b16 v[144:145], v7 offset:16384
v_mfma_f32_16x16x32_bf16 a[60:63], v[40:43], v[96:99], a[60:63]
buffer_load_dwordx4 v25, s[8:11], s18 offen offset:1024 lds
v_mfma_f32_16x16x32_bf16 a[64:67], v[44:47], v[68:71], a[64:67]
ds_read_b64_tr_b16 v[146:147], v7 offset:18432
v_mfma_f32_16x16x32_bf16 a[72:75], v[44:47], v[72:75], a[72:75]
v_mfma_f32_16x16x32_bf16 a[80:83], v[44:47], v[76:79], a[80:83]
ds_read_b64_tr_b16 v[148:149], v8 offset:16384
v_mfma_f32_16x16x32_bf16 a[88:91], v[44:47], v[80:83], a[88:91]
v_mfma_f32_16x16x32_bf16 a[96:99], v[44:47], v[84:87], a[96:99]
ds_read_b64_tr_b16 v[150:151], v8 offset:18432
v_mfma_f32_16x16x32_bf16 a[104:107], v[44:47], v[88:91], a[104:107]
buffer_load_dwordx4 v26, s[8:11], s18 offen offset:2048 lds
v_mfma_f32_16x16x32_bf16 a[112:115], v[44:47], v[92:95], a[112:115]
ds_read_b64_tr_b16 v[152:153], v9 offset:16384
v_mfma_f32_16x16x32_bf16 a[120:123], v[44:47], v[96:99], a[120:123]
v_mfma_f32_16x16x32_bf16 a[68:71], v[48:51], v[68:71], a[68:71]
ds_read_b64_tr_b16 v[154:155], v9 offset:18432
v_mfma_f32_16x16x32_bf16 a[76:79], v[48:51], v[72:75], a[76:79]
v_mfma_f32_16x16x32_bf16 a[84:87], v[48:51], v[76:79], a[84:87]
ds_read_b64_tr_b16 v[156:157], v10 offset:16384
v_mfma_f32_16x16x32_bf16 a[92:95], v[48:51], v[80:83], a[92:95]
buffer_load_dwordx4 v27, s[8:11], s18 offen offset:3072 lds
v_mfma_f32_16x16x32_bf16 a[100:103], v[48:51], v[84:87], a[100:103]
ds_read_b64_tr_b16 v[158:159], v10 offset:18432
v_mfma_f32_16x16x32_bf16 a[108:111], v[48:51], v[88:91], a[108:111]
v_mfma_f32_16x16x32_bf16 a[116:119], v[48:51], v[92:95], a[116:119]
ds_read_b64_tr_b16 v[160:161], v11 offset:16384
v_mfma_f32_16x16x32_bf16 a[124:127], v[48:51], v[96:99], a[124:127]
s_mov_b32 s85, 7736
v_mfma_f32_16x16x32_bf16 a[128:131], v[52:55], v[68:71], a[128:131]
ds_read_b64_tr_b16 v[162:163], v11 offset:18432
v_mfma_f32_16x16x32_bf16 a[136:139], v[52:55], v[72:75], a[136:139]
s_bitcmp1_b32 s85, s20
s_cbranch_scc1 L_k1_gr_0_2_0_0
buffer_load_dword v241, v240, s[4:7], 0 offen
s_branch L_k1_gd_0_2_0_0
L_k1_gr_0_2_0_0:
global_load_dword v241, v[242:243], off
v_mov_b32 v242, v244
v_mov_b32 v243, v245
v_mov_b32 v244, v246
v_mov_b32 v245, v247
v_mov_b32 v246, v248
v_mov_b32 v247, v249
L_k1_gd_0_2_0_0:
v_mfma_f32_16x16x32_bf16 a[144:147], v[52:55], v[76:79], a[144:147]
ds_read_b128 v[104:107], v3 offset:2048
v_mfma_f32_16x16x32_bf16 a[152:155], v[52:55], v[80:83], a[152:155]
v_mfma_f32_16x16x32_bf16 a[160:163], v[52:55], v[84:87], a[160:163]
ds_read_b128 v[108:111], v3 offset:4096
v_mfma_f32_16x16x32_bf16 a[168:171], v[52:55], v[88:91], a[168:171]
s_cmp_eq_u32 s20, 7
s_cbranch_scc1 L_f_loc_0_2_0
L_f_locret_0_2_0:
v_mfma_f32_16x16x32_bf16 a[176:179], v[52:55], v[92:95], a[176:179]
ds_read_b128 v[112:115], v3 offset:6144
v_mfma_f32_16x16x32_bf16 a[184:187], v[52:55], v[96:99], a[184:187]
v_mfma_f32_16x16x32_bf16 a[132:135], v[56:59], v[68:71], a[132:135]
ds_read_b128 v[116:119], v3 offset:8192
v_mfma_f32_16x16x32_bf16 a[140:143], v[56:59], v[72:75], a[140:143]
v_mfma_f32_16x16x32_bf16 a[148:151], v[56:59], v[76:79], a[148:151]
ds_read_b128 v[120:123], v3 offset:10240
v_mfma_f32_16x16x32_bf16 a[156:159], v[56:59], v[80:83], a[156:159]
v_mfma_f32_16x16x32_bf16 a[164:167], v[56:59], v[84:87], a[164:167]
ds_read_b128 v[124:127], v3 offset:12288
v_mfma_f32_16x16x32_bf16 a[172:175], v[56:59], v[88:91], a[172:175]
v_mfma_f32_16x16x32_bf16 a[180:183], v[56:59], v[92:95], a[180:183]
ds_read_b128 v[128:131], v3 offset:14336
v_mfma_f32_16x16x32_bf16 a[188:191], v[56:59], v[96:99], a[188:191]
v_mfma_f32_16x16x32_bf16 a[192:195], v[60:63], v[68:71], a[192:195]
v_mfma_f32_16x16x32_bf16 a[200:203], v[60:63], v[72:75], a[200:203]
v_mfma_f32_16x16x32_bf16 a[208:211], v[60:63], v[76:79], a[208:211]
v_mfma_f32_16x16x32_bf16 a[216:219], v[60:63], v[80:83], a[216:219]
v_mfma_f32_16x16x32_bf16 a[224:227], v[60:63], v[84:87], a[224:227]
v_mfma_f32_16x16x32_bf16 a[232:235], v[60:63], v[88:91], a[232:235]
v_mfma_f32_16x16x32_bf16 a[240:243], v[60:63], v[92:95], a[240:243]
v_mfma_f32_16x16x32_bf16 a[248:251], v[60:63], v[96:99], a[248:251]
v_mfma_f32_16x16x32_bf16 a[196:199], v[64:67], v[68:71], a[196:199]
v_mfma_f32_16x16x32_bf16 a[204:207], v[64:67], v[72:75], a[204:207]
s_waitcnt vmcnt(1) lgkmcnt(0)
s_barrier
s_nop 3
v_mfma_f32_16x16x32_bf16 a[212:215], v[64:67], v[76:79], a[212:215]
s_add_u32 s27, s27, 128
s_add_u32 s28, s28, s19
v_mfma_f32_16x16x32_bf16 a[220:223], v[64:67], v[80:83], a[220:223]
s_sub_u32 s70, s70, 1
s_cmp_gt_i32 s70, 0
v_mfma_f32_16x16x32_bf16 a[228:231], v[64:67], v[84:87], a[228:231]
s_cselect_b32 s17, s27, s30
s_cselect_b32 s18, s28, s30
v_mfma_f32_16x16x32_bf16 a[236:239], v[64:67], v[88:91], a[236:239]
s_xor_b32 s21, s21, 0x8000
s_xor_b32 s22, s22, 0x8000
v_mfma_f32_16x16x32_bf16 a[244:247], v[64:67], v[92:95], a[244:247]
s_mov_b32 m0, s21
v_mfma_f32_16x16x32_bf16 a[252:255], v[64:67], v[96:99], a[252:255]
s_waitcnt lgkmcnt(0)
v_mfma_f32_16x16x32_bf16 a[0:3], v[100:103], v[132:135], a[0:3]
v_xor_b32 v2, 0x8000, v2
buffer_load_dwordx4 v12, s[4:7], s17 offen offset:0 lds
v_mfma_f32_16x16x32_bf16 a[8:11], v[100:103], v[136:139], a[8:11]
v_xor_b32 v4, 0x8000, v4
v_mfma_f32_16x16x32_bf16 a[16:19], v[100:103], v[140:143], a[16:19]
ds_read_b128 v[36:39], v2 offset:0
v_mfma_f32_16x16x32_bf16 a[24:27], v[100:103], v[144:147], a[24:27]
v_xor_b32 v5, 0x8000, v5
v_mfma_f32_16x16x32_bf16 a[32:35], v[100:103], v[148:151], a[32:35]
ds_read_b64_tr_b16 v[68:69], v4 offset:0
v_mfma_f32_16x16x32_bf16 a[40:43], v[100:103], v[152:155], a[40:43]
v_xor_b32 v6, 0x8000, v6
v_mfma_f32_16x16x32_bf16 a[48:51], v[100:103], v[156:159], a[48:51]
ds_read_b64_tr_b16 v[70:71], v4 offset:2048
buffer_load_dwordx4 v13, s[4:7], s17 offen offset:1024 lds
v_mfma_f32_16x16x32_bf16 a[56:59], v[100:103], v[160:163], a[56:59]
v_xor_b32 v7, 0x8000, v7
v_mfma_f32_16x16x32_bf16 a[4:7], v[104:107], v[132:135], a[4:7]
ds_read_b64_tr_b16 v[72:73], v5 offset:0
v_mfma_f32_16x16x32_bf16 a[12:15], v[104:107], v[136:139], a[12:15]
v_xor_b32 v8, 0x8000, v8
v_mfma_f32_16x16x32_bf16 a[20:23], v[104:107], v[140:143], a[20:23]
ds_read_b64_tr_b16 v[74:75], v5 offset:2048
v_mfma_f32_16x16x32_bf16 a[28:31], v[104:107], v[144:147], a[28:31]
v_xor_b32 v9, 0x8000, v9
v_mfma_f32_16x16x32_bf16 a[36:39], v[104:107], v[148:151], a[36:39]
ds_read_b64_tr_b16 v[76:77], v6 offset:0
buffer_load_dwordx4 v14, s[4:7], s17 offen offset:2048 lds
v_mfma_f32_16x16x32_bf16 a[44:47], v[104:107], v[152:155], a[44:47]
v_xor_b32 v10, 0x8000, v10
v_mfma_f32_16x16x32_bf16 a[52:55], v[104:107], v[156:159], a[52:55]
ds_read_b64_tr_b16 v[78:79], v6 offset:2048
v_mfma_f32_16x16x32_bf16 a[60:63], v[104:107], v[160:163], a[60:63]
v_xor_b32 v11, 0x8000, v11
v_mfma_f32_16x16x32_bf16 a[64:67], v[108:111], v[132:135], a[64:67]
ds_read_b64_tr_b16 v[80:81], v7 offset:0
v_mfma_f32_16x16x32_bf16 a[72:75], v[108:111], v[136:139], a[72:75]
v_xor_b32 v3, 0x8000, v3
v_mfma_f32_16x16x32_bf16 a[80:83], v[108:111], v[140:143], a[80:83]
ds_read_b64_tr_b16 v[82:83], v7 offset:2048
v_mfma_f32_16x16x32_bf16 a[88:91], v[108:111], v[144:147], a[88:91]
buffer_load_dwordx4 v15, s[4:7], s17 offen offset:3072 lds
v_mfma_f32_16x16x32_bf16 a[96:99], v[108:111], v[148:151], a[96:99]
ds_read_b64_tr_b16 v[84:85], v8 offset:0
v_mfma_f32_16x16x32_bf16 a[104:107], v[108:111], v[152:155], a[104:107]
s_add_u32 m0, s21, 4096
v_mfma_f32_16x16x32_bf16 a[112:115], v[108:111], v[156:159], a[112:115]
ds_read_b64_tr_b16 v[86:87], v8 offset:2048
v_mfma_f32_16x16x32_bf16 a[120:123], v[108:111], v[160:163], a[120:123]
v_mfma_f32_16x16x32_bf16 a[68:71], v[112:115], v[132:135], a[68:71]
ds_read_b64_tr_b16 v[88:89], v9 offset:0
v_mfma_f32_16x16x32_bf16 a[76:79], v[112:115], v[136:139], a[76:79]
buffer_load_dwordx4 v16, s[4:7], s17 offen offset:0 lds
v_mfma_f32_16x16x32_bf16 a[84:87], v[112:115], v[140:143], a[84:87]
ds_read_b64_tr_b16 v[90:91], v9 offset:2048
v_mfma_f32_16x16x32_bf16 a[92:95], v[112:115], v[144:147], a[92:95]
v_mfma_f32_16x16x32_bf16 a[100:103], v[112:115], v[148:151], a[100:103]
ds_read_b64_tr_b16 v[92:93], v10 offset:0
v_mfma_f32_16x16x32_bf16 a[108:111], v[112:115], v[152:155], a[108:111]
v_mfma_f32_16x16x32_bf16 a[116:119], v[112:115], v[156:159], a[116:119]
ds_read_b64_tr_b16 v[94:95], v10 offset:2048
v_mfma_f32_16x16x32_bf16 a[124:127], v[112:115], v[160:163], a[124:127]
buffer_load_dwordx4 v17, s[4:7], s17 offen offset:1024 lds
v_mfma_f32_16x16x32_bf16 a[128:131], v[116:119], v[132:135], a[128:131]
ds_read_b64_tr_b16 v[96:97], v11 offset:0
v_mfma_f32_16x16x32_bf16 a[136:139], v[116:119], v[136:139], a[136:139]
v_mfma_f32_16x16x32_bf16 a[144:147], v[116:119], v[140:143], a[144:147]
ds_read_b64_tr_b16 v[98:99], v11 offset:2048
v_mfma_f32_16x16x32_bf16 a[152:155], v[116:119], v[144:147], a[152:155]
v_mfma_f32_16x16x32_bf16 a[160:163], v[116:119], v[148:151], a[160:163]
ds_read_b128 v[40:43], v2 offset:2048
v_mfma_f32_16x16x32_bf16 a[168:171], v[116:119], v[152:155], a[168:171]
buffer_load_dwordx4 v18, s[4:7], s17 offen offset:2048 lds
v_mfma_f32_16x16x32_bf16 a[176:179], v[116:119], v[156:159], a[176:179]
ds_read_b128 v[44:47], v2 offset:4096
v_mfma_f32_16x16x32_bf16 a[184:187], v[116:119], v[160:163], a[184:187]
v_mfma_f32_16x16x32_bf16 a[132:135], v[120:123], v[132:135], a[132:135]
ds_read_b128 v[48:51], v2 offset:6144
v_mfma_f32_16x16x32_bf16 a[140:143], v[120:123], v[136:139], a[140:143]
v_mfma_f32_16x16x32_bf16 a[148:151], v[120:123], v[140:143], a[148:151]
ds_read_b128 v[52:55], v2 offset:8192
v_mfma_f32_16x16x32_bf16 a[156:159], v[120:123], v[144:147], a[156:159]
buffer_load_dwordx4 v19, s[4:7], s17 offen offset:3072 lds
v_mfma_f32_16x16x32_bf16 a[164:167], v[120:123], v[148:151], a[164:167]
ds_read_b128 v[56:59], v2 offset:10240
v_mfma_f32_16x16x32_bf16 a[172:175], v[120:123], v[152:155], a[172:175]
s_mov_b32 m0, s22
v_mfma_f32_16x16x32_bf16 a[180:183], v[120:123], v[156:159], a[180:183]
ds_read_b128 v[60:63], v2 offset:12288
v_mfma_f32_16x16x32_bf16 a[188:191], v[120:123], v[160:163], a[188:191]
v_mfma_f32_16x16x32_bf16 a[192:195], v[124:127], v[132:135], a[192:195]
ds_read_b128 v[64:67], v2 offset:14336
v_mfma_f32_16x16x32_bf16 a[200:203], v[124:127], v[136:139], a[200:203]
buffer_load_dwordx4 v20, s[8:11], s18 offen offset:0 lds
v_mfma_f32_16x16x32_bf16 a[208:211], v[124:127], v[140:143], a[208:211]
v_mfma_f32_16x16x32_bf16 a[216:219], v[124:127], v[144:147], a[216:219]
v_mfma_f32_16x16x32_bf16 a[224:227], v[124:127], v[148:151], a[224:227]
v_mfma_f32_16x16x32_bf16 a[232:235], v[124:127], v[152:155], a[232:235]
v_mfma_f32_16x16x32_bf16 a[240:243], v[124:127], v[156:159], a[240:243]
v_mfma_f32_16x16x32_bf16 a[248:251], v[124:127], v[160:163], a[248:251]
buffer_load_dwordx4 v21, s[8:11], s18 offen offset:1024 lds
v_mfma_f32_16x16x32_bf16 a[196:199], v[128:131], v[132:135], a[196:199]
v_mfma_f32_16x16x32_bf16 a[204:207], v[128:131], v[136:139], a[204:207]
v_mfma_f32_16x16x32_bf16 a[212:215], v[128:131], v[140:143], a[212:215]
v_mfma_f32_16x16x32_bf16 a[220:223], v[128:131], v[144:147], a[220:223]
v_mfma_f32_16x16x32_bf16 a[228:231], v[128:131], v[148:151], a[228:231]
v_mfma_f32_16x16x32_bf16 a[236:239], v[128:131], v[152:155], a[236:239]
buffer_load_dwordx4 v22, s[8:11], s18 offen offset:2048 lds
v_mfma_f32_16x16x32_bf16 a[244:247], v[128:131], v[156:159], a[244:247]
s_sub_u32 s20, s20, 1
v_mfma_f32_16x16x32_bf16 a[252:255], v[128:131], v[160:163], a[252:255]
s_cmp_lg_u32 s20, 0
s_cbranch_scc1 L_f_loop_0_2
s_branch L_f_kvdone
L_f_go_0_3:
s_waitcnt lgkmcnt(0)
v_mfma_f32_16x16x32_bf16 a[0:3], v[36:39], v[68:71], 0
ds_read_b128 v[100:103], v3 offset:0
v_mfma_f32_16x16x32_bf16 a[8:11], v[36:39], v[72:75], 0
s_cmp_ge_u32 s2, 128
s_cselect_b32 s80, s48, s42
s_cselect_b32 s81, s49, s43
s_mov_b32 s62, 401408
s_cselect_b32 s82, s62, 3670016
s_mov_b32 s83, 0x20000
v_mfma_f32_16x16x32_bf16 a[16:19], v[36:39], v[76:79], 0
ds_read_b64_tr_b16 v[132:133], v4 offset:16384
v_mfma_f32_16x16x32_bf16 a[24:27], v[36:39], v[80:83], 0
s_sub_u32 s61, s2, 128
s_cselect_b32 s61, s61, s61
s_cmp_ge_u32 s2, 128
s_cselect_b32 s61, s61, s2
s_cselect_b32 s62, 28, 32
v_mfma_f32_16x16x32_bf16 a[32:35], v[36:39], v[84:87], 0
ds_read_b64_tr_b16 v[134:135], v4 offset:18432
v_mfma_f32_16x16x32_bf16 a[40:43], v[36:39], v[88:91], 0
s_mul_i32 s62, s62, s61
s_mul_i32 s62, s62, 896
v_mfma_f32_16x16x32_bf16 a[48:51], v[36:39], v[92:95], 0
ds_read_b64_tr_b16 v[136:137], v5 offset:16384
v_mfma_f32_16x16x32_bf16 a[56:59], v[36:39], v[96:99], 0
s_lshl_b32 s90, s61, 10
s_cmp_ge_u32 s2, 128
s_mov_b32 s63, 79691776
s_cselect_b32 s63, s63, 75497472
v_mfma_f32_16x16x32_bf16 a[4:7], v[40:43], v[68:71], 0
ds_read_b64_tr_b16 v[138:139], v5 offset:18432
v_mfma_f32_16x16x32_bf16 a[12:15], v[40:43], v[72:75], 0
s_add_u32 s90, s90, s63
s_cmp_ge_u32 s2, 128
s_mov_b32 s63, 16384
s_cselect_b32 s100, s63, 131072
v_mfma_f32_16x16x32_bf16 a[20:23], v[40:43], v[76:79], 0
ds_read_b64_tr_b16 v[140:141], v6 offset:16384
v_mfma_f32_16x16x32_bf16 a[28:31], v[40:43], v[80:83], 0
s_cmp_ge_u32 s2, 144
s_cselect_b32 s62, s30, s62
s_cselect_b32 s90, s30, s90
s_cselect_b32 s100, 0, s100
s_mul_i32 s63, s16, 7168
v_mfma_f32_16x16x32_bf16 a[36:39], v[40:43], v[84:87], 0
ds_read_b64_tr_b16 v[142:143], v6 offset:18432
v_mfma_f32_16x16x32_bf16 a[44:47], v[40:43], v[88:91], 0
s_add_u32 s62, s62, s63
s_add_u32 s63, s63, 131072
v_mfma_f32_16x16x32_bf16 a[52:55], v[40:43], v[92:95], 0
ds_read_b64_tr_b16 v[144:145], v7 offset:16384
v_mfma_f32_16x16x32_bf16 a[60:63], v[40:43], v[96:99], 0
s_add_u32 m0, s63, 0
s_add_u32 s61, s62, 0
buffer_load_dwordx4 v1, s[80:83], s61 offen lds
s_add_u32 m0, s63, 1024
s_add_u32 s61, s62, 1024
buffer_load_dwordx4 v1, s[80:83], s61 offen lds
v_mfma_f32_16x16x32_bf16 a[64:67], v[44:47], v[68:71], 0
ds_read_b64_tr_b16 v[146:147], v7 offset:18432
v_mfma_f32_16x16x32_bf16 a[72:75], v[44:47], v[72:75], 0
s_add_u32 m0, s63, 2048
s_add_u32 s61, s62, 2048
buffer_load_dwordx4 v1, s[80:83], s61 offen lds
s_add_u32 m0, s63, 3072
s_add_u32 s61, s62, 3072
buffer_load_dwordx4 v1, s[80:83], s61 offen lds
v_mfma_f32_16x16x32_bf16 a[80:83], v[44:47], v[76:79], 0
ds_read_b64_tr_b16 v[148:149], v8 offset:16384
v_mfma_f32_16x16x32_bf16 a[88:91], v[44:47], v[80:83], 0
s_add_u32 m0, s63, 4096
s_add_u32 s61, s62, 4096
buffer_load_dwordx4 v1, s[80:83], s61 offen lds
s_add_u32 m0, s63, 5120
s_add_u32 s61, s62, 5120
buffer_load_dwordx4 v1, s[80:83], s61 offen lds
v_mfma_f32_16x16x32_bf16 a[96:99], v[44:47], v[84:87], 0
ds_read_b64_tr_b16 v[150:151], v8 offset:18432
v_mfma_f32_16x16x32_bf16 a[104:107], v[44:47], v[88:91], 0
s_add_u32 m0, s63, 6144
s_add_u32 s61, s62, 6144
buffer_load_dwordx4 v1, s[80:83], s61 offen lds
v_and_b32 v28, 63, v0
v_mfma_f32_16x16x32_bf16 a[112:115], v[44:47], v[92:95], 0
ds_read_b64_tr_b16 v[152:153], v9 offset:16384
v_mfma_f32_16x16x32_bf16 a[120:123], v[44:47], v[96:99], 0
v_and_b32 v29, 15, v28
v_lshrrev_b32 v30, 4, v28
v_mfma_f32_16x16x32_bf16 a[68:71], v[48:51], v[68:71], 0
ds_read_b64_tr_b16 v[154:155], v9 offset:18432
v_mfma_f32_16x16x32_bf16 a[76:79], v[48:51], v[72:75], 0
v_bfe_u32 v31, v28, 2, 2
v_and_b32 v32, 3, v28
v_mfma_f32_16x16x32_bf16 a[84:87], v[48:51], v[76:79], 0
ds_read_b64_tr_b16 v[156:157], v10 offset:16384
v_mfma_f32_16x16x32_bf16 a[92:95], v[48:51], v[80:83], 0
v_lshl_add_u32 v33, v30, 2, v31
v_mul_u32_u24 v33, 896, v33
v_mfma_f32_16x16x32_bf16 a[100:103], v[48:51], v[84:87], 0
ds_read_b64_tr_b16 v[158:159], v10 offset:18432
v_mfma_f32_16x16x32_bf16 a[108:111], v[48:51], v[88:91], 0
v_lshl_add_u32 v33, v32, 3, v33
s_mul_i32 s62, s16, 224
v_mfma_f32_16x16x32_bf16 a[116:119], v[48:51], v[92:95], 0
ds_read_b64_tr_b16 v[160:161], v11 offset:16384
v_mfma_f32_16x16x32_bf16 a[124:127], v[48:51], v[96:99], 0
s_mov_b32 s85, 7736
v_mfma_f32_16x16x32_bf16 a[128:131], v[52:55], v[68:71], 0
ds_read_b64_tr_b16 v[162:163], v11 offset:18432
v_mfma_f32_16x16x32_bf16 a[136:139], v[52:55], v[72:75], 0
s_bitcmp1_b32 s85, s20
s_cbranch_scc1 L_k1_gr_0_3_1_0
buffer_load_dword v241, v240, s[4:7], 0 offen
s_branch L_k1_gd_0_3_1_0
L_k1_gr_0_3_1_0:
global_load_dword v241, v[242:243], off
v_mov_b32 v242, v244
v_mov_b32 v243, v245
v_mov_b32 v244, v246
v_mov_b32 v245, v247
v_mov_b32 v246, v248
v_mov_b32 v247, v249
L_k1_gd_0_3_1_0:
v_mfma_f32_16x16x32_bf16 a[144:147], v[52:55], v[76:79], 0
ds_read_b128 v[104:107], v3 offset:2048
v_mfma_f32_16x16x32_bf16 a[152:155], v[52:55], v[80:83], 0
s_add_u32 s62, s62, 131072
v_add_u32 v178, s62, v33
v_mfma_f32_16x16x32_bf16 a[160:163], v[52:55], v[84:87], 0
ds_read_b128 v[108:111], v3 offset:4096
v_mfma_f32_16x16x32_bf16 a[168:171], v[52:55], v[88:91], 0
v_mfma_f32_16x16x32_bf16 a[176:179], v[52:55], v[92:95], 0
ds_read_b128 v[112:115], v3 offset:6144
v_mfma_f32_16x16x32_bf16 a[184:187], v[52:55], v[96:99], 0
v_mfma_f32_16x16x32_bf16 a[132:135], v[56:59], v[68:71], 0
ds_read_b128 v[116:119], v3 offset:8192
v_mfma_f32_16x16x32_bf16 a[140:143], v[56:59], v[72:75], 0
v_mfma_f32_16x16x32_bf16 a[148:151], v[56:59], v[76:79], 0
ds_read_b128 v[120:123], v3 offset:10240
v_mfma_f32_16x16x32_bf16 a[156:159], v[56:59], v[80:83], 0
v_mfma_f32_16x16x32_bf16 a[164:167], v[56:59], v[84:87], 0
ds_read_b128 v[124:127], v3 offset:12288
v_mfma_f32_16x16x32_bf16 a[172:175], v[56:59], v[88:91], 0
v_mfma_f32_16x16x32_bf16 a[180:183], v[56:59], v[92:95], 0
ds_read_b128 v[128:131], v3 offset:14336
v_mfma_f32_16x16x32_bf16 a[188:191], v[56:59], v[96:99], 0
v_mfma_f32_16x16x32_bf16 a[192:195], v[60:63], v[68:71], 0
v_mfma_f32_16x16x32_bf16 a[200:203], v[60:63], v[72:75], 0
v_mfma_f32_16x16x32_bf16 a[208:211], v[60:63], v[76:79], 0
v_mfma_f32_16x16x32_bf16 a[216:219], v[60:63], v[80:83], 0
v_mfma_f32_16x16x32_bf16 a[224:227], v[60:63], v[84:87], 0
v_mfma_f32_16x16x32_bf16 a[232:235], v[60:63], v[88:91], 0
v_mfma_f32_16x16x32_bf16 a[240:243], v[60:63], v[92:95], 0
v_mfma_f32_16x16x32_bf16 a[248:251], v[60:63], v[96:99], 0
v_mfma_f32_16x16x32_bf16 a[196:199], v[64:67], v[68:71], 0
v_mfma_f32_16x16x32_bf16 a[204:207], v[64:67], v[72:75], 0
s_waitcnt vmcnt(11) lgkmcnt(0)
s_barrier
s_nop 5
v_mfma_f32_16x16x32_bf16 a[212:215], v[64:67], v[76:79], 0
s_add_u32 s27, s27, 128
s_add_u32 s28, s28, s19
v_mfma_f32_16x16x32_bf16 a[220:223], v[64:67], v[80:83], 0
s_sub_u32 s70, s70, 1
s_cmp_gt_i32 s70, 0
v_mfma_f32_16x16x32_bf16 a[228:231], v[64:67], v[84:87], 0
s_cselect_b32 s17, s27, s30
s_cselect_b32 s18, s28, s30
v_mfma_f32_16x16x32_bf16 a[236:239], v[64:67], v[88:91], 0
s_xor_b32 s21, s21, 0x8000
s_xor_b32 s22, s22, 0x8000
v_mfma_f32_16x16x32_bf16 a[244:247], v[64:67], v[92:95], 0
s_mov_b32 m0, s21
v_mfma_f32_16x16x32_bf16 a[252:255], v[64:67], v[96:99], 0
s_waitcnt lgkmcnt(0)
v_mfma_f32_16x16x32_bf16 a[0:3], v[100:103], v[132:135], a[0:3]
v_xor_b32 v2, 0x8000, v2
buffer_load_dwordx4 v12, s[4:7], s17 offen offset:0 lds
v_mfma_f32_16x16x32_bf16 a[8:11], v[100:103], v[136:139], a[8:11]
v_xor_b32 v4, 0x8000, v4
v_mfma_f32_16x16x32_bf16 a[16:19], v[100:103], v[140:143], a[16:19]
ds_read_b128 v[36:39], v2 offset:0
v_mfma_f32_16x16x32_bf16 a[24:27], v[100:103], v[144:147], a[24:27]
v_xor_b32 v5, 0x8000, v5
v_mfma_f32_16x16x32_bf16 a[32:35], v[100:103], v[148:151], a[32:35]
ds_read_b64_tr_b16 v[68:69], v4 offset:0
v_mfma_f32_16x16x32_bf16 a[40:43], v[100:103], v[152:155], a[40:43]
v_xor_b32 v6, 0x8000, v6
v_mfma_f32_16x16x32_bf16 a[48:51], v[100:103], v[156:159], a[48:51]
ds_read_b64_tr_b16 v[70:71], v4 offset:2048
buffer_load_dwordx4 v13, s[4:7], s17 offen offset:1024 lds
v_mfma_f32_16x16x32_bf16 a[56:59], v[100:103], v[160:163], a[56:59]
v_xor_b32 v7, 0x8000, v7
v_mfma_f32_16x16x32_bf16 a[4:7], v[104:107], v[132:135], a[4:7]
ds_read_b64_tr_b16 v[72:73], v5 offset:0
v_mfma_f32_16x16x32_bf16 a[12:15], v[104:107], v[136:139], a[12:15]
v_xor_b32 v8, 0x8000, v8
v_mfma_f32_16x16x32_bf16 a[20:23], v[104:107], v[140:143], a[20:23]
ds_read_b64_tr_b16 v[74:75], v5 offset:2048
v_mfma_f32_16x16x32_bf16 a[28:31], v[104:107], v[144:147], a[28:31]
v_xor_b32 v9, 0x8000, v9
v_mfma_f32_16x16x32_bf16 a[36:39], v[104:107], v[148:151], a[36:39]
ds_read_b64_tr_b16 v[76:77], v6 offset:0
buffer_load_dwordx4 v14, s[4:7], s17 offen offset:2048 lds
v_mfma_f32_16x16x32_bf16 a[44:47], v[104:107], v[152:155], a[44:47]
v_xor_b32 v10, 0x8000, v10
v_mfma_f32_16x16x32_bf16 a[52:55], v[104:107], v[156:159], a[52:55]
ds_read_b64_tr_b16 v[78:79], v6 offset:2048
v_mfma_f32_16x16x32_bf16 a[60:63], v[104:107], v[160:163], a[60:63]
v_xor_b32 v11, 0x8000, v11
v_mfma_f32_16x16x32_bf16 a[64:67], v[108:111], v[132:135], a[64:67]
ds_read_b64_tr_b16 v[80:81], v7 offset:0
v_mfma_f32_16x16x32_bf16 a[72:75], v[108:111], v[136:139], a[72:75]
v_xor_b32 v3, 0x8000, v3
v_mfma_f32_16x16x32_bf16 a[80:83], v[108:111], v[140:143], a[80:83]
ds_read_b64_tr_b16 v[82:83], v7 offset:2048
v_mfma_f32_16x16x32_bf16 a[88:91], v[108:111], v[144:147], a[88:91]
buffer_load_dwordx4 v15, s[4:7], s17 offen offset:3072 lds
v_mfma_f32_16x16x32_bf16 a[96:99], v[108:111], v[148:151], a[96:99]
ds_read_b64_tr_b16 v[84:85], v8 offset:0
v_mfma_f32_16x16x32_bf16 a[104:107], v[108:111], v[152:155], a[104:107]
s_add_u32 m0, s21, 4096
v_mfma_f32_16x16x32_bf16 a[112:115], v[108:111], v[156:159], a[112:115]
ds_read_b64_tr_b16 v[86:87], v8 offset:2048
v_mfma_f32_16x16x32_bf16 a[120:123], v[108:111], v[160:163], a[120:123]
v_mfma_f32_16x16x32_bf16 a[68:71], v[112:115], v[132:135], a[68:71]
ds_read_b64_tr_b16 v[88:89], v9 offset:0
v_mfma_f32_16x16x32_bf16 a[76:79], v[112:115], v[136:139], a[76:79]
buffer_load_dwordx4 v16, s[4:7], s17 offen offset:0 lds
v_mfma_f32_16x16x32_bf16 a[84:87], v[112:115], v[140:143], a[84:87]
ds_read_b64_tr_b16 v[90:91], v9 offset:2048
v_mfma_f32_16x16x32_bf16 a[92:95], v[112:115], v[144:147], a[92:95]
v_mfma_f32_16x16x32_bf16 a[100:103], v[112:115], v[148:151], a[100:103]
ds_read_b64_tr_b16 v[92:93], v10 offset:0
v_mfma_f32_16x16x32_bf16 a[108:111], v[112:115], v[152:155], a[108:111]
v_mfma_f32_16x16x32_bf16 a[116:119], v[112:115], v[156:159], a[116:119]
ds_read_b64_tr_b16 v[94:95], v10 offset:2048
v_mfma_f32_16x16x32_bf16 a[124:127], v[112:115], v[160:163], a[124:127]
buffer_load_dwordx4 v17, s[4:7], s17 offen offset:1024 lds
v_mfma_f32_16x16x32_bf16 a[128:131], v[116:119], v[132:135], a[128:131]
ds_read_b64_tr_b16 v[96:97], v11 offset:0
v_mfma_f32_16x16x32_bf16 a[136:139], v[116:119], v[136:139], a[136:139]
v_mfma_f32_16x16x32_bf16 a[144:147], v[116:119], v[140:143], a[144:147]
ds_read_b64_tr_b16 v[98:99], v11 offset:2048
v_mfma_f32_16x16x32_bf16 a[152:155], v[116:119], v[144:147], a[152:155]
v_mfma_f32_16x16x32_bf16 a[160:163], v[116:119], v[148:151], a[160:163]
ds_read_b128 v[40:43], v2 offset:2048
v_mfma_f32_16x16x32_bf16 a[168:171], v[116:119], v[152:155], a[168:171]
buffer_load_dwordx4 v18, s[4:7], s17 offen offset:2048 lds
v_mfma_f32_16x16x32_bf16 a[176:179], v[116:119], v[156:159], a[176:179]
ds_read_b128 v[44:47], v2 offset:4096
v_mfma_f32_16x16x32_bf16 a[184:187], v[116:119], v[160:163], a[184:187]
v_mfma_f32_16x16x32_bf16 a[132:135], v[120:123], v[132:135], a[132:135]
ds_read_b128 v[48:51], v2 offset:6144
v_mfma_f32_16x16x32_bf16 a[140:143], v[120:123], v[136:139], a[140:143]
v_mfma_f32_16x16x32_bf16 a[148:151], v[120:123], v[140:143], a[148:151]
ds_read_b128 v[52:55], v2 offset:8192
v_mfma_f32_16x16x32_bf16 a[156:159], v[120:123], v[144:147], a[156:159]
buffer_load_dwordx4 v19, s[4:7], s17 offen offset:3072 lds
v_mfma_f32_16x16x32_bf16 a[164:167], v[120:123], v[148:151], a[164:167]
ds_read_b128 v[56:59], v2 offset:10240
v_mfma_f32_16x16x32_bf16 a[172:175], v[120:123], v[152:155], a[172:175]
s_mov_b32 m0, s22
v_mfma_f32_16x16x32_bf16 a[180:183], v[120:123], v[156:159], a[180:183]
ds_read_b128 v[60:63], v2 offset:12288
v_mfma_f32_16x16x32_bf16 a[188:191], v[120:123], v[160:163], a[188:191]
v_mfma_f32_16x16x32_bf16 a[192:195], v[124:127], v[132:135], a[192:195]
ds_read_b128 v[64:67], v2 offset:14336
v_mfma_f32_16x16x32_bf16 a[200:203], v[124:127], v[136:139], a[200:203]
buffer_load_dwordx4 v20, s[8:11], s18 offen offset:0 lds
v_mfma_f32_16x16x32_bf16 a[208:211], v[124:127], v[140:143], a[208:211]
v_mfma_f32_16x16x32_bf16 a[216:219], v[124:127], v[144:147], a[216:219]
v_mfma_f32_16x16x32_bf16 a[224:227], v[124:127], v[148:151], a[224:227]
v_mfma_f32_16x16x32_bf16 a[232:235], v[124:127], v[152:155], a[232:235]
v_mfma_f32_16x16x32_bf16 a[240:243], v[124:127], v[156:159], a[240:243]
v_mfma_f32_16x16x32_bf16 a[248:251], v[124:127], v[160:163], a[248:251]
buffer_load_dwordx4 v21, s[8:11], s18 offen offset:1024 lds
v_mfma_f32_16x16x32_bf16 a[196:199], v[128:131], v[132:135], a[196:199]
v_mfma_f32_16x16x32_bf16 a[204:207], v[128:131], v[136:139], a[204:207]
v_mfma_f32_16x16x32_bf16 a[212:215], v[128:131], v[140:143], a[212:215]
v_mfma_f32_16x16x32_bf16 a[220:223], v[128:131], v[144:147], a[220:223]
v_mfma_f32_16x16x32_bf16 a[228:231], v[128:131], v[148:151], a[228:231]
v_mfma_f32_16x16x32_bf16 a[236:239], v[128:131], v[152:155], a[236:239]
buffer_load_dwordx4 v22, s[8:11], s18 offen offset:2048 lds
v_mfma_f32_16x16x32_bf16 a[244:247], v[128:131], v[156:159], a[244:247]
s_sub_u32 s20, s20, 1
v_mfma_f32_16x16x32_bf16 a[252:255], v[128:131], v[160:163], a[252:255]
s_cmp_lg_u32 s20, 0
.p2align 6
L_f_loop_0_3:
s_waitcnt lgkmcnt(0)
v_mfma_f32_16x16x32_bf16 a[0:3], v[36:39], v[68:71], a[0:3]
ds_read_b128 v[100:103], v3 offset:0
v_mfma_f32_16x16x32_bf16 a[8:11], v[36:39], v[72:75], a[8:11]
v_mfma_f32_16x16x32_bf16 a[16:19], v[36:39], v[76:79], a[16:19]
ds_read_b64_tr_b16 v[132:133], v4 offset:16384
v_mfma_f32_16x16x32_bf16 a[24:27], v[36:39], v[80:83], a[24:27]
buffer_load_dwordx4 v23, s[8:11], s18 offen offset:3072 lds
v_mfma_f32_16x16x32_bf16 a[32:35], v[36:39], v[84:87], a[32:35]
ds_read_b64_tr_b16 v[134:135], v4 offset:18432
v_mfma_f32_16x16x32_bf16 a[40:43], v[36:39], v[88:91], a[40:43]
s_add_u32 m0, s22, 4096
v_mfma_f32_16x16x32_bf16 a[48:51], v[36:39], v[92:95], a[48:51]
ds_read_b64_tr_b16 v[136:137], v5 offset:16384
v_mfma_f32_16x16x32_bf16 a[56:59], v[36:39], v[96:99], a[56:59]
v_mfma_f32_16x16x32_bf16 a[4:7], v[40:43], v[68:71], a[4:7]
ds_read_b64_tr_b16 v[138:139], v5 offset:18432
v_mfma_f32_16x16x32_bf16 a[12:15], v[40:43], v[72:75], a[12:15]
buffer_load_dwordx4 v24, s[8:11], s18 offen offset:0 lds
v_mfma_f32_16x16x32_bf16 a[20:23], v[40:43], v[76:79], a[20:23]
ds_read_b64_tr_b16 v[140:141], v6 offset:16384
v_mfma_f32_16x16x32_bf16 a[28:31], v[40:43], v[80:83], a[28:31]
v_mfma_f32_16x16x32_bf16 a[36:39], v[40:43], v[84:87], a[36:39]
ds_read_b64_tr_b16 v[142:143], v6 offset:18432
v_mfma_f32_16x16x32_bf16 a[44:47], v[40:43], v[88:91], a[44:47]
v_mfma_f32_16x16x32_bf16 a[52:55], v[40:43], v[92:95], a[52:55]
ds_read_b64_tr_b16 v[144:145], v7 offset:16384
v_mfma_f32_16x16x32_bf16 a[60:63], v[40:43], v[96:99], a[60:63]
buffer_load_dwordx4 v25, s[8:11], s18 offen offset:1024 lds
v_mfma_f32_16x16x32_bf16 a[64:67], v[44:47], v[68:71], a[64:67]
ds_read_b64_tr_b16 v[146:147], v7 offset:18432
v_mfma_f32_16x16x32_bf16 a[72:75], v[44:47], v[72:75], a[72:75]
v_mfma_f32_16x16x32_bf16 a[80:83], v[44:47], v[76:79], a[80:83]
ds_read_b64_tr_b16 v[148:149], v8 offset:16384
v_mfma_f32_16x16x32_bf16 a[88:91], v[44:47], v[80:83], a[88:91]
v_mfma_f32_16x16x32_bf16 a[96:99], v[44:47], v[84:87], a[96:99]
ds_read_b64_tr_b16 v[150:151], v8 offset:18432
v_mfma_f32_16x16x32_bf16 a[104:107], v[44:47], v[88:91], a[104:107]
buffer_load_dwordx4 v26, s[8:11], s18 offen offset:2048 lds
v_mfma_f32_16x16x32_bf16 a[112:115], v[44:47], v[92:95], a[112:115]
ds_read_b64_tr_b16 v[152:153], v9 offset:16384
v_mfma_f32_16x16x32_bf16 a[120:123], v[44:47], v[96:99], a[120:123]
v_mfma_f32_16x16x32_bf16 a[68:71], v[48:51], v[68:71], a[68:71]
ds_read_b64_tr_b16 v[154:155], v9 offset:18432
v_mfma_f32_16x16x32_bf16 a[76:79], v[48:51], v[72:75], a[76:79]
v_mfma_f32_16x16x32_bf16 a[84:87], v[48:51], v[76:79], a[84:87]
ds_read_b64_tr_b16 v[156:157], v10 offset:16384
v_mfma_f32_16x16x32_bf16 a[92:95], v[48:51], v[80:83], a[92:95]
buffer_load_dwordx4 v27, s[8:11], s18 offen offset:3072 lds
v_mfma_f32_16x16x32_bf16 a[100:103], v[48:51], v[84:87], a[100:103]
ds_read_b64_tr_b16 v[158:159], v10 offset:18432
v_mfma_f32_16x16x32_bf16 a[108:111], v[48:51], v[88:91], a[108:111]
v_mfma_f32_16x16x32_bf16 a[116:119], v[48:51], v[92:95], a[116:119]
ds_read_b64_tr_b16 v[160:161], v11 offset:16384
v_mfma_f32_16x16x32_bf16 a[124:127], v[48:51], v[96:99], a[124:127]
s_mov_b32 s85, 7736
v_mfma_f32_16x16x32_bf16 a[128:131], v[52:55], v[68:71], a[128:131]
ds_read_b64_tr_b16 v[162:163], v11 offset:18432
v_mfma_f32_16x16x32_bf16 a[136:139], v[52:55], v[72:75], a[136:139]
s_bitcmp1_b32 s85, s20
s_cbranch_scc1 L_k1_gr_0_3_0_0
buffer_load_dword v241, v240, s[4:7], 0 offen
s_branch L_k1_gd_0_3_0_0
L_k1_gr_0_3_0_0:
global_load_dword v241, v[242:243], off
v_mov_b32 v242, v244
v_mov_b32 v243, v245
v_mov_b32 v244, v246
v_mov_b32 v245, v247
v_mov_b32 v246, v248
v_mov_b32 v247, v249
L_k1_gd_0_3_0_0:
v_mfma_f32_16x16x32_bf16 a[144:147], v[52:55], v[76:79], a[144:147]
ds_read_b128 v[104:107], v3 offset:2048
v_mfma_f32_16x16x32_bf16 a[152:155], v[52:55], v[80:83], a[152:155]
v_mfma_f32_16x16x32_bf16 a[160:163], v[52:55], v[84:87], a[160:163]
ds_read_b128 v[108:111], v3 offset:4096
v_mfma_f32_16x16x32_bf16 a[168:171], v[52:55], v[88:91], a[168:171]
s_cmp_eq_u32 s20, 7
s_cbranch_scc1 L_f_loc_0_3_0
L_f_locret_0_3_0:
v_mfma_f32_16x16x32_bf16 a[176:179], v[52:55], v[92:95], a[176:179]
ds_read_b128 v[112:115], v3 offset:6144
v_mfma_f32_16x16x32_bf16 a[184:187], v[52:55], v[96:99], a[184:187]
v_mfma_f32_16x16x32_bf16 a[132:135], v[56:59], v[68:71], a[132:135]
ds_read_b128 v[116:119], v3 offset:8192
v_mfma_f32_16x16x32_bf16 a[140:143], v[56:59], v[72:75], a[140:143]
v_mfma_f32_16x16x32_bf16 a[148:151], v[56:59], v[76:79], a[148:151]
ds_read_b128 v[120:123], v3 offset:10240
v_mfma_f32_16x16x32_bf16 a[156:159], v[56:59], v[80:83], a[156:159]
v_mfma_f32_16x16x32_bf16 a[164:167], v[56:59], v[84:87], a[164:167]
ds_read_b128 v[124:127], v3 offset:12288
v_mfma_f32_16x16x32_bf16 a[172:175], v[56:59], v[88:91], a[172:175]
v_mfma_f32_16x16x32_bf16 a[180:183], v[56:59], v[92:95], a[180:183]
ds_read_b128 v[128:131], v3 offset:14336
v_mfma_f32_16x16x32_bf16 a[188:191], v[56:59], v[96:99], a[188:191]
v_mfma_f32_16x16x32_bf16 a[192:195], v[60:63], v[68:71], a[192:195]
v_mfma_f32_16x16x32_bf16 a[200:203], v[60:63], v[72:75], a[200:203]
v_mfma_f32_16x16x32_bf16 a[208:211], v[60:63], v[76:79], a[208:211]
v_mfma_f32_16x16x32_bf16 a[216:219], v[60:63], v[80:83], a[216:219]
v_mfma_f32_16x16x32_bf16 a[224:227], v[60:63], v[84:87], a[224:227]
v_mfma_f32_16x16x32_bf16 a[232:235], v[60:63], v[88:91], a[232:235]
v_mfma_f32_16x16x32_bf16 a[240:243], v[60:63], v[92:95], a[240:243]
v_mfma_f32_16x16x32_bf16 a[248:251], v[60:63], v[96:99], a[248:251]
v_mfma_f32_16x16x32_bf16 a[196:199], v[64:67], v[68:71], a[196:199]
v_mfma_f32_16x16x32_bf16 a[204:207], v[64:67], v[72:75], a[204:207]
s_waitcnt vmcnt(1) lgkmcnt(0)
s_barrier
s_nop 5
v_mfma_f32_16x16x32_bf16 a[212:215], v[64:67], v[76:79], a[212:215]
s_add_u32 s27, s27, 128
s_add_u32 s28, s28, s19
v_mfma_f32_16x16x32_bf16 a[220:223], v[64:67], v[80:83], a[220:223]
s_sub_u32 s70, s70, 1
s_cmp_gt_i32 s70, 0
v_mfma_f32_16x16x32_bf16 a[228:231], v[64:67], v[84:87], a[228:231]
s_cselect_b32 s17, s27, s30
s_cselect_b32 s18, s28, s30
v_mfma_f32_16x16x32_bf16 a[236:239], v[64:67], v[88:91], a[236:239]
s_xor_b32 s21, s21, 0x8000
s_xor_b32 s22, s22, 0x8000
v_mfma_f32_16x16x32_bf16 a[244:247], v[64:67], v[92:95], a[244:247]
s_mov_b32 m0, s21
v_mfma_f32_16x16x32_bf16 a[252:255], v[64:67], v[96:99], a[252:255]
s_waitcnt lgkmcnt(0)
v_mfma_f32_16x16x32_bf16 a[0:3], v[100:103], v[132:135], a[0:3]
v_xor_b32 v2, 0x8000, v2
buffer_load_dwordx4 v12, s[4:7], s17 offen offset:0 lds
v_mfma_f32_16x16x32_bf16 a[8:11], v[100:103], v[136:139], a[8:11]
v_xor_b32 v4, 0x8000, v4
v_mfma_f32_16x16x32_bf16 a[16:19], v[100:103], v[140:143], a[16:19]
ds_read_b128 v[36:39], v2 offset:0
v_mfma_f32_16x16x32_bf16 a[24:27], v[100:103], v[144:147], a[24:27]
v_xor_b32 v5, 0x8000, v5
v_mfma_f32_16x16x32_bf16 a[32:35], v[100:103], v[148:151], a[32:35]
ds_read_b64_tr_b16 v[68:69], v4 offset:0
v_mfma_f32_16x16x32_bf16 a[40:43], v[100:103], v[152:155], a[40:43]
v_xor_b32 v6, 0x8000, v6
v_mfma_f32_16x16x32_bf16 a[48:51], v[100:103], v[156:159], a[48:51]
ds_read_b64_tr_b16 v[70:71], v4 offset:2048
buffer_load_dwordx4 v13, s[4:7], s17 offen offset:1024 lds
v_mfma_f32_16x16x32_bf16 a[56:59], v[100:103], v[160:163], a[56:59]
v_xor_b32 v7, 0x8000, v7
v_mfma_f32_16x16x32_bf16 a[4:7], v[104:107], v[132:135], a[4:7]
ds_read_b64_tr_b16 v[72:73], v5 offset:0
v_mfma_f32_16x16x32_bf16 a[12:15], v[104:107], v[136:139], a[12:15]
v_xor_b32 v8, 0x8000, v8
v_mfma_f32_16x16x32_bf16 a[20:23], v[104:107], v[140:143], a[20:23]
ds_read_b64_tr_b16 v[74:75], v5 offset:2048
v_mfma_f32_16x16x32_bf16 a[28:31], v[104:107], v[144:147], a[28:31]
v_xor_b32 v9, 0x8000, v9
v_mfma_f32_16x16x32_bf16 a[36:39], v[104:107], v[148:151], a[36:39]
ds_read_b64_tr_b16 v[76:77], v6 offset:0
buffer_load_dwordx4 v14, s[4:7], s17 offen offset:2048 lds
v_mfma_f32_16x16x32_bf16 a[44:47], v[104:107], v[152:155], a[44:47]
v_xor_b32 v10, 0x8000, v10
v_mfma_f32_16x16x32_bf16 a[52:55], v[104:107], v[156:159], a[52:55]
ds_read_b64_tr_b16 v[78:79], v6 offset:2048
v_mfma_f32_16x16x32_bf16 a[60:63], v[104:107], v[160:163], a[60:63]
v_xor_b32 v11, 0x8000, v11
v_mfma_f32_16x16x32_bf16 a[64:67], v[108:111], v[132:135], a[64:67]
ds_read_b64_tr_b16 v[80:81], v7 offset:0
v_mfma_f32_16x16x32_bf16 a[72:75], v[108:111], v[136:139], a[72:75]
v_xor_b32 v3, 0x8000, v3
v_mfma_f32_16x16x32_bf16 a[80:83], v[108:111], v[140:143], a[80:83]
ds_read_b64_tr_b16 v[82:83], v7 offset:2048
v_mfma_f32_16x16x32_bf16 a[88:91], v[108:111], v[144:147], a[88:91]
buffer_load_dwordx4 v15, s[4:7], s17 offen offset:3072 lds
v_mfma_f32_16x16x32_bf16 a[96:99], v[108:111], v[148:151], a[96:99]
ds_read_b64_tr_b16 v[84:85], v8 offset:0
v_mfma_f32_16x16x32_bf16 a[104:107], v[108:111], v[152:155], a[104:107]
s_add_u32 m0, s21, 4096
v_mfma_f32_16x16x32_bf16 a[112:115], v[108:111], v[156:159], a[112:115]
ds_read_b64_tr_b16 v[86:87], v8 offset:2048
v_mfma_f32_16x16x32_bf16 a[120:123], v[108:111], v[160:163], a[120:123]
v_mfma_f32_16x16x32_bf16 a[68:71], v[112:115], v[132:135], a[68:71]
ds_read_b64_tr_b16 v[88:89], v9 offset:0
v_mfma_f32_16x16x32_bf16 a[76:79], v[112:115], v[136:139], a[76:79]
buffer_load_dwordx4 v16, s[4:7], s17 offen offset:0 lds
v_mfma_f32_16x16x32_bf16 a[84:87], v[112:115], v[140:143], a[84:87]
ds_read_b64_tr_b16 v[90:91], v9 offset:2048
v_mfma_f32_16x16x32_bf16 a[92:95], v[112:115], v[144:147], a[92:95]
v_mfma_f32_16x16x32_bf16 a[100:103], v[112:115], v[148:151], a[100:103]
ds_read_b64_tr_b16 v[92:93], v10 offset:0
v_mfma_f32_16x16x32_bf16 a[108:111], v[112:115], v[152:155], a[108:111]
v_mfma_f32_16x16x32_bf16 a[116:119], v[112:115], v[156:159], a[116:119]
ds_read_b64_tr_b16 v[94:95], v10 offset:2048
v_mfma_f32_16x16x32_bf16 a[124:127], v[112:115], v[160:163], a[124:127]
buffer_load_dwordx4 v17, s[4:7], s17 offen offset:1024 lds
v_mfma_f32_16x16x32_bf16 a[128:131], v[116:119], v[132:135], a[128:131]
ds_read_b64_tr_b16 v[96:97], v11 offset:0
v_mfma_f32_16x16x32_bf16 a[136:139], v[116:119], v[136:139], a[136:139]
v_mfma_f32_16x16x32_bf16 a[144:147], v[116:119], v[140:143], a[144:147]
ds_read_b64_tr_b16 v[98:99], v11 offset:2048
v_mfma_f32_16x16x32_bf16 a[152:155], v[116:119], v[144:147], a[152:155]
v_mfma_f32_16x16x32_bf16 a[160:163], v[116:119], v[148:151], a[160:163]
ds_read_b128 v[40:43], v2 offset:2048
v_mfma_f32_16x16x32_bf16 a[168:171], v[116:119], v[152:155], a[168:171]
buffer_load_dwordx4 v18, s[4:7], s17 offen offset:2048 lds
v_mfma_f32_16x16x32_bf16 a[176:179], v[116:119], v[156:159], a[176:179]
ds_read_b128 v[44:47], v2 offset:4096
v_mfma_f32_16x16x32_bf16 a[184:187], v[116:119], v[160:163], a[184:187]
v_mfma_f32_16x16x32_bf16 a[132:135], v[120:123], v[132:135], a[132:135]
ds_read_b128 v[48:51], v2 offset:6144
v_mfma_f32_16x16x32_bf16 a[140:143], v[120:123], v[136:139], a[140:143]
v_mfma_f32_16x16x32_bf16 a[148:151], v[120:123], v[140:143], a[148:151]
ds_read_b128 v[52:55], v2 offset:8192
v_mfma_f32_16x16x32_bf16 a[156:159], v[120:123], v[144:147], a[156:159]
buffer_load_dwordx4 v19, s[4:7], s17 offen offset:3072 lds
v_mfma_f32_16x16x32_bf16 a[164:167], v[120:123], v[148:151], a[164:167]
ds_read_b128 v[56:59], v2 offset:10240
v_mfma_f32_16x16x32_bf16 a[172:175], v[120:123], v[152:155], a[172:175]
s_mov_b32 m0, s22
v_mfma_f32_16x16x32_bf16 a[180:183], v[120:123], v[156:159], a[180:183]
ds_read_b128 v[60:63], v2 offset:12288
v_mfma_f32_16x16x32_bf16 a[188:191], v[120:123], v[160:163], a[188:191]
v_mfma_f32_16x16x32_bf16 a[192:195], v[124:127], v[132:135], a[192:195]
ds_read_b128 v[64:67], v2 offset:14336
v_mfma_f32_16x16x32_bf16 a[200:203], v[124:127], v[136:139], a[200:203]
buffer_load_dwordx4 v20, s[8:11], s18 offen offset:0 lds
v_mfma_f32_16x16x32_bf16 a[208:211], v[124:127], v[140:143], a[208:211]
v_mfma_f32_16x16x32_bf16 a[216:219], v[124:127], v[144:147], a[216:219]
v_mfma_f32_16x16x32_bf16 a[224:227], v[124:127], v[148:151], a[224:227]
v_mfma_f32_16x16x32_bf16 a[232:235], v[124:127], v[152:155], a[232:235]
v_mfma_f32_16x16x32_bf16 a[240:243], v[124:127], v[156:159], a[240:243]
v_mfma_f32_16x16x32_bf16 a[248:251], v[124:127], v[160:163], a[248:251]
buffer_load_dwordx4 v21, s[8:11], s18 offen offset:1024 lds
v_mfma_f32_16x16x32_bf16 a[196:199], v[128:131], v[132:135], a[196:199]
v_mfma_f32_16x16x32_bf16 a[204:207], v[128:131], v[136:139], a[204:207]
v_mfma_f32_16x16x32_bf16 a[212:215], v[128:131], v[140:143], a[212:215]
v_mfma_f32_16x16x32_bf16 a[220:223], v[128:131], v[144:147], a[220:223]
v_mfma_f32_16x16x32_bf16 a[228:231], v[128:131], v[148:151], a[228:231]
v_mfma_f32_16x16x32_bf16 a[236:239], v[128:131], v[152:155], a[236:239]
buffer_load_dwordx4 v22, s[8:11], s18 offen offset:2048 lds
v_mfma_f32_16x16x32_bf16 a[244:247], v[128:131], v[156:159], a[244:247]
s_sub_u32 s20, s20, 1
v_mfma_f32_16x16x32_bf16 a[252:255], v[128:131], v[160:163], a[252:255]
s_cmp_lg_u32 s20, 0
s_cbranch_scc1 L_f_loop_0_3
s_branch L_f_kvdone
L_f_kvdone:
s_waitcnt vmcnt(0) lgkmcnt(0)
s_cmp_lg_u32 s16, 0
s_cbranch_scc1 L_f_tok1
v_cmp_eq_u32 vcc, 0, v251
v_mov_b32 v254, 163836
s_nop 0
v_cndmask_b32 v251, v251, v252, vcc
s_mov_b64 exec, 1
ds_write_b32 v254, v251
s_mov_b64 exec, -1
s_waitcnt lgkmcnt(0)
L_f_tok1:
s_barrier
v_mov_b32 v254, 163836
ds_read_b32 v251, v254
s_waitcnt lgkmcnt(0)
v_readfirstlane_b32 s3, v251
s_lshr_b32 s61, s16, 1
s_lshl_b32 s61, s61, 16
s_and_b32 s62, s16, 1
s_cmp_eq_u32 s60, 0
s_cselect_b32 s63, 12, 13
s_lshl_b32 s62, s62, s63
s_add_u32 s71, s61, s62
s_add_u32 s71, s71, s68
s_mov_b32 s80, s46
s_mov_b32 s81, s47
s_mov_b32 s82, 1204224
s_mov_b32 s83, 0x20000
ds_read_b64_tr_b16 v[36:37], v178 offset:0
ds_read_b64_tr_b16 v[38:39], v178 offset:14336
ds_read_b64_tr_b16 v[40:41], v178 offset:32
ds_read_b64_tr_b16 v[42:43], v178 offset:14368
ds_read_b64_tr_b16 v[44:45], v178 offset:64
ds_read_b64_tr_b16 v[46:47], v178 offset:14400
ds_read_b64_tr_b16 v[48:49], v178 offset:96
ds_read_b64_tr_b16 v[50:51], v178 offset:14432
ds_read_b64_tr_b16 v[52:53], v178 offset:128
ds_read_b64_tr_b16 v[54:55], v178 offset:14464
ds_read_b64_tr_b16 v[56:57], v178 offset:160
ds_read_b64_tr_b16 v[58:59], v178 offset:14496
ds_read_b64_tr_b16 v[60:61], v178 offset:192
ds_read_b64_tr_b16 v[62:63], v178 offset:14528
s_waitcnt lgkmcnt(0)
s_barrier
v_accvgpr_read_b32 v100, a0
v_accvgpr_read_b32 v101, a1
v_accvgpr_read_b32 v102, a2
v_accvgpr_read_b32 v103, a3
v_accvgpr_read_b32 v104, a4
s_add_u32 m0, s84, 0
s_mov_b32 s88, 0
buffer_load_dwordx4 v168, s[96:99], s88 offen offset:0 lds
v_accvgpr_read_b32 v105, a5
v_accvgpr_read_b32 v106, a6
v_accvgpr_read_b32 v107, a7
v_cvt_pk_bf16_f32 v108, v100, v101
v_cvt_pk_bf16_f32 v109, v102, v103
buffer_load_dwordx4 v169, s[96:99], s88 offen offset:1024 lds
v_cvt_pk_bf16_f32 v110, v104, v105
v_cvt_pk_bf16_f32 v111, v106, v107
v_accvgpr_write_b32 a0, v108
v_accvgpr_write_b32 a1, v109
v_accvgpr_write_b32 a2, v110
buffer_load_dwordx4 v170, s[96:99], s88 offen offset:2048 lds
v_accvgpr_write_b32 a3, v111
v_accvgpr_read_b32 v112, a8
v_accvgpr_read_b32 v113, a9
v_accvgpr_read_b32 v114, a10
v_accvgpr_read_b32 v115, a11
buffer_load_dwordx4 v171, s[96:99], s88 offen offset:3072 lds
v_accvgpr_read_b32 v116, a12
v_accvgpr_read_b32 v117, a13
v_accvgpr_read_b32 v118, a14
v_accvgpr_read_b32 v119, a15
v_cvt_pk_bf16_f32 v120, v112, v113
s_add_u32 m0, s84, 16384
s_mov_b32 s88, 0
buffer_load_dwordx4 v172, s[80:83], s88 offen offset:0 lds
v_cvt_pk_bf16_f32 v121, v114, v115
v_cvt_pk_bf16_f32 v122, v116, v117
v_cvt_pk_bf16_f32 v123, v118, v119
v_accvgpr_write_b32 a4, v120
v_accvgpr_write_b32 a5, v121
buffer_load_dwordx4 v173, s[80:83], s88 offen offset:1024 lds
v_accvgpr_write_b32 a6, v122
v_accvgpr_write_b32 a7, v123
v_accvgpr_read_b32 v100, a16
v_accvgpr_read_b32 v101, a17
v_accvgpr_read_b32 v102, a18
buffer_load_dwordx4 v174, s[80:83], s88 offen offset:2048 lds
v_accvgpr_read_b32 v103, a19
v_accvgpr_read_b32 v104, a20
v_accvgpr_read_b32 v105, a21
v_accvgpr_read_b32 v106, a22
v_accvgpr_read_b32 v107, a23
buffer_load_dwordx4 v175, s[80:83], s88 offen offset:3072 lds
v_cvt_pk_bf16_f32 v108, v100, v101
v_cvt_pk_bf16_f32 v109, v102, v103
v_cvt_pk_bf16_f32 v110, v104, v105
v_cvt_pk_bf16_f32 v111, v106, v107
v_accvgpr_write_b32 a8, v108
s_add_u32 m0, s84, 32768
s_mov_b32 s88, 128
buffer_load_dwordx4 v168, s[96:99], s88 offen offset:0 lds
v_accvgpr_write_b32 a9, v109
v_accvgpr_write_b32 a10, v110
v_accvgpr_write_b32 a11, v111
v_accvgpr_read_b32 v112, a24
v_accvgpr_read_b32 v113, a25
buffer_load_dwordx4 v169, s[96:99], s88 offen offset:1024 lds
v_accvgpr_read_b32 v114, a26
v_accvgpr_read_b32 v115, a27
v_accvgpr_read_b32 v116, a28
v_accvgpr_read_b32 v117, a29
v_accvgpr_read_b32 v118, a30
buffer_load_dwordx4 v170, s[96:99], s88 offen offset:2048 lds
v_accvgpr_read_b32 v119, a31
v_cvt_pk_bf16_f32 v120, v112, v113
v_cvt_pk_bf16_f32 v121, v114, v115
v_cvt_pk_bf16_f32 v122, v116, v117
v_cvt_pk_bf16_f32 v123, v118, v119
buffer_load_dwordx4 v171, s[96:99], s88 offen offset:3072 lds
v_accvgpr_write_b32 a12, v120
v_accvgpr_write_b32 a13, v121
v_accvgpr_write_b32 a14, v122
v_accvgpr_write_b32 a15, v123
v_accvgpr_read_b32 v100, a32
s_add_u32 m0, s84, 49152
s_mov_b32 s88, 172032
buffer_load_dwordx4 v172, s[80:83], s88 offen offset:0 lds
v_accvgpr_read_b32 v101, a33
v_accvgpr_read_b32 v102, a34
v_accvgpr_read_b32 v103, a35
v_accvgpr_read_b32 v104, a36
v_accvgpr_read_b32 v105, a37
buffer_load_dwordx4 v173, s[80:83], s88 offen offset:1024 lds
v_accvgpr_read_b32 v106, a38
v_accvgpr_read_b32 v107, a39
v_cvt_pk_bf16_f32 v108, v100, v101
v_cvt_pk_bf16_f32 v109, v102, v103
v_cvt_pk_bf16_f32 v110, v104, v105
buffer_load_dwordx4 v174, s[80:83], s88 offen offset:2048 lds
v_cvt_pk_bf16_f32 v111, v106, v107
v_accvgpr_write_b32 a16, v108
v_accvgpr_write_b32 a17, v109
v_accvgpr_write_b32 a18, v110
v_accvgpr_write_b32 a19, v111
buffer_load_dwordx4 v175, s[80:83], s88 offen offset:3072 lds
v_accvgpr_read_b32 v112, a40
v_accvgpr_read_b32 v113, a41
v_accvgpr_read_b32 v114, a42
v_accvgpr_read_b32 v115, a43
v_accvgpr_read_b32 v116, a44
s_add_u32 m0, s84, 65536
s_mov_b32 s88, 256
buffer_load_dwordx4 v168, s[96:99], s88 offen offset:0 lds
v_accvgpr_read_b32 v117, a45
v_accvgpr_read_b32 v118, a46
v_accvgpr_read_b32 v119, a47
v_cvt_pk_bf16_f32 v120, v112, v113
v_cvt_pk_bf16_f32 v121, v114, v115
buffer_load_dwordx4 v169, s[96:99], s88 offen offset:1024 lds
v_cvt_pk_bf16_f32 v122, v116, v117
v_cvt_pk_bf16_f32 v123, v118, v119
v_accvgpr_write_b32 a20, v120
v_accvgpr_write_b32 a21, v121
v_accvgpr_write_b32 a22, v122
buffer_load_dwordx4 v170, s[96:99], s88 offen offset:2048 lds
v_accvgpr_write_b32 a23, v123
v_accvgpr_read_b32 v100, a48
v_accvgpr_read_b32 v101, a49
v_accvgpr_read_b32 v102, a50
v_accvgpr_read_b32 v103, a51
buffer_load_dwordx4 v171, s[96:99], s88 offen offset:3072 lds
v_accvgpr_read_b32 v104, a52
v_accvgpr_read_b32 v105, a53
v_accvgpr_read_b32 v106, a54
v_accvgpr_read_b32 v107, a55
v_cvt_pk_bf16_f32 v108, v100, v101
s_add_u32 m0, s84, 81920
s_mov_b32 s88, 344064
buffer_load_dwordx4 v172, s[80:83], s88 offen offset:0 lds
v_cvt_pk_bf16_f32 v109, v102, v103
v_cvt_pk_bf16_f32 v110, v104, v105
v_cvt_pk_bf16_f32 v111, v106, v107
v_accvgpr_write_b32 a24, v108
v_accvgpr_write_b32 a25, v109
buffer_load_dwordx4 v173, s[80:83], s88 offen offset:1024 lds
v_accvgpr_write_b32 a26, v110
v_accvgpr_write_b32 a27, v111
v_accvgpr_read_b32 v112, a56
v_accvgpr_read_b32 v113, a57
v_accvgpr_read_b32 v114, a58
buffer_load_dwordx4 v174, s[80:83], s88 offen offset:2048 lds
v_accvgpr_read_b32 v115, a59
v_accvgpr_read_b32 v116, a60
v_accvgpr_read_b32 v117, a61
v_accvgpr_read_b32 v118, a62
v_accvgpr_read_b32 v119, a63
buffer_load_dwordx4 v175, s[80:83], s88 offen offset:3072 lds
v_cvt_pk_bf16_f32 v120, v112, v113
v_cvt_pk_bf16_f32 v121, v114, v115
v_cvt_pk_bf16_f32 v122, v116, v117
v_cvt_pk_bf16_f32 v123, v118, v119
v_accvgpr_write_b32 a28, v120
s_add_u32 m0, s84, 98304
s_mov_b32 s88, 384
buffer_load_dwordx4 v168, s[96:99], s88 offen offset:0 lds
v_accvgpr_write_b32 a29, v121
v_accvgpr_write_b32 a30, v122
v_accvgpr_write_b32 a31, v123
v_accvgpr_read_b32 v100, a64
v_accvgpr_read_b32 v101, a65
buffer_load_dwordx4 v169, s[96:99], s88 offen offset:1024 lds
v_accvgpr_read_b32 v102, a66
v_accvgpr_read_b32 v103, a67
v_accvgpr_read_b32 v104, a68
v_accvgpr_read_b32 v105, a69
v_accvgpr_read_b32 v106, a70
buffer_load_dwordx4 v170, s[96:99], s88 offen offset:2048 lds
v_accvgpr_read_b32 v107, a71
v_cvt_pk_bf16_f32 v108, v100, v101
v_cvt_pk_bf16_f32 v109, v102, v103
v_cvt_pk_bf16_f32 v110, v104, v105
v_cvt_pk_bf16_f32 v111, v106, v107
buffer_load_dwordx4 v171, s[96:99], s88 offen offset:3072 lds
v_accvgpr_write_b32 a32, v108
v_accvgpr_write_b32 a33, v109
v_accvgpr_write_b32 a34, v110
v_accvgpr_write_b32 a35, v111
v_accvgpr_read_b32 v112, a72
s_add_u32 m0, s84, 114688
s_mov_b32 s88, 516096
buffer_load_dwordx4 v172, s[80:83], s88 offen offset:0 lds
v_accvgpr_read_b32 v113, a73
v_accvgpr_read_b32 v114, a74
v_accvgpr_read_b32 v115, a75
v_accvgpr_read_b32 v116, a76
v_accvgpr_read_b32 v117, a77
buffer_load_dwordx4 v173, s[80:83], s88 offen offset:1024 lds
v_accvgpr_read_b32 v118, a78
v_accvgpr_read_b32 v119, a79
v_cvt_pk_bf16_f32 v120, v112, v113
v_cvt_pk_bf16_f32 v121, v114, v115
v_cvt_pk_bf16_f32 v122, v116, v117
buffer_load_dwordx4 v174, s[80:83], s88 offen offset:2048 lds
v_cvt_pk_bf16_f32 v123, v118, v119
v_accvgpr_write_b32 a36, v120
v_accvgpr_write_b32 a37, v121
v_accvgpr_write_b32 a38, v122
v_accvgpr_write_b32 a39, v123
buffer_load_dwordx4 v175, s[80:83], s88 offen offset:3072 lds
v_accvgpr_read_b32 v100, a80
v_accvgpr_read_b32 v101, a81
v_accvgpr_read_b32 v102, a82
v_accvgpr_read_b32 v103, a83
v_accvgpr_read_b32 v104, a84
s_add_u32 m0, s84, 131072
s_mov_b32 s88, 0
buffer_load_dwordx4 v164, s[72:75], s88 offen offset:0 lds
v_accvgpr_read_b32 v105, a85
v_accvgpr_read_b32 v106, a86
v_accvgpr_read_b32 v107, a87
v_cvt_pk_bf16_f32 v108, v100, v101
v_cvt_pk_bf16_f32 v109, v102, v103
buffer_load_dwordx4 v165, s[72:75], s88 offen offset:1024 lds
v_cvt_pk_bf16_f32 v110, v104, v105
v_cvt_pk_bf16_f32 v111, v106, v107
v_accvgpr_write_b32 a40, v108
v_accvgpr_write_b32 a41, v109
v_accvgpr_write_b32 a42, v110
buffer_load_dwordx4 v166, s[72:75], s88 offen offset:2048 lds
v_accvgpr_write_b32 a43, v111
v_accvgpr_read_b32 v112, a88
v_accvgpr_read_b32 v113, a89
v_accvgpr_read_b32 v114, a90
v_accvgpr_read_b32 v115, a91
buffer_load_dwordx4 v167, s[72:75], s88 offen offset:3072 lds
v_accvgpr_read_b32 v116, a92
v_accvgpr_read_b32 v117, a93
v_accvgpr_read_b32 v118, a94
v_accvgpr_read_b32 v119, a95
v_cvt_pk_bf16_f32 v120, v112, v113
s_add_u32 m0, s84, 147456
s_mov_b32 s88, 128
buffer_load_dwordx4 v164, s[72:75], s88 offen offset:0 lds
v_cvt_pk_bf16_f32 v121, v114, v115
v_cvt_pk_bf16_f32 v122, v116, v117
v_cvt_pk_bf16_f32 v123, v118, v119
v_accvgpr_write_b32 a44, v120
v_accvgpr_write_b32 a45, v121
buffer_load_dwordx4 v165, s[72:75], s88 offen offset:1024 lds
v_accvgpr_write_b32 a46, v122
v_accvgpr_write_b32 a47, v123
v_accvgpr_read_b32 v100, a96
v_accvgpr_read_b32 v101, a97
v_accvgpr_read_b32 v102, a98
buffer_load_dwordx4 v166, s[72:75], s88 offen offset:2048 lds
v_accvgpr_read_b32 v103, a99
v_accvgpr_read_b32 v104, a100
v_accvgpr_read_b32 v105, a101
v_accvgpr_read_b32 v106, a102
v_accvgpr_read_b32 v107, a103
buffer_load_dwordx4 v167, s[72:75], s88 offen offset:3072 lds
v_cvt_pk_bf16_f32 v108, v100, v101
v_cvt_pk_bf16_f32 v109, v102, v103
v_cvt_pk_bf16_f32 v110, v104, v105
v_cvt_pk_bf16_f32 v111, v106, v107
v_accvgpr_write_b32 a48, v108
s_mul_i32 s62, s16, 7
s_mul_i32 s62, s62, s100
s_add_u32 s61, s90, s62
buffer_store_dwordx4 v[36:39], v1, s[12:15], s61 offen sc1
v_accvgpr_write_b32 a49, v109
v_accvgpr_write_b32 a50, v110
v_accvgpr_write_b32 a51, v111
v_accvgpr_read_b32 v112, a104
v_accvgpr_read_b32 v113, a105
s_add_u32 s61, s61, s100
buffer_store_dwordx4 v[40:43], v1, s[12:15], s61 offen sc1
v_accvgpr_read_b32 v114, a106
v_accvgpr_read_b32 v115, a107
v_accvgpr_read_b32 v116, a108
v_accvgpr_read_b32 v117, a109
v_accvgpr_read_b32 v118, a110
s_add_u32 s61, s61, s100
buffer_store_dwordx4 v[44:47], v1, s[12:15], s61 offen sc1
v_accvgpr_read_b32 v119, a111
v_cvt_pk_bf16_f32 v120, v112, v113
v_cvt_pk_bf16_f32 v121, v114, v115
v_cvt_pk_bf16_f32 v122, v116, v117
v_cvt_pk_bf16_f32 v123, v118, v119
s_add_u32 s61, s61, s100
buffer_store_dwordx4 v[48:51], v1, s[12:15], s61 offen sc1
v_accvgpr_write_b32 a52, v120
v_accvgpr_write_b32 a53, v121
v_accvgpr_write_b32 a54, v122
v_accvgpr_write_b32 a55, v123
v_accvgpr_read_b32 v100, a112
s_add_u32 s61, s61, s100
buffer_store_dwordx4 v[52:55], v1, s[12:15], s61 offen sc1
v_accvgpr_read_b32 v101, a113
v_accvgpr_read_b32 v102, a114
v_accvgpr_read_b32 v103, a115
v_accvgpr_read_b32 v104, a116
v_accvgpr_read_b32 v105, a117
s_add_u32 s61, s61, s100
buffer_store_dwordx4 v[56:59], v1, s[12:15], s61 offen sc1
v_accvgpr_read_b32 v106, a118
v_accvgpr_read_b32 v107, a119
v_cvt_pk_bf16_f32 v108, v100, v101
v_cvt_pk_bf16_f32 v109, v102, v103
v_cvt_pk_bf16_f32 v110, v104, v105
s_add_u32 s61, s61, s100
buffer_store_dwordx4 v[60:63], v1, s[12:15], s61 offen sc1
v_cvt_pk_bf16_f32 v111, v106, v107
v_accvgpr_write_b32 a56, v108
v_accvgpr_write_b32 a57, v109
v_accvgpr_write_b32 a58, v110
v_accvgpr_write_b32 a59, v111
v_accvgpr_read_b32 v112, a120
v_accvgpr_read_b32 v113, a121
v_accvgpr_read_b32 v114, a122
v_accvgpr_read_b32 v115, a123
v_accvgpr_read_b32 v116, a124
v_accvgpr_read_b32 v117, a125
v_accvgpr_read_b32 v118, a126
v_accvgpr_read_b32 v119, a127
v_cvt_pk_bf16_f32 v120, v112, v113
v_cvt_pk_bf16_f32 v121, v114, v115
v_cvt_pk_bf16_f32 v122, v116, v117
v_cvt_pk_bf16_f32 v123, v118, v119
v_accvgpr_write_b32 a60, v120
v_accvgpr_write_b32 a61, v121
v_accvgpr_write_b32 a62, v122
v_accvgpr_write_b32 a63, v123
v_accvgpr_read_b32 v100, a128
v_accvgpr_read_b32 v101, a129
v_accvgpr_read_b32 v102, a130
v_accvgpr_read_b32 v103, a131
v_accvgpr_read_b32 v104, a132
v_accvgpr_read_b32 v105, a133
v_accvgpr_read_b32 v106, a134
v_accvgpr_read_b32 v107, a135
v_cvt_pk_bf16_f32 v108, v100, v101
v_cvt_pk_bf16_f32 v109, v102, v103
v_cvt_pk_bf16_f32 v110, v104, v105
v_cvt_pk_bf16_f32 v111, v106, v107
s_add_u32 s64, s71, 32768
buffer_store_dwordx4 v[108:111], v1, s[12:15], s64 offen sc1
v_accvgpr_read_b32 v112, a136
v_accvgpr_read_b32 v113, a137
v_accvgpr_read_b32 v114, a138
v_accvgpr_read_b32 v115, a139
v_accvgpr_read_b32 v116, a140
v_accvgpr_read_b32 v117, a141
v_accvgpr_read_b32 v118, a142
v_accvgpr_read_b32 v119, a143
v_cvt_pk_bf16_f32 v120, v112, v113
v_cvt_pk_bf16_f32 v121, v114, v115
v_cvt_pk_bf16_f32 v122, v116, v117
v_cvt_pk_bf16_f32 v123, v118, v119
s_add_u32 s64, s71, 33792
buffer_store_dwordx4 v[120:123], v1, s[12:15], s64 offen sc1
v_accvgpr_read_b32 v100, a144
v_accvgpr_read_b32 v101, a145
v_accvgpr_read_b32 v102, a146
v_accvgpr_read_b32 v103, a147
v_accvgpr_read_b32 v104, a148
v_accvgpr_read_b32 v105, a149
v_accvgpr_read_b32 v106, a150
v_accvgpr_read_b32 v107, a151
v_cvt_pk_bf16_f32 v108, v100, v101
v_cvt_pk_bf16_f32 v109, v102, v103
v_cvt_pk_bf16_f32 v110, v104, v105
v_cvt_pk_bf16_f32 v111, v106, v107
s_add_u32 s64, s71, 34816
buffer_store_dwordx4 v[108:111], v1, s[12:15], s64 offen sc1
v_accvgpr_read_b32 v112, a152
v_accvgpr_read_b32 v113, a153
v_accvgpr_read_b32 v114, a154
v_accvgpr_read_b32 v115, a155
v_accvgpr_read_b32 v116, a156
v_accvgpr_read_b32 v117, a157
v_accvgpr_read_b32 v118, a158
v_accvgpr_read_b32 v119, a159
v_cvt_pk_bf16_f32 v120, v112, v113
v_cvt_pk_bf16_f32 v121, v114, v115
v_cvt_pk_bf16_f32 v122, v116, v117
v_cvt_pk_bf16_f32 v123, v118, v119
s_add_u32 s64, s71, 35840
buffer_store_dwordx4 v[120:123], v1, s[12:15], s64 offen sc1
v_accvgpr_read_b32 v100, a160
v_accvgpr_read_b32 v101, a161
v_accvgpr_read_b32 v102, a162
v_accvgpr_read_b32 v103, a163
v_accvgpr_read_b32 v104, a164
v_accvgpr_read_b32 v105, a165
v_accvgpr_read_b32 v106, a166
v_accvgpr_read_b32 v107, a167
v_cvt_pk_bf16_f32 v108, v100, v101
v_cvt_pk_bf16_f32 v109, v102, v103
v_cvt_pk_bf16_f32 v110, v104, v105
v_cvt_pk_bf16_f32 v111, v106, v107
s_mul_i32 s64, s60, -4096
s_add_u32 s64, s64, 40960
s_add_u32 s64, s64, s71
buffer_store_dwordx4 v[108:111], v1, s[12:15], s64 offen sc1
v_accvgpr_read_b32 v112, a168
v_accvgpr_read_b32 v113, a169
v_accvgpr_read_b32 v114, a170
v_accvgpr_read_b32 v115, a171
v_accvgpr_read_b32 v116, a172
v_accvgpr_read_b32 v117, a173
v_accvgpr_read_b32 v118, a174
v_accvgpr_read_b32 v119, a175
v_cvt_pk_bf16_f32 v120, v112, v113
v_cvt_pk_bf16_f32 v121, v114, v115
v_cvt_pk_bf16_f32 v122, v116, v117
v_cvt_pk_bf16_f32 v123, v118, v119
s_mul_i32 s64, s60, -4096
s_add_u32 s64, s64, 41984
s_add_u32 s64, s64, s71
buffer_store_dwordx4 v[120:123], v1, s[12:15], s64 offen sc1
v_accvgpr_read_b32 v100, a176
v_accvgpr_read_b32 v101, a177
v_accvgpr_read_b32 v102, a178
v_accvgpr_read_b32 v103, a179
v_accvgpr_read_b32 v104, a180
v_accvgpr_read_b32 v105, a181
v_accvgpr_read_b32 v106, a182
v_accvgpr_read_b32 v107, a183
v_cvt_pk_bf16_f32 v108, v100, v101
v_cvt_pk_bf16_f32 v109, v102, v103
v_cvt_pk_bf16_f32 v110, v104, v105
v_cvt_pk_bf16_f32 v111, v106, v107
s_mul_i32 s64, s60, -4096
s_add_u32 s64, s64, 43008
s_add_u32 s64, s64, s71
buffer_store_dwordx4 v[108:111], v1, s[12:15], s64 offen sc1
v_accvgpr_read_b32 v112, a184
v_accvgpr_read_b32 v113, a185
v_accvgpr_read_b32 v114, a186
v_accvgpr_read_b32 v115, a187
v_accvgpr_read_b32 v116, a188
v_accvgpr_read_b32 v117, a189
v_accvgpr_read_b32 v118, a190
v_accvgpr_read_b32 v119, a191
v_cvt_pk_bf16_f32 v120, v112, v113
v_cvt_pk_bf16_f32 v121, v114, v115
v_cvt_pk_bf16_f32 v122, v116, v117
v_cvt_pk_bf16_f32 v123, v118, v119
s_mul_i32 s64, s60, -4096
s_add_u32 s64, s64, 44032
s_add_u32 s64, s64, s71
buffer_store_dwordx4 v[120:123], v1, s[12:15], s64 offen sc1
v_accvgpr_read_b32 v100, a192
v_accvgpr_read_b32 v101, a193
v_accvgpr_read_b32 v102, a194
v_accvgpr_read_b32 v103, a195
v_accvgpr_read_b32 v104, a196
v_accvgpr_read_b32 v105, a197
v_accvgpr_read_b32 v106, a198
v_accvgpr_read_b32 v107, a199
v_cvt_pk_bf16_f32 v108, v100, v101
v_cvt_pk_bf16_f32 v109, v102, v103
v_cvt_pk_bf16_f32 v110, v104, v105
v_cvt_pk_bf16_f32 v111, v106, v107
s_add_u32 s64, s71, 49152
buffer_store_dwordx4 v[108:111], v1, s[12:15], s64 offen sc1
v_accvgpr_read_b32 v112, a200
v_accvgpr_read_b32 v113, a201
v_accvgpr_read_b32 v114, a202
v_accvgpr_read_b32 v115, a203
v_accvgpr_read_b32 v116, a204
v_accvgpr_read_b32 v117, a205
v_accvgpr_read_b32 v118, a206
v_accvgpr_read_b32 v119, a207
v_cvt_pk_bf16_f32 v120, v112, v113
v_cvt_pk_bf16_f32 v121, v114, v115
v_cvt_pk_bf16_f32 v122, v116, v117
v_cvt_pk_bf16_f32 v123, v118, v119
s_add_u32 s64, s71, 50176
buffer_store_dwordx4 v[120:123], v1, s[12:15], s64 offen sc1
v_accvgpr_read_b32 v100, a208
v_accvgpr_read_b32 v101, a209
v_accvgpr_read_b32 v102, a210
v_accvgpr_read_b32 v103, a211
v_accvgpr_read_b32 v104, a212
v_accvgpr_read_b32 v105, a213
v_accvgpr_read_b32 v106, a214
v_accvgpr_read_b32 v107, a215
v_cvt_pk_bf16_f32 v108, v100, v101
v_cvt_pk_bf16_f32 v109, v102, v103
v_cvt_pk_bf16_f32 v110, v104, v105
v_cvt_pk_bf16_f32 v111, v106, v107
s_add_u32 s64, s71, 51200
buffer_store_dwordx4 v[108:111], v1, s[12:15], s64 offen sc1
v_accvgpr_read_b32 v112, a216
v_accvgpr_read_b32 v113, a217
v_accvgpr_read_b32 v114, a218
v_accvgpr_read_b32 v115, a219
v_accvgpr_read_b32 v116, a220
v_accvgpr_read_b32 v117, a221
v_accvgpr_read_b32 v118, a222
v_accvgpr_read_b32 v119, a223
v_cvt_pk_bf16_f32 v120, v112, v113
v_cvt_pk_bf16_f32 v121, v114, v115
v_cvt_pk_bf16_f32 v122, v116, v117
v_cvt_pk_bf16_f32 v123, v118, v119
s_add_u32 s64, s71, 52224
buffer_store_dwordx4 v[120:123], v1, s[12:15], s64 offen sc1
v_accvgpr_read_b32 v100, a224
v_accvgpr_read_b32 v101, a225
v_accvgpr_read_b32 v102, a226
v_accvgpr_read_b32 v103, a227
v_accvgpr_read_b32 v104, a228
v_accvgpr_read_b32 v105, a229
v_accvgpr_read_b32 v106, a230
v_accvgpr_read_b32 v107, a231
v_cvt_pk_bf16_f32 v108, v100, v101
v_cvt_pk_bf16_f32 v109, v102, v103
v_cvt_pk_bf16_f32 v110, v104, v105
v_cvt_pk_bf16_f32 v111, v106, v107
s_mul_i32 s64, s60, -4096
s_add_u32 s64, s64, 57344
s_add_u32 s64, s64, s71
buffer_store_dwordx4 v[108:111], v1, s[12:15], s64 offen sc1
v_accvgpr_read_b32 v112, a232
v_accvgpr_read_b32 v113, a233
v_accvgpr_read_b32 v114, a234
v_accvgpr_read_b32 v115, a235
v_accvgpr_read_b32 v116, a236
v_accvgpr_read_b32 v117, a237
v_accvgpr_read_b32 v118, a238
v_accvgpr_read_b32 v119, a239
v_cvt_pk_bf16_f32 v120, v112, v113
v_cvt_pk_bf16_f32 v121, v114, v115
v_cvt_pk_bf16_f32 v122, v116, v117
v_cvt_pk_bf16_f32 v123, v118, v119
s_mul_i32 s64, s60, -4096
s_add_u32 s64, s64, 58368
s_add_u32 s64, s64, s71
buffer_store_dwordx4 v[120:123], v1, s[12:15], s64 offen sc1
v_accvgpr_read_b32 v100, a240
v_accvgpr_read_b32 v101, a241
v_accvgpr_read_b32 v102, a242
v_accvgpr_read_b32 v103, a243
v_accvgpr_read_b32 v104, a244
v_accvgpr_read_b32 v105, a245
v_accvgpr_read_b32 v106, a246
v_accvgpr_read_b32 v107, a247
v_cvt_pk_bf16_f32 v108, v100, v101
v_cvt_pk_bf16_f32 v109, v102, v103
v_cvt_pk_bf16_f32 v110, v104, v105
v_cvt_pk_bf16_f32 v111, v106, v107
s_mul_i32 s64, s60, -4096
s_add_u32 s64, s64, 59392
s_add_u32 s64, s64, s71
buffer_store_dwordx4 v[108:111], v1, s[12:15], s64 offen sc1
v_accvgpr_read_b32 v112, a248
v_accvgpr_read_b32 v113, a249
v_accvgpr_read_b32 v114, a250
v_accvgpr_read_b32 v115, a251
v_accvgpr_read_b32 v116, a252
v_accvgpr_read_b32 v117, a253
v_accvgpr_read_b32 v118, a254
v_accvgpr_read_b32 v119, a255
v_cvt_pk_bf16_f32 v120, v112, v113
v_cvt_pk_bf16_f32 v121, v114, v115
v_cvt_pk_bf16_f32 v122, v116, v117
v_cvt_pk_bf16_f32 v123, v118, v119
s_mul_i32 s64, s60, -4096
s_add_u32 s64, s64, 60416
s_add_u32 s64, s64, s71
buffer_store_dwordx4 v[120:123], v1, s[12:15], s64 offen sc1
v_and_b32 v28, 63, v0
v_and_b32 v29, 15, v28
v_lshrrev_b32 v30, 4, v28
v_bfe_u32 v31, v28, 2, 2
v_and_b32 v32, 3, v28
v_lshl_add_u32 v33, v30, 3, v31
v_lshlrev_b32 v33, 8, v33
v_and_b32 v34, 1, v30
v_lshl_add_u32 v34, v34, 2, v31
v_lshlrev_b32 v34, 5, v34
v_lshlrev_b32 v32, 3, v32
v_add_u32 v32, s89, v32
v_add_u32 v35, 0, v32
v_xor_b32 v35, v35, v34
v_add_u32 v4, v35, v33
v_add_u32 v35, 32, v32
v_xor_b32 v35, v35, v34
v_add_u32 v5, v35, v33
v_add_u32 v35, 80, v32
v_xor_b32 v35, v35, v34
v_add_u32 v6, v35, v33
v_add_u32 v35, 112, v32
v_xor_b32 v35, v35, v34
v_add_u32 v7, v35, v33
v_add_u32 v35, 160, v32
v_xor_b32 v35, v35, v34
v_add_u32 v8, v35, v33
v_add_u32 v35, 192, v32
v_xor_b32 v35, v35, v34
v_add_u32 v9, v35, v33
s_waitcnt vmcnt(55)
s_barrier
ds_read_b128 v[56:59], v176 offset:0
ds_read_b128 v[60:63], v176 offset:2048
ds_read_b64_tr_b16 v[96:97], v4 offset:16384
ds_read_b64_tr_b16 v[98:99], v4 offset:17408
ds_read_b64_tr_b16 v[100:101], v5 offset:16384
ds_read_b64_tr_b16 v[102:103], v5 offset:17408
ds_read_b64_tr_b16 v[104:105], v6 offset:16384
ds_read_b64_tr_b16 v[106:107], v6 offset:17408
ds_read_b64_tr_b16 v[108:109], v7 offset:16384
ds_read_b64_tr_b16 v[110:111], v7 offset:17408
ds_read_b64_tr_b16 v[112:113], v8 offset:16384
ds_read_b64_tr_b16 v[114:115], v8 offset:17408
ds_read_b64_tr_b16 v[116:117], v9 offset:16384
ds_read_b64_tr_b16 v[118:119], v9 offset:17408
ds_read_b128 v[64:67], v177 offset:0
ds_read_b128 v[68:71], v177 offset:2048
ds_read_b64_tr_b16 v[120:121], v4 offset:24576
ds_read_b64_tr_b16 v[122:123], v4 offset:25600
ds_read_b64_tr_b16 v[124:125], v5 offset:24576
ds_read_b64_tr_b16 v[126:127], v5 offset:25600
ds_read_b64_tr_b16 v[128:129], v6 offset:24576
ds_read_b64_tr_b16 v[130:131], v6 offset:25600
ds_read_b64_tr_b16 v[132:133], v7 offset:24576
ds_read_b64_tr_b16 v[134:135], v7 offset:25600
ds_read_b64_tr_b16 v[136:137], v8 offset:24576
ds_read_b64_tr_b16 v[138:139], v8 offset:25600
ds_read_b64_tr_b16 v[140:141], v9 offset:24576
ds_read_b64_tr_b16 v[142:143], v9 offset:25600
s_add_u32 s64, s71, 0
buffer_store_dwordx4 a[0:3], v1, s[12:15], s64 offen sc1
s_waitcnt lgkmcnt(15)
v_mfma_f32_16x16x32_bf16 v[180:183], v[96:99], v[56:59], 0
v_mfma_f32_16x16x32_bf16 v[184:187], v[96:99], v[60:63], 0
v_mfma_f32_16x16x32_bf16 v[188:191], v[100:103], v[56:59], 0
v_mfma_f32_16x16x32_bf16 v[192:195], v[100:103], v[60:63], 0
v_mfma_f32_16x16x32_bf16 v[196:199], v[104:107], v[56:59], 0
v_mfma_f32_16x16x32_bf16 v[200:203], v[104:107], v[60:63], 0
v_mfma_f32_16x16x32_bf16 v[204:207], v[108:111], v[56:59], 0
v_mfma_f32_16x16x32_bf16 v[208:211], v[108:111], v[60:63], 0
v_mfma_f32_16x16x32_bf16 v[212:215], v[56:59], v[112:115], 0
v_mfma_f32_16x16x32_bf16 v[216:219], v[60:63], v[112:115], 0
s_waitcnt lgkmcnt(14)
v_mfma_f32_16x16x32_bf16 v[220:223], v[56:59], v[116:119], 0
v_mfma_f32_16x16x32_bf16 v[224:227], v[60:63], v[116:119], 0
s_waitcnt lgkmcnt(10)
v_mfma_f32_16x16x32_bf16 v[180:183], v[120:123], v[64:67], v[180:183]
v_mfma_f32_16x16x32_bf16 v[184:187], v[120:123], v[68:71], v[184:187]
s_waitcnt lgkmcnt(8)
v_mfma_f32_16x16x32_bf16 v[188:191], v[124:127], v[64:67], v[188:191]
v_mfma_f32_16x16x32_bf16 v[192:195], v[124:127], v[68:71], v[192:195]
s_waitcnt lgkmcnt(6)
v_mfma_f32_16x16x32_bf16 v[196:199], v[128:131], v[64:67], v[196:199]
v_mfma_f32_16x16x32_bf16 v[200:203], v[128:131], v[68:71], v[200:203]
s_waitcnt lgkmcnt(4)
v_mfma_f32_16x16x32_bf16 v[204:207], v[132:135], v[64:67], v[204:207]
v_mfma_f32_16x16x32_bf16 v[208:211], v[132:135], v[68:71], v[208:211]
s_waitcnt lgkmcnt(2)
v_mfma_f32_16x16x32_bf16 v[212:215], v[64:67], v[136:139], v[212:215]
v_mfma_f32_16x16x32_bf16 v[216:219], v[68:71], v[136:139], v[216:219]
s_waitcnt lgkmcnt(0)
v_mfma_f32_16x16x32_bf16 v[220:223], v[64:67], v[140:143], v[220:223]
v_mfma_f32_16x16x32_bf16 v[224:227], v[68:71], v[140:143], v[224:227]
v_add_u32 v176, 32768, v176
v_add_u32 v177, 32768, v177
v_add_u32 v4, 32768, v4
v_add_u32 v5, 32768, v5
v_add_u32 v6, 32768, v6
v_add_u32 v7, 32768, v7
v_add_u32 v8, 32768, v8
v_add_u32 v9, 32768, v9
s_waitcnt vmcnt(48)
s_barrier
ds_read_b128 v[56:59], v176 offset:0
ds_read_b128 v[60:63], v176 offset:2048
ds_read_b64_tr_b16 v[96:97], v4 offset:16384
ds_read_b64_tr_b16 v[98:99], v4 offset:17408
ds_read_b64_tr_b16 v[100:101], v5 offset:16384
ds_read_b64_tr_b16 v[102:103], v5 offset:17408
ds_read_b64_tr_b16 v[104:105], v6 offset:16384
ds_read_b64_tr_b16 v[106:107], v6 offset:17408
ds_read_b64_tr_b16 v[108:109], v7 offset:16384
ds_read_b64_tr_b16 v[110:111], v7 offset:17408
ds_read_b64_tr_b16 v[112:113], v8 offset:16384
ds_read_b64_tr_b16 v[114:115], v8 offset:17408
ds_read_b64_tr_b16 v[116:117], v9 offset:16384
ds_read_b64_tr_b16 v[118:119], v9 offset:17408
ds_read_b128 v[64:67], v177 offset:0
ds_read_b128 v[68:71], v177 offset:2048
ds_read_b64_tr_b16 v[120:121], v4 offset:24576
ds_read_b64_tr_b16 v[122:123], v4 offset:25600
ds_read_b64_tr_b16 v[124:125], v5 offset:24576
ds_read_b64_tr_b16 v[126:127], v5 offset:25600
ds_read_b64_tr_b16 v[128:129], v6 offset:24576
ds_read_b64_tr_b16 v[130:131], v6 offset:25600
ds_read_b64_tr_b16 v[132:133], v7 offset:24576
ds_read_b64_tr_b16 v[134:135], v7 offset:25600
ds_read_b64_tr_b16 v[136:137], v8 offset:24576
ds_read_b64_tr_b16 v[138:139], v8 offset:25600
ds_read_b64_tr_b16 v[140:141], v9 offset:24576
ds_read_b64_tr_b16 v[142:143], v9 offset:25600
s_add_u32 m0, s84, 0
s_mov_b32 s88, 512
buffer_load_dwordx4 v168, s[96:99], s88 offen offset:0 lds
buffer_load_dwordx4 v169, s[96:99], s88 offen offset:1024 lds
s_waitcnt lgkmcnt(15)
v_mfma_f32_16x16x32_bf16 v[180:183], v[96:99], v[56:59], v[180:183]
v_mfma_f32_16x16x32_bf16 v[184:187], v[96:99], v[60:63], v[184:187]
buffer_load_dwordx4 v170, s[96:99], s88 offen offset:2048 lds
v_mfma_f32_16x16x32_bf16 v[188:191], v[100:103], v[56:59], v[188:191]
v_mfma_f32_16x16x32_bf16 v[192:195], v[100:103], v[60:63], v[192:195]
buffer_load_dwordx4 v171, s[96:99], s88 offen offset:3072 lds
v_mfma_f32_16x16x32_bf16 v[196:199], v[104:107], v[56:59], v[196:199]
v_mfma_f32_16x16x32_bf16 v[200:203], v[104:107], v[60:63], v[200:203]
s_add_u32 m0, s84, 16384
s_mov_b32 s88, 688128
buffer_load_dwordx4 v172, s[80:83], s88 offen offset:0 lds
v_mfma_f32_16x16x32_bf16 v[204:207], v[108:111], v[56:59], v[204:207]
v_mfma_f32_16x16x32_bf16 v[208:211], v[108:111], v[60:63], v[208:211]
buffer_load_dwordx4 v173, s[80:83], s88 offen offset:1024 lds
v_mfma_f32_16x16x32_bf16 v[212:215], v[56:59], v[112:115], v[212:215]
v_mfma_f32_16x16x32_bf16 v[216:219], v[60:63], v[112:115], v[216:219]
buffer_load_dwordx4 v174, s[80:83], s88 offen offset:2048 lds
s_waitcnt lgkmcnt(14)
v_mfma_f32_16x16x32_bf16 v[220:223], v[56:59], v[116:119], v[220:223]
v_mfma_f32_16x16x32_bf16 v[224:227], v[60:63], v[116:119], v[224:227]
buffer_load_dwordx4 v175, s[80:83], s88 offen offset:3072 lds
s_waitcnt lgkmcnt(10)
v_mfma_f32_16x16x32_bf16 v[180:183], v[120:123], v[64:67], v[180:183]
v_mfma_f32_16x16x32_bf16 v[184:187], v[120:123], v[68:71], v[184:187]
s_add_u32 s64, s71, 1024
buffer_store_dwordx4 a[4:7], v1, s[12:15], s64 offen sc1
s_waitcnt lgkmcnt(8)
v_mfma_f32_16x16x32_bf16 v[188:191], v[124:127], v[64:67], v[188:191]
v_mfma_f32_16x16x32_bf16 v[192:195], v[124:127], v[68:71], v[192:195]
s_waitcnt lgkmcnt(6)
v_mfma_f32_16x16x32_bf16 v[196:199], v[128:131], v[64:67], v[196:199]
v_mfma_f32_16x16x32_bf16 v[200:203], v[128:131], v[68:71], v[200:203]
s_waitcnt lgkmcnt(4)
v_mfma_f32_16x16x32_bf16 v[204:207], v[132:135], v[64:67], v[204:207]
v_mfma_f32_16x16x32_bf16 v[208:211], v[132:135], v[68:71], v[208:211]
s_waitcnt lgkmcnt(2)
v_mfma_f32_16x16x32_bf16 v[212:215], v[64:67], v[136:139], v[212:215]
v_mfma_f32_16x16x32_bf16 v[216:219], v[68:71], v[136:139], v[216:219]
s_waitcnt lgkmcnt(0)
v_mfma_f32_16x16x32_bf16 v[220:223], v[64:67], v[140:143], v[220:223]
v_mfma_f32_16x16x32_bf16 v[224:227], v[68:71], v[140:143], v[224:227]
v_add_u32 v176, 32768, v176
v_add_u32 v177, 32768, v177
v_add_u32 v4, 32768, v4
v_add_u32 v5, 32768, v5
v_add_u32 v6, 32768, v6
v_add_u32 v7, 32768, v7
v_add_u32 v8, 32768, v8
v_add_u32 v9, 32768, v9
s_waitcnt vmcnt(49)
s_barrier
ds_read_b128 v[56:59], v176 offset:0
ds_read_b128 v[60:63], v176 offset:2048
ds_read_b64_tr_b16 v[96:97], v4 offset:16384
ds_read_b64_tr_b16 v[98:99], v4 offset:17408
ds_read_b64_tr_b16 v[100:101], v5 offset:16384
ds_read_b64_tr_b16 v[102:103], v5 offset:17408
ds_read_b64_tr_b16 v[104:105], v6 offset:16384
ds_read_b64_tr_b16 v[106:107], v6 offset:17408
ds_read_b64_tr_b16 v[108:109], v7 offset:16384
ds_read_b64_tr_b16 v[110:111], v7 offset:17408
ds_read_b64_tr_b16 v[112:113], v8 offset:16384
ds_read_b64_tr_b16 v[114:115], v8 offset:17408
ds_read_b64_tr_b16 v[116:117], v9 offset:16384
ds_read_b64_tr_b16 v[118:119], v9 offset:17408
ds_read_b128 v[64:67], v177 offset:0
ds_read_b128 v[68:71], v177 offset:2048
ds_read_b64_tr_b16 v[120:121], v4 offset:24576
ds_read_b64_tr_b16 v[122:123], v4 offset:25600
ds_read_b64_tr_b16 v[124:125], v5 offset:24576
ds_read_b64_tr_b16 v[126:127], v5 offset:25600
ds_read_b64_tr_b16 v[128:129], v6 offset:24576
ds_read_b64_tr_b16 v[130:131], v6 offset:25600
ds_read_b64_tr_b16 v[132:133], v7 offset:24576
ds_read_b64_tr_b16 v[134:135], v7 offset:25600
ds_read_b64_tr_b16 v[136:137], v8 offset:24576
ds_read_b64_tr_b16 v[138:139], v8 offset:25600
ds_read_b64_tr_b16 v[140:141], v9 offset:24576
ds_read_b64_tr_b16 v[142:143], v9 offset:25600
s_add_u32 m0, s84, 32768
s_mov_b32 s88, 640
buffer_load_dwordx4 v168, s[96:99], s88 offen offset:0 lds
buffer_load_dwordx4 v169, s[96:99], s88 offen offset:1024 lds
s_waitcnt lgkmcnt(15)
v_mfma_f32_16x16x32_bf16 v[180:183], v[96:99], v[56:59], v[180:183]
v_mfma_f32_16x16x32_bf16 v[184:187], v[96:99], v[60:63], v[184:187]
buffer_load_dwordx4 v170, s[96:99], s88 offen offset:2048 lds
v_mfma_f32_16x16x32_bf16 v[188:191], v[100:103], v[56:59], v[188:191]
v_mfma_f32_16x16x32_bf16 v[192:195], v[100:103], v[60:63], v[192:195]
buffer_load_dwordx4 v171, s[96:99], s88 offen offset:3072 lds
v_mfma_f32_16x16x32_bf16 v[196:199], v[104:107], v[56:59], v[196:199]
v_mfma_f32_16x16x32_bf16 v[200:203], v[104:107], v[60:63], v[200:203]
s_add_u32 m0, s84, 49152
s_mov_b32 s88, 860160
buffer_load_dwordx4 v172, s[80:83], s88 offen offset:0 lds
v_mfma_f32_16x16x32_bf16 v[204:207], v[108:111], v[56:59], v[204:207]
v_mfma_f32_16x16x32_bf16 v[208:211], v[108:111], v[60:63], v[208:211]
buffer_load_dwordx4 v173, s[80:83], s88 offen offset:1024 lds
v_mfma_f32_16x16x32_bf16 v[212:215], v[56:59], v[112:115], v[212:215]
v_mfma_f32_16x16x32_bf16 v[216:219], v[60:63], v[112:115], v[216:219]
buffer_load_dwordx4 v174, s[80:83], s88 offen offset:2048 lds
s_waitcnt lgkmcnt(14)
v_mfma_f32_16x16x32_bf16 v[220:223], v[56:59], v[116:119], v[220:223]
v_mfma_f32_16x16x32_bf16 v[224:227], v[60:63], v[116:119], v[224:227]
buffer_load_dwordx4 v175, s[80:83], s88 offen offset:3072 lds
s_waitcnt lgkmcnt(10)
v_mfma_f32_16x16x32_bf16 v[180:183], v[120:123], v[64:67], v[180:183]
v_mfma_f32_16x16x32_bf16 v[184:187], v[120:123], v[68:71], v[184:187]
s_add_u32 s64, s71, 2048
buffer_store_dwordx4 a[8:11], v1, s[12:15], s64 offen sc1
s_waitcnt lgkmcnt(8)
v_mfma_f32_16x16x32_bf16 v[188:191], v[124:127], v[64:67], v[188:191]
v_mfma_f32_16x16x32_bf16 v[192:195], v[124:127], v[68:71], v[192:195]
s_waitcnt lgkmcnt(6)
v_mfma_f32_16x16x32_bf16 v[196:199], v[128:131], v[64:67], v[196:199]
v_mfma_f32_16x16x32_bf16 v[200:203], v[128:131], v[68:71], v[200:203]
s_waitcnt lgkmcnt(4)
v_mfma_f32_16x16x32_bf16 v[204:207], v[132:135], v[64:67], v[204:207]
v_mfma_f32_16x16x32_bf16 v[208:211], v[132:135], v[68:71], v[208:211]
s_waitcnt lgkmcnt(2)
v_mfma_f32_16x16x32_bf16 v[212:215], v[64:67], v[136:139], v[212:215]
v_mfma_f32_16x16x32_bf16 v[216:219], v[68:71], v[136:139], v[216:219]
s_waitcnt lgkmcnt(0)
v_mfma_f32_16x16x32_bf16 v[220:223], v[64:67], v[140:143], v[220:223]
v_mfma_f32_16x16x32_bf16 v[224:227], v[68:71], v[140:143], v[224:227]
v_add_u32 v176, 32768, v176
v_add_u32 v177, 32768, v177
v_add_u32 v4, 32768, v4
v_add_u32 v5, 32768, v5
v_add_u32 v6, 32768, v6
v_add_u32 v7, 32768, v7
v_add_u32 v8, 32768, v8
v_add_u32 v9, 32768, v9
s_waitcnt vmcnt(50)
s_barrier
ds_read_b128 v[56:59], v176 offset:0
ds_read_b128 v[60:63], v176 offset:2048
ds_read_b64_tr_b16 v[96:97], v4 offset:16384
ds_read_b64_tr_b16 v[98:99], v4 offset:17408
ds_read_b64_tr_b16 v[100:101], v5 offset:16384
ds_read_b64_tr_b16 v[102:103], v5 offset:17408
ds_read_b64_tr_b16 v[104:105], v6 offset:16384
ds_read_b64_tr_b16 v[106:107], v6 offset:17408
ds_read_b64_tr_b16 v[108:109], v7 offset:16384
ds_read_b64_tr_b16 v[110:111], v7 offset:17408
ds_read_b64_tr_b16 v[112:113], v8 offset:16384
ds_read_b64_tr_b16 v[114:115], v8 offset:17408
ds_read_b64_tr_b16 v[116:117], v9 offset:16384
ds_read_b64_tr_b16 v[118:119], v9 offset:17408
ds_read_b128 v[64:67], v177 offset:0
ds_read_b128 v[68:71], v177 offset:2048
ds_read_b64_tr_b16 v[120:121], v4 offset:24576
ds_read_b64_tr_b16 v[122:123], v4 offset:25600
ds_read_b64_tr_b16 v[124:125], v5 offset:24576
ds_read_b64_tr_b16 v[126:127], v5 offset:25600
ds_read_b64_tr_b16 v[128:129], v6 offset:24576
ds_read_b64_tr_b16 v[130:131], v6 offset:25600
ds_read_b64_tr_b16 v[132:133], v7 offset:24576
ds_read_b64_tr_b16 v[134:135], v7 offset:25600
ds_read_b64_tr_b16 v[136:137], v8 offset:24576
ds_read_b64_tr_b16 v[138:139], v8 offset:25600
ds_read_b64_tr_b16 v[140:141], v9 offset:24576
ds_read_b64_tr_b16 v[142:143], v9 offset:25600
s_add_u32 m0, s84, 65536
s_mov_b32 s88, 768
buffer_load_dwordx4 v168, s[96:99], s88 offen offset:0 lds
buffer_load_dwordx4 v169, s[96:99], s88 offen offset:1024 lds
s_waitcnt lgkmcnt(15)
v_mfma_f32_16x16x32_bf16 v[180:183], v[96:99], v[56:59], v[180:183]
v_mfma_f32_16x16x32_bf16 v[184:187], v[96:99], v[60:63], v[184:187]
buffer_load_dwordx4 v170, s[96:99], s88 offen offset:2048 lds
v_mfma_f32_16x16x32_bf16 v[188:191], v[100:103], v[56:59], v[188:191]
v_mfma_f32_16x16x32_bf16 v[192:195], v[100:103], v[60:63], v[192:195]
buffer_load_dwordx4 v171, s[96:99], s88 offen offset:3072 lds
v_mfma_f32_16x16x32_bf16 v[196:199], v[104:107], v[56:59], v[196:199]
v_mfma_f32_16x16x32_bf16 v[200:203], v[104:107], v[60:63], v[200:203]
s_add_u32 m0, s84, 81920
s_mov_b32 s88, 1032192
buffer_load_dwordx4 v172, s[80:83], s88 offen offset:0 lds
v_mfma_f32_16x16x32_bf16 v[204:207], v[108:111], v[56:59], v[204:207]
v_mfma_f32_16x16x32_bf16 v[208:211], v[108:111], v[60:63], v[208:211]
buffer_load_dwordx4 v173, s[80:83], s88 offen offset:1024 lds
v_mfma_f32_16x16x32_bf16 v[212:215], v[56:59], v[112:115], v[212:215]
v_mfma_f32_16x16x32_bf16 v[216:219], v[60:63], v[112:115], v[216:219]
buffer_load_dwordx4 v174, s[80:83], s88 offen offset:2048 lds
s_waitcnt lgkmcnt(14)
v_mfma_f32_16x16x32_bf16 v[220:223], v[56:59], v[116:119], v[220:223]
v_mfma_f32_16x16x32_bf16 v[224:227], v[60:63], v[116:119], v[224:227]
buffer_load_dwordx4 v175, s[80:83], s88 offen offset:3072 lds
s_waitcnt lgkmcnt(10)
v_mfma_f32_16x16x32_bf16 v[180:183], v[120:123], v[64:67], v[180:183]
v_mfma_f32_16x16x32_bf16 v[184:187], v[120:123], v[68:71], v[184:187]
s_add_u32 s64, s71, 3072
buffer_store_dwordx4 a[12:15], v1, s[12:15], s64 offen sc1
s_waitcnt lgkmcnt(8)
v_mfma_f32_16x16x32_bf16 v[188:191], v[124:127], v[64:67], v[188:191]
v_mfma_f32_16x16x32_bf16 v[192:195], v[124:127], v[68:71], v[192:195]
s_waitcnt lgkmcnt(6)
v_mfma_f32_16x16x32_bf16 v[196:199], v[128:131], v[64:67], v[196:199]
v_mfma_f32_16x16x32_bf16 v[200:203], v[128:131], v[68:71], v[200:203]
s_waitcnt lgkmcnt(4)
v_mfma_f32_16x16x32_bf16 v[204:207], v[132:135], v[64:67], v[204:207]
v_mfma_f32_16x16x32_bf16 v[208:211], v[132:135], v[68:71], v[208:211]
s_waitcnt lgkmcnt(2)
v_mfma_f32_16x16x32_bf16 v[212:215], v[64:67], v[136:139], v[212:215]
v_mfma_f32_16x16x32_bf16 v[216:219], v[68:71], v[136:139], v[216:219]
s_waitcnt lgkmcnt(0)
v_mfma_f32_16x16x32_bf16 v[220:223], v[64:67], v[140:143], v[220:223]
v_mfma_f32_16x16x32_bf16 v[224:227], v[68:71], v[140:143], v[224:227]
v_add_u32 v176, 4294868992, v176
v_add_u32 v177, 4294868992, v177
v_add_u32 v4, 4294868992, v4
v_add_u32 v5, 4294868992, v5
v_add_u32 v6, 4294868992, v6
v_add_u32 v7, 4294868992, v7
v_add_u32 v8, 4294868992, v8
v_add_u32 v9, 4294868992, v9
s_waitcnt vmcnt(19)
s_barrier
ds_read_b128 v[56:59], v176 offset:0
ds_read_b128 v[60:63], v176 offset:2048
ds_read_b64_tr_b16 v[96:97], v4 offset:16384
ds_read_b64_tr_b16 v[98:99], v4 offset:17408
ds_read_b64_tr_b16 v[100:101], v5 offset:16384
ds_read_b64_tr_b16 v[102:103], v5 offset:17408
ds_read_b64_tr_b16 v[104:105], v6 offset:16384
ds_read_b64_tr_b16 v[106:107], v6 offset:17408
ds_read_b64_tr_b16 v[108:109], v7 offset:16384
ds_read_b64_tr_b16 v[110:111], v7 offset:17408
ds_read_b64_tr_b16 v[112:113], v8 offset:16384
ds_read_b64_tr_b16 v[114:115], v8 offset:17408
ds_read_b64_tr_b16 v[116:117], v9 offset:16384
ds_read_b64_tr_b16 v[118:119], v9 offset:17408
ds_read_b128 v[64:67], v177 offset:0
ds_read_b128 v[68:71], v177 offset:2048
ds_read_b64_tr_b16 v[120:121], v4 offset:24576
ds_read_b64_tr_b16 v[122:123], v4 offset:25600
ds_read_b64_tr_b16 v[124:125], v5 offset:24576
ds_read_b64_tr_b16 v[126:127], v5 offset:25600
ds_read_b64_tr_b16 v[128:129], v6 offset:24576
ds_read_b64_tr_b16 v[130:131], v6 offset:25600
ds_read_b64_tr_b16 v[132:133], v7 offset:24576
ds_read_b64_tr_b16 v[134:135], v7 offset:25600
ds_read_b64_tr_b16 v[136:137], v8 offset:24576
ds_read_b64_tr_b16 v[138:139], v8 offset:25600
ds_read_b64_tr_b16 v[140:141], v9 offset:24576
ds_read_b64_tr_b16 v[142:143], v9 offset:25600
s_add_u32 m0, s67, 98304
s_mov_b32 s69, 0
buffer_load_dwordx4 v20, s[76:79], s69 offen offset:0 lds
buffer_load_dwordx4 v21, s[76:79], s69 offen offset:1024 lds
s_waitcnt lgkmcnt(15)
v_mfma_f32_16x16x32_bf16 v[180:183], v[96:99], v[56:59], v[180:183]
v_mfma_f32_16x16x32_bf16 v[184:187], v[96:99], v[60:63], v[184:187]
buffer_load_dwordx4 v22, s[76:79], s69 offen offset:2048 lds
v_mfma_f32_16x16x32_bf16 v[188:191], v[100:103], v[56:59], v[188:191]
v_mfma_f32_16x16x32_bf16 v[192:195], v[100:103], v[60:63], v[192:195]
buffer_load_dwordx4 v23, s[76:79], s69 offen offset:3072 lds
v_mfma_f32_16x16x32_bf16 v[196:199], v[104:107], v[56:59], v[196:199]
v_mfma_f32_16x16x32_bf16 v[200:203], v[104:107], v[60:63], v[200:203]
s_add_u32 m0, s67, 102400
s_mov_b32 s69, 0
buffer_load_dwordx4 v24, s[76:79], s69 offen offset:0 lds
v_mfma_f32_16x16x32_bf16 v[204:207], v[108:111], v[56:59], v[204:207]
v_mfma_f32_16x16x32_bf16 v[208:211], v[108:111], v[60:63], v[208:211]
buffer_load_dwordx4 v25, s[76:79], s69 offen offset:1024 lds
v_mfma_f32_16x16x32_bf16 v[212:215], v[56:59], v[112:115], v[212:215]
v_mfma_f32_16x16x32_bf16 v[216:219], v[60:63], v[112:115], v[216:219]
buffer_load_dwordx4 v26, s[76:79], s69 offen offset:2048 lds
s_waitcnt lgkmcnt(14)
v_mfma_f32_16x16x32_bf16 v[220:223], v[56:59], v[116:119], v[220:223]
v_mfma_f32_16x16x32_bf16 v[224:227], v[60:63], v[116:119], v[224:227]
buffer_load_dwordx4 v27, s[76:79], s69 offen offset:3072 lds
s_waitcnt lgkmcnt(10)
v_mfma_f32_16x16x32_bf16 v[180:183], v[120:123], v[64:67], v[180:183]
v_mfma_f32_16x16x32_bf16 v[184:187], v[120:123], v[68:71], v[184:187]
s_mul_i32 s64, s60, -4096
s_add_u32 s64, s64, 8192
s_add_u32 s64, s64, s71
buffer_store_dwordx4 a[16:19], v1, s[12:15], s64 offen sc1
s_waitcnt lgkmcnt(8)
v_mfma_f32_16x16x32_bf16 v[188:191], v[124:127], v[64:67], v[188:191]
v_mfma_f32_16x16x32_bf16 v[192:195], v[124:127], v[68:71], v[192:195]
s_waitcnt lgkmcnt(6)
v_mfma_f32_16x16x32_bf16 v[196:199], v[128:131], v[64:67], v[196:199]
v_mfma_f32_16x16x32_bf16 v[200:203], v[128:131], v[68:71], v[200:203]
s_waitcnt lgkmcnt(4)
v_mfma_f32_16x16x32_bf16 v[204:207], v[132:135], v[64:67], v[204:207]
v_mfma_f32_16x16x32_bf16 v[208:211], v[132:135], v[68:71], v[208:211]
s_waitcnt lgkmcnt(2)
v_mfma_f32_16x16x32_bf16 v[212:215], v[64:67], v[136:139], v[212:215]
v_mfma_f32_16x16x32_bf16 v[216:219], v[68:71], v[136:139], v[216:219]
s_waitcnt lgkmcnt(0)
v_mfma_f32_16x16x32_bf16 v[220:223], v[64:67], v[140:143], v[220:223]
v_mfma_f32_16x16x32_bf16 v[224:227], v[68:71], v[140:143], v[224:227]
v_add_u32 v176, 32768, v176
v_add_u32 v177, 32768, v177
v_add_u32 v4, 32768, v4
v_add_u32 v5, 32768, v5
v_add_u32 v6, 32768, v6
v_add_u32 v7, 32768, v7
v_add_u32 v8, 32768, v8
v_add_u32 v9, 32768, v9
s_waitcnt vmcnt(19)
s_barrier
ds_read_b128 v[56:59], v176 offset:0
ds_read_b128 v[60:63], v176 offset:2048
ds_read_b64_tr_b16 v[96:97], v4 offset:16384
ds_read_b64_tr_b16 v[98:99], v4 offset:17408
ds_read_b64_tr_b16 v[100:101], v5 offset:16384
ds_read_b64_tr_b16 v[102:103], v5 offset:17408
ds_read_b64_tr_b16 v[104:105], v6 offset:16384
ds_read_b64_tr_b16 v[106:107], v6 offset:17408
ds_read_b64_tr_b16 v[108:109], v7 offset:16384
ds_read_b64_tr_b16 v[110:111], v7 offset:17408
ds_read_b64_tr_b16 v[112:113], v8 offset:16384
ds_read_b64_tr_b16 v[114:115], v8 offset:17408
ds_read_b64_tr_b16 v[116:117], v9 offset:16384
ds_read_b64_tr_b16 v[118:119], v9 offset:17408
ds_read_b128 v[64:67], v177 offset:0
ds_read_b128 v[68:71], v177 offset:2048
ds_read_b64_tr_b16 v[120:121], v4 offset:24576
ds_read_b64_tr_b16 v[122:123], v4 offset:25600
ds_read_b64_tr_b16 v[124:125], v5 offset:24576
ds_read_b64_tr_b16 v[126:127], v5 offset:25600
ds_read_b64_tr_b16 v[128:129], v6 offset:24576
ds_read_b64_tr_b16 v[130:131], v6 offset:25600
ds_read_b64_tr_b16 v[132:133], v7 offset:24576
ds_read_b64_tr_b16 v[134:135], v7 offset:25600
ds_read_b64_tr_b16 v[136:137], v8 offset:24576
ds_read_b64_tr_b16 v[138:139], v8 offset:25600
ds_read_b64_tr_b16 v[140:141], v9 offset:24576
ds_read_b64_tr_b16 v[142:143], v9 offset:25600
s_add_u32 m0, s67, 0
s_mov_b32 s69, 524288
buffer_load_dwordx4 v20, s[76:79], s69 offen offset:0 lds
buffer_load_dwordx4 v21, s[76:79], s69 offen offset:1024 lds
s_waitcnt lgkmcnt(15)
v_mfma_f32_16x16x32_bf16 v[180:183], v[96:99], v[56:59], v[180:183]
v_mfma_f32_16x16x32_bf16 v[184:187], v[96:99], v[60:63], v[184:187]
buffer_load_dwordx4 v22, s[76:79], s69 offen offset:2048 lds
v_mfma_f32_16x16x32_bf16 v[188:191], v[100:103], v[56:59], v[188:191]
v_mfma_f32_16x16x32_bf16 v[192:195], v[100:103], v[60:63], v[192:195]
buffer_load_dwordx4 v23, s[76:79], s69 offen offset:3072 lds
v_mfma_f32_16x16x32_bf16 v[196:199], v[104:107], v[56:59], v[196:199]
v_mfma_f32_16x16x32_bf16 v[200:203], v[104:107], v[60:63], v[200:203]
s_add_u32 m0, s67, 4096
s_mov_b32 s69, 524288
buffer_load_dwordx4 v24, s[76:79], s69 offen offset:0 lds
v_mfma_f32_16x16x32_bf16 v[204:207], v[108:111], v[56:59], v[204:207]
v_mfma_f32_16x16x32_bf16 v[208:211], v[108:111], v[60:63], v[208:211]
buffer_load_dwordx4 v25, s[76:79], s69 offen offset:1024 lds
v_mfma_f32_16x16x32_bf16 v[212:215], v[56:59], v[112:115], v[212:215]
v_mfma_f32_16x16x32_bf16 v[216:219], v[60:63], v[112:115], v[216:219]
buffer_load_dwordx4 v26, s[76:79], s69 offen offset:2048 lds
s_waitcnt lgkmcnt(14)
v_mfma_f32_16x16x32_bf16 v[220:223], v[56:59], v[116:119], v[220:223]
v_mfma_f32_16x16x32_bf16 v[224:227], v[60:63], v[116:119], v[224:227]
buffer_load_dwordx4 v27, s[76:79], s69 offen offset:3072 lds
s_waitcnt lgkmcnt(10)
v_mfma_f32_16x16x32_bf16 v[180:183], v[120:123], v[64:67], v[180:183]
v_mfma_f32_16x16x32_bf16 v[184:187], v[120:123], v[68:71], v[184:187]
s_mul_i32 s64, s60, -4096
s_add_u32 s64, s64, 9216
s_add_u32 s64, s64, s71
buffer_store_dwordx4 a[20:23], v1, s[12:15], s64 offen sc1
s_waitcnt lgkmcnt(8)
v_mfma_f32_16x16x32_bf16 v[188:191], v[124:127], v[64:67], v[188:191]
v_mfma_f32_16x16x32_bf16 v[192:195], v[124:127], v[68:71], v[192:195]
s_waitcnt lgkmcnt(6)
v_mfma_f32_16x16x32_bf16 v[196:199], v[128:131], v[64:67], v[196:199]
v_mfma_f32_16x16x32_bf16 v[200:203], v[128:131], v[68:71], v[200:203]
s_waitcnt lgkmcnt(4)
v_mfma_f32_16x16x32_bf16 v[204:207], v[132:135], v[64:67], v[204:207]
v_mfma_f32_16x16x32_bf16 v[208:211], v[132:135], v[68:71], v[208:211]
s_waitcnt lgkmcnt(2)
v_mfma_f32_16x16x32_bf16 v[212:215], v[64:67], v[136:139], v[212:215]
v_mfma_f32_16x16x32_bf16 v[216:219], v[68:71], v[136:139], v[216:219]
s_waitcnt lgkmcnt(0)
v_mfma_f32_16x16x32_bf16 v[220:223], v[64:67], v[140:143], v[220:223]
v_mfma_f32_16x16x32_bf16 v[224:227], v[68:71], v[140:143], v[224:227]
v_add_u32 v176, 32768, v176
v_add_u32 v177, 32768, v177
v_add_u32 v4, 32768, v4
v_add_u32 v5, 32768, v5
v_add_u32 v6, 32768, v6
v_add_u32 v7, 32768, v7
v_add_u32 v8, 32768, v8
v_add_u32 v9, 32768, v9
s_waitcnt vmcnt(19)
s_barrier
ds_read_b128 v[56:59], v176 offset:0
ds_read_b128 v[60:63], v176 offset:2048
ds_read_b64_tr_b16 v[96:97], v4 offset:16384
ds_read_b64_tr_b16 v[98:99], v4 offset:17408
ds_read_b64_tr_b16 v[100:101], v5 offset:16384
ds_read_b64_tr_b16 v[102:103], v5 offset:17408
ds_read_b64_tr_b16 v[104:105], v6 offset:16384
ds_read_b64_tr_b16 v[106:107], v6 offset:17408
ds_read_b64_tr_b16 v[108:109], v7 offset:16384
ds_read_b64_tr_b16 v[110:111], v7 offset:17408
ds_read_b64_tr_b16 v[112:113], v8 offset:16384
ds_read_b64_tr_b16 v[114:115], v8 offset:17408
ds_read_b64_tr_b16 v[116:117], v9 offset:16384
ds_read_b64_tr_b16 v[118:119], v9 offset:17408
ds_read_b128 v[64:67], v177 offset:0
ds_read_b128 v[68:71], v177 offset:2048
ds_read_b64_tr_b16 v[120:121], v4 offset:24576
ds_read_b64_tr_b16 v[122:123], v4 offset:25600
ds_read_b64_tr_b16 v[124:125], v5 offset:24576
ds_read_b64_tr_b16 v[126:127], v5 offset:25600
ds_read_b64_tr_b16 v[128:129], v6 offset:24576
ds_read_b64_tr_b16 v[130:131], v6 offset:25600
ds_read_b64_tr_b16 v[132:133], v7 offset:24576
ds_read_b64_tr_b16 v[134:135], v7 offset:25600
ds_read_b64_tr_b16 v[136:137], v8 offset:24576
ds_read_b64_tr_b16 v[138:139], v8 offset:25600
ds_read_b64_tr_b16 v[140:141], v9 offset:24576
ds_read_b64_tr_b16 v[142:143], v9 offset:25600
s_add_u32 m0, s67, 32768
s_mov_b32 s69, 1048576
buffer_load_dwordx4 v20, s[76:79], s69 offen offset:0 lds
buffer_load_dwordx4 v21, s[76:79], s69 offen offset:1024 lds
s_waitcnt lgkmcnt(15)
v_mfma_f32_16x16x32_bf16 v[180:183], v[96:99], v[56:59], v[180:183]
v_mfma_f32_16x16x32_bf16 v[184:187], v[96:99], v[60:63], v[184:187]
buffer_load_dwordx4 v22, s[76:79], s69 offen offset:2048 lds
v_mfma_f32_16x16x32_bf16 v[188:191], v[100:103], v[56:59], v[188:191]
v_mfma_f32_16x16x32_bf16 v[192:195], v[100:103], v[60:63], v[192:195]
buffer_load_dwordx4 v23, s[76:79], s69 offen offset:3072 lds
v_mfma_f32_16x16x32_bf16 v[196:199], v[104:107], v[56:59], v[196:199]
v_mfma_f32_16x16x32_bf16 v[200:203], v[104:107], v[60:63], v[200:203]
s_add_u32 m0, s67, 36864
s_mov_b32 s69, 1048576
buffer_load_dwordx4 v24, s[76:79], s69 offen offset:0 lds
v_mfma_f32_16x16x32_bf16 v[204:207], v[108:111], v[56:59], v[204:207]
v_mfma_f32_16x16x32_bf16 v[208:211], v[108:111], v[60:63], v[208:211]
buffer_load_dwordx4 v25, s[76:79], s69 offen offset:1024 lds
v_mfma_f32_16x16x32_bf16 v[212:215], v[56:59], v[112:115], v[212:215]
v_mfma_f32_16x16x32_bf16 v[216:219], v[60:63], v[112:115], v[216:219]
buffer_load_dwordx4 v26, s[76:79], s69 offen offset:2048 lds
s_waitcnt lgkmcnt(14)
v_mfma_f32_16x16x32_bf16 v[220:223], v[56:59], v[116:119], v[220:223]
v_mfma_f32_16x16x32_bf16 v[224:227], v[60:63], v[116:119], v[224:227]
buffer_load_dwordx4 v27, s[76:79], s69 offen offset:3072 lds
s_waitcnt lgkmcnt(10)
v_mfma_f32_16x16x32_bf16 v[180:183], v[120:123], v[64:67], v[180:183]
v_mfma_f32_16x16x32_bf16 v[184:187], v[120:123], v[68:71], v[184:187]
s_mul_i32 s64, s60, -4096
s_add_u32 s64, s64, 10240
s_add_u32 s64, s64, s71
buffer_store_dwordx4 a[24:27], v1, s[12:15], s64 offen sc1
s_waitcnt lgkmcnt(8)
v_mfma_f32_16x16x32_bf16 v[188:191], v[124:127], v[64:67], v[188:191]
v_mfma_f32_16x16x32_bf16 v[192:195], v[124:127], v[68:71], v[192:195]
s_waitcnt lgkmcnt(6)
v_mfma_f32_16x16x32_bf16 v[196:199], v[128:131], v[64:67], v[196:199]
v_mfma_f32_16x16x32_bf16 v[200:203], v[128:131], v[68:71], v[200:203]
s_waitcnt lgkmcnt(4)
v_mfma_f32_16x16x32_bf16 v[204:207], v[132:135], v[64:67], v[204:207]
v_mfma_f32_16x16x32_bf16 v[208:211], v[132:135], v[68:71], v[208:211]
s_waitcnt lgkmcnt(2)
v_mfma_f32_16x16x32_bf16 v[212:215], v[64:67], v[136:139], v[212:215]
v_mfma_f32_16x16x32_bf16 v[216:219], v[68:71], v[136:139], v[216:219]
s_waitcnt lgkmcnt(0)
v_mfma_f32_16x16x32_bf16 v[220:223], v[64:67], v[140:143], v[220:223]
v_mfma_f32_16x16x32_bf16 v[224:227], v[68:71], v[140:143], v[224:227]
s_nop 7
v_cmp_gt_u32 vcc, 768, v1
s_mov_b32 s61, 0x3e8b97f6
v_mov_b32 v28, s61
v_cndmask_b32 v29, 0, v28, vcc
v_mul_f32 v100, v180, v28
v_mul_f32 v101, v181, v28
v_mul_f32 v102, v182, v28
v_mul_f32 v103, v183, v28
v_mul_f32 v104, v188, v29
v_mul_f32 v105, v189, v29
v_mul_f32 v106, v190, v29
v_mul_f32 v107, v191, v29
v_cvt_pk_bf16_f32 v244, v100, v101
v_cvt_pk_bf16_f32 v245, v102, v103
v_cvt_pk_bf16_f32 v246, v104, v105
v_cvt_pk_bf16_f32 v247, v106, v107
v_mul_f32 v100, v184, v28
v_mul_f32 v101, v185, v28
v_mul_f32 v102, v186, v28
v_mul_f32 v103, v187, v28
v_mul_f32 v104, v192, v29
v_mul_f32 v105, v193, v29
v_mul_f32 v106, v194, v29
v_mul_f32 v107, v195, v29
v_cvt_pk_bf16_f32 v248, v100, v101
v_cvt_pk_bf16_f32 v249, v102, v103
v_cvt_pk_bf16_f32 v250, v104, v105
v_cvt_pk_bf16_f32 v251, v106, v107
s_lshl_b32 s61, s24, 17
s_lshl_b32 s62, s25, 2
s_add_u32 s62, s62, s16
s_lshl_b32 s62, s62, 11
s_add_u32 s61, s61, s62
s_add_u32 s62, s61, 69206016
s_add_u32 s63, s61, 71303168
v_cvt_pk_bf16_f32 v108, v196, v197
v_cvt_pk_bf16_f32 v109, v198, v199
v_cvt_pk_bf16_f32 v110, v204, v205
v_cvt_pk_bf16_f32 v111, v206, v207
buffer_store_dwordx4 v[108:111], v1, s[12:15], s62 offen offset:0 sc1
v_cvt_pk_bf16_f32 v112, v200, v201
v_cvt_pk_bf16_f32 v113, v202, v203
v_cvt_pk_bf16_f32 v114, v208, v209
v_cvt_pk_bf16_f32 v115, v210, v211
buffer_store_dwordx4 v[112:115], v1, s[12:15], s62 offen offset:1024 sc1
v_cvt_pk_bf16_f32 v116, v212, v213
v_cvt_pk_bf16_f32 v117, v214, v215
v_cvt_pk_bf16_f32 v118, v216, v217
v_cvt_pk_bf16_f32 v119, v218, v219
buffer_store_dwordx4 v[116:119], v1, s[12:15], s63 offen offset:0 sc1
v_cvt_pk_bf16_f32 v120, v220, v221
v_cvt_pk_bf16_f32 v121, v222, v223
v_cvt_pk_bf16_f32 v122, v224, v225
v_cvt_pk_bf16_f32 v123, v226, v227
buffer_store_dwordx4 v[120:123], v1, s[12:15], s63 offen offset:1024 sc1
s_barrier
s_add_u32 m0, s67, 65536
s_mov_b32 s69, 1572864
buffer_load_dwordx4 v20, s[76:79], s69 offen offset:0 lds
buffer_load_dwordx4 v21, s[76:79], s69 offen offset:1024 lds
buffer_load_dwordx4 v22, s[76:79], s69 offen offset:2048 lds
buffer_load_dwordx4 v23, s[76:79], s69 offen offset:3072 lds
s_add_u32 m0, s67, 69632
s_mov_b32 s69, 1572864
buffer_load_dwordx4 v24, s[76:79], s69 offen offset:0 lds
buffer_load_dwordx4 v25, s[76:79], s69 offen offset:1024 lds
buffer_load_dwordx4 v26, s[76:79], s69 offen offset:2048 lds
buffer_load_dwordx4 v27, s[76:79], s69 offen offset:3072 lds
v_and_b32 v28, 63, v0
v_and_b32 v29, 15, v28
v_lshrrev_b32 v30, 4, v28
v_bfe_u32 v31, v28, 2, 2
v_and_b32 v32, 3, v28
v_lshl_add_u32 v33, v30, 3, v31
v_lshlrev_b32 v33, 9, v33
v_lshl_add_u32 v33, v32, 3, v33
v_and_b32 v34, 1, v30
v_lshl_add_u32 v34, v34, 2, v31
v_xor_b32 v35, 0, v34
v_lshl_add_u32 v4, v35, 5, v33
v_add_u32 v48, 0x10000, v4
v_xor_b32 v35, 1, v34
v_lshl_add_u32 v5, v35, 5, v33
v_add_u32 v49, 0x10000, v5
v_xor_b32 v35, 2, v34
v_lshl_add_u32 v6, v35, 5, v33
v_add_u32 v50, 0x10000, v6
v_xor_b32 v35, 3, v34
v_lshl_add_u32 v7, v35, 5, v33
v_add_u32 v51, 0x10000, v7
v_xor_b32 v35, 4, v34
v_lshl_add_u32 v8, v35, 5, v33
v_add_u32 v52, 0x10000, v8
v_xor_b32 v35, 5, v34
v_lshl_add_u32 v9, v35, 5, v33
v_add_u32 v53, 0x10000, v9
v_xor_b32 v35, 6, v34
v_lshl_add_u32 v10, v35, 5, v33
v_add_u32 v54, 0x10000, v10
v_xor_b32 v35, 7, v34
v_lshl_add_u32 v11, v35, 5, v33
v_add_u32 v55, 0x10000, v11
v_add_u32 v176, 65536, v176
v_add_u32 v177, 65536, v177
s_waitcnt vmcnt(31)
s_barrier
ds_read_b128 v[56:59], v176 offset:0
ds_read_b128 v[60:63], v176 offset:2048
ds_read_b128 v[64:67], v177 offset:0
ds_read_b128 v[68:71], v177 offset:2048
ds_read_b64_tr_b16 v[96:97], v48 offset:32768
ds_read_b64_tr_b16 v[98:99], v48 offset:34816
ds_read_b64_tr_b16 v[100:101], v49 offset:32768
ds_read_b64_tr_b16 v[102:103], v49 offset:34816
ds_read_b64_tr_b16 v[104:105], v50 offset:32768
ds_read_b64_tr_b16 v[106:107], v50 offset:34816
ds_read_b64_tr_b16 v[108:109], v51 offset:32768
ds_read_b64_tr_b16 v[110:111], v51 offset:34816
ds_read_b64_tr_b16 v[112:113], v52 offset:32768
ds_read_b64_tr_b16 v[114:115], v52 offset:34816
ds_read_b64_tr_b16 v[116:117], v53 offset:32768
ds_read_b64_tr_b16 v[118:119], v53 offset:34816
ds_read_b64_tr_b16 v[120:121], v54 offset:32768
ds_read_b64_tr_b16 v[122:123], v54 offset:34816
ds_read_b64_tr_b16 v[124:125], v55 offset:32768
ds_read_b64_tr_b16 v[126:127], v55 offset:34816
ds_read_b64_tr_b16 v[128:129], v48 offset:33024
ds_read_b64_tr_b16 v[130:131], v48 offset:35072
ds_read_b64_tr_b16 v[132:133], v49 offset:33024
ds_read_b64_tr_b16 v[134:135], v49 offset:35072
s_waitcnt lgkmcnt(15)
v_mfma_f32_16x16x32_bf16 a[128:131], v[96:99], v[56:59], 0
ds_read_b64_tr_b16 v[136:137], v50 offset:33024
v_mfma_f32_16x16x32_bf16 a[136:139], v[96:99], v[60:63], 0
ds_read_b64_tr_b16 v[138:139], v50 offset:35072
v_mfma_f32_16x16x32_bf16 a[132:135], v[100:103], v[56:59], 0
ds_read_b64_tr_b16 v[140:141], v51 offset:33024
v_mfma_f32_16x16x32_bf16 a[140:143], v[100:103], v[60:63], 0
ds_read_b64_tr_b16 v[142:143], v51 offset:35072
s_waitcnt lgkmcnt(15)
v_mfma_f32_16x16x32_bf16 a[144:147], v[104:107], v[56:59], 0
ds_read_b64_tr_b16 v[144:145], v52 offset:33024
s_add_u32 m0, s84, 131072
s_mov_b32 s88, 256
buffer_load_dwordx4 v164, s[72:75], s88 offen offset:0 lds
v_mfma_f32_16x16x32_bf16 a[152:155], v[104:107], v[60:63], 0
ds_read_b64_tr_b16 v[146:147], v52 offset:35072
v_mfma_f32_16x16x32_bf16 a[148:151], v[108:111], v[56:59], 0
ds_read_b64_tr_b16 v[148:149], v53 offset:33024
v_mfma_f32_16x16x32_bf16 a[156:159], v[108:111], v[60:63], 0
ds_read_b64_tr_b16 v[150:151], v53 offset:35072
s_waitcnt lgkmcnt(15)
v_mfma_f32_16x16x32_bf16 a[160:163], v[112:115], v[56:59], 0
ds_read_b64_tr_b16 v[152:153], v54 offset:33024
buffer_load_dwordx4 v165, s[72:75], s88 offen offset:1024 lds
v_mfma_f32_16x16x32_bf16 a[168:171], v[112:115], v[60:63], 0
ds_read_b64_tr_b16 v[154:155], v54 offset:35072
v_mfma_f32_16x16x32_bf16 a[164:167], v[116:119], v[56:59], 0
ds_read_b64_tr_b16 v[156:157], v55 offset:33024
v_mfma_f32_16x16x32_bf16 a[172:175], v[116:119], v[60:63], 0
ds_read_b64_tr_b16 v[158:159], v55 offset:35072
s_waitcnt lgkmcnt(15)
v_mfma_f32_16x16x32_bf16 a[176:179], v[120:123], v[56:59], 0
ds_read_b64_tr_b16 v[96:97], v48 offset:49152
buffer_load_dwordx4 v166, s[72:75], s88 offen offset:2048 lds
v_mfma_f32_16x16x32_bf16 a[184:187], v[120:123], v[60:63], 0
ds_read_b64_tr_b16 v[98:99], v48 offset:51200
v_mfma_f32_16x16x32_bf16 a[180:183], v[124:127], v[56:59], 0
ds_read_b64_tr_b16 v[100:101], v49 offset:49152
v_mfma_f32_16x16x32_bf16 a[188:191], v[124:127], v[60:63], 0
ds_read_b64_tr_b16 v[102:103], v49 offset:51200
s_waitcnt lgkmcnt(15)
v_mfma_f32_16x16x32_bf16 a[192:195], v[128:131], v[56:59], 0
ds_read_b64_tr_b16 v[104:105], v50 offset:49152
buffer_load_dwordx4 v167, s[72:75], s88 offen offset:3072 lds
v_mfma_f32_16x16x32_bf16 a[200:203], v[128:131], v[60:63], 0
ds_read_b64_tr_b16 v[106:107], v50 offset:51200
v_mfma_f32_16x16x32_bf16 a[196:199], v[132:135], v[56:59], 0
ds_read_b64_tr_b16 v[108:109], v51 offset:49152
v_mfma_f32_16x16x32_bf16 a[204:207], v[132:135], v[60:63], 0
ds_read_b64_tr_b16 v[110:111], v51 offset:51200
s_waitcnt lgkmcnt(15)
v_mfma_f32_16x16x32_bf16 a[208:211], v[136:139], v[56:59], 0
ds_read_b64_tr_b16 v[112:113], v52 offset:49152
s_mul_i32 s64, s60, -4096
s_add_u32 s64, s64, 11264
s_add_u32 s64, s64, s71
buffer_store_dwordx4 a[28:31], v1, s[12:15], s64 offen sc1
v_mfma_f32_16x16x32_bf16 a[216:219], v[136:139], v[60:63], 0
ds_read_b64_tr_b16 v[114:115], v52 offset:51200
v_mfma_f32_16x16x32_bf16 a[212:215], v[140:143], v[56:59], 0
ds_read_b64_tr_b16 v[116:117], v53 offset:49152
v_mfma_f32_16x16x32_bf16 a[220:223], v[140:143], v[60:63], 0
ds_read_b64_tr_b16 v[118:119], v53 offset:51200
s_waitcnt lgkmcnt(15)
v_mfma_f32_16x16x32_bf16 a[224:227], v[144:147], v[56:59], 0
ds_read_b64_tr_b16 v[120:121], v54 offset:49152
s_add_u32 s64, s71, 16384
buffer_store_dwordx4 a[32:35], v1, s[12:15], s64 offen sc1
v_mfma_f32_16x16x32_bf16 a[232:235], v[144:147], v[60:63], 0
ds_read_b64_tr_b16 v[122:123], v54 offset:51200
v_mfma_f32_16x16x32_bf16 a[228:231], v[148:151], v[56:59], 0
ds_read_b64_tr_b16 v[124:125], v55 offset:49152
v_mfma_f32_16x16x32_bf16 a[236:239], v[148:151], v[60:63], 0
ds_read_b64_tr_b16 v[126:127], v55 offset:51200
s_waitcnt lgkmcnt(15)
v_mfma_f32_16x16x32_bf16 a[240:243], v[152:155], v[56:59], 0
ds_read_b64_tr_b16 v[128:129], v48 offset:49408
s_add_u32 s64, s71, 17408
buffer_store_dwordx4 a[36:39], v1, s[12:15], s64 offen sc1
v_mfma_f32_16x16x32_bf16 a[248:251], v[152:155], v[60:63], 0
ds_read_b64_tr_b16 v[130:131], v48 offset:51456
v_mfma_f32_16x16x32_bf16 a[244:247], v[156:159], v[56:59], 0
ds_read_b64_tr_b16 v[132:133], v49 offset:49408
v_mfma_f32_16x16x32_bf16 a[252:255], v[156:159], v[60:63], 0
ds_read_b64_tr_b16 v[134:135], v49 offset:51456
s_waitcnt lgkmcnt(15)
v_mfma_f32_16x16x32_bf16 a[128:131], v[96:99], v[64:67], a[128:131]
ds_read_b64_tr_b16 v[136:137], v50 offset:49408
s_add_u32 s64, s71, 18432
buffer_store_dwordx4 a[40:43], v1, s[12:15], s64 offen sc1
v_mfma_f32_16x16x32_bf16 a[136:139], v[96:99], v[68:71], a[136:139]
ds_read_b64_tr_b16 v[138:139], v50 offset:51456
v_mfma_f32_16x16x32_bf16 a[132:135], v[100:103], v[64:67], a[132:135]
ds_read_b64_tr_b16 v[140:141], v51 offset:49408
v_mfma_f32_16x16x32_bf16 a[140:143], v[100:103], v[68:71], a[140:143]
ds_read_b64_tr_b16 v[142:143], v51 offset:51456
s_waitcnt lgkmcnt(15)
v_mfma_f32_16x16x32_bf16 a[144:147], v[104:107], v[64:67], a[144:147]
ds_read_b64_tr_b16 v[144:145], v52 offset:49408
v_mfma_f32_16x16x32_bf16 a[152:155], v[104:107], v[68:71], a[152:155]
ds_read_b64_tr_b16 v[146:147], v52 offset:51456
v_mfma_f32_16x16x32_bf16 a[148:151], v[108:111], v[64:67], a[148:151]
ds_read_b64_tr_b16 v[148:149], v53 offset:49408
v_mfma_f32_16x16x32_bf16 a[156:159], v[108:111], v[68:71], a[156:159]
ds_read_b64_tr_b16 v[150:151], v53 offset:51456
s_waitcnt lgkmcnt(15)
v_mfma_f32_16x16x32_bf16 a[160:163], v[112:115], v[64:67], a[160:163]
ds_read_b64_tr_b16 v[152:153], v54 offset:49408
v_mfma_f32_16x16x32_bf16 a[168:171], v[112:115], v[68:71], a[168:171]
ds_read_b64_tr_b16 v[154:155], v54 offset:51456
v_mfma_f32_16x16x32_bf16 a[164:167], v[116:119], v[64:67], a[164:167]
ds_read_b64_tr_b16 v[156:157], v55 offset:49408
v_mfma_f32_16x16x32_bf16 a[172:175], v[116:119], v[68:71], a[172:175]
ds_read_b64_tr_b16 v[158:159], v55 offset:51456
s_waitcnt lgkmcnt(15)
v_mfma_f32_16x16x32_bf16 a[176:179], v[120:123], v[64:67], a[176:179]
v_mfma_f32_16x16x32_bf16 a[184:187], v[120:123], v[68:71], a[184:187]
v_mfma_f32_16x16x32_bf16 a[180:183], v[124:127], v[64:67], a[180:183]
v_mfma_f32_16x16x32_bf16 a[188:191], v[124:127], v[68:71], a[188:191]
s_waitcnt lgkmcnt(14)
v_mfma_f32_16x16x32_bf16 a[192:195], v[128:131], v[64:67], a[192:195]
v_mfma_f32_16x16x32_bf16 a[200:203], v[128:131], v[68:71], a[200:203]
s_waitcnt vmcnt(16)
s_waitcnt vmcnt(30) lgkmcnt(0)
s_barrier
s_lshl_b32 s61, s24, 4
s_add_u32 s61, s61, s25
s_lshl_b32 s61, s61, 7
s_add_u32 s61, s61, 104890368
s_cmp_lg_u32 s16, 0
s_cbranch_scc1 L_f_sig2
v_mov_b32 v28, 0
v_mov_b32 v29, s3
s_mov_b64 exec, 1
buffer_store_dword v29, v28, s[12:15], s61 offen sc1
s_mov_b64 exec, -1
L_f_sig2:
s_lshl_b32 s61, s2, 7
s_add_u32 s61, s61, 105054208
s_cmp_lg_u32 s16, 0
s_cbranch_scc1 L_f_sig3
v_mov_b32 v28, 0
v_mov_b32 v29, s3
s_mov_b64 exec, 1
buffer_store_dword v29, v28, s[12:15], s61 offen sc1
s_mov_b64 exec, -1
L_f_sig3:
ds_read_b128 v[72:75], v176 offset:16384
ds_read_b128 v[76:79], v176 offset:18432
ds_read_b128 v[80:83], v177 offset:16384
ds_read_b128 v[84:87], v177 offset:18432
v_mfma_f32_16x16x32_bf16 a[196:199], v[132:135], v[64:67], a[196:199]
ds_read_b64_tr_b16 v[96:97], v4 offset:0
ds_read_b64_tr_b16 v[98:99], v4 offset:2048
v_mfma_f32_16x16x32_bf16 a[204:207], v[132:135], v[68:71], a[204:207]
ds_read_b64_tr_b16 v[100:101], v5 offset:0
ds_read_b64_tr_b16 v[102:103], v5 offset:2048
v_mfma_f32_16x16x32_bf16 a[208:211], v[136:139], v[64:67], a[208:211]
ds_read_b64_tr_b16 v[104:105], v6 offset:0
ds_read_b64_tr_b16 v[106:107], v6 offset:2048
s_add_u32 m0, s67, 98304
s_mov_b32 s69, 2097152
buffer_load_dwordx4 v20, s[76:79], s69 offen offset:0 lds
v_mfma_f32_16x16x32_bf16 a[216:219], v[136:139], v[68:71], a[216:219]
ds_read_b64_tr_b16 v[108:109], v7 offset:0
ds_read_b64_tr_b16 v[110:111], v7 offset:2048
v_mfma_f32_16x16x32_bf16 a[212:215], v[140:143], v[64:67], a[212:215]
ds_read_b64_tr_b16 v[112:113], v8 offset:0
ds_read_b64_tr_b16 v[114:115], v8 offset:2048
v_mfma_f32_16x16x32_bf16 a[220:223], v[140:143], v[68:71], a[220:223]
ds_read_b64_tr_b16 v[116:117], v9 offset:0
ds_read_b64_tr_b16 v[118:119], v9 offset:2048
v_mfma_f32_16x16x32_bf16 a[224:227], v[144:147], v[64:67], a[224:227]
ds_read_b64_tr_b16 v[120:121], v10 offset:0
buffer_load_dwordx4 v21, s[76:79], s69 offen offset:1024 lds
v_mfma_f32_16x16x32_bf16 a[232:235], v[144:147], v[68:71], a[232:235]
ds_read_b64_tr_b16 v[122:123], v10 offset:2048
v_mfma_f32_16x16x32_bf16 a[228:231], v[148:151], v[64:67], a[228:231]
ds_read_b64_tr_b16 v[124:125], v11 offset:0
v_mfma_f32_16x16x32_bf16 a[236:239], v[148:151], v[68:71], a[236:239]
ds_read_b64_tr_b16 v[126:127], v11 offset:2048
v_mfma_f32_16x16x32_bf16 a[240:243], v[152:155], v[64:67], a[240:243]
ds_read_b64_tr_b16 v[128:129], v4 offset:256
buffer_load_dwordx4 v22, s[76:79], s69 offen offset:2048 lds
v_mfma_f32_16x16x32_bf16 a[248:251], v[152:155], v[68:71], a[248:251]
ds_read_b64_tr_b16 v[130:131], v4 offset:2304
v_mfma_f32_16x16x32_bf16 a[244:247], v[156:159], v[64:67], a[244:247]
ds_read_b64_tr_b16 v[132:133], v5 offset:256
v_mfma_f32_16x16x32_bf16 a[252:255], v[156:159], v[68:71], a[252:255]
ds_read_b64_tr_b16 v[134:135], v5 offset:2304
s_waitcnt lgkmcnt(15)
v_mfma_f32_16x16x32_bf16 a[128:131], v[96:99], v[72:75], a[128:131]
ds_read_b64_tr_b16 v[136:137], v6 offset:256
buffer_load_dwordx4 v23, s[76:79], s69 offen offset:3072 lds
v_mfma_f32_16x16x32_bf16 a[136:139], v[96:99], v[76:79], a[136:139]
ds_read_b64_tr_b16 v[138:139], v6 offset:2304
v_mfma_f32_16x16x32_bf16 a[132:135], v[100:103], v[72:75], a[132:135]
ds_read_b64_tr_b16 v[140:141], v7 offset:256
v_mfma_f32_16x16x32_bf16 a[140:143], v[100:103], v[76:79], a[140:143]
ds_read_b64_tr_b16 v[142:143], v7 offset:2304
s_waitcnt lgkmcnt(15)
v_mfma_f32_16x16x32_bf16 a[144:147], v[104:107], v[72:75], a[144:147]
ds_read_b64_tr_b16 v[144:145], v8 offset:256
s_add_u32 m0, s67, 102400
s_mov_b32 s69, 2097152
buffer_load_dwordx4 v24, s[76:79], s69 offen offset:0 lds
v_mfma_f32_16x16x32_bf16 a[152:155], v[104:107], v[76:79], a[152:155]
ds_read_b64_tr_b16 v[146:147], v8 offset:2304
v_mfma_f32_16x16x32_bf16 a[148:151], v[108:111], v[72:75], a[148:151]
ds_read_b64_tr_b16 v[148:149], v9 offset:256
v_mfma_f32_16x16x32_bf16 a[156:159], v[108:111], v[76:79], a[156:159]
ds_read_b64_tr_b16 v[150:151], v9 offset:2304
s_waitcnt lgkmcnt(15)
v_mfma_f32_16x16x32_bf16 a[160:163], v[112:115], v[72:75], a[160:163]
ds_read_b64_tr_b16 v[152:153], v10 offset:256
buffer_load_dwordx4 v25, s[76:79], s69 offen offset:1024 lds
v_mfma_f32_16x16x32_bf16 a[168:171], v[112:115], v[76:79], a[168:171]
ds_read_b64_tr_b16 v[154:155], v10 offset:2304
v_mfma_f32_16x16x32_bf16 a[164:167], v[116:119], v[72:75], a[164:167]
ds_read_b64_tr_b16 v[156:157], v11 offset:256
v_mfma_f32_16x16x32_bf16 a[172:175], v[116:119], v[76:79], a[172:175]
ds_read_b64_tr_b16 v[158:159], v11 offset:2304
s_waitcnt lgkmcnt(15)
v_mfma_f32_16x16x32_bf16 a[176:179], v[120:123], v[72:75], a[176:179]
ds_read_b64_tr_b16 v[96:97], v4 offset:16384
buffer_load_dwordx4 v26, s[76:79], s69 offen offset:2048 lds
v_mfma_f32_16x16x32_bf16 a[184:187], v[120:123], v[76:79], a[184:187]
ds_read_b64_tr_b16 v[98:99], v4 offset:18432
v_mfma_f32_16x16x32_bf16 a[180:183], v[124:127], v[72:75], a[180:183]
ds_read_b64_tr_b16 v[100:101], v5 offset:16384
v_mfma_f32_16x16x32_bf16 a[188:191], v[124:127], v[76:79], a[188:191]
ds_read_b64_tr_b16 v[102:103], v5 offset:18432
s_waitcnt lgkmcnt(15)
v_mfma_f32_16x16x32_bf16 a[192:195], v[128:131], v[72:75], a[192:195]
ds_read_b64_tr_b16 v[104:105], v6 offset:16384
buffer_load_dwordx4 v27, s[76:79], s69 offen offset:3072 lds
v_mfma_f32_16x16x32_bf16 a[200:203], v[128:131], v[76:79], a[200:203]
ds_read_b64_tr_b16 v[106:107], v6 offset:18432
v_mfma_f32_16x16x32_bf16 a[196:199], v[132:135], v[72:75], a[196:199]
ds_read_b64_tr_b16 v[108:109], v7 offset:16384
v_mfma_f32_16x16x32_bf16 a[204:207], v[132:135], v[76:79], a[204:207]
ds_read_b64_tr_b16 v[110:111], v7 offset:18432
s_waitcnt lgkmcnt(15)
v_mfma_f32_16x16x32_bf16 a[208:211], v[136:139], v[72:75], a[208:211]
ds_read_b64_tr_b16 v[112:113], v8 offset:16384
s_add_u32 m0, s84, 147456
s_mov_b32 s88, 384
buffer_load_dwordx4 v164, s[72:75], s88 offen offset:0 lds
v_mfma_f32_16x16x32_bf16 a[216:219], v[136:139], v[76:79], a[216:219]
ds_read_b64_tr_b16 v[114:115], v8 offset:18432
v_mfma_f32_16x16x32_bf16 a[212:215], v[140:143], v[72:75], a[212:215]
ds_read_b64_tr_b16 v[116:117], v9 offset:16384
v_mfma_f32_16x16x32_bf16 a[220:223], v[140:143], v[76:79], a[220:223]
ds_read_b64_tr_b16 v[118:119], v9 offset:18432
s_waitcnt lgkmcnt(15)
v_mfma_f32_16x16x32_bf16 a[224:227], v[144:147], v[72:75], a[224:227]
ds_read_b64_tr_b16 v[120:121], v10 offset:16384
buffer_load_dwordx4 v165, s[72:75], s88 offen offset:1024 lds
v_mfma_f32_16x16x32_bf16 a[232:235], v[144:147], v[76:79], a[232:235]
ds_read_b64_tr_b16 v[122:123], v10 offset:18432
v_mfma_f32_16x16x32_bf16 a[228:231], v[148:151], v[72:75], a[228:231]
ds_read_b64_tr_b16 v[124:125], v11 offset:16384
v_mfma_f32_16x16x32_bf16 a[236:239], v[148:151], v[76:79], a[236:239]
ds_read_b64_tr_b16 v[126:127], v11 offset:18432
s_waitcnt lgkmcnt(15)
v_mfma_f32_16x16x32_bf16 a[240:243], v[152:155], v[72:75], a[240:243]
ds_read_b64_tr_b16 v[128:129], v4 offset:16640
buffer_load_dwordx4 v166, s[72:75], s88 offen offset:2048 lds
v_mfma_f32_16x16x32_bf16 a[248:251], v[152:155], v[76:79], a[248:251]
ds_read_b64_tr_b16 v[130:131], v4 offset:18688
v_mfma_f32_16x16x32_bf16 a[244:247], v[156:159], v[72:75], a[244:247]
ds_read_b64_tr_b16 v[132:133], v5 offset:16640
v_mfma_f32_16x16x32_bf16 a[252:255], v[156:159], v[76:79], a[252:255]
ds_read_b64_tr_b16 v[134:135], v5 offset:18688
s_waitcnt lgkmcnt(15)
v_mfma_f32_16x16x32_bf16 a[128:131], v[96:99], v[80:83], a[128:131]
ds_read_b64_tr_b16 v[136:137], v6 offset:16640
buffer_load_dwordx4 v167, s[72:75], s88 offen offset:3072 lds
v_mfma_f32_16x16x32_bf16 a[136:139], v[96:99], v[84:87], a[136:139]
ds_read_b64_tr_b16 v[138:139], v6 offset:18688
v_mfma_f32_16x16x32_bf16 a[132:135], v[100:103], v[80:83], a[132:135]
ds_read_b64_tr_b16 v[140:141], v7 offset:16640
v_mfma_f32_16x16x32_bf16 a[140:143], v[100:103], v[84:87], a[140:143]
ds_read_b64_tr_b16 v[142:143], v7 offset:18688
s_waitcnt lgkmcnt(15)
v_mfma_f32_16x16x32_bf16 a[144:147], v[104:107], v[80:83], a[144:147]
ds_read_b64_tr_b16 v[144:145], v8 offset:16640
s_add_u32 s64, s71, 19456
buffer_store_dwordx4 a[44:47], v1, s[12:15], s64 offen sc1
v_mfma_f32_16x16x32_bf16 a[152:155], v[104:107], v[84:87], a[152:155]
ds_read_b64_tr_b16 v[146:147], v8 offset:18688
v_mfma_f32_16x16x32_bf16 a[148:151], v[108:111], v[80:83], a[148:151]
ds_read_b64_tr_b16 v[148:149], v9 offset:16640
v_mfma_f32_16x16x32_bf16 a[156:159], v[108:111], v[84:87], a[156:159]
ds_read_b64_tr_b16 v[150:151], v9 offset:18688
s_waitcnt lgkmcnt(15)
v_mfma_f32_16x16x32_bf16 a[160:163], v[112:115], v[80:83], a[160:163]
ds_read_b64_tr_b16 v[152:153], v10 offset:16640
s_mul_i32 s64, s60, -4096
s_add_u32 s64, s64, 24576
s_add_u32 s64, s64, s71
buffer_store_dwordx4 a[48:51], v1, s[12:15], s64 offen sc1
v_mfma_f32_16x16x32_bf16 a[168:171], v[112:115], v[84:87], a[168:171]
ds_read_b64_tr_b16 v[154:155], v10 offset:18688
v_mfma_f32_16x16x32_bf16 a[164:167], v[116:119], v[80:83], a[164:167]
ds_read_b64_tr_b16 v[156:157], v11 offset:16640
v_mfma_f32_16x16x32_bf16 a[172:175], v[116:119], v[84:87], a[172:175]
ds_read_b64_tr_b16 v[158:159], v11 offset:18688
s_waitcnt lgkmcnt(15)
v_mfma_f32_16x16x32_bf16 a[176:179], v[120:123], v[80:83], a[176:179]
s_mul_i32 s64, s60, -4096
s_add_u32 s64, s64, 25600
s_add_u32 s64, s64, s71
buffer_store_dwordx4 a[52:55], v1, s[12:15], s64 offen sc1
v_mfma_f32_16x16x32_bf16 a[184:187], v[120:123], v[84:87], a[184:187]
v_mfma_f32_16x16x32_bf16 a[180:183], v[124:127], v[80:83], a[180:183]
v_mfma_f32_16x16x32_bf16 a[188:191], v[124:127], v[84:87], a[188:191]
s_waitcnt lgkmcnt(14)
v_mfma_f32_16x16x32_bf16 a[192:195], v[128:131], v[80:83], a[192:195]
s_mul_i32 s64, s60, -4096
s_add_u32 s64, s64, 26624
s_add_u32 s64, s64, s71
buffer_store_dwordx4 a[56:59], v1, s[12:15], s64 offen sc1
v_mfma_f32_16x16x32_bf16 a[200:203], v[128:131], v[84:87], a[200:203]
s_waitcnt vmcnt(20) lgkmcnt(0)
s_barrier
ds_read_b128 v[56:59], v176 offset:0
ds_read_b128 v[60:63], v176 offset:2048
ds_read_b128 v[64:67], v177 offset:0
ds_read_b128 v[68:71], v177 offset:2048
v_mfma_f32_16x16x32_bf16 a[196:199], v[132:135], v[80:83], a[196:199]
ds_read_b64_tr_b16 v[96:97], v4 offset:32768
ds_read_b64_tr_b16 v[98:99], v4 offset:34816
v_mfma_f32_16x16x32_bf16 a[204:207], v[132:135], v[84:87], a[204:207]
ds_read_b64_tr_b16 v[100:101], v5 offset:32768
ds_read_b64_tr_b16 v[102:103], v5 offset:34816
v_mfma_f32_16x16x32_bf16 a[208:211], v[136:139], v[80:83], a[208:211]
ds_read_b64_tr_b16 v[104:105], v6 offset:32768
ds_read_b64_tr_b16 v[106:107], v6 offset:34816
s_add_u32 m0, s67, 0
s_mov_b32 s69, 2621440
buffer_load_dwordx4 v20, s[76:79], s69 offen offset:0 lds
v_mfma_f32_16x16x32_bf16 a[216:219], v[136:139], v[84:87], a[216:219]
ds_read_b64_tr_b16 v[108:109], v7 offset:32768
ds_read_b64_tr_b16 v[110:111], v7 offset:34816
v_mfma_f32_16x16x32_bf16 a[212:215], v[140:143], v[80:83], a[212:215]
ds_read_b64_tr_b16 v[112:113], v8 offset:32768
ds_read_b64_tr_b16 v[114:115], v8 offset:34816
v_mfma_f32_16x16x32_bf16 a[220:223], v[140:143], v[84:87], a[220:223]
ds_read_b64_tr_b16 v[116:117], v9 offset:32768
ds_read_b64_tr_b16 v[118:119], v9 offset:34816
v_mfma_f32_16x16x32_bf16 a[224:227], v[144:147], v[80:83], a[224:227]
ds_read_b64_tr_b16 v[120:121], v10 offset:32768
buffer_load_dwordx4 v21, s[76:79], s69 offen offset:1024 lds
v_mfma_f32_16x16x32_bf16 a[232:235], v[144:147], v[84:87], a[232:235]
ds_read_b64_tr_b16 v[122:123], v10 offset:34816
v_mfma_f32_16x16x32_bf16 a[228:231], v[148:151], v[80:83], a[228:231]
ds_read_b64_tr_b16 v[124:125], v11 offset:32768
v_mfma_f32_16x16x32_bf16 a[236:239], v[148:151], v[84:87], a[236:239]
ds_read_b64_tr_b16 v[126:127], v11 offset:34816
v_mfma_f32_16x16x32_bf16 a[240:243], v[152:155], v[80:83], a[240:243]
ds_read_b64_tr_b16 v[128:129], v4 offset:33024
buffer_load_dwordx4 v22, s[76:79], s69 offen offset:2048 lds
v_mfma_f32_16x16x32_bf16 a[248:251], v[152:155], v[84:87], a[248:251]
ds_read_b64_tr_b16 v[130:131], v4 offset:35072
v_mfma_f32_16x16x32_bf16 a[244:247], v[156:159], v[80:83], a[244:247]
ds_read_b64_tr_b16 v[132:133], v5 offset:33024
v_mfma_f32_16x16x32_bf16 a[252:255], v[156:159], v[84:87], a[252:255]
ds_read_b64_tr_b16 v[134:135], v5 offset:35072
s_waitcnt lgkmcnt(15)
v_mfma_f32_16x16x32_bf16 a[128:131], v[96:99], v[56:59], a[128:131]
ds_read_b64_tr_b16 v[136:137], v6 offset:33024
buffer_load_dwordx4 v23, s[76:79], s69 offen offset:3072 lds
v_mfma_f32_16x16x32_bf16 a[136:139], v[96:99], v[60:63], a[136:139]
ds_read_b64_tr_b16 v[138:139], v6 offset:35072
v_mfma_f32_16x16x32_bf16 a[132:135], v[100:103], v[56:59], a[132:135]
ds_read_b64_tr_b16 v[140:141], v7 offset:33024
v_mfma_f32_16x16x32_bf16 a[140:143], v[100:103], v[60:63], a[140:143]
ds_read_b64_tr_b16 v[142:143], v7 offset:35072
s_waitcnt lgkmcnt(15)
v_mfma_f32_16x16x32_bf16 a[144:147], v[104:107], v[56:59], a[144:147]
ds_read_b64_tr_b16 v[144:145], v8 offset:33024
s_add_u32 m0, s67, 4096
s_mov_b32 s69, 2621440
buffer_load_dwordx4 v24, s[76:79], s69 offen offset:0 lds
v_mfma_f32_16x16x32_bf16 a[152:155], v[104:107], v[60:63], a[152:155]
ds_read_b64_tr_b16 v[146:147], v8 offset:35072
v_mfma_f32_16x16x32_bf16 a[148:151], v[108:111], v[56:59], a[148:151]
ds_read_b64_tr_b16 v[148:149], v9 offset:33024
v_mfma_f32_16x16x32_bf16 a[156:159], v[108:111], v[60:63], a[156:159]
ds_read_b64_tr_b16 v[150:151], v9 offset:35072
s_waitcnt lgkmcnt(15)
v_mfma_f32_16x16x32_bf16 a[160:163], v[112:115], v[56:59], a[160:163]
ds_read_b64_tr_b16 v[152:153], v10 offset:33024
buffer_load_dwordx4 v25, s[76:79], s69 offen offset:1024 lds
v_mfma_f32_16x16x32_bf16 a[168:171], v[112:115], v[60:63], a[168:171]
ds_read_b64_tr_b16 v[154:155], v10 offset:35072
v_mfma_f32_16x16x32_bf16 a[164:167], v[116:119], v[56:59], a[164:167]
ds_read_b64_tr_b16 v[156:157], v11 offset:33024
v_mfma_f32_16x16x32_bf16 a[172:175], v[116:119], v[60:63], a[172:175]
ds_read_b64_tr_b16 v[158:159], v11 offset:35072
s_waitcnt lgkmcnt(15)
v_mfma_f32_16x16x32_bf16 a[176:179], v[120:123], v[56:59], a[176:179]
ds_read_b64_tr_b16 v[96:97], v4 offset:49152
buffer_load_dwordx4 v26, s[76:79], s69 offen offset:2048 lds
v_mfma_f32_16x16x32_bf16 a[184:187], v[120:123], v[60:63], a[184:187]
ds_read_b64_tr_b16 v[98:99], v4 offset:51200
v_mfma_f32_16x16x32_bf16 a[180:183], v[124:127], v[56:59], a[180:183]
ds_read_b64_tr_b16 v[100:101], v5 offset:49152
v_mfma_f32_16x16x32_bf16 a[188:191], v[124:127], v[60:63], a[188:191]
ds_read_b64_tr_b16 v[102:103], v5 offset:51200
s_waitcnt lgkmcnt(15)
v_mfma_f32_16x16x32_bf16 a[192:195], v[128:131], v[56:59], a[192:195]
ds_read_b64_tr_b16 v[104:105], v6 offset:49152
buffer_load_dwordx4 v27, s[76:79], s69 offen offset:3072 lds
v_mfma_f32_16x16x32_bf16 a[200:203], v[128:131], v[60:63], a[200:203]
ds_read_b64_tr_b16 v[106:107], v6 offset:51200
v_mfma_f32_16x16x32_bf16 a[196:199], v[132:135], v[56:59], a[196:199]
ds_read_b64_tr_b16 v[108:109], v7 offset:49152
v_mfma_f32_16x16x32_bf16 a[204:207], v[132:135], v[60:63], a[204:207]
ds_read_b64_tr_b16 v[110:111], v7 offset:51200
s_waitcnt lgkmcnt(15)
v_mfma_f32_16x16x32_bf16 a[208:211], v[136:139], v[56:59], a[208:211]
ds_read_b64_tr_b16 v[112:113], v8 offset:49152
s_add_u32 m0, s84, 131072
s_mov_b32 s88, 512
buffer_load_dwordx4 v164, s[72:75], s88 offen offset:0 lds
v_mfma_f32_16x16x32_bf16 a[216:219], v[136:139], v[60:63], a[216:219]
ds_read_b64_tr_b16 v[114:115], v8 offset:51200
v_mfma_f32_16x16x32_bf16 a[212:215], v[140:143], v[56:59], a[212:215]
ds_read_b64_tr_b16 v[116:117], v9 offset:49152
v_mfma_f32_16x16x32_bf16 a[220:223], v[140:143], v[60:63], a[220:223]
ds_read_b64_tr_b16 v[118:119], v9 offset:51200
s_waitcnt lgkmcnt(15)
v_mfma_f32_16x16x32_bf16 a[224:227], v[144:147], v[56:59], a[224:227]
ds_read_b64_tr_b16 v[120:121], v10 offset:49152
buffer_load_dwordx4 v165, s[72:75], s88 offen offset:1024 lds
v_mfma_f32_16x16x32_bf16 a[232:235], v[144:147], v[60:63], a[232:235]
ds_read_b64_tr_b16 v[122:123], v10 offset:51200
v_mfma_f32_16x16x32_bf16 a[228:231], v[148:151], v[56:59], a[228:231]
ds_read_b64_tr_b16 v[124:125], v11 offset:49152
v_mfma_f32_16x16x32_bf16 a[236:239], v[148:151], v[60:63], a[236:239]
ds_read_b64_tr_b16 v[126:127], v11 offset:51200
s_waitcnt lgkmcnt(15)
v_mfma_f32_16x16x32_bf16 a[240:243], v[152:155], v[56:59], a[240:243]
ds_read_b64_tr_b16 v[128:129], v4 offset:49408
buffer_load_dwordx4 v166, s[72:75], s88 offen offset:2048 lds
v_mfma_f32_16x16x32_bf16 a[248:251], v[152:155], v[60:63], a[248:251]
ds_read_b64_tr_b16 v[130:131], v4 offset:51456
v_mfma_f32_16x16x32_bf16 a[244:247], v[156:159], v[56:59], a[244:247]
ds_read_b64_tr_b16 v[132:133], v5 offset:49408
v_mfma_f32_16x16x32_bf16 a[252:255], v[156:159], v[60:63], a[252:255]
ds_read_b64_tr_b16 v[134:135], v5 offset:51456
s_waitcnt lgkmcnt(15)
v_mfma_f32_16x16x32_bf16 a[128:131], v[96:99], v[64:67], a[128:131]
ds_read_b64_tr_b16 v[136:137], v6 offset:49408
buffer_load_dwordx4 v167, s[72:75], s88 offen offset:3072 lds
v_mfma_f32_16x16x32_bf16 a[136:139], v[96:99], v[68:71], a[136:139]
ds_read_b64_tr_b16 v[138:139], v6 offset:51456
v_mfma_f32_16x16x32_bf16 a[132:135], v[100:103], v[64:67], a[132:135]
ds_read_b64_tr_b16 v[140:141], v7 offset:49408
v_mfma_f32_16x16x32_bf16 a[140:143], v[100:103], v[68:71], a[140:143]
ds_read_b64_tr_b16 v[142:143], v7 offset:51456
s_waitcnt lgkmcnt(15)
v_mfma_f32_16x16x32_bf16 a[144:147], v[104:107], v[64:67], a[144:147]
ds_read_b64_tr_b16 v[144:145], v8 offset:49408
s_mul_i32 s64, s60, -4096
s_add_u32 s64, s64, 27648
s_add_u32 s64, s64, s71
buffer_store_dwordx4 a[60:63], v1, s[12:15], s64 offen sc1
v_mfma_f32_16x16x32_bf16 a[152:155], v[104:107], v[68:71], a[152:155]
ds_read_b64_tr_b16 v[146:147], v8 offset:51456
v_mfma_f32_16x16x32_bf16 a[148:151], v[108:111], v[64:67], a[148:151]
ds_read_b64_tr_b16 v[148:149], v9 offset:49408
v_mfma_f32_16x16x32_bf16 a[156:159], v[108:111], v[68:71], a[156:159]
ds_read_b64_tr_b16 v[150:151], v9 offset:51456
s_waitcnt lgkmcnt(15)
v_mfma_f32_16x16x32_bf16 a[160:163], v[112:115], v[64:67], a[160:163]
ds_read_b64_tr_b16 v[152:153], v10 offset:49408
v_mfma_f32_16x16x32_bf16 a[168:171], v[112:115], v[68:71], a[168:171]
ds_read_b64_tr_b16 v[154:155], v10 offset:51456
v_mfma_f32_16x16x32_bf16 a[164:167], v[116:119], v[64:67], a[164:167]
ds_read_b64_tr_b16 v[156:157], v11 offset:49408
v_mfma_f32_16x16x32_bf16 a[172:175], v[116:119], v[68:71], a[172:175]
ds_read_b64_tr_b16 v[158:159], v11 offset:51456
s_waitcnt lgkmcnt(15)
v_mfma_f32_16x16x32_bf16 a[176:179], v[120:123], v[64:67], a[176:179]
v_mfma_f32_16x16x32_bf16 a[184:187], v[120:123], v[68:71], a[184:187]
v_mfma_f32_16x16x32_bf16 a[180:183], v[124:127], v[64:67], a[180:183]
v_mfma_f32_16x16x32_bf16 a[188:191], v[124:127], v[68:71], a[188:191]
s_waitcnt lgkmcnt(14)
v_mfma_f32_16x16x32_bf16 a[192:195], v[128:131], v[64:67], a[192:195]
v_mfma_f32_16x16x32_bf16 a[200:203], v[128:131], v[68:71], a[200:203]
s_waitcnt vmcnt(17) lgkmcnt(0)
s_barrier
ds_read_b128 v[72:75], v176 offset:16384
ds_read_b128 v[76:79], v176 offset:18432
ds_read_b128 v[80:83], v177 offset:16384
ds_read_b128 v[84:87], v177 offset:18432
v_mfma_f32_16x16x32_bf16 a[196:199], v[132:135], v[64:67], a[196:199]
ds_read_b64_tr_b16 v[96:97], v48 offset:0
ds_read_b64_tr_b16 v[98:99], v48 offset:2048
v_mfma_f32_16x16x32_bf16 a[204:207], v[132:135], v[68:71], a[204:207]
ds_read_b64_tr_b16 v[100:101], v49 offset:0
ds_read_b64_tr_b16 v[102:103], v49 offset:2048
v_mfma_f32_16x16x32_bf16 a[208:211], v[136:139], v[64:67], a[208:211]
ds_read_b64_tr_b16 v[104:105], v50 offset:0
ds_read_b64_tr_b16 v[106:107], v50 offset:2048
s_add_u32 m0, s67, 32768
s_mov_b32 s69, 3145728
buffer_load_dwordx4 v20, s[76:79], s69 offen offset:0 lds
v_mfma_f32_16x16x32_bf16 a[216:219], v[136:139], v[68:71], a[216:219]
ds_read_b64_tr_b16 v[108:109], v51 offset:0
ds_read_b64_tr_b16 v[110:111], v51 offset:2048
v_mfma_f32_16x16x32_bf16 a[212:215], v[140:143], v[64:67], a[212:215]
ds_read_b64_tr_b16 v[112:113], v52 offset:0
ds_read_b64_tr_b16 v[114:115], v52 offset:2048
v_mfma_f32_16x16x32_bf16 a[220:223], v[140:143], v[68:71], a[220:223]
ds_read_b64_tr_b16 v[116:117], v53 offset:0
ds_read_b64_tr_b16 v[118:119], v53 offset:2048
v_mfma_f32_16x16x32_bf16 a[224:227], v[144:147], v[64:67], a[224:227]
ds_read_b64_tr_b16 v[120:121], v54 offset:0
buffer_load_dwordx4 v21, s[76:79], s69 offen offset:1024 lds
v_mfma_f32_16x16x32_bf16 a[232:235], v[144:147], v[68:71], a[232:235]
ds_read_b64_tr_b16 v[122:123], v54 offset:2048
v_mfma_f32_16x16x32_bf16 a[228:231], v[148:151], v[64:67], a[228:231]
ds_read_b64_tr_b16 v[124:125], v55 offset:0
v_mfma_f32_16x16x32_bf16 a[236:239], v[148:151], v[68:71], a[236:239]
ds_read_b64_tr_b16 v[126:127], v55 offset:2048
v_mfma_f32_16x16x32_bf16 a[240:243], v[152:155], v[64:67], a[240:243]
ds_read_b64_tr_b16 v[128:129], v48 offset:256
buffer_load_dwordx4 v22, s[76:79], s69 offen offset:2048 lds
v_mfma_f32_16x16x32_bf16 a[248:251], v[152:155], v[68:71], a[248:251]
ds_read_b64_tr_b16 v[130:131], v48 offset:2304
v_mfma_f32_16x16x32_bf16 a[244:247], v[156:159], v[64:67], a[244:247]
ds_read_b64_tr_b16 v[132:133], v49 offset:256
v_mfma_f32_16x16x32_bf16 a[252:255], v[156:159], v[68:71], a[252:255]
ds_read_b64_tr_b16 v[134:135], v49 offset:2304
s_waitcnt lgkmcnt(15)
v_mfma_f32_16x16x32_bf16 a[128:131], v[96:99], v[72:75], a[128:131]
ds_read_b64_tr_b16 v[136:137], v50 offset:256
buffer_load_dwordx4 v23, s[76:79], s69 offen offset:3072 lds
v_mfma_f32_16x16x32_bf16 a[136:139], v[96:99], v[76:79], a[136:139]
ds_read_b64_tr_b16 v[138:139], v50 offset:2304
v_mfma_f32_16x16x32_bf16 a[132:135], v[100:103], v[72:75], a[132:135]
ds_read_b64_tr_b16 v[140:141], v51 offset:256
v_mfma_f32_16x16x32_bf16 a[140:143], v[100:103], v[76:79], a[140:143]
ds_read_b64_tr_b16 v[142:143], v51 offset:2304
s_waitcnt lgkmcnt(15)
v_mfma_f32_16x16x32_bf16 a[144:147], v[104:107], v[72:75], a[144:147]
ds_read_b64_tr_b16 v[144:145], v52 offset:256
s_add_u32 m0, s67, 36864
s_mov_b32 s69, 3145728
buffer_load_dwordx4 v24, s[76:79], s69 offen offset:0 lds
v_mfma_f32_16x16x32_bf16 a[152:155], v[104:107], v[76:79], a[152:155]
ds_read_b64_tr_b16 v[146:147], v52 offset:2304
v_mfma_f32_16x16x32_bf16 a[148:151], v[108:111], v[72:75], a[148:151]
ds_read_b64_tr_b16 v[148:149], v53 offset:256
v_mfma_f32_16x16x32_bf16 a[156:159], v[108:111], v[76:79], a[156:159]
ds_read_b64_tr_b16 v[150:151], v53 offset:2304
s_waitcnt lgkmcnt(15)
v_mfma_f32_16x16x32_bf16 a[160:163], v[112:115], v[72:75], a[160:163]
ds_read_b64_tr_b16 v[152:153], v54 offset:256
buffer_load_dwordx4 v25, s[76:79], s69 offen offset:1024 lds
v_mfma_f32_16x16x32_bf16 a[168:171], v[112:115], v[76:79], a[168:171]
ds_read_b64_tr_b16 v[154:155], v54 offset:2304
v_mfma_f32_16x16x32_bf16 a[164:167], v[116:119], v[72:75], a[164:167]
ds_read_b64_tr_b16 v[156:157], v55 offset:256
v_mfma_f32_16x16x32_bf16 a[172:175], v[116:119], v[76:79], a[172:175]
ds_read_b64_tr_b16 v[158:159], v55 offset:2304
s_waitcnt lgkmcnt(15)
v_mfma_f32_16x16x32_bf16 a[176:179], v[120:123], v[72:75], a[176:179]
ds_read_b64_tr_b16 v[96:97], v48 offset:16384
buffer_load_dwordx4 v26, s[76:79], s69 offen offset:2048 lds
v_mfma_f32_16x16x32_bf16 a[184:187], v[120:123], v[76:79], a[184:187]
ds_read_b64_tr_b16 v[98:99], v48 offset:18432
v_mfma_f32_16x16x32_bf16 a[180:183], v[124:127], v[72:75], a[180:183]
ds_read_b64_tr_b16 v[100:101], v49 offset:16384
v_mfma_f32_16x16x32_bf16 a[188:191], v[124:127], v[76:79], a[188:191]
ds_read_b64_tr_b16 v[102:103], v49 offset:18432
s_waitcnt lgkmcnt(15)
v_mfma_f32_16x16x32_bf16 a[192:195], v[128:131], v[72:75], a[192:195]
ds_read_b64_tr_b16 v[104:105], v50 offset:16384
buffer_load_dwordx4 v27, s[76:79], s69 offen offset:3072 lds
v_mfma_f32_16x16x32_bf16 a[200:203], v[128:131], v[76:79], a[200:203]
ds_read_b64_tr_b16 v[106:107], v50 offset:18432
v_mfma_f32_16x16x32_bf16 a[196:199], v[132:135], v[72:75], a[196:199]
ds_read_b64_tr_b16 v[108:109], v51 offset:16384
v_mfma_f32_16x16x32_bf16 a[204:207], v[132:135], v[76:79], a[204:207]
ds_read_b64_tr_b16 v[110:111], v51 offset:18432
s_waitcnt lgkmcnt(15)
v_mfma_f32_16x16x32_bf16 a[208:211], v[136:139], v[72:75], a[208:211]
ds_read_b64_tr_b16 v[112:113], v52 offset:16384
s_add_u32 m0, s84, 147456
s_mov_b32 s88, 640
buffer_load_dwordx4 v164, s[72:75], s88 offen offset:0 lds
v_mfma_f32_16x16x32_bf16 a[216:219], v[136:139], v[76:79], a[216:219]
ds_read_b64_tr_b16 v[114:115], v52 offset:18432
v_mfma_f32_16x16x32_bf16 a[212:215], v[140:143], v[72:75], a[212:215]
ds_read_b64_tr_b16 v[116:117], v53 offset:16384
v_mfma_f32_16x16x32_bf16 a[220:223], v[140:143], v[76:79], a[220:223]
ds_read_b64_tr_b16 v[118:119], v53 offset:18432
s_waitcnt lgkmcnt(15)
v_mfma_f32_16x16x32_bf16 a[224:227], v[144:147], v[72:75], a[224:227]
ds_read_b64_tr_b16 v[120:121], v54 offset:16384
buffer_load_dwordx4 v165, s[72:75], s88 offen offset:1024 lds
v_mfma_f32_16x16x32_bf16 a[232:235], v[144:147], v[76:79], a[232:235]
ds_read_b64_tr_b16 v[122:123], v54 offset:18432
v_mfma_f32_16x16x32_bf16 a[228:231], v[148:151], v[72:75], a[228:231]
ds_read_b64_tr_b16 v[124:125], v55 offset:16384
v_mfma_f32_16x16x32_bf16 a[236:239], v[148:151], v[76:79], a[236:239]
ds_read_b64_tr_b16 v[126:127], v55 offset:18432
s_waitcnt lgkmcnt(15)
v_mfma_f32_16x16x32_bf16 a[240:243], v[152:155], v[72:75], a[240:243]
ds_read_b64_tr_b16 v[128:129], v48 offset:16640
buffer_load_dwordx4 v166, s[72:75], s88 offen offset:2048 lds
v_mfma_f32_16x16x32_bf16 a[248:251], v[152:155], v[76:79], a[248:251]
ds_read_b64_tr_b16 v[130:131], v48 offset:18688
v_mfma_f32_16x16x32_bf16 a[244:247], v[156:159], v[72:75], a[244:247]
ds_read_b64_tr_b16 v[132:133], v49 offset:16640
v_mfma_f32_16x16x32_bf16 a[252:255], v[156:159], v[76:79], a[252:255]
ds_read_b64_tr_b16 v[134:135], v49 offset:18688
s_waitcnt lgkmcnt(15)
v_mfma_f32_16x16x32_bf16 a[128:131], v[96:99], v[80:83], a[128:131]
ds_read_b64_tr_b16 v[136:137], v50 offset:16640
buffer_load_dwordx4 v167, s[72:75], s88 offen offset:3072 lds
v_mfma_f32_16x16x32_bf16 a[136:139], v[96:99], v[84:87], a[136:139]
ds_read_b64_tr_b16 v[138:139], v50 offset:18688
v_mfma_f32_16x16x32_bf16 a[132:135], v[100:103], v[80:83], a[132:135]
ds_read_b64_tr_b16 v[140:141], v51 offset:16640
v_mfma_f32_16x16x32_bf16 a[140:143], v[100:103], v[84:87], a[140:143]
ds_read_b64_tr_b16 v[142:143], v51 offset:18688
s_waitcnt lgkmcnt(15)
v_mfma_f32_16x16x32_bf16 a[144:147], v[104:107], v[80:83], a[144:147]
ds_read_b64_tr_b16 v[144:145], v52 offset:16640
v_mfma_f32_16x16x32_bf16 a[152:155], v[104:107], v[84:87], a[152:155]
ds_read_b64_tr_b16 v[146:147], v52 offset:18688
v_mfma_f32_16x16x32_bf16 a[148:151], v[108:111], v[80:83], a[148:151]
ds_read_b64_tr_b16 v[148:149], v53 offset:16640
v_mfma_f32_16x16x32_bf16 a[156:159], v[108:111], v[84:87], a[156:159]
ds_read_b64_tr_b16 v[150:151], v53 offset:18688
s_waitcnt lgkmcnt(15)
v_mfma_f32_16x16x32_bf16 a[160:163], v[112:115], v[80:83], a[160:163]
ds_read_b64_tr_b16 v[152:153], v54 offset:16640
v_mfma_f32_16x16x32_bf16 a[168:171], v[112:115], v[84:87], a[168:171]
ds_read_b64_tr_b16 v[154:155], v54 offset:18688
v_mfma_f32_16x16x32_bf16 a[164:167], v[116:119], v[80:83], a[164:167]
ds_read_b64_tr_b16 v[156:157], v55 offset:16640
v_mfma_f32_16x16x32_bf16 a[172:175], v[116:119], v[84:87], a[172:175]
ds_read_b64_tr_b16 v[158:159], v55 offset:18688
s_waitcnt lgkmcnt(15)
v_mfma_f32_16x16x32_bf16 a[176:179], v[120:123], v[80:83], a[176:179]
v_mfma_f32_16x16x32_bf16 a[184:187], v[120:123], v[84:87], a[184:187]
v_mfma_f32_16x16x32_bf16 a[180:183], v[124:127], v[80:83], a[180:183]
v_mfma_f32_16x16x32_bf16 a[188:191], v[124:127], v[84:87], a[188:191]
s_waitcnt lgkmcnt(14)
v_mfma_f32_16x16x32_bf16 a[192:195], v[128:131], v[80:83], a[192:195]
v_mfma_f32_16x16x32_bf16 a[200:203], v[128:131], v[84:87], a[200:203]
s_waitcnt vmcnt(13) lgkmcnt(0)
s_barrier
ds_read_b128 v[56:59], v176 offset:0
ds_read_b128 v[60:63], v176 offset:2048
ds_read_b128 v[64:67], v177 offset:0
ds_read_b128 v[68:71], v177 offset:2048
v_mfma_f32_16x16x32_bf16 a[196:199], v[132:135], v[80:83], a[196:199]
ds_read_b64_tr_b16 v[96:97], v48 offset:32768
ds_read_b64_tr_b16 v[98:99], v48 offset:34816
v_mfma_f32_16x16x32_bf16 a[204:207], v[132:135], v[84:87], a[204:207]
ds_read_b64_tr_b16 v[100:101], v49 offset:32768
ds_read_b64_tr_b16 v[102:103], v49 offset:34816
v_mfma_f32_16x16x32_bf16 a[208:211], v[136:139], v[80:83], a[208:211]
ds_read_b64_tr_b16 v[104:105], v50 offset:32768
ds_read_b64_tr_b16 v[106:107], v50 offset:34816
v_mfma_f32_16x16x32_bf16 a[216:219], v[136:139], v[84:87], a[216:219]
ds_read_b64_tr_b16 v[108:109], v51 offset:32768
ds_read_b64_tr_b16 v[110:111], v51 offset:34816
v_mfma_f32_16x16x32_bf16 a[212:215], v[140:143], v[80:83], a[212:215]
ds_read_b64_tr_b16 v[112:113], v52 offset:32768
ds_read_b64_tr_b16 v[114:115], v52 offset:34816
v_mfma_f32_16x16x32_bf16 a[220:223], v[140:143], v[84:87], a[220:223]
ds_read_b64_tr_b16 v[116:117], v53 offset:32768
ds_read_b64_tr_b16 v[118:119], v53 offset:34816
v_mfma_f32_16x16x32_bf16 a[224:227], v[144:147], v[80:83], a[224:227]
ds_read_b64_tr_b16 v[120:121], v54 offset:32768
v_mfma_f32_16x16x32_bf16 a[232:235], v[144:147], v[84:87], a[232:235]
ds_read_b64_tr_b16 v[122:123], v54 offset:34816
v_mfma_f32_16x16x32_bf16 a[228:231], v[148:151], v[80:83], a[228:231]
ds_read_b64_tr_b16 v[124:125], v55 offset:32768
v_mfma_f32_16x16x32_bf16 a[236:239], v[148:151], v[84:87], a[236:239]
ds_read_b64_tr_b16 v[126:127], v55 offset:34816
v_mfma_f32_16x16x32_bf16 a[240:243], v[152:155], v[80:83], a[240:243]
ds_read_b64_tr_b16 v[128:129], v48 offset:33024
v_mfma_f32_16x16x32_bf16 a[248:251], v[152:155], v[84:87], a[248:251]
ds_read_b64_tr_b16 v[130:131], v48 offset:35072
v_mfma_f32_16x16x32_bf16 a[244:247], v[156:159], v[80:83], a[244:247]
ds_read_b64_tr_b16 v[132:133], v49 offset:33024
v_mfma_f32_16x16x32_bf16 a[252:255], v[156:159], v[84:87], a[252:255]
ds_read_b64_tr_b16 v[134:135], v49 offset:35072
s_waitcnt lgkmcnt(15)
v_mfma_f32_16x16x32_bf16 a[128:131], v[96:99], v[56:59], a[128:131]
ds_read_b64_tr_b16 v[136:137], v50 offset:33024
v_mfma_f32_16x16x32_bf16 a[136:139], v[96:99], v[60:63], a[136:139]
ds_read_b64_tr_b16 v[138:139], v50 offset:35072
v_mfma_f32_16x16x32_bf16 a[132:135], v[100:103], v[56:59], a[132:135]
ds_read_b64_tr_b16 v[140:141], v51 offset:33024
v_mfma_f32_16x16x32_bf16 a[140:143], v[100:103], v[60:63], a[140:143]
ds_read_b64_tr_b16 v[142:143], v51 offset:35072
s_waitcnt lgkmcnt(15)
v_mfma_f32_16x16x32_bf16 a[144:147], v[104:107], v[56:59], a[144:147]
ds_read_b64_tr_b16 v[144:145], v52 offset:33024
s_add_u32 m0, s84, 131072
s_mov_b32 s88, 768
buffer_load_dwordx4 v164, s[72:75], s88 offen offset:0 lds
v_mfma_f32_16x16x32_bf16 a[152:155], v[104:107], v[60:63], a[152:155]
ds_read_b64_tr_b16 v[146:147], v52 offset:35072
v_mfma_f32_16x16x32_bf16 a[148:151], v[108:111], v[56:59], a[148:151]
ds_read_b64_tr_b16 v[148:149], v53 offset:33024
v_mfma_f32_16x16x32_bf16 a[156:159], v[108:111], v[60:63], a[156:159]
ds_read_b64_tr_b16 v[150:151], v53 offset:35072
s_waitcnt lgkmcnt(15)
v_mfma_f32_16x16x32_bf16 a[160:163], v[112:115], v[56:59], a[160:163]
ds_read_b64_tr_b16 v[152:153], v54 offset:33024
buffer_load_dwordx4 v165, s[72:75], s88 offen offset:1024 lds
v_mfma_f32_16x16x32_bf16 a[168:171], v[112:115], v[60:63], a[168:171]
ds_read_b64_tr_b16 v[154:155], v54 offset:35072
v_mfma_f32_16x16x32_bf16 a[164:167], v[116:119], v[56:59], a[164:167]
ds_read_b64_tr_b16 v[156:157], v55 offset:33024
v_mfma_f32_16x16x32_bf16 a[172:175], v[116:119], v[60:63], a[172:175]
ds_read_b64_tr_b16 v[158:159], v55 offset:35072
s_waitcnt lgkmcnt(15)
v_mfma_f32_16x16x32_bf16 a[176:179], v[120:123], v[56:59], a[176:179]
ds_read_b64_tr_b16 v[96:97], v48 offset:49152
buffer_load_dwordx4 v166, s[72:75], s88 offen offset:2048 lds
v_mfma_f32_16x16x32_bf16 a[184:187], v[120:123], v[60:63], a[184:187]
ds_read_b64_tr_b16 v[98:99], v48 offset:51200
v_mfma_f32_16x16x32_bf16 a[180:183], v[124:127], v[56:59], a[180:183]
ds_read_b64_tr_b16 v[100:101], v49 offset:49152
v_mfma_f32_16x16x32_bf16 a[188:191], v[124:127], v[60:63], a[188:191]
ds_read_b64_tr_b16 v[102:103], v49 offset:51200
s_waitcnt lgkmcnt(15)
v_mfma_f32_16x16x32_bf16 a[192:195], v[128:131], v[56:59], a[192:195]
ds_read_b64_tr_b16 v[104:105], v50 offset:49152
buffer_load_dwordx4 v167, s[72:75], s88 offen offset:3072 lds
v_mfma_f32_16x16x32_bf16 a[200:203], v[128:131], v[60:63], a[200:203]
ds_read_b64_tr_b16 v[106:107], v50 offset:51200
v_mfma_f32_16x16x32_bf16 a[196:199], v[132:135], v[56:59], a[196:199]
ds_read_b64_tr_b16 v[108:109], v51 offset:49152
v_mfma_f32_16x16x32_bf16 a[204:207], v[132:135], v[60:63], a[204:207]
ds_read_b64_tr_b16 v[110:111], v51 offset:51200
s_waitcnt lgkmcnt(15)
v_mfma_f32_16x16x32_bf16 a[208:211], v[136:139], v[56:59], a[208:211]
ds_read_b64_tr_b16 v[112:113], v52 offset:49152
v_mfma_f32_16x16x32_bf16 a[216:219], v[136:139], v[60:63], a[216:219]
ds_read_b64_tr_b16 v[114:115], v52 offset:51200
v_mfma_f32_16x16x32_bf16 a[212:215], v[140:143], v[56:59], a[212:215]
ds_read_b64_tr_b16 v[116:117], v53 offset:49152
v_mfma_f32_16x16x32_bf16 a[220:223], v[140:143], v[60:63], a[220:223]
ds_read_b64_tr_b16 v[118:119], v53 offset:51200
s_waitcnt lgkmcnt(15)
v_mfma_f32_16x16x32_bf16 a[224:227], v[144:147], v[56:59], a[224:227]
ds_read_b64_tr_b16 v[120:121], v54 offset:49152
v_mfma_f32_16x16x32_bf16 a[232:235], v[144:147], v[60:63], a[232:235]
ds_read_b64_tr_b16 v[122:123], v54 offset:51200
v_mfma_f32_16x16x32_bf16 a[228:231], v[148:151], v[56:59], a[228:231]
ds_read_b64_tr_b16 v[124:125], v55 offset:49152
v_mfma_f32_16x16x32_bf16 a[236:239], v[148:151], v[60:63], a[236:239]
ds_read_b64_tr_b16 v[126:127], v55 offset:51200
s_waitcnt lgkmcnt(15)
v_mfma_f32_16x16x32_bf16 a[240:243], v[152:155], v[56:59], a[240:243]
ds_read_b64_tr_b16 v[128:129], v48 offset:49408
v_mfma_f32_16x16x32_bf16 a[248:251], v[152:155], v[60:63], a[248:251]
ds_read_b64_tr_b16 v[130:131], v48 offset:51456
v_mfma_f32_16x16x32_bf16 a[244:247], v[156:159], v[56:59], a[244:247]
ds_read_b64_tr_b16 v[132:133], v49 offset:49408
v_mfma_f32_16x16x32_bf16 a[252:255], v[156:159], v[60:63], a[252:255]
ds_read_b64_tr_b16 v[134:135], v49 offset:51456
s_waitcnt lgkmcnt(15)
v_mfma_f32_16x16x32_bf16 a[128:131], v[96:99], v[64:67], a[128:131]
ds_read_b64_tr_b16 v[136:137], v50 offset:49408
v_mfma_f32_16x16x32_bf16 a[136:139], v[96:99], v[68:71], a[136:139]
ds_read_b64_tr_b16 v[138:139], v50 offset:51456
v_mfma_f32_16x16x32_bf16 a[132:135], v[100:103], v[64:67], a[132:135]
ds_read_b64_tr_b16 v[140:141], v51 offset:49408
v_mfma_f32_16x16x32_bf16 a[140:143], v[100:103], v[68:71], a[140:143]
ds_read_b64_tr_b16 v[142:143], v51 offset:51456
s_waitcnt lgkmcnt(15)
v_mfma_f32_16x16x32_bf16 a[144:147], v[104:107], v[64:67], a[144:147]
ds_read_b64_tr_b16 v[144:145], v52 offset:49408
v_mfma_f32_16x16x32_bf16 a[152:155], v[104:107], v[68:71], a[152:155]
ds_read_b64_tr_b16 v[146:147], v52 offset:51456
v_mfma_f32_16x16x32_bf16 a[148:151], v[108:111], v[64:67], a[148:151]
ds_read_b64_tr_b16 v[148:149], v53 offset:49408
v_mfma_f32_16x16x32_bf16 a[156:159], v[108:111], v[68:71], a[156:159]
ds_read_b64_tr_b16 v[150:151], v53 offset:51456
s_waitcnt lgkmcnt(15)
v_mfma_f32_16x16x32_bf16 a[160:163], v[112:115], v[64:67], a[160:163]
ds_read_b64_tr_b16 v[152:153], v54 offset:49408
v_mfma_f32_16x16x32_bf16 a[168:171], v[112:115], v[68:71], a[168:171]
ds_read_b64_tr_b16 v[154:155], v54 offset:51456
v_mfma_f32_16x16x32_bf16 a[164:167], v[116:119], v[64:67], a[164:167]
ds_read_b64_tr_b16 v[156:157], v55 offset:49408
v_mfma_f32_16x16x32_bf16 a[172:175], v[116:119], v[68:71], a[172:175]
ds_read_b64_tr_b16 v[158:159], v55 offset:51456
s_waitcnt lgkmcnt(15)
v_mfma_f32_16x16x32_bf16 a[176:179], v[120:123], v[64:67], a[176:179]
v_mfma_f32_16x16x32_bf16 a[184:187], v[120:123], v[68:71], a[184:187]
v_mfma_f32_16x16x32_bf16 a[180:183], v[124:127], v[64:67], a[180:183]
v_mfma_f32_16x16x32_bf16 a[188:191], v[124:127], v[68:71], a[188:191]
s_waitcnt lgkmcnt(14)
v_mfma_f32_16x16x32_bf16 a[192:195], v[128:131], v[64:67], a[192:195]
v_mfma_f32_16x16x32_bf16 a[200:203], v[128:131], v[68:71], a[200:203]
s_waitcnt vmcnt(16)
s_waitcnt vmcnt(4) lgkmcnt(0)
s_barrier
s_lshl_b32 s61, s101, 4
s_lshl_b32 s62, s60, 3
s_add_u32 s61, s61, s62
s_lshr_b32 s62, s2, 5
s_add_u32 s61, s61, s62
s_lshl_b32 s61, s61, 7
s_add_u32 s61, s61, 104857600
s_cmp_lg_u32 s16, 0
s_cbranch_scc1 L_f_sig1
v_mov_b32 v28, 0
v_mov_b32 v29, s3
s_mov_b64 exec, 1
buffer_store_dword v29, v28, s[12:15], s61 offen sc1
s_mov_b64 exec, -1
L_f_sig1:
v_and_b32 v30, 3, v0
v_min_u32 v30, 2, v30
s_sub_i32 s61, s25, 2
v_add_u32 v30, s61, v30
v_max_i32 v30, 0, v30
v_lshlrev_b32 v30, 7, v30
s_lshl_b32 s71, s24, 11
s_add_u32 s71, s71, 104890368
buffer_load_dword v31, v30, s[12:15], s71 offen sc1
ds_read_b128 v[72:75], v176 offset:16384
ds_read_b128 v[76:79], v176 offset:18432
ds_read_b128 v[80:83], v177 offset:16384
ds_read_b128 v[84:87], v177 offset:18432
v_mfma_f32_16x16x32_bf16 a[196:199], v[132:135], v[64:67], a[196:199]
ds_read_b64_tr_b16 v[96:97], v4 offset:0
ds_read_b64_tr_b16 v[98:99], v4 offset:2048
v_mfma_f32_16x16x32_bf16 a[204:207], v[132:135], v[68:71], a[204:207]
ds_read_b64_tr_b16 v[100:101], v5 offset:0
ds_read_b64_tr_b16 v[102:103], v5 offset:2048
v_mfma_f32_16x16x32_bf16 a[208:211], v[136:139], v[64:67], a[208:211]
ds_read_b64_tr_b16 v[104:105], v6 offset:0
ds_read_b64_tr_b16 v[106:107], v6 offset:2048
v_mfma_f32_16x16x32_bf16 a[216:219], v[136:139], v[68:71], a[216:219]
ds_read_b64_tr_b16 v[108:109], v7 offset:0
ds_read_b64_tr_b16 v[110:111], v7 offset:2048
v_mfma_f32_16x16x32_bf16 a[212:215], v[140:143], v[64:67], a[212:215]
ds_read_b64_tr_b16 v[112:113], v8 offset:0
ds_read_b64_tr_b16 v[114:115], v8 offset:2048
v_mfma_f32_16x16x32_bf16 a[220:223], v[140:143], v[68:71], a[220:223]
ds_read_b64_tr_b16 v[116:117], v9 offset:0
ds_read_b64_tr_b16 v[118:119], v9 offset:2048
v_mfma_f32_16x16x32_bf16 a[224:227], v[144:147], v[64:67], a[224:227]
ds_read_b64_tr_b16 v[120:121], v10 offset:0
v_mfma_f32_16x16x32_bf16 a[232:235], v[144:147], v[68:71], a[232:235]
ds_read_b64_tr_b16 v[122:123], v10 offset:2048
v_mfma_f32_16x16x32_bf16 a[228:231], v[148:151], v[64:67], a[228:231]
ds_read_b64_tr_b16 v[124:125], v11 offset:0
v_mfma_f32_16x16x32_bf16 a[236:239], v[148:151], v[68:71], a[236:239]
ds_read_b64_tr_b16 v[126:127], v11 offset:2048
v_mfma_f32_16x16x32_bf16 a[240:243], v[152:155], v[64:67], a[240:243]
ds_read_b64_tr_b16 v[128:129], v4 offset:256
v_mfma_f32_16x16x32_bf16 a[248:251], v[152:155], v[68:71], a[248:251]
ds_read_b64_tr_b16 v[130:131], v4 offset:2304
v_mfma_f32_16x16x32_bf16 a[244:247], v[156:159], v[64:67], a[244:247]
ds_read_b64_tr_b16 v[132:133], v5 offset:256
v_mfma_f32_16x16x32_bf16 a[252:255], v[156:159], v[68:71], a[252:255]
ds_read_b64_tr_b16 v[134:135], v5 offset:2304
s_waitcnt lgkmcnt(15)
v_mfma_f32_16x16x32_bf16 a[128:131], v[96:99], v[72:75], a[128:131]
ds_read_b64_tr_b16 v[136:137], v6 offset:256
v_mfma_f32_16x16x32_bf16 a[136:139], v[96:99], v[76:79], a[136:139]
ds_read_b64_tr_b16 v[138:139], v6 offset:2304
v_mfma_f32_16x16x32_bf16 a[132:135], v[100:103], v[72:75], a[132:135]
ds_read_b64_tr_b16 v[140:141], v7 offset:256
v_mfma_f32_16x16x32_bf16 a[140:143], v[100:103], v[76:79], a[140:143]
ds_read_b64_tr_b16 v[142:143], v7 offset:2304
s_waitcnt lgkmcnt(15)
v_mfma_f32_16x16x32_bf16 a[144:147], v[104:107], v[72:75], a[144:147]
ds_read_b64_tr_b16 v[144:145], v8 offset:256
v_mfma_f32_16x16x32_bf16 a[152:155], v[104:107], v[76:79], a[152:155]
ds_read_b64_tr_b16 v[146:147], v8 offset:2304
v_mfma_f32_16x16x32_bf16 a[148:151], v[108:111], v[72:75], a[148:151]
ds_read_b64_tr_b16 v[148:149], v9 offset:256
v_mfma_f32_16x16x32_bf16 a[156:159], v[108:111], v[76:79], a[156:159]
ds_read_b64_tr_b16 v[150:151], v9 offset:2304
s_waitcnt lgkmcnt(15)
v_mfma_f32_16x16x32_bf16 a[160:163], v[112:115], v[72:75], a[160:163]
ds_read_b64_tr_b16 v[152:153], v10 offset:256
v_mfma_f32_16x16x32_bf16 a[168:171], v[112:115], v[76:79], a[168:171]
ds_read_b64_tr_b16 v[154:155], v10 offset:2304
v_mfma_f32_16x16x32_bf16 a[164:167], v[116:119], v[72:75], a[164:167]
ds_read_b64_tr_b16 v[156:157], v11 offset:256
v_mfma_f32_16x16x32_bf16 a[172:175], v[116:119], v[76:79], a[172:175]
ds_read_b64_tr_b16 v[158:159], v11 offset:2304
s_waitcnt lgkmcnt(15)
v_mfma_f32_16x16x32_bf16 a[176:179], v[120:123], v[72:75], a[176:179]
ds_read_b64_tr_b16 v[96:97], v4 offset:16384
v_mfma_f32_16x16x32_bf16 a[184:187], v[120:123], v[76:79], a[184:187]
ds_read_b64_tr_b16 v[98:99], v4 offset:18432
v_mfma_f32_16x16x32_bf16 a[180:183], v[124:127], v[72:75], a[180:183]
ds_read_b64_tr_b16 v[100:101], v5 offset:16384
v_mfma_f32_16x16x32_bf16 a[188:191], v[124:127], v[76:79], a[188:191]
ds_read_b64_tr_b16 v[102:103], v5 offset:18432
s_waitcnt lgkmcnt(15)
v_mfma_f32_16x16x32_bf16 a[192:195], v[128:131], v[72:75], a[192:195]
ds_read_b64_tr_b16 v[104:105], v6 offset:16384
v_mfma_f32_16x16x32_bf16 a[200:203], v[128:131], v[76:79], a[200:203]
ds_read_b64_tr_b16 v[106:107], v6 offset:18432
v_mfma_f32_16x16x32_bf16 a[196:199], v[132:135], v[72:75], a[196:199]
ds_read_b64_tr_b16 v[108:109], v7 offset:16384
v_mfma_f32_16x16x32_bf16 a[204:207], v[132:135], v[76:79], a[204:207]
ds_read_b64_tr_b16 v[110:111], v7 offset:18432
s_waitcnt lgkmcnt(15)
v_mfma_f32_16x16x32_bf16 a[208:211], v[136:139], v[72:75], a[208:211]
ds_read_b64_tr_b16 v[112:113], v8 offset:16384
v_mfma_f32_16x16x32_bf16 a[216:219], v[136:139], v[76:79], a[216:219]
ds_read_b64_tr_b16 v[114:115], v8 offset:18432
v_mfma_f32_16x16x32_bf16 a[212:215], v[140:143], v[72:75], a[212:215]
ds_read_b64_tr_b16 v[116:117], v9 offset:16384
v_mfma_f32_16x16x32_bf16 a[220:223], v[140:143], v[76:79], a[220:223]
ds_read_b64_tr_b16 v[118:119], v9 offset:18432
s_waitcnt lgkmcnt(15)
v_mfma_f32_16x16x32_bf16 a[224:227], v[144:147], v[72:75], a[224:227]
ds_read_b64_tr_b16 v[120:121], v10 offset:16384
v_mfma_f32_16x16x32_bf16 a[232:235], v[144:147], v[76:79], a[232:235]
ds_read_b64_tr_b16 v[122:123], v10 offset:18432
v_mfma_f32_16x16x32_bf16 a[228:231], v[148:151], v[72:75], a[228:231]
ds_read_b64_tr_b16 v[124:125], v11 offset:16384
v_mfma_f32_16x16x32_bf16 a[236:239], v[148:151], v[76:79], a[236:239]
ds_read_b64_tr_b16 v[126:127], v11 offset:18432
s_waitcnt lgkmcnt(15)
v_mfma_f32_16x16x32_bf16 a[240:243], v[152:155], v[72:75], a[240:243]
ds_read_b64_tr_b16 v[128:129], v4 offset:16640
v_mfma_f32_16x16x32_bf16 a[248:251], v[152:155], v[76:79], a[248:251]
ds_read_b64_tr_b16 v[130:131], v4 offset:18688
v_mfma_f32_16x16x32_bf16 a[244:247], v[156:159], v[72:75], a[244:247]
ds_read_b64_tr_b16 v[132:133], v5 offset:16640
v_mfma_f32_16x16x32_bf16 a[252:255], v[156:159], v[76:79], a[252:255]
ds_read_b64_tr_b16 v[134:135], v5 offset:18688
s_waitcnt lgkmcnt(15)
v_mfma_f32_16x16x32_bf16 a[128:131], v[96:99], v[80:83], a[128:131]
ds_read_b64_tr_b16 v[136:137], v6 offset:16640
v_mfma_f32_16x16x32_bf16 a[136:139], v[96:99], v[84:87], a[136:139]
ds_read_b64_tr_b16 v[138:139], v6 offset:18688
v_mfma_f32_16x16x32_bf16 a[132:135], v[100:103], v[80:83], a[132:135]
ds_read_b64_tr_b16 v[140:141], v7 offset:16640
v_mfma_f32_16x16x32_bf16 a[140:143], v[100:103], v[84:87], a[140:143]
ds_read_b64_tr_b16 v[142:143], v7 offset:18688
s_waitcnt lgkmcnt(15)
v_mfma_f32_16x16x32_bf16 a[144:147], v[104:107], v[80:83], a[144:147]
ds_read_b64_tr_b16 v[144:145], v8 offset:16640
v_mfma_f32_16x16x32_bf16 a[152:155], v[104:107], v[84:87], a[152:155]
ds_read_b64_tr_b16 v[146:147], v8 offset:18688
v_mfma_f32_16x16x32_bf16 a[148:151], v[108:111], v[80:83], a[148:151]
ds_read_b64_tr_b16 v[148:149], v9 offset:16640
v_mfma_f32_16x16x32_bf16 a[156:159], v[108:111], v[84:87], a[156:159]
ds_read_b64_tr_b16 v[150:151], v9 offset:18688
s_waitcnt lgkmcnt(15)
v_mfma_f32_16x16x32_bf16 a[160:163], v[112:115], v[80:83], a[160:163]
ds_read_b64_tr_b16 v[152:153], v10 offset:16640
v_mfma_f32_16x16x32_bf16 a[168:171], v[112:115], v[84:87], a[168:171]
ds_read_b64_tr_b16 v[154:155], v10 offset:18688
v_mfma_f32_16x16x32_bf16 a[164:167], v[116:119], v[80:83], a[164:167]
ds_read_b64_tr_b16 v[156:157], v11 offset:16640
v_mfma_f32_16x16x32_bf16 a[172:175], v[116:119], v[84:87], a[172:175]
ds_read_b64_tr_b16 v[158:159], v11 offset:18688
s_waitcnt lgkmcnt(15)
v_mfma_f32_16x16x32_bf16 a[176:179], v[120:123], v[80:83], a[176:179]
v_mfma_f32_16x16x32_bf16 a[184:187], v[120:123], v[84:87], a[184:187]
v_mfma_f32_16x16x32_bf16 a[180:183], v[124:127], v[80:83], a[180:183]
v_mfma_f32_16x16x32_bf16 a[188:191], v[124:127], v[84:87], a[188:191]
s_waitcnt lgkmcnt(14)
v_mfma_f32_16x16x32_bf16 a[192:195], v[128:131], v[80:83], a[192:195]
v_mfma_f32_16x16x32_bf16 a[200:203], v[128:131], v[84:87], a[200:203]
s_waitcnt vmcnt(1) lgkmcnt(0)
s_barrier
s_waitcnt vmcnt(0)
v_cmp_ne_u32 vcc, s3, v31
s_nop 4
s_cbranch_vccz L_f_b1ok
s_mov_b32 s61, 0
L_poll_b1:
buffer_load_dword v31, v30, s[12:15], s71 offen sc1
s_waitcnt vmcnt(0)
v_cmp_ne_u32 vcc, s3, v31
s_nop 4
s_cbranch_vccz L_pollok_b1
s_add_u32 s61, s61, 1
s_sleep 1
s_cmp_lt_u32 s61, 400000
s_cbranch_scc1 L_poll_b1
L_pollok_b1:
L_f_b1ok:
ds_read_b128 v[56:59], v176 offset:0
ds_read_b128 v[60:63], v176 offset:2048
ds_read_b128 v[64:67], v177 offset:0
ds_read_b128 v[68:71], v177 offset:2048
v_mfma_f32_16x16x32_bf16 a[196:199], v[132:135], v[80:83], a[196:199]
ds_read_b64_tr_b16 v[96:97], v4 offset:32768
ds_read_b64_tr_b16 v[98:99], v4 offset:34816
v_mfma_f32_16x16x32_bf16 a[204:207], v[132:135], v[84:87], a[204:207]
ds_read_b64_tr_b16 v[100:101], v5 offset:32768
ds_read_b64_tr_b16 v[102:103], v5 offset:34816
v_mfma_f32_16x16x32_bf16 a[208:211], v[136:139], v[80:83], a[208:211]
ds_read_b64_tr_b16 v[104:105], v6 offset:32768
ds_read_b64_tr_b16 v[106:107], v6 offset:34816
v_mfma_f32_16x16x32_bf16 a[216:219], v[136:139], v[84:87], a[216:219]
ds_read_b64_tr_b16 v[108:109], v7 offset:32768
ds_read_b64_tr_b16 v[110:111], v7 offset:34816
s_waitcnt lgkmcnt(0)
s_barrier
s_lshl_b32 s61, s25, 3
s_mul_i32 s62, s16, 6
s_add_i32 s61, s61, s62
s_sub_i32 s61, s61, 16
s_lshl_b32 s63, s24, 17
s_mul_i32 s69, s16, 6144
s_add_i32 s62, s61, 0
s_max_i32 s64, s62, 0
s_lshl_b32 s64, s64, 10
s_add_u32 s64, s64, s63
s_cmp_ge_i32 s62, 0
s_cselect_b32 s64, s64, s30
s_add_u32 m0, s69, 114688
s_add_u32 s62, s64, 69206016
buffer_load_dwordx4 v1, s[12:15], s62 offen sc1 lds
s_add_u32 m0, s69, 139264
s_add_u32 s62, s64, 71303168
buffer_load_dwordx4 v1, s[12:15], s62 offen sc1 lds
s_add_i32 s62, s61, 1
s_max_i32 s64, s62, 0
s_lshl_b32 s64, s64, 10
s_add_u32 s64, s64, s63
s_cmp_ge_i32 s62, 0
s_cselect_b32 s64, s64, s30
s_add_u32 m0, s69, 115712
s_add_u32 s62, s64, 69206016
buffer_load_dwordx4 v1, s[12:15], s62 offen sc1 lds
s_add_u32 m0, s69, 140288
s_add_u32 s62, s64, 71303168
buffer_load_dwordx4 v1, s[12:15], s62 offen sc1 lds
s_add_i32 s62, s61, 2
s_max_i32 s64, s62, 0
s_lshl_b32 s64, s64, 10
s_add_u32 s64, s64, s63
s_cmp_ge_i32 s62, 0
s_cselect_b32 s64, s64, s30
s_add_u32 m0, s69, 116736
s_add_u32 s62, s64, 69206016
buffer_load_dwordx4 v1, s[12:15], s62 offen sc1 lds
s_add_u32 m0, s69, 141312
s_add_u32 s62, s64, 71303168
buffer_load_dwordx4 v1, s[12:15], s62 offen sc1 lds
s_add_i32 s62, s61, 3
s_max_i32 s64, s62, 0
s_lshl_b32 s64, s64, 10
s_add_u32 s64, s64, s63
s_cmp_ge_i32 s62, 0
s_cselect_b32 s64, s64, s30
s_add_u32 m0, s69, 117760
s_add_u32 s62, s64, 69206016
buffer_load_dwordx4 v1, s[12:15], s62 offen sc1 lds
s_add_u32 m0, s69, 142336
s_add_u32 s62, s64, 71303168
buffer_load_dwordx4 v1, s[12:15], s62 offen sc1 lds
s_add_i32 s62, s61, 4
s_max_i32 s64, s62, 0
s_lshl_b32 s64, s64, 10
s_add_u32 s64, s64, s63
s_cmp_ge_i32 s62, 0
s_cselect_b32 s64, s64, s30
s_add_u32 m0, s69, 118784
s_add_u32 s62, s64, 69206016
buffer_load_dwordx4 v1, s[12:15], s62 offen sc1 lds
s_add_u32 m0, s69, 143360
s_add_u32 s62, s64, 71303168
buffer_load_dwordx4 v1, s[12:15], s62 offen sc1 lds
s_add_i32 s62, s61, 5
s_max_i32 s64, s62, 0
s_lshl_b32 s64, s64, 10
s_add_u32 s64, s64, s63
s_cmp_ge_i32 s62, 0
s_cselect_b32 s64, s64, s30
s_add_u32 m0, s69, 119808
s_add_u32 s62, s64, 69206016
buffer_load_dwordx4 v1, s[12:15], s62 offen sc1 lds
s_add_u32 m0, s69, 144384
s_add_u32 s62, s64, 71303168
buffer_load_dwordx4 v1, s[12:15], s62 offen sc1 lds
v_mfma_f32_16x16x32_bf16 a[212:215], v[140:143], v[80:83], a[212:215]
ds_read_b64_tr_b16 v[112:113], v8 offset:32768
ds_read_b64_tr_b16 v[114:115], v8 offset:34816
v_mfma_f32_16x16x32_bf16 a[220:223], v[140:143], v[84:87], a[220:223]
ds_read_b64_tr_b16 v[116:117], v9 offset:32768
ds_read_b64_tr_b16 v[118:119], v9 offset:34816
v_mfma_f32_16x16x32_bf16 a[224:227], v[144:147], v[80:83], a[224:227]
ds_read_b64_tr_b16 v[120:121], v10 offset:32768
v_mfma_f32_16x16x32_bf16 a[232:235], v[144:147], v[84:87], a[232:235]
ds_read_b64_tr_b16 v[122:123], v10 offset:34816
v_mfma_f32_16x16x32_bf16 a[228:231], v[148:151], v[80:83], a[228:231]
ds_read_b64_tr_b16 v[124:125], v11 offset:32768
v_mfma_f32_16x16x32_bf16 a[236:239], v[148:151], v[84:87], a[236:239]
ds_read_b64_tr_b16 v[126:127], v11 offset:34816
v_mfma_f32_16x16x32_bf16 a[240:243], v[152:155], v[80:83], a[240:243]
ds_read_b64_tr_b16 v[128:129], v4 offset:33024
v_mfma_f32_16x16x32_bf16 a[248:251], v[152:155], v[84:87], a[248:251]
ds_read_b64_tr_b16 v[130:131], v4 offset:35072
v_mfma_f32_16x16x32_bf16 a[244:247], v[156:159], v[80:83], a[244:247]
ds_read_b64_tr_b16 v[132:133], v5 offset:33024
v_mfma_f32_16x16x32_bf16 a[252:255], v[156:159], v[84:87], a[252:255]
ds_read_b64_tr_b16 v[134:135], v5 offset:35072
v_mfma_f32_16x16x32_bf16 a[128:131], v[96:99], v[56:59], a[128:131]
ds_read_b64_tr_b16 v[136:137], v6 offset:33024
v_mfma_f32_16x16x32_bf16 a[136:139], v[96:99], v[60:63], a[136:139]
ds_read_b64_tr_b16 v[138:139], v6 offset:35072
v_mfma_f32_16x16x32_bf16 a[132:135], v[100:103], v[56:59], a[132:135]
ds_read_b64_tr_b16 v[140:141], v7 offset:33024
v_mfma_f32_16x16x32_bf16 a[140:143], v[100:103], v[60:63], a[140:143]
ds_read_b64_tr_b16 v[142:143], v7 offset:35072
v_mfma_f32_16x16x32_bf16 a[144:147], v[104:107], v[56:59], a[144:147]
ds_read_b64_tr_b16 v[144:145], v8 offset:33024
v_mfma_f32_16x16x32_bf16 a[152:155], v[104:107], v[60:63], a[152:155]
ds_read_b64_tr_b16 v[146:147], v8 offset:35072
v_mfma_f32_16x16x32_bf16 a[148:151], v[108:111], v[56:59], a[148:151]
ds_read_b64_tr_b16 v[148:149], v9 offset:33024
v_mfma_f32_16x16x32_bf16 a[156:159], v[108:111], v[60:63], a[156:159]
ds_read_b64_tr_b16 v[150:151], v9 offset:35072
s_waitcnt lgkmcnt(15)
v_mfma_f32_16x16x32_bf16 a[160:163], v[112:115], v[56:59], a[160:163]
ds_read_b64_tr_b16 v[152:153], v10 offset:33024
v_mfma_f32_16x16x32_bf16 a[168:171], v[112:115], v[60:63], a[168:171]
ds_read_b64_tr_b16 v[154:155], v10 offset:35072
v_mfma_f32_16x16x32_bf16 a[164:167], v[116:119], v[56:59], a[164:167]
ds_read_b64_tr_b16 v[156:157], v11 offset:33024
v_mfma_f32_16x16x32_bf16 a[172:175], v[116:119], v[60:63], a[172:175]
ds_read_b64_tr_b16 v[158:159], v11 offset:35072
s_waitcnt lgkmcnt(15)
v_mfma_f32_16x16x32_bf16 a[176:179], v[120:123], v[56:59], a[176:179]
ds_read_b64_tr_b16 v[96:97], v4 offset:49152
v_mfma_f32_16x16x32_bf16 a[184:187], v[120:123], v[60:63], a[184:187]
ds_read_b64_tr_b16 v[98:99], v4 offset:51200
v_mfma_f32_16x16x32_bf16 a[180:183], v[124:127], v[56:59], a[180:183]
ds_read_b64_tr_b16 v[100:101], v5 offset:49152
v_mfma_f32_16x16x32_bf16 a[188:191], v[124:127], v[60:63], a[188:191]
ds_read_b64_tr_b16 v[102:103], v5 offset:51200
s_waitcnt lgkmcnt(15)
v_mfma_f32_16x16x32_bf16 a[192:195], v[128:131], v[56:59], a[192:195]
ds_read_b64_tr_b16 v[104:105], v6 offset:49152
v_mfma_f32_16x16x32_bf16 a[200:203], v[128:131], v[60:63], a[200:203]
ds_read_b64_tr_b16 v[106:107], v6 offset:51200
v_mfma_f32_16x16x32_bf16 a[196:199], v[132:135], v[56:59], a[196:199]
ds_read_b64_tr_b16 v[108:109], v7 offset:49152
v_mfma_f32_16x16x32_bf16 a[204:207], v[132:135], v[60:63], a[204:207]
ds_read_b64_tr_b16 v[110:111], v7 offset:51200
s_waitcnt lgkmcnt(15)
v_mfma_f32_16x16x32_bf16 a[208:211], v[136:139], v[56:59], a[208:211]
ds_read_b64_tr_b16 v[112:113], v8 offset:49152
v_mfma_f32_16x16x32_bf16 a[216:219], v[136:139], v[60:63], a[216:219]
ds_read_b64_tr_b16 v[114:115], v8 offset:51200
v_mfma_f32_16x16x32_bf16 a[212:215], v[140:143], v[56:59], a[212:215]
ds_read_b64_tr_b16 v[116:117], v9 offset:49152
v_mfma_f32_16x16x32_bf16 a[220:223], v[140:143], v[60:63], a[220:223]
ds_read_b64_tr_b16 v[118:119], v9 offset:51200
s_waitcnt lgkmcnt(15)
v_mfma_f32_16x16x32_bf16 a[224:227], v[144:147], v[56:59], a[224:227]
ds_read_b64_tr_b16 v[120:121], v10 offset:49152
v_mfma_f32_16x16x32_bf16 a[232:235], v[144:147], v[60:63], a[232:235]
ds_read_b64_tr_b16 v[122:123], v10 offset:51200
v_mfma_f32_16x16x32_bf16 a[228:231], v[148:151], v[56:59], a[228:231]
ds_read_b64_tr_b16 v[124:125], v11 offset:49152
v_mfma_f32_16x16x32_bf16 a[236:239], v[148:151], v[60:63], a[236:239]
ds_read_b64_tr_b16 v[126:127], v11 offset:51200
s_waitcnt lgkmcnt(15)
v_mfma_f32_16x16x32_bf16 a[240:243], v[152:155], v[56:59], a[240:243]
ds_read_b64_tr_b16 v[128:129], v4 offset:49408
v_mfma_f32_16x16x32_bf16 a[248:251], v[152:155], v[60:63], a[248:251]
ds_read_b64_tr_b16 v[130:131], v4 offset:51456
v_mfma_f32_16x16x32_bf16 a[244:247], v[156:159], v[56:59], a[244:247]
ds_read_b64_tr_b16 v[132:133], v5 offset:49408
v_mfma_f32_16x16x32_bf16 a[252:255], v[156:159], v[60:63], a[252:255]
ds_read_b64_tr_b16 v[134:135], v5 offset:51456
s_waitcnt lgkmcnt(15)
v_mfma_f32_16x16x32_bf16 a[128:131], v[96:99], v[64:67], a[128:131]
ds_read_b64_tr_b16 v[136:137], v6 offset:49408
v_mfma_f32_16x16x32_bf16 a[136:139], v[96:99], v[68:71], a[136:139]
ds_read_b64_tr_b16 v[138:139], v6 offset:51456
v_mfma_f32_16x16x32_bf16 a[132:135], v[100:103], v[64:67], a[132:135]
ds_read_b64_tr_b16 v[140:141], v7 offset:49408
v_mfma_f32_16x16x32_bf16 a[140:143], v[100:103], v[68:71], a[140:143]
ds_read_b64_tr_b16 v[142:143], v7 offset:51456
s_waitcnt lgkmcnt(15)
v_mfma_f32_16x16x32_bf16 a[144:147], v[104:107], v[64:67], a[144:147]
ds_read_b64_tr_b16 v[144:145], v8 offset:49408
v_mfma_f32_16x16x32_bf16 a[152:155], v[104:107], v[68:71], a[152:155]
ds_read_b64_tr_b16 v[146:147], v8 offset:51456
v_mfma_f32_16x16x32_bf16 a[148:151], v[108:111], v[64:67], a[148:151]
ds_read_b64_tr_b16 v[148:149], v9 offset:49408
v_mfma_f32_16x16x32_bf16 a[156:159], v[108:111], v[68:71], a[156:159]
ds_read_b64_tr_b16 v[150:151], v9 offset:51456
s_waitcnt lgkmcnt(15)
v_mfma_f32_16x16x32_bf16 a[160:163], v[112:115], v[64:67], a[160:163]
ds_read_b64_tr_b16 v[152:153], v10 offset:49408
v_mfma_f32_16x16x32_bf16 a[168:171], v[112:115], v[68:71], a[168:171]
ds_read_b64_tr_b16 v[154:155], v10 offset:51456
v_mfma_f32_16x16x32_bf16 a[164:167], v[116:119], v[64:67], a[164:167]
ds_read_b64_tr_b16 v[156:157], v11 offset:49408
v_mfma_f32_16x16x32_bf16 a[172:175], v[116:119], v[68:71], a[172:175]
ds_read_b64_tr_b16 v[158:159], v11 offset:51456
s_waitcnt lgkmcnt(15)
v_mfma_f32_16x16x32_bf16 a[176:179], v[120:123], v[64:67], a[176:179]
v_mfma_f32_16x16x32_bf16 a[184:187], v[120:123], v[68:71], a[184:187]
v_mfma_f32_16x16x32_bf16 a[180:183], v[124:127], v[64:67], a[180:183]
v_mfma_f32_16x16x32_bf16 a[188:191], v[124:127], v[68:71], a[188:191]
s_waitcnt lgkmcnt(14)
v_mfma_f32_16x16x32_bf16 a[192:195], v[128:131], v[64:67], a[192:195]
v_mfma_f32_16x16x32_bf16 a[200:203], v[128:131], v[68:71], a[200:203]
s_waitcnt lgkmcnt(12)
v_mfma_f32_16x16x32_bf16 a[196:199], v[132:135], v[64:67], a[196:199]
v_mfma_f32_16x16x32_bf16 a[204:207], v[132:135], v[68:71], a[204:207]
s_waitcnt lgkmcnt(10)
v_mfma_f32_16x16x32_bf16 a[208:211], v[136:139], v[64:67], a[208:211]
v_mfma_f32_16x16x32_bf16 a[216:219], v[136:139], v[68:71], a[216:219]
s_waitcnt lgkmcnt(8)
v_mfma_f32_16x16x32_bf16 a[212:215], v[140:143], v[64:67], a[212:215]
v_mfma_f32_16x16x32_bf16 a[220:223], v[140:143], v[68:71], a[220:223]
s_waitcnt lgkmcnt(6)
v_mfma_f32_16x16x32_bf16 a[224:227], v[144:147], v[64:67], a[224:227]
v_mfma_f32_16x16x32_bf16 a[232:235], v[144:147], v[68:71], a[232:235]
s_waitcnt lgkmcnt(4)
v_mfma_f32_16x16x32_bf16 a[228:231], v[148:151], v[64:67], a[228:231]
v_mfma_f32_16x16x32_bf16 a[236:239], v[148:151], v[68:71], a[236:239]
s_waitcnt lgkmcnt(2)
v_mfma_f32_16x16x32_bf16 a[240:243], v[152:155], v[64:67], a[240:243]
v_mfma_f32_16x16x32_bf16 a[248:251], v[152:155], v[68:71], a[248:251]
s_waitcnt lgkmcnt(0)
v_mfma_f32_16x16x32_bf16 a[244:247], v[156:159], v[64:67], a[244:247]
v_mfma_f32_16x16x32_bf16 a[252:255], v[156:159], v[68:71], a[252:255]
v_and_b32 v252, 15, v0
v_lshlrev_b32 v252, 7, v252
s_lshl_b32 s71, s26, 11
s_add_u32 s71, s71, 104857600
buffer_load_dword v253, v252, s[12:15], s71 offen sc1
v_and_b32 v32, 63, v0
v_lshlrev_b32 v32, 7, v32
v_mov_b32 v34, 1920
v_min_u32 v34, v34, v32
s_mov_b32 s69, 105054208
s_mov_b32 s88, 105062400
s_mov_b32 s84, 105070592
buffer_load_dword v33, v32, s[12:15], s69 offen sc1
buffer_load_dword v35, v32, s[12:15], s88 offen sc1
buffer_load_dword v31, v34, s[12:15], s84 offen sc1
s_nop 7
s_mov_b32 s64, 0x3db8aa3b
s_lshl_b32 s61, s66, 3
s_lshl_b32 s62, s16, 1
s_add_u32 s61, s61, s62
s_lshl_b32 s61, s61, 13
s_lshl_b32 s62, s26, 20
s_add_u32 s61, s61, s62
s_add_u32 s61, s61, 33554432
s_cmp_eq_u32 s31, 0
s_cselect_b32 s61, s61, 0x7f000000
v_accvgpr_read_b32 v100, a128
v_accvgpr_read_b32 v101, a129
v_accvgpr_read_b32 v102, a130
v_accvgpr_read_b32 v103, a131
v_accvgpr_read_b32 v104, a132
v_accvgpr_read_b32 v105, a133
v_accvgpr_read_b32 v106, a134
v_accvgpr_read_b32 v107, a135
v_mul_f32 v100, s64, v100
v_mul_f32 v101, s64, v101
v_mul_f32 v102, s64, v102
v_mul_f32 v103, s64, v103
v_mul_f32 v104, s64, v104
v_mul_f32 v105, s64, v105
v_mul_f32 v106, s64, v106
v_mul_f32 v107, s64, v107
v_cvt_pk_bf16_f32 v108, v100, v101
v_cvt_pk_bf16_f32 v109, v102, v103
v_cvt_pk_bf16_f32 v110, v104, v105
v_cvt_pk_bf16_f32 v111, v106, v107
v_accvgpr_write_b32 a0, v108
v_accvgpr_write_b32 a1, v109
v_accvgpr_write_b32 a2, v110
v_accvgpr_write_b32 a3, v111
s_add_u32 s62, s61, 0
buffer_store_dwordx4 v[108:111], v1, s[12:15], s62 offen offset:0 sc1
v_accvgpr_read_b32 v112, a144
v_accvgpr_read_b32 v113, a145
v_accvgpr_read_b32 v114, a146
v_accvgpr_read_b32 v115, a147
v_accvgpr_read_b32 v116, a148
v_accvgpr_read_b32 v117, a149
v_accvgpr_read_b32 v118, a150
v_accvgpr_read_b32 v119, a151
v_mul_f32 v112, s64, v112
v_mul_f32 v113, s64, v113
v_mul_f32 v114, s64, v114
v_mul_f32 v115, s64, v115
v_mul_f32 v116, s64, v116
v_mul_f32 v117, s64, v117
v_mul_f32 v118, s64, v118
v_mul_f32 v119, s64, v119
v_cvt_pk_bf16_f32 v120, v112, v113
v_cvt_pk_bf16_f32 v121, v114, v115
v_cvt_pk_bf16_f32 v122, v116, v117
v_cvt_pk_bf16_f32 v123, v118, v119
v_accvgpr_write_b32 a4, v120
v_accvgpr_write_b32 a5, v121
v_accvgpr_write_b32 a6, v122
v_accvgpr_write_b32 a7, v123
buffer_store_dwordx4 v[120:123], v1, s[12:15], s62 offen offset:1024 sc1
v_accvgpr_read_b32 v100, a160
v_accvgpr_read_b32 v101, a161
v_accvgpr_read_b32 v102, a162
v_accvgpr_read_b32 v103, a163
v_accvgpr_read_b32 v104, a164
v_accvgpr_read_b32 v105, a165
v_accvgpr_read_b32 v106, a166
v_accvgpr_read_b32 v107, a167
v_mul_f32 v100, s64, v100
v_mul_f32 v101, s64, v101
v_mul_f32 v102, s64, v102
v_mul_f32 v103, s64, v103
v_mul_f32 v104, s64, v104
v_mul_f32 v105, s64, v105
v_mul_f32 v106, s64, v106
v_mul_f32 v107, s64, v107
v_cvt_pk_bf16_f32 v108, v100, v101
v_cvt_pk_bf16_f32 v109, v102, v103
v_cvt_pk_bf16_f32 v110, v104, v105
v_cvt_pk_bf16_f32 v111, v106, v107
v_accvgpr_write_b32 a8, v108
v_accvgpr_write_b32 a9, v109
v_accvgpr_write_b32 a10, v110
v_accvgpr_write_b32 a11, v111
buffer_store_dwordx4 v[108:111], v1, s[12:15], s62 offen offset:2048 sc1
v_accvgpr_read_b32 v112, a176
v_accvgpr_read_b32 v113, a177
v_accvgpr_read_b32 v114, a178
v_accvgpr_read_b32 v115, a179
v_accvgpr_read_b32 v116, a180
v_accvgpr_read_b32 v117, a181
v_accvgpr_read_b32 v118, a182
v_accvgpr_read_b32 v119, a183
v_mul_f32 v112, s64, v112
v_mul_f32 v113, s64, v113
v_mul_f32 v114, s64, v114
v_mul_f32 v115, s64, v115
v_mul_f32 v116, s64, v116
v_mul_f32 v117, s64, v117
v_mul_f32 v118, s64, v118
v_mul_f32 v119, s64, v119
v_cvt_pk_bf16_f32 v120, v112, v113
v_cvt_pk_bf16_f32 v121, v114, v115
v_cvt_pk_bf16_f32 v122, v116, v117
v_cvt_pk_bf16_f32 v123, v118, v119
v_accvgpr_write_b32 a12, v120
v_accvgpr_write_b32 a13, v121
v_accvgpr_write_b32 a14, v122
v_accvgpr_write_b32 a15, v123
buffer_store_dwordx4 v[120:123], v1, s[12:15], s62 offen offset:3072 sc1
v_accvgpr_read_b32 v100, a192
v_accvgpr_read_b32 v101, a193
v_accvgpr_read_b32 v102, a194
v_accvgpr_read_b32 v103, a195
v_accvgpr_read_b32 v104, a196
v_accvgpr_read_b32 v105, a197
v_accvgpr_read_b32 v106, a198
v_accvgpr_read_b32 v107, a199
v_mul_f32 v100, s64, v100
v_mul_f32 v101, s64, v101
v_mul_f32 v102, s64, v102
v_mul_f32 v103, s64, v103
v_mul_f32 v104, s64, v104
v_mul_f32 v105, s64, v105
v_mul_f32 v106, s64, v106
v_mul_f32 v107, s64, v107
v_cvt_pk_bf16_f32 v108, v100, v101
v_cvt_pk_bf16_f32 v109, v102, v103
v_cvt_pk_bf16_f32 v110, v104, v105
v_cvt_pk_bf16_f32 v111, v106, v107
v_accvgpr_write_b32 a16, v108
v_accvgpr_write_b32 a17, v109
v_accvgpr_write_b32 a18, v110
v_accvgpr_write_b32 a19, v111
s_add_u32 s62, s61, 4096
buffer_store_dwordx4 v[108:111], v1, s[12:15], s62 offen offset:0 sc1
v_accvgpr_read_b32 v112, a208
v_accvgpr_read_b32 v113, a209
v_accvgpr_read_b32 v114, a210
v_accvgpr_read_b32 v115, a211
v_accvgpr_read_b32 v116, a212
v_accvgpr_read_b32 v117, a213
v_accvgpr_read_b32 v118, a214
v_accvgpr_read_b32 v119, a215
v_mul_f32 v112, s64, v112
v_mul_f32 v113, s64, v113
v_mul_f32 v114, s64, v114
v_mul_f32 v115, s64, v115
v_mul_f32 v116, s64, v116
v_mul_f32 v117, s64, v117
v_mul_f32 v118, s64, v118
v_mul_f32 v119, s64, v119
v_cvt_pk_bf16_f32 v120, v112, v113
v_cvt_pk_bf16_f32 v121, v114, v115
v_cvt_pk_bf16_f32 v122, v116, v117
v_cvt_pk_bf16_f32 v123, v118, v119
v_accvgpr_write_b32 a20, v120
v_accvgpr_write_b32 a21, v121
v_accvgpr_write_b32 a22, v122
v_accvgpr_write_b32 a23, v123
buffer_store_dwordx4 v[120:123], v1, s[12:15], s62 offen offset:1024 sc1
v_accvgpr_read_b32 v100, a224
v_accvgpr_read_b32 v101, a225
v_accvgpr_read_b32 v102, a226
v_accvgpr_read_b32 v103, a227
v_accvgpr_read_b32 v104, a228
v_accvgpr_read_b32 v105, a229
v_accvgpr_read_b32 v106, a230
v_accvgpr_read_b32 v107, a231
v_mul_f32 v100, s64, v100
v_mul_f32 v101, s64, v101
v_mul_f32 v102, s64, v102
v_mul_f32 v103, s64, v103
v_mul_f32 v104, s64, v104
v_mul_f32 v105, s64, v105
v_mul_f32 v106, s64, v106
v_mul_f32 v107, s64, v107
v_cvt_pk_bf16_f32 v108, v100, v101
v_cvt_pk_bf16_f32 v109, v102, v103
v_cvt_pk_bf16_f32 v110, v104, v105
v_cvt_pk_bf16_f32 v111, v106, v107
v_accvgpr_write_b32 a24, v108
v_accvgpr_write_b32 a25, v109
v_accvgpr_write_b32 a26, v110
v_accvgpr_write_b32 a27, v111
buffer_store_dwordx4 v[108:111], v1, s[12:15], s62 offen offset:2048 sc1
v_accvgpr_read_b32 v112, a240
v_accvgpr_read_b32 v113, a241
v_accvgpr_read_b32 v114, a242
v_accvgpr_read_b32 v115, a243
v_accvgpr_read_b32 v116, a244
v_accvgpr_read_b32 v117, a245
v_accvgpr_read_b32 v118, a246
v_accvgpr_read_b32 v119, a247
v_mul_f32 v112, s64, v112
v_mul_f32 v113, s64, v113
v_mul_f32 v114, s64, v114
v_mul_f32 v115, s64, v115
v_mul_f32 v116, s64, v116
v_mul_f32 v117, s64, v117
v_mul_f32 v118, s64, v118
v_mul_f32 v119, s64, v119
v_cvt_pk_bf16_f32 v120, v112, v113
v_cvt_pk_bf16_f32 v121, v114, v115
v_cvt_pk_bf16_f32 v122, v116, v117
v_cvt_pk_bf16_f32 v123, v118, v119
v_accvgpr_write_b32 a28, v120
v_accvgpr_write_b32 a29, v121
v_accvgpr_write_b32 a30, v122
v_accvgpr_write_b32 a31, v123
buffer_store_dwordx4 v[120:123], v1, s[12:15], s62 offen offset:3072 sc1
v_accvgpr_read_b32 v100, a136
v_accvgpr_read_b32 v101, a137
v_accvgpr_read_b32 v102, a138
v_accvgpr_read_b32 v103, a139
v_accvgpr_read_b32 v104, a140
v_accvgpr_read_b32 v105, a141
v_accvgpr_read_b32 v106, a142
v_accvgpr_read_b32 v107, a143
v_mul_f32 v100, s64, v100
v_mul_f32 v101, s64, v101
v_mul_f32 v102, s64, v102
v_mul_f32 v103, s64, v103
v_mul_f32 v104, s64, v104
v_mul_f32 v105, s64, v105
v_mul_f32 v106, s64, v106
v_mul_f32 v107, s64, v107
v_cvt_pk_bf16_f32 v108, v100, v101
v_cvt_pk_bf16_f32 v109, v102, v103
v_cvt_pk_bf16_f32 v110, v104, v105
v_cvt_pk_bf16_f32 v111, v106, v107
v_accvgpr_write_b32 a32, v108
v_accvgpr_write_b32 a33, v109
v_accvgpr_write_b32 a34, v110
v_accvgpr_write_b32 a35, v111
s_add_u32 s62, s61, 8192
buffer_store_dwordx4 v[108:111], v1, s[12:15], s62 offen offset:0 sc1
v_accvgpr_read_b32 v112, a152
v_accvgpr_read_b32 v113, a153
v_accvgpr_read_b32 v114, a154
v_accvgpr_read_b32 v115, a155
v_accvgpr_read_b32 v116, a156
v_accvgpr_read_b32 v117, a157
v_accvgpr_read_b32 v118, a158
v_accvgpr_read_b32 v119, a159
v_mul_f32 v112, s64, v112
v_mul_f32 v113, s64, v113
v_mul_f32 v114, s64, v114
v_mul_f32 v115, s64, v115
v_mul_f32 v116, s64, v116
v_mul_f32 v117, s64, v117
v_mul_f32 v118, s64, v118
v_mul_f32 v119, s64, v119
v_cvt_pk_bf16_f32 v120, v112, v113
v_cvt_pk_bf16_f32 v121, v114, v115
v_cvt_pk_bf16_f32 v122, v116, v117
v_cvt_pk_bf16_f32 v123, v118, v119
v_accvgpr_write_b32 a36, v120
v_accvgpr_write_b32 a37, v121
v_accvgpr_write_b32 a38, v122
v_accvgpr_write_b32 a39, v123
buffer_store_dwordx4 v[120:123], v1, s[12:15], s62 offen offset:1024 sc1
v_accvgpr_read_b32 v100, a168
v_accvgpr_read_b32 v101, a169
v_accvgpr_read_b32 v102, a170
v_accvgpr_read_b32 v103, a171
v_accvgpr_read_b32 v104, a172
v_accvgpr_read_b32 v105, a173
v_accvgpr_read_b32 v106, a174
v_accvgpr_read_b32 v107, a175
v_mul_f32 v100, s64, v100
v_mul_f32 v101, s64, v101
v_mul_f32 v102, s64, v102
v_mul_f32 v103, s64, v103
v_mul_f32 v104, s64, v104
v_mul_f32 v105, s64, v105
v_mul_f32 v106, s64, v106
v_mul_f32 v107, s64, v107
v_cvt_pk_bf16_f32 v108, v100, v101
v_cvt_pk_bf16_f32 v109, v102, v103
v_cvt_pk_bf16_f32 v110, v104, v105
v_cvt_pk_bf16_f32 v111, v106, v107
v_accvgpr_write_b32 a40, v108
v_accvgpr_write_b32 a41, v109
v_accvgpr_write_b32 a42, v110
v_accvgpr_write_b32 a43, v111
buffer_store_dwordx4 v[108:111], v1, s[12:15], s62 offen offset:2048 sc1
v_accvgpr_read_b32 v112, a184
v_accvgpr_read_b32 v113, a185
v_accvgpr_read_b32 v114, a186
v_accvgpr_read_b32 v115, a187
v_accvgpr_read_b32 v116, a188
v_accvgpr_read_b32 v117, a189
v_accvgpr_read_b32 v118, a190
v_accvgpr_read_b32 v119, a191
v_mul_f32 v112, s64, v112
v_mul_f32 v113, s64, v113
v_mul_f32 v114, s64, v114
v_mul_f32 v115, s64, v115
v_mul_f32 v116, s64, v116
v_mul_f32 v117, s64, v117
v_mul_f32 v118, s64, v118
v_mul_f32 v119, s64, v119
v_cvt_pk_bf16_f32 v120, v112, v113
v_cvt_pk_bf16_f32 v121, v114, v115
v_cvt_pk_bf16_f32 v122, v116, v117
v_cvt_pk_bf16_f32 v123, v118, v119
v_accvgpr_write_b32 a44, v120
v_accvgpr_write_b32 a45, v121
v_accvgpr_write_b32 a46, v122
v_accvgpr_write_b32 a47, v123
buffer_store_dwordx4 v[120:123], v1, s[12:15], s62 offen offset:3072 sc1
v_accvgpr_read_b32 v100, a200
v_accvgpr_read_b32 v101, a201
v_accvgpr_read_b32 v102, a202
v_accvgpr_read_b32 v103, a203
v_accvgpr_read_b32 v104, a204
v_accvgpr_read_b32 v105, a205
v_accvgpr_read_b32 v106, a206
v_accvgpr_read_b32 v107, a207
v_mul_f32 v100, s64, v100
v_mul_f32 v101, s64, v101
v_mul_f32 v102, s64, v102
v_mul_f32 v103, s64, v103
v_mul_f32 v104, s64, v104
v_mul_f32 v105, s64, v105
v_mul_f32 v106, s64, v106
v_mul_f32 v107, s64, v107
v_cvt_pk_bf16_f32 v108, v100, v101
v_cvt_pk_bf16_f32 v109, v102, v103
v_cvt_pk_bf16_f32 v110, v104, v105
v_cvt_pk_bf16_f32 v111, v106, v107
v_accvgpr_write_b32 a48, v108
v_accvgpr_write_b32 a49, v109
v_accvgpr_write_b32 a50, v110
v_accvgpr_write_b32 a51, v111
s_add_u32 s62, s61, 12288
buffer_store_dwordx4 v[108:111], v1, s[12:15], s62 offen offset:0 sc1
v_accvgpr_read_b32 v112, a216
v_accvgpr_read_b32 v113, a217
v_accvgpr_read_b32 v114, a218
v_accvgpr_read_b32 v115, a219
v_accvgpr_read_b32 v116, a220
v_accvgpr_read_b32 v117, a221
v_accvgpr_read_b32 v118, a222
v_accvgpr_read_b32 v119, a223
v_mul_f32 v112, s64, v112
v_mul_f32 v113, s64, v113
v_mul_f32 v114, s64, v114
v_mul_f32 v115, s64, v115
v_mul_f32 v116, s64, v116
v_mul_f32 v117, s64, v117
v_mul_f32 v118, s64, v118
v_mul_f32 v119, s64, v119
v_cvt_pk_bf16_f32 v120, v112, v113
v_cvt_pk_bf16_f32 v121, v114, v115
v_cvt_pk_bf16_f32 v122, v116, v117
v_cvt_pk_bf16_f32 v123, v118, v119
v_accvgpr_write_b32 a52, v120
v_accvgpr_write_b32 a53, v121
v_accvgpr_write_b32 a54, v122
v_accvgpr_write_b32 a55, v123
buffer_store_dwordx4 v[120:123], v1, s[12:15], s62 offen offset:1024 sc1
v_accvgpr_read_b32 v100, a232
v_accvgpr_read_b32 v101, a233
v_accvgpr_read_b32 v102, a234
v_accvgpr_read_b32 v103, a235
v_accvgpr_read_b32 v104, a236
v_accvgpr_read_b32 v105, a237
v_accvgpr_read_b32 v106, a238
v_accvgpr_read_b32 v107, a239
v_mul_f32 v100, s64, v100
v_mul_f32 v101, s64, v101
v_mul_f32 v102, s64, v102
v_mul_f32 v103, s64, v103
v_mul_f32 v104, s64, v104
v_mul_f32 v105, s64, v105
v_mul_f32 v106, s64, v106
v_mul_f32 v107, s64, v107
v_cvt_pk_bf16_f32 v108, v100, v101
v_cvt_pk_bf16_f32 v109, v102, v103
v_cvt_pk_bf16_f32 v110, v104, v105
v_cvt_pk_bf16_f32 v111, v106, v107
v_accvgpr_write_b32 a56, v108
v_accvgpr_write_b32 a57, v109
v_accvgpr_write_b32 a58, v110
v_accvgpr_write_b32 a59, v111
buffer_store_dwordx4 v[108:111], v1, s[12:15], s62 offen offset:2048 sc1
v_accvgpr_read_b32 v112, a248
v_accvgpr_read_b32 v113, a249
v_accvgpr_read_b32 v114, a250
v_accvgpr_read_b32 v115, a251
v_accvgpr_read_b32 v116, a252
v_accvgpr_read_b32 v117, a253
v_accvgpr_read_b32 v118, a254
v_accvgpr_read_b32 v119, a255
v_mul_f32 v112, s64, v112
v_mul_f32 v113, s64, v113
v_mul_f32 v114, s64, v114
v_mul_f32 v115, s64, v115
v_mul_f32 v116, s64, v116
v_mul_f32 v117, s64, v117
v_mul_f32 v118, s64, v118
v_mul_f32 v119, s64, v119
v_cvt_pk_bf16_f32 v120, v112, v113
v_cvt_pk_bf16_f32 v121, v114, v115
v_cvt_pk_bf16_f32 v122, v116, v117
v_cvt_pk_bf16_f32 v123, v118, v119
v_accvgpr_write_b32 a60, v120
v_accvgpr_write_b32 a61, v121
v_accvgpr_write_b32 a62, v122
v_accvgpr_write_b32 a63, v123
buffer_store_dwordx4 v[120:123], v1, s[12:15], s62 offen offset:3072 sc1
s_waitcnt vmcnt(16)
v_cmp_ne_u32 vcc, s3, v33
s_nop 4
s_cbranch_vccz L_f_ok_woa
s_mov_b32 s61, 0
L_poll_woa:
buffer_load_dword v33, v32, s[12:15], s69 offen sc1
s_waitcnt vmcnt(0)
v_cmp_ne_u32 vcc, s3, v33
s_nop 4
s_cbranch_vccz L_pollok_woa
s_add_u32 s61, s61, 1
s_sleep 1
s_cmp_lt_u32 s61, 400000
s_cbranch_scc1 L_poll_woa
L_pollok_woa:
L_f_ok_woa:
v_cmp_ne_u32 vcc, s3, v35
s_nop 4
s_cbranch_vccz L_f_ok_wob2
s_mov_b32 s61, 0
L_poll_wob2:
buffer_load_dword v35, v32, s[12:15], s88 offen sc1
s_waitcnt vmcnt(0)
v_cmp_ne_u32 vcc, s3, v35
s_nop 4
s_cbranch_vccz L_pollok_wob2
s_add_u32 s61, s61, 1
s_sleep 1
s_cmp_lt_u32 s61, 400000
s_cbranch_scc1 L_poll_wob2
L_pollok_wob2:
L_f_ok_wob2:
v_cmp_ne_u32 vcc, s3, v31
s_nop 4
s_cbranch_vccz L_f_ok_woc
s_mov_b32 s61, 0
L_poll_woc:
buffer_load_dword v31, v34, s[12:15], s84 offen sc1
s_waitcnt vmcnt(0)
v_cmp_ne_u32 vcc, s3, v31
s_nop 4
s_cbranch_vccz L_pollok_woc
s_add_u32 s61, s61, 1
s_sleep 1
s_cmp_lt_u32 s61, 400000
s_cbranch_scc1 L_poll_woc
L_pollok_woc:
L_f_ok_woc:
v_cmp_ne_u32 vcc, s3, v253
s_nop 4
s_cbranch_vccz L_f_kvok
s_mov_b32 s61, 0
L_poll_kv:
buffer_load_dword v253, v252, s[12:15], s71 offen sc1
s_waitcnt vmcnt(0)
v_cmp_ne_u32 vcc, s3, v253
s_nop 4
s_cbranch_vccz L_pollok_kv
s_add_u32 s61, s61, 1
s_sleep 1
s_cmp_lt_u32 s61, 400000
s_cbranch_scc1 L_poll_kv
L_pollok_kv:
L_f_kvok:
s_mov_b32 s62, 0x7f000000
v_accvgpr_write_b32 a200, v244
v_accvgpr_write_b32 a201, v245
v_accvgpr_write_b32 a202, v246
v_accvgpr_write_b32 a203, v247
v_accvgpr_write_b32 a204, v248
v_accvgpr_write_b32 a205, v249
v_accvgpr_write_b32 a206, v250
v_accvgpr_write_b32 a207, v251
s_mov_b32 s4, s54
s_mov_b32 s5, s55
s_mov_b32 s6, 16777216
s_mov_b32 s7, 0x20000
s_add_u32 s8, s54, 16777216
s_addc_u32 s9, s55, 0
s_mov_b32 s10, 16777216
s_mov_b32 s11, 0x20000
s_and_b32 s56, s2, 7
s_lshr_b32 s57, s2, 3
s_lshl_b32 s17, s56, 1
s_and_b32 s58, s57, 1
s_add_u32 s17, s17, s58
s_lshr_b32 s57, s57, 1
s_and_b32 s18, s57, 1
s_lshr_b32 s19, s57, 1
v_and_b32 v9, 63, v0
v_lshlrev_b32 v1, 4, v9
s_lshl_b32 s56, s16, 12
v_add_u32 v6, s56, v1
v_subrev_u32 v5, s56, v1
v_add_u32 v5, 0x10000, v5
v_and_b32 v10, 15, v9
v_lshrrev_b32 v11, 4, v9
v_lshlrev_b32 v11, 2, v11
v_sub_u32 v7, v10, v11
v_add_u32 v8, 16, v7
v_mov_b32 v72, 0x3f803f80
v_mov_b32 v73, 0x3f803f80
v_mov_b32 v74, 0x3f803f80
v_mov_b32 v75, 0x3f803f80
s_sub_u32 s30, 15, s19
s_add_u32 s57, s30, 1
s_lshl_b32 s57, s57, 2
s_sub_u32 s59, s57, 34
s_lshl_b32 s58, s17, 20
s_cmp_eq_u32 s18, 0
s_cbranch_scc0 L_k2_roleS
s_mov_b32 s27, s59
s_mov_b32 s29, s57
s_lshl_b32 s20, s59, 14
s_add_u32 s20, s20, s58
s_mov_b32 s22, 34
s_mov_b32 s23, s62
s_mov_b32 s24, 1000
s_mov_b32 s65, 2
s_branch L_k2_roledone
L_k2_roleS:
s_mov_b32 s27, 0
s_mov_b32 s29, s59
s_mov_b32 s20, s58
s_mov_b32 s22, s59
s_mov_b32 s23, s58
s_add_u32 s61, s19, 1
s_lshl_b32 s61, s61, 2
s_mov_b32 s24, s61
s_mov_b32 s65, 1
L_k2_roledone:
s_mov_b32 s88, 0
s_mov_b32 s89, 0
s_sub_u32 s90, s29, 1
s_cmp_eq_u32 s65, 2
s_cselect_b32 s90, s90, -1
s_lshl_b32 s98, s17, 3
s_add_u32 s98, s98, s19
s_lshl_b32 s98, s98, 7
s_add_u32 s97, s98, 104955904
s_add_u32 s99, s98, 104923136
v_mov_b32 v114, 0
s_cmp_eq_u32 s18, 0
s_cbranch_scc1 L_k2_nocopy
v_accvgpr_mov_b32 a64, a0
v_accvgpr_mov_b32 a65, a1
v_accvgpr_mov_b32 a66, a2
v_accvgpr_mov_b32 a67, a3
v_accvgpr_mov_b32 a68, a4
v_accvgpr_mov_b32 a69, a5
v_accvgpr_mov_b32 a70, a6
v_accvgpr_mov_b32 a71, a7
v_accvgpr_mov_b32 a72, a8
v_accvgpr_mov_b32 a73, a9
v_accvgpr_mov_b32 a74, a10
v_accvgpr_mov_b32 a75, a11
v_accvgpr_mov_b32 a76, a12
v_accvgpr_mov_b32 a77, a13
v_accvgpr_mov_b32 a78, a14
v_accvgpr_mov_b32 a79, a15
v_accvgpr_mov_b32 a80, a16
v_accvgpr_mov_b32 a81, a17
v_accvgpr_mov_b32 a82, a18
v_accvgpr_mov_b32 a83, a19
v_accvgpr_mov_b32 a84, a20
v_accvgpr_mov_b32 a85, a21
v_accvgpr_mov_b32 a86, a22
v_accvgpr_mov_b32 a87, a23
v_accvgpr_mov_b32 a88, a24
v_accvgpr_mov_b32 a89, a25
v_accvgpr_mov_b32 a90, a26
v_accvgpr_mov_b32 a91, a27
v_accvgpr_mov_b32 a92, a28
v_accvgpr_mov_b32 a93, a29
v_accvgpr_mov_b32 a94, a30
v_accvgpr_mov_b32 a95, a31
v_accvgpr_mov_b32 a96, a32
v_accvgpr_mov_b32 a97, a33
v_accvgpr_mov_b32 a98, a34
v_accvgpr_mov_b32 a99, a35
v_accvgpr_mov_b32 a100, a36
v_accvgpr_mov_b32 a101, a37
v_accvgpr_mov_b32 a102, a38
v_accvgpr_mov_b32 a103, a39
v_accvgpr_mov_b32 a104, a40
v_accvgpr_mov_b32 a105, a41
v_accvgpr_mov_b32 a106, a42
v_accvgpr_mov_b32 a107, a43
v_accvgpr_mov_b32 a108, a44
v_accvgpr_mov_b32 a109, a45
v_accvgpr_mov_b32 a110, a46
v_accvgpr_mov_b32 a111, a47
v_accvgpr_mov_b32 a112, a48
v_accvgpr_mov_b32 a113, a49
v_accvgpr_mov_b32 a114, a50
v_accvgpr_mov_b32 a115, a51
v_accvgpr_mov_b32 a116, a52
v_accvgpr_mov_b32 a117, a53
v_accvgpr_mov_b32 a118, a54
v_accvgpr_mov_b32 a119, a55
v_accvgpr_mov_b32 a120, a56
v_accvgpr_mov_b32 a121, a57
v_accvgpr_mov_b32 a122, a58
v_accvgpr_mov_b32 a123, a59
v_accvgpr_mov_b32 a124, a60
v_accvgpr_mov_b32 a125, a61
v_accvgpr_mov_b32 a126, a62
v_accvgpr_mov_b32 a127, a63
L_k2_nocopy:
s_mov_b32 s31, 0
s_lshl_b32 s68, s16, 12
s_lshr_b32 s69, s2, 4
s_and_b32 s70, s2, 7
s_lshl_b32 s70, s70, 1
s_bfe_u32 s56, s2, 0x10003
s_add_u32 s70, s70, s56
s_lshl_b32 s70, s70, 2
s_add_u32 s70, s70, s16
s_lshl_b32 s71, s69, 17
s_lshl_b32 s56, s70, 11
s_add_u32 s71, s71, s56
v_mov_b32 v76, 0xff800000
v_mov_b32 v77, 0
s_cmp_ge_u32 s70, 8
s_cselect_b32 s72, 0, 0xff800000
s_cmp_ge_u32 s70, 7
s_cselect_b32 s73, 0, 0xff800000
s_cmp_ge_u32 s70, 6
s_cselect_b32 s74, 0, 0xff800000
s_cmp_ge_u32 s70, 5
s_cselect_b32 s75, 0, 0xff800000
s_cmp_ge_u32 s70, 4
s_cselect_b32 s76, 0, 0xff800000
s_cmp_ge_u32 s70, 3
s_cselect_b32 s77, 0, 0xff800000
s_cmp_ge_u32 s70, 2
s_cselect_b32 s78, 0, 0xff800000
s_cmp_ge_u32 s70, 1
s_cselect_b32 s79, 0, 0xff800000
v_cmp_gt_i32 s[80:81], 0, v7
v_cmp_gt_i32 s[82:83], 1, v7
v_cmp_gt_i32 s[84:85], 2, v7
v_cmp_gt_i32 s[86:87], 3, v7
s_nop 0
v_cndmask_b32 v16, v77, v76, s[80:81]
v_cndmask_b32 v32, v76, v77, s[80:81]
v_cndmask_b32 v17, v77, v76, s[82:83]
v_cndmask_b32 v33, v76, v77, s[82:83]
v_cndmask_b32 v18, v77, v76, s[84:85]
v_cndmask_b32 v34, v76, v77, s[84:85]
v_cndmask_b32 v19, v77, v76, s[86:87]
v_cndmask_b32 v35, v76, v77, s[86:87]
v_cmp_gt_i32 s[80:81], 0, v8
v_cmp_gt_i32 s[82:83], 1, v8
v_cmp_gt_i32 s[84:85], 2, v8
v_cmp_gt_i32 s[86:87], 3, v8
s_nop 0
v_cndmask_b32 v20, v77, v76, s[80:81]
v_cndmask_b32 v36, v76, v77, s[80:81]
v_cndmask_b32 v21, v77, v76, s[82:83]
v_cndmask_b32 v37, v76, v77, s[82:83]
v_cndmask_b32 v22, v77, v76, s[84:85]
v_cndmask_b32 v38, v76, v77, s[84:85]
v_cndmask_b32 v23, v77, v76, s[86:87]
v_cndmask_b32 v39, v76, v77, s[86:87]
v_cmp_gt_i32 s[80:81], 16, v7
v_cmp_gt_i32 s[82:83], 17, v7
v_cmp_gt_i32 s[84:85], 18, v7
v_cmp_gt_i32 s[86:87], 19, v7
s_nop 0
v_cndmask_b32 v24, v77, v76, s[80:81]
v_cndmask_b32 v40, v76, v77, s[80:81]
v_cndmask_b32 v25, v77, v76, s[82:83]
v_cndmask_b32 v41, v76, v77, s[82:83]
v_cndmask_b32 v26, v77, v76, s[84:85]
v_cndmask_b32 v42, v76, v77, s[84:85]
v_cndmask_b32 v27, v77, v76, s[86:87]
v_cndmask_b32 v43, v76, v77, s[86:87]
v_cmp_gt_i32 s[80:81], 16, v8
v_cmp_gt_i32 s[82:83], 17, v8
v_cmp_gt_i32 s[84:85], 18, v8
v_cmp_gt_i32 s[86:87], 19, v8
s_nop 0
v_cndmask_b32 v28, v77, v76, s[80:81]
v_cndmask_b32 v44, v76, v77, s[80:81]
v_cndmask_b32 v29, v77, v76, s[82:83]
v_cndmask_b32 v45, v76, v77, s[82:83]
v_cndmask_b32 v30, v77, v76, s[84:85]
v_cndmask_b32 v46, v76, v77, s[84:85]
v_cndmask_b32 v31, v77, v76, s[86:87]
v_cndmask_b32 v47, v76, v77, s[86:87]
v_add_f32 v32, s72, v32
v_add_f32 v33, s72, v33
v_add_f32 v34, s72, v34
v_add_f32 v35, s72, v35
v_add_f32 v36, s72, v36
v_add_f32 v37, s72, v37
v_add_f32 v38, s72, v38
v_add_f32 v39, s72, v39
v_add_f32 v40, s72, v40
v_add_f32 v41, s72, v41
v_add_f32 v42, s72, v42
v_add_f32 v43, s72, v43
v_add_f32 v44, s72, v44
v_add_f32 v45, s72, v45
v_add_f32 v46, s72, v46
v_add_f32 v47, s72, v47
v_mov_b32 v48, s73
v_mov_b32 v49, s73
v_mov_b32 v50, s73
v_mov_b32 v51, s73
v_mov_b32 v52, s74
v_mov_b32 v53, s74
v_mov_b32 v54, s74
v_mov_b32 v55, s74
v_mov_b32 v56, s75
v_mov_b32 v57, s75
v_mov_b32 v58, s75
v_mov_b32 v59, s75
v_mov_b32 v60, s76
v_mov_b32 v61, s76
v_mov_b32 v62, s76
v_mov_b32 v63, s76
v_mov_b32 v64, s77
v_mov_b32 v65, s77
v_mov_b32 v66, s77
v_mov_b32 v67, s77
v_mov_b32 v68, s78
v_mov_b32 v69, s78
v_mov_b32 v70, s78
v_mov_b32 v71, s78
v_mov_b32 v100, s79
v_mov_b32 v101, s79
v_mov_b32 v102, s79
v_mov_b32 v103, s79
s_mov_b32 s72, s20
s_add_u32 s57, s20, 16384
s_sub_u32 s22, s22, 1
s_cmp_eq_u32 s22, 0
s_cselect_b32 s57, s23, s57
s_cselect_b32 s22, s24, s22
s_cselect_b32 s23, s62, s23
s_add_u32 s58, s57, 16384
s_sub_u32 s22, s22, 1
s_cmp_eq_u32 s22, 0
s_cselect_b32 s58, s23, s58
s_cselect_b32 s22, s24, s22
s_cselect_b32 s23, s62, s23
s_add_u32 s59, s58, 16384
s_sub_u32 s22, s22, 1
s_cmp_eq_u32 s22, 0
s_cselect_b32 s59, s23, s59
s_cselect_b32 s22, s24, s22
s_cselect_b32 s23, s62, s23
s_mov_b32 s21, s59
s_mov_b32 s73, s57
s_mov_b32 s74, s58
s_add_u32 s20, s21, 16384
s_sub_u32 s22, s22, 1
s_cmp_eq_u32 s22, 0
s_cselect_b32 s20, s23, s20
s_cselect_b32 s22, s24, s22
s_cselect_b32 s23, s62, s23
s_lshl_b32 s96, s30, 3
s_lshl_b32 s56, s16, 1
s_add_u32 s96, s96, s56
s_lshl_b32 s96, s96, 13
s_lshl_b32 s56, s17, 20
s_add_u32 s96, s96, s56
s_add_u32 s96, s96, 33554432
s_waitcnt vmcnt(0)
s_barrier
s_cmp_eq_u32 s18, 0
s_cbranch_scc0 L_k2_noqsig
s_cmp_lg_u32 s16, 0
s_cbranch_scc1 L_k2_qsig
v_mov_b32 v115, 0
v_mov_b32 v116, s3
s_mov_b64 exec, 1
buffer_store_dword v116, v115, s[12:15], s99 offen sc1
s_mov_b64 exec, -1
L_k2_qsig:
L_k2_noqsig:
v_mov_b32 v115, 0
buffer_load_dword v116, v115, s[12:15], s99 offen sc1
s_lshl_b32 s56, s16, 11
s_add_u32 s56, s56, 114688
v_add_u32 v14, s56, v1
ds_read_b128 a[128:131], v14 offset:0
ds_read_b128 a[132:135], v14 offset:1024
ds_read_b128 a[136:139], v14 offset:2048
ds_read_b128 a[140:143], v14 offset:3072
ds_read_b128 a[144:147], v14 offset:4096
ds_read_b128 a[148:151], v14 offset:5120
ds_read_b128 a[152:155], v14 offset:6144
ds_read_b128 a[156:159], v14 offset:7168
ds_read_b128 a[160:163], v14 offset:8192
ds_read_b128 a[164:167], v14 offset:9216
ds_read_b128 a[168:171], v14 offset:10240
ds_read_b128 a[172:175], v14 offset:11264
ds_read_b128 a[176:179], v14 offset:12288
ds_read_b128 a[180:183], v14 offset:13312
ds_read_b128 a[184:187], v14 offset:14336
ds_read_b128 a[188:191], v14 offset:15360
ds_read_b128 a[192:195], v14 offset:16384
ds_read_b128 a[196:199], v14 offset:17408
s_waitcnt lgkmcnt(0)
v_mfma_f32_16x16x32_bf16 v[128:131], a[128:131], a[200:203], v[32:35]
v_mfma_f32_16x16x32_bf16 v[132:135], a[128:131], a[204:207], v[36:39]
v_mfma_f32_16x16x32_bf16 v[136:139], a[132:135], a[200:203], v[40:43]
v_mfma_f32_16x16x32_bf16 v[140:143], a[132:135], a[204:207], v[44:47]
v_mfma_f32_16x16x32_bf16 v[144:147], a[136:139], a[200:203], v[48:51]
v_mfma_f32_16x16x32_bf16 v[148:151], a[136:139], a[204:207], v[48:51]
v_mfma_f32_16x16x32_bf16 v[152:155], a[140:143], a[200:203], v[48:51]
v_mfma_f32_16x16x32_bf16 v[156:159], a[140:143], a[204:207], v[48:51]
v_mfma_f32_16x16x32_bf16 v[160:163], a[144:147], a[200:203], v[52:55]
v_mfma_f32_16x16x32_bf16 v[164:167], a[144:147], a[204:207], v[52:55]
v_mfma_f32_16x16x32_bf16 v[168:171], a[148:151], a[200:203], v[52:55]
v_mfma_f32_16x16x32_bf16 v[172:175], a[148:151], a[204:207], v[52:55]
v_mfma_f32_16x16x32_bf16 v[176:179], a[152:155], a[200:203], v[56:59]
v_mfma_f32_16x16x32_bf16 v[180:183], a[152:155], a[204:207], v[56:59]
v_mfma_f32_16x16x32_bf16 v[184:187], a[156:159], a[200:203], v[56:59]
v_mfma_f32_16x16x32_bf16 v[188:191], a[156:159], a[204:207], v[56:59]
v_mfma_f32_16x16x32_bf16 v[192:195], a[160:163], a[200:203], v[60:63]
v_mfma_f32_16x16x32_bf16 v[196:199], a[160:163], a[204:207], v[60:63]
v_mfma_f32_16x16x32_bf16 v[200:203], a[164:167], a[200:203], v[60:63]
v_mfma_f32_16x16x32_bf16 v[204:207], a[164:167], a[204:207], v[60:63]
v_mfma_f32_16x16x32_bf16 v[208:211], a[168:171], a[200:203], v[64:67]
v_mfma_f32_16x16x32_bf16 v[212:215], a[168:171], a[204:207], v[64:67]
v_mfma_f32_16x16x32_bf16 v[216:219], a[172:175], a[200:203], v[64:67]
v_mfma_f32_16x16x32_bf16 v[220:223], a[172:175], a[204:207], v[64:67]
v_mfma_f32_16x16x32_bf16 v[224:227], a[176:179], a[200:203], v[68:71]
s_add_u32 m0, s68, 0
v_mfma_f32_16x16x32_bf16 v[228:231], a[176:179], a[204:207], v[68:71]
v_mfma_f32_16x16x32_bf16 v[232:235], a[180:183], a[200:203], v[68:71]
v_mfma_f32_16x16x32_bf16 v[236:239], a[180:183], a[204:207], v[68:71]
v_mfma_f32_16x16x32_bf16 v[240:243], a[184:187], a[200:203], v[100:103]
v_mfma_f32_16x16x32_bf16 v[244:247], a[184:187], a[204:207], v[100:103]
v_mfma_f32_16x16x32_bf16 v[248:251], a[188:191], a[200:203], v[100:103]
v_mfma_f32_16x16x32_bf16 v[252:255], a[188:191], a[204:207], v[100:103]
v_mfma_f32_16x16x32_bf16 v[84:87], a[192:195], a[200:203], v[16:19]
v_mfma_f32_16x16x32_bf16 v[88:91], a[192:195], a[204:207], v[20:23]
v_mfma_f32_16x16x32_bf16 v[92:95], a[196:199], a[200:203], v[24:27]
v_mfma_f32_16x16x32_bf16 v[96:99], a[196:199], a[204:207], v[28:31]
s_lshl_b32 s56, s16, 11
s_add_u32 s56, s56, 139264
v_add_u32 v14, s56, v1
ds_read_b128 a[128:131], v14 offset:0
ds_read_b128 a[132:135], v14 offset:1024
ds_read_b128 a[136:139], v14 offset:2048
ds_read_b128 a[140:143], v14 offset:3072
ds_read_b128 a[144:147], v14 offset:4096
ds_read_b128 a[148:151], v14 offset:5120
ds_read_b128 a[152:155], v14 offset:6144
ds_read_b128 a[156:159], v14 offset:7168
ds_read_b128 a[160:163], v14 offset:8192
ds_read_b128 a[164:167], v14 offset:9216
ds_read_b128 a[168:171], v14 offset:10240
buffer_load_dwordx4 v6, s[4:7], s72 offen offset:0 sc1 lds
ds_read_b128 a[172:175], v14 offset:11264
ds_read_b128 a[176:179], v14 offset:12288
ds_read_b128 a[180:183], v14 offset:13312
ds_read_b128 a[184:187], v14 offset:14336
ds_read_b128 a[188:191], v14 offset:15360
ds_read_b128 a[192:195], v14 offset:16384
ds_read_b128 a[196:199], v14 offset:17408
s_nop 7
v_max3_f32 v9, v128, v129, v130
v_max3_f32 v11, v132, v133, v134
v_max3_f32 v10, v131, v136, v137
v_max3_f32 v12, v135, v140, v141
v_max3_f32 v9, v9, v138, v139
v_max3_f32 v11, v11, v142, v143
v_max3_f32 v10, v10, v144, v145
v_max3_f32 v12, v12, v148, v149
v_max3_f32 v9, v9, v146, v147
v_max3_f32 v11, v11, v150, v151
v_max3_f32 v10, v10, v152, v153
v_max3_f32 v12, v12, v156, v157
v_max3_f32 v9, v9, v154, v155
v_max3_f32 v11, v11, v158, v159
v_max3_f32 v10, v10, v160, v161
v_max3_f32 v12, v12, v164, v165
v_max3_f32 v9, v9, v162, v163
buffer_load_dwordx4 v6, s[4:7], s72 offen offset:1024 sc1 lds
v_max3_f32 v11, v11, v166, v167
v_max3_f32 v10, v10, v168, v169
v_max3_f32 v12, v12, v172, v173
v_max3_f32 v9, v9, v170, v171
v_max3_f32 v11, v11, v174, v175
v_max3_f32 v10, v10, v176, v177
v_max3_f32 v12, v12, v180, v181
v_max3_f32 v9, v9, v178, v179
v_max3_f32 v11, v11, v182, v183
v_max3_f32 v10, v10, v184, v185
v_max3_f32 v12, v12, v188, v189
v_max3_f32 v9, v9, v186, v187
v_max3_f32 v11, v11, v190, v191
v_max3_f32 v10, v10, v192, v193
v_max3_f32 v12, v12, v196, v197
v_max3_f32 v9, v9, v194, v195
v_max3_f32 v11, v11, v198, v199
v_max3_f32 v10, v10, v200, v201
v_max3_f32 v12, v12, v204, v205
v_max3_f32 v9, v9, v202, v203
v_max3_f32 v11, v11, v206, v207
v_max3_f32 v10, v10, v208, v209
v_max3_f32 v12, v12, v212, v213
v_max3_f32 v9, v9, v210, v211
v_max3_f32 v11, v11, v214, v215
buffer_load_dwordx4 v6, s[4:7], s72 offen offset:2048 sc1 lds
v_max3_f32 v10, v10, v216, v217
v_max3_f32 v12, v12, v220, v221
v_max3_f32 v9, v9, v218, v219
v_max3_f32 v11, v11, v222, v223
v_max3_f32 v10, v10, v224, v225
v_max3_f32 v12, v12, v228, v229
v_max3_f32 v9, v9, v226, v227
v_max3_f32 v11, v11, v230, v231
v_max3_f32 v10, v10, v232, v233
v_max3_f32 v12, v12, v236, v237
v_max3_f32 v9, v9, v234, v235
v_max3_f32 v11, v11, v238, v239
v_max3_f32 v10, v10, v240, v241
v_max3_f32 v12, v12, v244, v245
v_max3_f32 v9, v9, v242, v243
v_max3_f32 v11, v11, v246, v247
v_max3_f32 v10, v10, v248, v249
v_max3_f32 v12, v12, v252, v253
v_max3_f32 v9, v9, v250, v251
v_max3_f32 v11, v11, v254, v255
v_max3_f32 v10, v10, v84, v85
v_max3_f32 v12, v12, v88, v89
v_max3_f32 v9, v9, v86, v87
v_max3_f32 v11, v11, v90, v91
v_max3_f32 v10, v10, v92, v93
buffer_load_dwordx4 v6, s[4:7], s72 offen offset:3072 sc1 lds
v_max3_f32 v12, v12, v96, v97
v_max3_f32 v9, v9, v94, v95
v_max3_f32 v11, v11, v98, v99
v_max_f32 v9, v9, v10
v_max_f32 v11, v11, v12
v_mov_b32 v10, v9
v_mov_b32 v12, v11
s_nop 0
v_permlane32_swap_b32 v9, v10
v_permlane32_swap_b32 v11, v12
s_nop 0
v_max_f32 v9, v9, v10
v_max_f32 v11, v11, v12
v_mov_b32 v10, v9
v_mov_b32 v12, v11
s_nop 0
v_permlane16_swap_b32 v9, v10
v_permlane16_swap_b32 v11, v12
s_nop 0
v_max_f32 v9, v9, v10
v_max_f32 v11, v11, v12
v_mov_b32 v78, v9
v_mov_b32 v79, v9
v_mov_b32 v82, v11
v_mov_b32 v83, v11
s_waitcnt lgkmcnt(0)
s_cmp_eq_u32 s18, 0
s_cbranch_scc1 L_k2_noq2
s_waitcnt vmcnt(4)
v_cmp_ne_u32 vcc, s3, v116
s_nop 4
s_cbranch_vccz L_k2_qok
s_mov_b32 s67, 0
L_poll_q:
buffer_load_dword v116, v115, s[12:15], s99 offen sc1
s_waitcnt vmcnt(0)
v_cmp_ne_u32 vcc, s3, v116
s_nop 4
s_cbranch_vccz L_pollok_q
s_add_u32 s67, s67, 1
s_sleep 1
s_cmp_lt_u32 s67, 400000
s_cbranch_scc1 L_poll_q
L_pollok_q:
L_k2_qok:
s_lshl_b32 s56, s30, 3
s_lshl_b32 s57, s16, 1
s_add_u32 s56, s56, s57
s_lshl_b32 s56, s56, 13
s_lshl_b32 s57, s17, 20
s_add_u32 s56, s56, s57
s_add_u32 s56, s56, 33554432
buffer_load_dwordx4 a[0:3], v1, s[12:15], s56 offen offset:0 sc1
buffer_load_dwordx4 a[4:7], v1, s[12:15], s56 offen offset:1024 sc1
buffer_load_dwordx4 a[8:11], v1, s[12:15], s56 offen offset:2048 sc1
buffer_load_dwordx4 a[12:15], v1, s[12:15], s56 offen offset:3072 sc1
s_add_u32 s56, s56, 4096
buffer_load_dwordx4 a[16:19], v1, s[12:15], s56 offen offset:0 sc1
buffer_load_dwordx4 a[20:23], v1, s[12:15], s56 offen offset:1024 sc1
buffer_load_dwordx4 a[24:27], v1, s[12:15], s56 offen offset:2048 sc1
buffer_load_dwordx4 a[28:31], v1, s[12:15], s56 offen offset:3072 sc1
s_add_u32 s56, s56, 4096
buffer_load_dwordx4 a[32:35], v1, s[12:15], s56 offen offset:0 sc1
buffer_load_dwordx4 a[36:39], v1, s[12:15], s56 offen offset:1024 sc1
buffer_load_dwordx4 a[40:43], v1, s[12:15], s56 offen offset:2048 sc1
buffer_load_dwordx4 a[44:47], v1, s[12:15], s56 offen offset:3072 sc1
s_add_u32 s56, s56, 4096
buffer_load_dwordx4 a[48:51], v1, s[12:15], s56 offen offset:0 sc1
buffer_load_dwordx4 a[52:55], v1, s[12:15], s56 offen offset:1024 sc1
buffer_load_dwordx4 a[56:59], v1, s[12:15], s56 offen offset:2048 sc1
buffer_load_dwordx4 a[60:63], v1, s[12:15], s56 offen offset:3072 sc1
L_k2_noq2:
v_pk_add_f32 v[128:129], v[128:129], v[78:79] neg_lo:[0,1] neg_hi:[0,1]
v_pk_add_f32 v[130:131], v[130:131], v[78:79] neg_lo:[0,1] neg_hi:[0,1]
v_pk_add_f32 v[136:137], v[136:137], v[78:79] neg_lo:[0,1] neg_hi:[0,1]
v_pk_add_f32 v[138:139], v[138:139], v[78:79] neg_lo:[0,1] neg_hi:[0,1]
v_pk_add_f32 v[132:133], v[132:133], v[82:83] neg_lo:[0,1] neg_hi:[0,1]
v_pk_add_f32 v[134:135], v[134:135], v[82:83] neg_lo:[0,1] neg_hi:[0,1]
v_pk_add_f32 v[140:141], v[140:141], v[82:83] neg_lo:[0,1] neg_hi:[0,1]
v_pk_add_f32 v[142:143], v[142:143], v[82:83] neg_lo:[0,1] neg_hi:[0,1]
v_exp_f32 v128, v128
v_exp_f32 v129, v129
v_exp_f32 v130, v130
v_exp_f32 v131, v131
v_exp_f32 v136, v136
v_exp_f32 v137, v137
v_exp_f32 v138, v138
v_exp_f32 v139, v139
v_exp_f32 v132, v132
v_exp_f32 v133, v133
v_exp_f32 v134, v134
v_exp_f32 v135, v135
v_exp_f32 v140, v140
s_add_u32 m0, s68, 16384
v_exp_f32 v141, v141
v_exp_f32 v142, v142
v_exp_f32 v143, v143
v_cvt_pk_bf16_f32 v48, v128, v129
v_cvt_pk_bf16_f32 v49, v130, v131
v_cvt_pk_bf16_f32 v50, v136, v137
v_cvt_pk_bf16_f32 v51, v138, v139
v_cvt_pk_bf16_f32 v52, v132, v133
v_cvt_pk_bf16_f32 v53, v134, v135
v_cvt_pk_bf16_f32 v54, v140, v141
v_cvt_pk_bf16_f32 v55, v142, v143
v_pk_add_f32 v[144:145], v[144:145], v[78:79] neg_lo:[0,1] neg_hi:[0,1]
v_pk_add_f32 v[146:147], v[146:147], v[78:79] neg_lo:[0,1] neg_hi:[0,1]
v_mfma_f32_16x16x32_bf16 v[16:19], a[128:131], v[48:51], 0
v_pk_add_f32 v[152:153], v[152:153], v[78:79] neg_lo:[0,1] neg_hi:[0,1]
v_pk_add_f32 v[154:155], v[154:155], v[78:79] neg_lo:[0,1] neg_hi:[0,1]
v_pk_add_f32 v[148:149], v[148:149], v[82:83] neg_lo:[0,1] neg_hi:[0,1]
v_pk_add_f32 v[150:151], v[150:151], v[82:83] neg_lo:[0,1] neg_hi:[0,1]
v_pk_add_f32 v[156:157], v[156:157], v[82:83] neg_lo:[0,1] neg_hi:[0,1]
v_mfma_f32_16x16x32_bf16 v[24:27], a[132:135], v[48:51], 0
v_pk_add_f32 v[158:159], v[158:159], v[82:83] neg_lo:[0,1] neg_hi:[0,1]
buffer_load_dwordx4 v6, s[4:7], s73 offen offset:0 sc1 lds
v_exp_f32 v144, v144
v_exp_f32 v145, v145
v_exp_f32 v146, v146
v_exp_f32 v147, v147
v_mfma_f32_16x16x32_bf16 v[32:35], v[72:75], v[48:51], 0
v_exp_f32 v152, v152
v_exp_f32 v153, v153
v_exp_f32 v154, v154
v_exp_f32 v155, v155
v_exp_f32 v148, v148
v_mfma_f32_16x16x32_bf16 v[20:23], a[128:131], v[52:55], 0
v_exp_f32 v149, v149
v_exp_f32 v150, v150
v_exp_f32 v151, v151
v_exp_f32 v156, v156
v_exp_f32 v157, v157
v_mfma_f32_16x16x32_bf16 v[28:31], a[132:135], v[52:55], 0
v_exp_f32 v158, v158
v_exp_f32 v159, v159
v_cvt_pk_bf16_f32 v56, v144, v145
v_cvt_pk_bf16_f32 v57, v146, v147
buffer_load_dwordx4 v6, s[4:7], s73 offen offset:1024 sc1 lds
v_cvt_pk_bf16_f32 v58, v152, v153
v_mfma_f32_16x16x32_bf16 v[36:39], v[72:75], v[52:55], 0
v_cvt_pk_bf16_f32 v59, v154, v155
v_cvt_pk_bf16_f32 v60, v148, v149
v_cvt_pk_bf16_f32 v61, v150, v151
v_cvt_pk_bf16_f32 v62, v156, v157
v_cvt_pk_bf16_f32 v63, v158, v159
v_pk_add_f32 v[160:161], v[160:161], v[78:79] neg_lo:[0,1] neg_hi:[0,1]
v_pk_add_f32 v[162:163], v[162:163], v[78:79] neg_lo:[0,1] neg_hi:[0,1]
v_mfma_f32_16x16x32_bf16 v[16:19], a[136:139], v[56:59], v[16:19]
v_pk_add_f32 v[168:169], v[168:169], v[78:79] neg_lo:[0,1] neg_hi:[0,1]
v_pk_add_f32 v[170:171], v[170:171], v[78:79] neg_lo:[0,1] neg_hi:[0,1]
v_pk_add_f32 v[164:165], v[164:165], v[82:83] neg_lo:[0,1] neg_hi:[0,1]
v_pk_add_f32 v[166:167], v[166:167], v[82:83] neg_lo:[0,1] neg_hi:[0,1]
v_pk_add_f32 v[172:173], v[172:173], v[82:83] neg_lo:[0,1] neg_hi:[0,1]
v_mfma_f32_16x16x32_bf16 v[24:27], a[140:143], v[56:59], v[24:27]
v_pk_add_f32 v[174:175], v[174:175], v[82:83] neg_lo:[0,1] neg_hi:[0,1]
v_exp_f32 v160, v160
v_exp_f32 v161, v161
v_exp_f32 v162, v162
v_exp_f32 v163, v163
buffer_load_dwordx4 v6, s[4:7], s73 offen offset:2048 sc1 lds
v_mfma_f32_16x16x32_bf16 v[32:35], v[72:75], v[56:59], v[32:35]
v_exp_f32 v168, v168
v_exp_f32 v169, v169
v_exp_f32 v170, v170
v_exp_f32 v171, v171
v_exp_f32 v164, v164
v_mfma_f32_16x16x32_bf16 v[20:23], a[136:139], v[60:63], v[20:23]
v_exp_f32 v165, v165
v_exp_f32 v166, v166
v_exp_f32 v167, v167
v_exp_f32 v172, v172
v_exp_f32 v173, v173
v_mfma_f32_16x16x32_bf16 v[28:31], a[140:143], v[60:63], v[28:31]
v_exp_f32 v174, v174
v_exp_f32 v175, v175
v_cvt_pk_bf16_f32 v48, v160, v161
v_cvt_pk_bf16_f32 v49, v162, v163
v_cvt_pk_bf16_f32 v50, v168, v169
v_mfma_f32_16x16x32_bf16 v[36:39], v[72:75], v[60:63], v[36:39]
v_cvt_pk_bf16_f32 v51, v170, v171
v_cvt_pk_bf16_f32 v52, v164, v165
buffer_load_dwordx4 v6, s[4:7], s73 offen offset:3072 sc1 lds
v_cvt_pk_bf16_f32 v53, v166, v167
v_cvt_pk_bf16_f32 v54, v172, v173
v_cvt_pk_bf16_f32 v55, v174, v175
v_pk_add_f32 v[176:177], v[176:177], v[78:79] neg_lo:[0,1] neg_hi:[0,1]
v_pk_add_f32 v[178:179], v[178:179], v[78:79] neg_lo:[0,1] neg_hi:[0,1]
v_mfma_f32_16x16x32_bf16 v[16:19], a[144:147], v[48:51], v[16:19]
v_pk_add_f32 v[184:185], v[184:185], v[78:79] neg_lo:[0,1] neg_hi:[0,1]
v_pk_add_f32 v[186:187], v[186:187], v[78:79] neg_lo:[0,1] neg_hi:[0,1]
v_pk_add_f32 v[180:181], v[180:181], v[82:83] neg_lo:[0,1] neg_hi:[0,1]
v_pk_add_f32 v[182:183], v[182:183], v[82:83] neg_lo:[0,1] neg_hi:[0,1]
v_pk_add_f32 v[188:189], v[188:189], v[82:83] neg_lo:[0,1] neg_hi:[0,1]
v_mfma_f32_16x16x32_bf16 v[24:27], a[148:151], v[48:51], v[24:27]
v_pk_add_f32 v[190:191], v[190:191], v[82:83] neg_lo:[0,1] neg_hi:[0,1]
v_exp_f32 v176, v176
v_exp_f32 v177, v177
v_exp_f32 v178, v178
v_exp_f32 v179, v179
v_mfma_f32_16x16x32_bf16 v[32:35], v[72:75], v[48:51], v[32:35]
v_exp_f32 v184, v184
v_exp_f32 v185, v185
v_exp_f32 v186, v186
s_add_u32 m0, s68, 65536
v_exp_f32 v187, v187
v_exp_f32 v180, v180
v_mfma_f32_16x16x32_bf16 v[20:23], a[144:147], v[52:55], v[20:23]
v_exp_f32 v181, v181
v_exp_f32 v182, v182
v_exp_f32 v183, v183
v_exp_f32 v188, v188
v_exp_f32 v189, v189
v_mfma_f32_16x16x32_bf16 v[28:31], a[148:151], v[52:55], v[28:31]
v_exp_f32 v190, v190
v_exp_f32 v191, v191
v_cvt_pk_bf16_f32 v56, v176, v177
v_cvt_pk_bf16_f32 v57, v178, v179
v_cvt_pk_bf16_f32 v58, v184, v185
v_mfma_f32_16x16x32_bf16 v[36:39], v[72:75], v[52:55], v[36:39]
v_cvt_pk_bf16_f32 v59, v186, v187
v_cvt_pk_bf16_f32 v60, v180, v181
v_cvt_pk_bf16_f32 v61, v182, v183
v_cvt_pk_bf16_f32 v62, v188, v189
v_cvt_pk_bf16_f32 v63, v190, v191
v_pk_add_f32 v[192:193], v[192:193], v[78:79] neg_lo:[0,1] neg_hi:[0,1]
buffer_load_dwordx4 v6, s[8:11], s72 offen offset:0 sc1 lds
v_pk_add_f32 v[194:195], v[194:195], v[78:79] neg_lo:[0,1] neg_hi:[0,1]
v_mfma_f32_16x16x32_bf16 v[16:19], a[152:155], v[56:59], v[16:19]
v_pk_add_f32 v[200:201], v[200:201], v[78:79] neg_lo:[0,1] neg_hi:[0,1]
v_pk_add_f32 v[202:203], v[202:203], v[78:79] neg_lo:[0,1] neg_hi:[0,1]
v_pk_add_f32 v[196:197], v[196:197], v[82:83] neg_lo:[0,1] neg_hi:[0,1]
v_pk_add_f32 v[198:199], v[198:199], v[82:83] neg_lo:[0,1] neg_hi:[0,1]
v_pk_add_f32 v[204:205], v[204:205], v[82:83] neg_lo:[0,1] neg_hi:[0,1]
v_mfma_f32_16x16x32_bf16 v[24:27], a[156:159], v[56:59], v[24:27]
v_pk_add_f32 v[206:207], v[206:207], v[82:83] neg_lo:[0,1] neg_hi:[0,1]
v_exp_f32 v192, v192
v_exp_f32 v193, v193
v_exp_f32 v194, v194
v_exp_f32 v195, v195
v_mfma_f32_16x16x32_bf16 v[32:35], v[72:75], v[56:59], v[32:35]
v_exp_f32 v200, v200
v_exp_f32 v201, v201
v_exp_f32 v202, v202
v_exp_f32 v203, v203
v_exp_f32 v196, v196
v_mfma_f32_16x16x32_bf16 v[20:23], a[152:155], v[60:63], v[20:23]
v_exp_f32 v197, v197
buffer_load_dwordx4 v6, s[8:11], s72 offen offset:1024 sc1 lds
v_exp_f32 v198, v198
v_exp_f32 v199, v199
v_exp_f32 v204, v204
v_exp_f32 v205, v205
v_mfma_f32_16x16x32_bf16 v[28:31], a[156:159], v[60:63], v[28:31]
v_exp_f32 v206, v206
v_exp_f32 v207, v207
v_cvt_pk_bf16_f32 v48, v192, v193
v_cvt_pk_bf16_f32 v49, v194, v195
v_cvt_pk_bf16_f32 v50, v200, v201
v_mfma_f32_16x16x32_bf16 v[36:39], v[72:75], v[60:63], v[36:39]
v_cvt_pk_bf16_f32 v51, v202, v203
v_cvt_pk_bf16_f32 v52, v196, v197
v_cvt_pk_bf16_f32 v53, v198, v199
v_cvt_pk_bf16_f32 v54, v204, v205
v_cvt_pk_bf16_f32 v55, v206, v207
v_pk_add_f32 v[208:209], v[208:209], v[78:79] neg_lo:[0,1] neg_hi:[0,1]
v_pk_add_f32 v[210:211], v[210:211], v[78:79] neg_lo:[0,1] neg_hi:[0,1]
v_mfma_f32_16x16x32_bf16 v[16:19], a[160:163], v[48:51], v[16:19]
v_pk_add_f32 v[216:217], v[216:217], v[78:79] neg_lo:[0,1] neg_hi:[0,1]
v_pk_add_f32 v[218:219], v[218:219], v[78:79] neg_lo:[0,1] neg_hi:[0,1]
buffer_load_dwordx4 v6, s[8:11], s72 offen offset:2048 sc1 lds
v_pk_add_f32 v[212:213], v[212:213], v[82:83] neg_lo:[0,1] neg_hi:[0,1]
v_pk_add_f32 v[214:215], v[214:215], v[82:83] neg_lo:[0,1] neg_hi:[0,1]
v_pk_add_f32 v[220:221], v[220:221], v[82:83] neg_lo:[0,1] neg_hi:[0,1]
v_mfma_f32_16x16x32_bf16 v[24:27], a[164:167], v[48:51], v[24:27]
v_pk_add_f32 v[222:223], v[222:223], v[82:83] neg_lo:[0,1] neg_hi:[0,1]
v_exp_f32 v208, v208
v_exp_f32 v209, v209
v_exp_f32 v210, v210
v_exp_f32 v211, v211
v_mfma_f32_16x16x32_bf16 v[32:35], v[72:75], v[48:51], v[32:35]
v_exp_f32 v216, v216
v_exp_f32 v217, v217
v_exp_f32 v218, v218
v_exp_f32 v219, v219
v_exp_f32 v212, v212
v_mfma_f32_16x16x32_bf16 v[20:23], a[160:163], v[52:55], v[20:23]
v_exp_f32 v213, v213
v_exp_f32 v214, v214
v_exp_f32 v215, v215
v_exp_f32 v220, v220
v_exp_f32 v221, v221
buffer_load_dwordx4 v6, s[8:11], s72 offen offset:3072 sc1 lds
v_mfma_f32_16x16x32_bf16 v[28:31], a[164:167], v[52:55], v[28:31]
v_exp_f32 v222, v222
v_exp_f32 v223, v223
v_cvt_pk_bf16_f32 v56, v208, v209
v_cvt_pk_bf16_f32 v57, v210, v211
v_cvt_pk_bf16_f32 v58, v216, v217
v_mfma_f32_16x16x32_bf16 v[36:39], v[72:75], v[52:55], v[36:39]
v_cvt_pk_bf16_f32 v59, v218, v219
v_cvt_pk_bf16_f32 v60, v212, v213
v_cvt_pk_bf16_f32 v61, v214, v215
v_cvt_pk_bf16_f32 v62, v220, v221
v_cvt_pk_bf16_f32 v63, v222, v223
v_pk_add_f32 v[224:225], v[224:225], v[78:79] neg_lo:[0,1] neg_hi:[0,1]
v_pk_add_f32 v[226:227], v[226:227], v[78:79] neg_lo:[0,1] neg_hi:[0,1]
v_mfma_f32_16x16x32_bf16 v[16:19], a[168:171], v[56:59], v[16:19]
v_pk_add_f32 v[232:233], v[232:233], v[78:79] neg_lo:[0,1] neg_hi:[0,1]
v_pk_add_f32 v[234:235], v[234:235], v[78:79] neg_lo:[0,1] neg_hi:[0,1]
v_pk_add_f32 v[228:229], v[228:229], v[82:83] neg_lo:[0,1] neg_hi:[0,1]
v_pk_add_f32 v[230:231], v[230:231], v[82:83] neg_lo:[0,1] neg_hi:[0,1]
v_pk_add_f32 v[236:237], v[236:237], v[82:83] neg_lo:[0,1] neg_hi:[0,1]
v_mfma_f32_16x16x32_bf16 v[24:27], a[172:175], v[56:59], v[24:27]
s_add_u32 m0, s68, 32768
v_pk_add_f32 v[238:239], v[238:239], v[82:83] neg_lo:[0,1] neg_hi:[0,1]
v_exp_f32 v224, v224
v_exp_f32 v225, v225
v_exp_f32 v226, v226
v_exp_f32 v227, v227
v_mfma_f32_16x16x32_bf16 v[32:35], v[72:75], v[56:59], v[32:35]
v_exp_f32 v232, v232
v_exp_f32 v233, v233
v_exp_f32 v234, v234
v_exp_f32 v235, v235
v_exp_f32 v228, v228
v_mfma_f32_16x16x32_bf16 v[20:23], a[168:171], v[60:63], v[20:23]
v_exp_f32 v229, v229
v_exp_f32 v230, v230
v_exp_f32 v231, v231
v_exp_f32 v236, v236
v_exp_f32 v237, v237
v_mfma_f32_16x16x32_bf16 v[28:31], a[172:175], v[60:63], v[28:31]
v_exp_f32 v238, v238
v_exp_f32 v239, v239
v_cvt_pk_bf16_f32 v48, v224, v225
buffer_load_dwordx4 v6, s[4:7], s74 offen offset:0 sc1 lds
v_cvt_pk_bf16_f32 v49, v226, v227
v_cvt_pk_bf16_f32 v50, v232, v233
v_mfma_f32_16x16x32_bf16 v[36:39], v[72:75], v[60:63], v[36:39]
v_cvt_pk_bf16_f32 v51, v234, v235
v_cvt_pk_bf16_f32 v52, v228, v229
v_cvt_pk_bf16_f32 v53, v230, v231
v_cvt_pk_bf16_f32 v54, v236, v237
v_cvt_pk_bf16_f32 v55, v238, v239
v_pk_add_f32 v[240:241], v[240:241], v[78:79] neg_lo:[0,1] neg_hi:[0,1]
v_pk_add_f32 v[242:243], v[242:243], v[78:79] neg_lo:[0,1] neg_hi:[0,1]
v_mfma_f32_16x16x32_bf16 v[16:19], a[176:179], v[48:51], v[16:19]
v_pk_add_f32 v[248:249], v[248:249], v[78:79] neg_lo:[0,1] neg_hi:[0,1]
v_pk_add_f32 v[250:251], v[250:251], v[78:79] neg_lo:[0,1] neg_hi:[0,1]
v_pk_add_f32 v[244:245], v[244:245], v[82:83] neg_lo:[0,1] neg_hi:[0,1]
v_pk_add_f32 v[246:247], v[246:247], v[82:83] neg_lo:[0,1] neg_hi:[0,1]
v_pk_add_f32 v[252:253], v[252:253], v[82:83] neg_lo:[0,1] neg_hi:[0,1]
v_mfma_f32_16x16x32_bf16 v[24:27], a[180:183], v[48:51], v[24:27]
v_pk_add_f32 v[254:255], v[254:255], v[82:83] neg_lo:[0,1] neg_hi:[0,1]
v_exp_f32 v240, v240
v_exp_f32 v241, v241
v_exp_f32 v242, v242
buffer_load_dwordx4 v6, s[4:7], s74 offen offset:1024 sc1 lds
v_exp_f32 v243, v243
v_mfma_f32_16x16x32_bf16 v[32:35], v[72:75], v[48:51], v[32:35]
v_exp_f32 v248, v248
v_exp_f32 v249, v249
v_exp_f32 v250, v250
v_exp_f32 v251, v251
v_exp_f32 v244, v244
v_mfma_f32_16x16x32_bf16 v[20:23], a[176:179], v[52:55], v[20:23]
v_exp_f32 v245, v245
v_exp_f32 v246, v246
v_exp_f32 v247, v247
v_exp_f32 v252, v252
v_exp_f32 v253, v253
v_mfma_f32_16x16x32_bf16 v[28:31], a[180:183], v[52:55], v[28:31]
v_exp_f32 v254, v254
v_exp_f32 v255, v255
v_cvt_pk_bf16_f32 v56, v240, v241
v_cvt_pk_bf16_f32 v57, v242, v243
v_cvt_pk_bf16_f32 v58, v248, v249
v_mfma_f32_16x16x32_bf16 v[36:39], v[72:75], v[52:55], v[36:39]
v_cvt_pk_bf16_f32 v59, v250, v251
buffer_load_dwordx4 v6, s[4:7], s74 offen offset:2048 sc1 lds
v_cvt_pk_bf16_f32 v60, v244, v245
v_cvt_pk_bf16_f32 v61, v246, v247
v_cvt_pk_bf16_f32 v62, v252, v253
v_cvt_pk_bf16_f32 v63, v254, v255
v_pk_add_f32 v[84:85], v[84:85], v[78:79] neg_lo:[0,1] neg_hi:[0,1]
v_pk_add_f32 v[86:87], v[86:87], v[78:79] neg_lo:[0,1] neg_hi:[0,1]
v_mfma_f32_16x16x32_bf16 v[16:19], a[184:187], v[56:59], v[16:19]
v_pk_add_f32 v[92:93], v[92:93], v[78:79] neg_lo:[0,1] neg_hi:[0,1]
v_pk_add_f32 v[94:95], v[94:95], v[78:79] neg_lo:[0,1] neg_hi:[0,1]
v_pk_add_f32 v[88:89], v[88:89], v[82:83] neg_lo:[0,1] neg_hi:[0,1]
v_pk_add_f32 v[90:91], v[90:91], v[82:83] neg_lo:[0,1] neg_hi:[0,1]
v_pk_add_f32 v[96:97], v[96:97], v[82:83] neg_lo:[0,1] neg_hi:[0,1]
v_mfma_f32_16x16x32_bf16 v[24:27], a[188:191], v[56:59], v[24:27]
v_pk_add_f32 v[98:99], v[98:99], v[82:83] neg_lo:[0,1] neg_hi:[0,1]
v_exp_f32 v84, v84
v_exp_f32 v85, v85
v_exp_f32 v86, v86
v_exp_f32 v87, v87
v_mfma_f32_16x16x32_bf16 v[32:35], v[72:75], v[56:59], v[32:35]
v_exp_f32 v92, v92
v_exp_f32 v93, v93
buffer_load_dwordx4 v6, s[4:7], s74 offen offset:3072 sc1 lds
v_exp_f32 v94, v94
v_exp_f32 v95, v95
v_exp_f32 v88, v88
v_mfma_f32_16x16x32_bf16 v[20:23], a[184:187], v[60:63], v[20:23]
v_exp_f32 v89, v89
v_exp_f32 v90, v90
v_exp_f32 v91, v91
v_exp_f32 v96, v96
v_exp_f32 v97, v97
v_mfma_f32_16x16x32_bf16 v[28:31], a[188:191], v[60:63], v[28:31]
v_exp_f32 v98, v98
v_exp_f32 v99, v99
v_cvt_pk_bf16_f32 v48, v84, v85
v_cvt_pk_bf16_f32 v49, v86, v87
v_cvt_pk_bf16_f32 v50, v92, v93
v_mfma_f32_16x16x32_bf16 v[36:39], v[72:75], v[60:63], v[36:39]
v_cvt_pk_bf16_f32 v51, v94, v95
v_cvt_pk_bf16_f32 v52, v88, v89
v_cvt_pk_bf16_f32 v53, v90, v91
v_cvt_pk_bf16_f32 v54, v96, v97
v_cvt_pk_bf16_f32 v55, v98, v99
s_nop 1
v_mfma_f32_16x16x32_bf16 v[16:19], a[192:195], v[48:51], v[16:19]
v_mfma_f32_16x16x32_bf16 v[24:27], a[196:199], v[48:51], v[24:27]
v_mfma_f32_16x16x32_bf16 v[32:35], v[72:75], v[48:51], v[32:35]
v_mfma_f32_16x16x32_bf16 v[20:23], a[192:195], v[52:55], v[20:23]
v_mfma_f32_16x16x32_bf16 v[28:31], a[196:199], v[52:55], v[28:31]
v_mfma_f32_16x16x32_bf16 v[36:39], v[72:75], v[52:55], v[36:39]
s_nop 7
v_cmp_gt_u32 vcc, 768, v1
s_lshl_b32 s59, s70, 5
s_add_u32 s59, s59, s69
s_lshl_b32 s59, s59, 10
s_add_u32 s59, s59, 73400320
v_rcp_f32 v80, v32
s_nop 0
v_cndmask_b32 v81, 0, v80, vcc
v_mul_f32 v100, v16, v80
v_mul_f32 v101, v17, v80
v_mul_f32 v102, v18, v80
v_mul_f32 v103, v19, v80
v_mul_f32 v104, v24, v81
v_mul_f32 v105, v25, v81
v_mul_f32 v106, v26, v81
v_mul_f32 v107, v27, v81
v_cvt_pk_bf16_f32 v48, v100, v101
v_cvt_pk_bf16_f32 v49, v102, v103
v_cvt_pk_bf16_f32 v50, v104, v105
v_cvt_pk_bf16_f32 v51, v106, v107
s_add_u32 s63, s59, 0
buffer_store_dwordx4 v[48:51], v1, s[12:15], s63 offen sc1
v_rcp_f32 v80, v36
s_nop 0
v_cndmask_b32 v81, 0, v80, vcc
v_mul_f32 v100, v20, v80
v_mul_f32 v101, v21, v80
v_mul_f32 v102, v22, v80
v_mul_f32 v103, v23, v80
v_mul_f32 v104, v28, v81
v_mul_f32 v105, v29, v81
v_mul_f32 v106, v30, v81
v_mul_f32 v107, v31, v81
v_cvt_pk_bf16_f32 v52, v100, v101
v_cvt_pk_bf16_f32 v53, v102, v103
v_cvt_pk_bf16_f32 v54, v104, v105
v_cvt_pk_bf16_f32 v55, v106, v107
s_add_u32 s63, s59, 16384
buffer_store_dwordx4 v[52:55], v1, s[12:15], s63 offen sc1
s_add_u32 m0, s68, 81920
s_nop 0
buffer_load_dwordx4 v6, s[8:11], s73 offen offset:0 sc1 lds
buffer_load_dwordx4 v6, s[8:11], s73 offen offset:1024 sc1 lds
buffer_load_dwordx4 v6, s[8:11], s73 offen offset:2048 sc1 lds
buffer_load_dwordx4 v6, s[8:11], s73 offen offset:3072 sc1 lds
s_add_u32 m0, s68, 49152
s_nop 0
buffer_load_dwordx4 v6, s[4:7], s21 offen offset:0 sc1 lds
buffer_load_dwordx4 v6, s[4:7], s21 offen offset:1024 sc1 lds
buffer_load_dwordx4 v6, s[4:7], s21 offen offset:2048 sc1 lds
buffer_load_dwordx4 v6, s[4:7], s21 offen offset:3072 sc1 lds
s_add_u32 m0, s68, 98304
s_nop 0
buffer_load_dwordx4 v6, s[8:11], s74 offen offset:0 sc1 lds
buffer_load_dwordx4 v6, s[8:11], s74 offen offset:1024 sc1 lds
buffer_load_dwordx4 v6, s[8:11], s74 offen offset:2048 sc1 lds
buffer_load_dwordx4 v6, s[8:11], s74 offen offset:3072 sc1 lds
s_mov_b32 s56, s68
s_add_u32 s26, s56, 49152
v_mov_b32 v2, v1
v_add_u32 v3, 16384, v1
s_waitcnt vmcnt(12)
s_barrier
s_lshr_b32 s57, s2, 4
s_and_b32 s56, s2, 7
s_lshl_b32 s56, s56, 1
s_bfe_u32 s58, s2, 0x10003
s_add_u32 s56, s56, s58
s_lshl_b32 s56, s56, 4
s_add_u32 s56, s56, s57
s_lshl_b32 s56, s56, 7
s_add_u32 s56, s56, 105021440
s_cmp_lg_u32 s16, 0
s_cbranch_scc1 L_k2_cbsig
v_mov_b32 v115, 0
v_mov_b32 v116, s3
s_mov_b64 exec, 1
buffer_store_dword v116, v115, s[12:15], s56 offen sc1
s_mov_b64 exec, -1
L_k2_cbsig:
L_k2_seg:
s_lshl_b32 s28, s30, 2
s_add_u32 s28, s28, s16
s_lshl_b32 s66, s28, 5
ds_read_b128 a[128:131], v2 offset:0
ds_read_b128 a[132:135], v2 offset:8192
ds_read_b128 a[136:139], v2 offset:1024
ds_read_b128 a[140:143], v2 offset:9216
ds_read_b128 a[144:147], v2 offset:2048
ds_read_b128 a[148:151], v2 offset:10240
ds_read_b128 a[152:155], v2 offset:3072
ds_read_b128 a[156:159], v2 offset:11264
ds_read_b128 a[160:163], v2 offset:4096
ds_read_b128 a[164:167], v2 offset:12288
ds_read_b128 a[168:171], v2 offset:5120
ds_read_b128 a[172:175], v2 offset:13312
ds_read_b128 a[176:179], v2 offset:6144
ds_read_b128 a[180:183], v2 offset:14336
ds_read_b128 a[184:187], v2 offset:7168
ds_read_b128 a[188:191], v2 offset:15360
v_pk_mov_b32 v[128:129], 0, 0
v_pk_mov_b32 v[130:131], 0, 0
v_pk_mov_b32 v[132:133], 0, 0
v_pk_mov_b32 v[134:135], 0, 0
v_pk_mov_b32 v[136:137], 0, 0
v_pk_mov_b32 v[138:139], 0, 0
v_pk_mov_b32 v[140:141], 0, 0
v_pk_mov_b32 v[142:143], 0, 0
v_pk_mov_b32 v[144:145], 0, 0
v_pk_mov_b32 v[146:147], 0, 0
v_pk_mov_b32 v[148:149], 0, 0
v_pk_mov_b32 v[150:151], 0, 0
v_pk_mov_b32 v[152:153], 0, 0
v_pk_mov_b32 v[154:155], 0, 0
v_pk_mov_b32 v[156:157], 0, 0
v_pk_mov_b32 v[158:159], 0, 0
v_pk_mov_b32 v[160:161], 0, 0
v_pk_mov_b32 v[162:163], 0, 0
v_pk_mov_b32 v[164:165], 0, 0
v_pk_mov_b32 v[166:167], 0, 0
v_pk_mov_b32 v[168:169], 0, 0
v_pk_mov_b32 v[170:171], 0, 0
v_pk_mov_b32 v[172:173], 0, 0
v_pk_mov_b32 v[174:175], 0, 0
v_pk_mov_b32 v[176:177], 0, 0
v_pk_mov_b32 v[178:179], 0, 0
v_pk_mov_b32 v[180:181], 0, 0
v_pk_mov_b32 v[182:183], 0, 0
v_pk_mov_b32 v[184:185], 0, 0
v_pk_mov_b32 v[186:187], 0, 0
v_pk_mov_b32 v[188:189], 0, 0
v_pk_mov_b32 v[190:191], 0, 0
v_pk_mov_b32 v[192:193], 0, 0
v_pk_mov_b32 v[194:195], 0, 0
v_pk_mov_b32 v[196:197], 0, 0
v_pk_mov_b32 v[198:199], 0, 0
v_pk_mov_b32 v[200:201], 0, 0
v_pk_mov_b32 v[202:203], 0, 0
v_pk_mov_b32 v[204:205], 0, 0
v_pk_mov_b32 v[206:207], 0, 0
v_pk_mov_b32 v[208:209], 0, 0
v_pk_mov_b32 v[210:211], 0, 0
v_pk_mov_b32 v[212:213], 0, 0
v_pk_mov_b32 v[214:215], 0, 0
v_pk_mov_b32 v[216:217], 0, 0
v_pk_mov_b32 v[218:219], 0, 0
v_pk_mov_b32 v[220:221], 0, 0
v_pk_mov_b32 v[222:223], 0, 0
v_pk_mov_b32 v[224:225], 0, 0
v_pk_mov_b32 v[226:227], 0, 0
v_pk_mov_b32 v[228:229], 0, 0
v_pk_mov_b32 v[230:231], 0, 0
v_pk_mov_b32 v[232:233], 0, 0
v_pk_mov_b32 v[234:235], 0, 0
v_pk_mov_b32 v[236:237], 0, 0
v_pk_mov_b32 v[238:239], 0, 0
v_pk_mov_b32 v[240:241], 0, 0
v_pk_mov_b32 v[242:243], 0, 0
v_pk_mov_b32 v[244:245], 0, 0
v_pk_mov_b32 v[246:247], 0, 0
v_pk_mov_b32 v[248:249], 0, 0
v_pk_mov_b32 v[250:251], 0, 0
v_pk_mov_b32 v[252:253], 0, 0
v_pk_mov_b32 v[254:255], 0, 0
v_pk_mov_b32 v[64:65], 0, 0
v_pk_mov_b32 v[66:67], 0, 0
v_pk_mov_b32 v[68:69], 0, 0
v_pk_mov_b32 v[70:71], 0, 0
s_waitcnt lgkmcnt(0)
v_mfma_f32_16x16x32_bf16 v[16:19], a[128:131], a[0:3], 0
v_mfma_f32_16x16x32_bf16 v[20:23], a[128:131], a[32:35], 0
v_mfma_f32_16x16x32_bf16 v[24:27], a[132:135], a[0:3], 0
v_mfma_f32_16x16x32_bf16 v[28:31], a[132:135], a[32:35], 0
v_mfma_f32_16x16x32_bf16 v[16:19], a[136:139], a[4:7], v[16:19]
v_mfma_f32_16x16x32_bf16 v[20:23], a[136:139], a[36:39], v[20:23]
v_mfma_f32_16x16x32_bf16 v[24:27], a[140:143], a[4:7], v[24:27]
v_mfma_f32_16x16x32_bf16 v[28:31], a[140:143], a[36:39], v[28:31]
v_mfma_f32_16x16x32_bf16 v[16:19], a[144:147], a[8:11], v[16:19]
v_mfma_f32_16x16x32_bf16 v[20:23], a[144:147], a[40:43], v[20:23]
v_mfma_f32_16x16x32_bf16 v[24:27], a[148:151], a[8:11], v[24:27]
v_mfma_f32_16x16x32_bf16 v[28:31], a[148:151], a[40:43], v[28:31]
v_mfma_f32_16x16x32_bf16 v[16:19], a[152:155], a[12:15], v[16:19]
v_mfma_f32_16x16x32_bf16 v[20:23], a[152:155], a[44:47], v[20:23]
v_mfma_f32_16x16x32_bf16 v[24:27], a[156:159], a[12:15], v[24:27]
v_mfma_f32_16x16x32_bf16 v[28:31], a[156:159], a[44:47], v[28:31]
v_mfma_f32_16x16x32_bf16 v[16:19], a[160:163], a[16:19], v[16:19]
v_mfma_f32_16x16x32_bf16 v[20:23], a[160:163], a[48:51], v[20:23]
v_mfma_f32_16x16x32_bf16 v[24:27], a[164:167], a[16:19], v[24:27]
v_mfma_f32_16x16x32_bf16 v[28:31], a[164:167], a[48:51], v[28:31]
v_mfma_f32_16x16x32_bf16 v[16:19], a[168:171], a[20:23], v[16:19]
v_mfma_f32_16x16x32_bf16 v[20:23], a[168:171], a[52:55], v[20:23]
v_mfma_f32_16x16x32_bf16 v[24:27], a[172:175], a[20:23], v[24:27]
v_mfma_f32_16x16x32_bf16 v[28:31], a[172:175], a[52:55], v[28:31]
v_mfma_f32_16x16x32_bf16 v[16:19], a[176:179], a[24:27], v[16:19]
v_mfma_f32_16x16x32_bf16 v[20:23], a[176:179], a[56:59], v[20:23]
v_mfma_f32_16x16x32_bf16 v[24:27], a[180:183], a[24:27], v[24:27]
v_mfma_f32_16x16x32_bf16 v[28:31], a[180:183], a[56:59], v[28:31]
v_mfma_f32_16x16x32_bf16 v[16:19], a[184:187], a[28:31], v[16:19]
v_mfma_f32_16x16x32_bf16 v[20:23], a[184:187], a[60:63], v[20:23]
v_mfma_f32_16x16x32_bf16 v[24:27], a[188:191], a[28:31], v[24:27]
v_mfma_f32_16x16x32_bf16 v[28:31], a[188:191], a[60:63], v[28:31]
ds_read_b128 a[128:131], v3 offset:0
ds_read_b128 a[132:135], v3 offset:8192
ds_read_b128 a[136:139], v3 offset:1024
ds_read_b128 a[140:143], v3 offset:9216
ds_read_b128 a[144:147], v3 offset:2048
ds_read_b128 a[148:151], v3 offset:10240
ds_read_b128 a[152:155], v3 offset:3072
ds_read_b128 a[156:159], v3 offset:11264
ds_read_b128 a[160:163], v3 offset:4096
ds_read_b128 a[164:167], v3 offset:12288
ds_read_b128 a[168:171], v3 offset:5120
ds_read_b128 a[172:175], v3 offset:13312
ds_read_b128 a[176:179], v3 offset:6144
ds_read_b128 a[180:183], v3 offset:14336
ds_read_b128 a[184:187], v3 offset:7168
ds_read_b128 a[188:191], v3 offset:15360
s_nop 7
s_cmp_ge_u32 s27, s28
s_cbranch_scc1 L_k2_maskP
L_k2_maskPret:
v_max3_f32 v76, v16, v17, v18
v_max3_f32 v77, v19, v24, v25
v_max3_f32 v76, v76, v26, v27
v_max_f32 v76, v76, v77
v_mov_b32 v77, v76
s_nop 1
v_permlane32_swap_b32 v76, v77
s_nop 1
v_max_f32 v76, v76, v77
v_mov_b32 v77, v76
s_nop 1
v_permlane16_swap_b32 v76, v77
s_nop 1
v_max_f32 v76, v76, v77
v_sub_f32 v16, v16, v76
v_sub_f32 v17, v17, v76
v_sub_f32 v18, v18, v76
v_sub_f32 v19, v19, v76
v_sub_f32 v24, v24, v76
v_sub_f32 v25, v25, v76
v_sub_f32 v26, v26, v76
v_sub_f32 v27, v27, v76
v_sub_f32 v56, 0, v76
v_sub_f32 v57, 0, v76
v_sub_f32 v58, 0, v76
v_sub_f32 v59, 0, v76
v_max3_f32 v76, v20, v21, v22
v_max3_f32 v77, v23, v28, v29
v_max3_f32 v76, v76, v30, v31
v_max_f32 v76, v76, v77
v_mov_b32 v77, v76
s_nop 1
v_permlane32_swap_b32 v76, v77
s_nop 1
v_max_f32 v76, v76, v77
v_mov_b32 v77, v76
s_nop 1
v_permlane16_swap_b32 v76, v77
s_nop 1
v_max_f32 v76, v76, v77
v_sub_f32 v20, v20, v76
v_sub_f32 v21, v21, v76
v_sub_f32 v22, v22, v76
v_sub_f32 v23, v23, v76
v_sub_f32 v28, v28, v76
v_sub_f32 v29, v29, v76
v_sub_f32 v30, v30, v76
v_sub_f32 v31, v31, v76
v_sub_f32 v60, 0, v76
v_sub_f32 v61, 0, v76
v_sub_f32 v62, 0, v76
v_sub_f32 v63, 0, v76
s_add_u32 s27, s27, 1
s_add_u32 s25, s26, 16384
s_and_b32 s25, s25, 0xffff
s_waitcnt lgkmcnt(8)
s_cmp_eq_u32 s88, 0
s_cbranch_scc1 L_k2_nopub
s_waitcnt vmcnt(0)
s_barrier
s_mov_b32 s88, 0
s_cmp_lg_u32 s16, 0
s_cbranch_scc1 L_k2_nopub2
v_mov_b32 v76, 0
v_mov_b32 v77, s3
s_mov_b64 exec, 1
buffer_store_dword v77, v76, s[12:15], s97 offen sc1
s_mov_b64 exec, -1
L_k2_nopub2:
L_k2_nopub:
s_waitcnt vmcnt(12)
s_barrier
s_cmp_eq_u32 s16, 1
s_cbranch_scc1 L_k2_loop_1
s_cmp_eq_u32 s16, 2
s_cbranch_scc1 L_k2_loop_2
s_cmp_eq_u32 s16, 3
s_cbranch_scc1 L_k2_loop_3
.p2align 6
L_k2_loop_0:
v_mfma_f32_16x16x32_bf16 v[32:35], a[128:131], a[0:3], v[56:59]
v_add_u32 v4, s25, v5
s_mov_b32 m0, s25
v_mfma_f32_16x16x32_bf16 v[36:39], a[128:131], a[32:35], v[60:63]
ds_read_b128 a[128:131], v4 offset:0
v_xor_b32 v2, 0x18000, v4
v_mfma_f32_16x16x32_bf16 v[40:43], a[132:135], a[0:3], v[56:59]
v_exp_f32 v16, v16
v_mfma_f32_16x16x32_bf16 v[44:47], a[132:135], a[32:35], v[60:63]
ds_read_b128 a[132:135], v4 offset:1024
v_mfma_f32_16x16x32_bf16 v[32:35], a[136:139], a[4:7], v[32:35]
v_exp_f32 v17, v17
v_mfma_f32_16x16x32_bf16 v[36:39], a[136:139], a[36:39], v[36:39]
ds_read_b128 a[136:139], v4 offset:2048
v_mfma_f32_16x16x32_bf16 v[40:43], a[140:143], a[4:7], v[40:43]
v_exp_f32 v18, v18
v_mfma_f32_16x16x32_bf16 v[44:47], a[140:143], a[36:39], v[44:47]
ds_read_b128 a[140:143], v4 offset:3072
v_cvt_pk_bf16_f32 v48, v16, v17
v_mfma_f32_16x16x32_bf16 v[32:35], a[144:147], a[8:11], v[32:35]
v_exp_f32 v19, v19
v_mfma_f32_16x16x32_bf16 v[36:39], a[144:147], a[40:43], v[36:39]
ds_read_b128 a[144:147], v4 offset:4096
v_mfma_f32_16x16x32_bf16 v[40:43], a[148:151], a[8:11], v[40:43]
v_exp_f32 v24, v24
v_mfma_f32_16x16x32_bf16 v[44:47], a[148:151], a[40:43], v[44:47]
ds_read_b128 a[148:151], v4 offset:5120
v_cvt_pk_bf16_f32 v49, v18, v19
v_mfma_f32_16x16x32_bf16 v[32:35], a[152:155], a[12:15], v[32:35]
v_exp_f32 v25, v25
v_mfma_f32_16x16x32_bf16 v[36:39], a[152:155], a[44:47], v[36:39]
ds_read_b128 a[152:155], v4 offset:6144
v_mfma_f32_16x16x32_bf16 v[40:43], a[156:159], a[12:15], v[40:43]
v_exp_f32 v26, v26
v_mfma_f32_16x16x32_bf16 v[44:47], a[156:159], a[44:47], v[44:47]
ds_read_b128 a[156:159], v4 offset:7168
s_waitcnt lgkmcnt(7)
v_mfma_f32_16x16x32_bf16 v[32:35], a[160:163], a[16:19], v[32:35]
v_exp_f32 v27, v27
v_mfma_f32_16x16x32_bf16 v[36:39], a[160:163], a[48:51], v[36:39]
ds_read_b128 a[160:163], v4 offset:8192
v_cvt_pk_bf16_f32 v50, v24, v25
v_mfma_f32_16x16x32_bf16 v[40:43], a[164:167], a[16:19], v[40:43]
buffer_load_dwordx4 v6, s[4:7], s20 offen offset:0 sc1 lds
v_mfma_f32_16x16x32_bf16 v[44:47], a[164:167], a[48:51], v[44:47]
ds_read_b128 a[164:167], v4 offset:9216
v_cvt_pk_bf16_f32 v51, v26, v27
v_mfma_f32_16x16x32_bf16 v[32:35], a[168:171], a[20:23], v[32:35]
s_cmp_eq_u32 s27, s90
s_cbranch_scc1 L_k2_fl_0
L_k2_flret_0:
v_mfma_f32_16x16x32_bf16 v[36:39], a[168:171], a[52:55], v[36:39]
ds_read_b128 a[168:171], v4 offset:10240
v_mfma_f32_16x16x32_bf16 v[40:43], a[172:175], a[20:23], v[40:43]
buffer_load_dwordx4 v6, s[4:7], s20 offen offset:1024 sc1 lds
v_mfma_f32_16x16x32_bf16 v[44:47], a[172:175], a[52:55], v[44:47]
ds_read_b128 a[172:175], v4 offset:11264
v_mfma_f32_16x16x32_bf16 v[32:35], a[176:179], a[24:27], v[32:35]
v_mfma_f32_16x16x32_bf16 v[36:39], a[176:179], a[56:59], v[36:39]
ds_read_b128 a[176:179], v4 offset:12288
v_mfma_f32_16x16x32_bf16 v[40:43], a[180:183], a[24:27], v[40:43]
buffer_load_dwordx4 v6, s[4:7], s20 offen offset:2048 sc1 lds
v_mfma_f32_16x16x32_bf16 v[44:47], a[180:183], a[56:59], v[44:47]
ds_read_b128 a[180:183], v4 offset:13312
v_mfma_f32_16x16x32_bf16 v[32:35], a[184:187], a[28:31], v[32:35]
v_mfma_f32_16x16x32_bf16 v[36:39], a[184:187], a[60:63], v[36:39]
ds_read_b128 a[184:187], v4 offset:14336
v_mfma_f32_16x16x32_bf16 v[40:43], a[188:191], a[28:31], v[40:43]
buffer_load_dwordx4 v6, s[4:7], s20 offen offset:3072 sc1 lds
v_mfma_f32_16x16x32_bf16 v[44:47], a[188:191], a[60:63], v[44:47]
ds_read_b128 a[188:191], v4 offset:15360
s_waitcnt lgkmcnt(8)
v_mfma_f32_16x16x32_bf16 v[128:131], a[128:131], v[48:51], v[128:131]
v_exp_f32 v20, v20
v_mfma_f32_16x16x32_bf16 v[136:139], a[132:135], v[48:51], v[136:139]
s_cmp_ge_u32 s27, s28
v_mfma_f32_16x16x32_bf16 v[64:67], v[72:75], v[48:51], v[64:67]
v_exp_f32 v21, v21
v_mfma_f32_16x16x32_bf16 v[144:147], a[136:139], v[48:51], v[144:147]
s_cbranch_scc1 L_k2_mask0_0
L_k2_maskret0_0:
v_mfma_f32_16x16x32_bf16 v[152:155], a[140:143], v[48:51], v[152:155]
v_exp_f32 v22, v22
v_mfma_f32_16x16x32_bf16 v[160:163], a[144:147], v[48:51], v[160:163]
v_cvt_pk_bf16_f32 v52, v20, v21
v_max3_f32 v9, v32, v33, v34
v_mfma_f32_16x16x32_bf16 v[168:171], a[148:151], v[48:51], v[168:171]
v_exp_f32 v23, v23
v_mfma_f32_16x16x32_bf16 v[176:179], a[152:155], v[48:51], v[176:179]
s_waitcnt lgkmcnt(0)
v_max3_f32 v10, v35, v40, v41
v_mfma_f32_16x16x32_bf16 v[184:187], a[156:159], v[48:51], v[184:187]
v_exp_f32 v28, v28
v_mfma_f32_16x16x32_bf16 v[192:195], a[160:163], v[48:51], v[192:195]
v_cvt_pk_bf16_f32 v53, v22, v23
v_max3_f32 v11, v42, v43, v36
v_mfma_f32_16x16x32_bf16 v[200:203], a[164:167], v[48:51], v[200:203]
v_exp_f32 v29, v29
v_mfma_f32_16x16x32_bf16 v[208:211], a[168:171], v[48:51], v[208:211]
v_max3_f32 v9, v9, v37, v38
v_max3_f32 v10, v10, v39, v44
v_mfma_f32_16x16x32_bf16 v[216:219], a[172:175], v[48:51], v[216:219]
v_exp_f32 v30, v30
v_mfma_f32_16x16x32_bf16 v[224:227], a[176:179], v[48:51], v[224:227]
v_cvt_pk_bf16_f32 v54, v28, v29
v_max3_f32 v11, v11, v45, v46
v_mfma_f32_16x16x32_bf16 v[232:235], a[180:183], v[48:51], v[232:235]
v_exp_f32 v31, v31
v_mfma_f32_16x16x32_bf16 v[240:243], a[184:187], v[48:51], v[240:243]
v_cvt_pk_bf16_f32 v55, v30, v31
v_max3_f32 v9, v9, v10, v47
v_mfma_f32_16x16x32_bf16 v[248:251], a[188:191], v[48:51], v[248:251]
v_max_f32 v9, v9, v11
v_cmp_lt_f32 vcc, 0x41c00000, v9
v_mfma_f32_16x16x32_bf16 v[132:135], a[128:131], v[52:55], v[132:135]
ds_read_b128 a[128:131], v2 offset:0
v_mfma_f32_16x16x32_bf16 v[140:143], a[132:135], v[52:55], v[140:143]
ds_read_b128 a[132:135], v2 offset:8192
v_mfma_f32_16x16x32_bf16 v[68:71], v[72:75], v[52:55], v[68:71]
s_add_u32 m0, s26, 0x10000
s_add_u32 s27, s27, 1
v_mfma_f32_16x16x32_bf16 v[148:151], a[136:139], v[52:55], v[148:151]
ds_read_b128 a[136:139], v2 offset:1024
buffer_load_dwordx4 v6, s[8:11], s21 offen offset:0 sc1 lds
v_mfma_f32_16x16x32_bf16 v[156:159], a[140:143], v[52:55], v[156:159]
ds_read_b128 a[140:143], v2 offset:9216
s_add_u32 s26, s25, 16384
v_mfma_f32_16x16x32_bf16 v[164:167], a[144:147], v[52:55], v[164:167]
ds_read_b128 a[144:147], v2 offset:2048
buffer_load_dwordx4 v6, s[8:11], s21 offen offset:1024 sc1 lds
v_mfma_f32_16x16x32_bf16 v[172:175], a[148:151], v[52:55], v[172:175]
ds_read_b128 a[148:151], v2 offset:10240
s_and_b32 s26, s26, 0xffff
v_mfma_f32_16x16x32_bf16 v[180:183], a[152:155], v[52:55], v[180:183]
ds_read_b128 a[152:155], v2 offset:3072
buffer_load_dwordx4 v6, s[8:11], s21 offen offset:2048 sc1 lds
v_mfma_f32_16x16x32_bf16 v[188:191], a[156:159], v[52:55], v[188:191]
ds_read_b128 a[156:159], v2 offset:11264
v_mfma_f32_16x16x32_bf16 v[196:199], a[160:163], v[52:55], v[196:199]
ds_read_b128 a[160:163], v2 offset:4096
buffer_load_dwordx4 v6, s[8:11], s21 offen offset:3072 sc1 lds
v_mfma_f32_16x16x32_bf16 v[204:207], a[164:167], v[52:55], v[204:207]
ds_read_b128 a[164:167], v2 offset:12288
s_add_u32 s21, s20, 16384
v_mfma_f32_16x16x32_bf16 v[212:215], a[168:171], v[52:55], v[212:215]
ds_read_b128 a[168:171], v2 offset:5120
s_sub_u32 s22, s22, 1
v_mfma_f32_16x16x32_bf16 v[220:223], a[172:175], v[52:55], v[220:223]
ds_read_b128 a[172:175], v2 offset:13312
s_cmp_eq_u32 s22, 0
v_mfma_f32_16x16x32_bf16 v[228:231], a[176:179], v[52:55], v[228:231]
ds_read_b128 a[176:179], v2 offset:6144
s_waitcnt vmcnt(12)
s_barrier
s_cselect_b32 s21, s23, s21
v_mfma_f32_16x16x32_bf16 v[236:239], a[180:183], v[52:55], v[236:239]
ds_read_b128 a[180:183], v2 offset:14336
s_cselect_b32 s22, s24, s22
v_mfma_f32_16x16x32_bf16 v[244:247], a[184:187], v[52:55], v[244:247]
ds_read_b128 a[184:187], v2 offset:7168
s_cselect_b32 s23, s62, s23
v_mfma_f32_16x16x32_bf16 v[252:255], a[188:191], v[52:55], v[252:255]
ds_read_b128 a[188:191], v2 offset:15360
s_waitcnt lgkmcnt(8)
s_cmp_eq_u32 s27, s29
s_cbranch_vccnz L_k2_resc0_0
L_k2_rescret0_0:
s_cbranch_scc1 L_k2_final_0
v_mfma_f32_16x16x32_bf16 v[16:19], a[128:131], a[0:3], v[56:59]
v_add_u32 v4, s26, v5
s_mov_b32 m0, s26
v_mfma_f32_16x16x32_bf16 v[20:23], a[128:131], a[32:35], v[60:63]
ds_read_b128 a[128:131], v4 offset:0
v_xor_b32 v3, 0x18000, v4
v_mfma_f32_16x16x32_bf16 v[24:27], a[132:135], a[0:3], v[56:59]
v_exp_f32 v32, v32
v_mfma_f32_16x16x32_bf16 v[28:31], a[132:135], a[32:35], v[60:63]
ds_read_b128 a[132:135], v4 offset:1024
v_mfma_f32_16x16x32_bf16 v[16:19], a[136:139], a[4:7], v[16:19]
v_exp_f32 v33, v33
v_mfma_f32_16x16x32_bf16 v[20:23], a[136:139], a[36:39], v[20:23]
ds_read_b128 a[136:139], v4 offset:2048
v_mfma_f32_16x16x32_bf16 v[24:27], a[140:143], a[4:7], v[24:27]
v_exp_f32 v34, v34
v_mfma_f32_16x16x32_bf16 v[28:31], a[140:143], a[36:39], v[28:31]
ds_read_b128 a[140:143], v4 offset:3072
v_cvt_pk_bf16_f32 v48, v32, v33
v_mfma_f32_16x16x32_bf16 v[16:19], a[144:147], a[8:11], v[16:19]
v_exp_f32 v35, v35
v_mfma_f32_16x16x32_bf16 v[20:23], a[144:147], a[40:43], v[20:23]
ds_read_b128 a[144:147], v4 offset:4096
v_mfma_f32_16x16x32_bf16 v[24:27], a[148:151], a[8:11], v[24:27]
v_exp_f32 v40, v40
v_mfma_f32_16x16x32_bf16 v[28:31], a[148:151], a[40:43], v[28:31]
ds_read_b128 a[148:151], v4 offset:5120
v_cvt_pk_bf16_f32 v49, v34, v35
v_mfma_f32_16x16x32_bf16 v[16:19], a[152:155], a[12:15], v[16:19]
v_exp_f32 v41, v41
v_mfma_f32_16x16x32_bf16 v[20:23], a[152:155], a[44:47], v[20:23]
ds_read_b128 a[152:155], v4 offset:6144
v_mfma_f32_16x16x32_bf16 v[24:27], a[156:159], a[12:15], v[24:27]
v_exp_f32 v42, v42
v_mfma_f32_16x16x32_bf16 v[28:31], a[156:159], a[44:47], v[28:31]
ds_read_b128 a[156:159], v4 offset:7168
s_waitcnt lgkmcnt(7)
v_mfma_f32_16x16x32_bf16 v[16:19], a[160:163], a[16:19], v[16:19]
v_exp_f32 v43, v43
v_mfma_f32_16x16x32_bf16 v[20:23], a[160:163], a[48:51], v[20:23]
ds_read_b128 a[160:163], v4 offset:8192
v_cvt_pk_bf16_f32 v50, v40, v41
v_mfma_f32_16x16x32_bf16 v[24:27], a[164:167], a[16:19], v[24:27]
buffer_load_dwordx4 v6, s[4:7], s21 offen offset:0 sc1 lds
v_mfma_f32_16x16x32_bf16 v[28:31], a[164:167], a[48:51], v[28:31]
ds_read_b128 a[164:167], v4 offset:9216
v_cvt_pk_bf16_f32 v51, v42, v43
v_mfma_f32_16x16x32_bf16 v[16:19], a[168:171], a[20:23], v[16:19]
v_mfma_f32_16x16x32_bf16 v[20:23], a[168:171], a[52:55], v[20:23]
ds_read_b128 a[168:171], v4 offset:10240
v_mfma_f32_16x16x32_bf16 v[24:27], a[172:175], a[20:23], v[24:27]
buffer_load_dwordx4 v6, s[4:7], s21 offen offset:1024 sc1 lds
v_mfma_f32_16x16x32_bf16 v[28:31], a[172:175], a[52:55], v[28:31]
ds_read_b128 a[172:175], v4 offset:11264
v_mfma_f32_16x16x32_bf16 v[16:19], a[176:179], a[24:27], v[16:19]
v_mfma_f32_16x16x32_bf16 v[20:23], a[176:179], a[56:59], v[20:23]
ds_read_b128 a[176:179], v4 offset:12288
v_mfma_f32_16x16x32_bf16 v[24:27], a[180:183], a[24:27], v[24:27]
buffer_load_dwordx4 v6, s[4:7], s21 offen offset:2048 sc1 lds
v_mfma_f32_16x16x32_bf16 v[28:31], a[180:183], a[56:59], v[28:31]
ds_read_b128 a[180:183], v4 offset:13312
v_mfma_f32_16x16x32_bf16 v[16:19], a[184:187], a[28:31], v[16:19]
v_mfma_f32_16x16x32_bf16 v[20:23], a[184:187], a[60:63], v[20:23]
ds_read_b128 a[184:187], v4 offset:14336
v_mfma_f32_16x16x32_bf16 v[24:27], a[188:191], a[28:31], v[24:27]
buffer_load_dwordx4 v6, s[4:7], s21 offen offset:3072 sc1 lds
v_mfma_f32_16x16x32_bf16 v[28:31], a[188:191], a[60:63], v[28:31]
ds_read_b128 a[188:191], v4 offset:15360
s_waitcnt lgkmcnt(8)
v_mfma_f32_16x16x32_bf16 v[128:131], a[128:131], v[48:51], v[128:131]
v_exp_f32 v36, v36
v_mfma_f32_16x16x32_bf16 v[136:139], a[132:135], v[48:51], v[136:139]
s_cmp_ge_u32 s27, s28
v_mfma_f32_16x16x32_bf16 v[64:67], v[72:75], v[48:51], v[64:67]
v_exp_f32 v37, v37
v_mfma_f32_16x16x32_bf16 v[144:147], a[136:139], v[48:51], v[144:147]
s_cbranch_scc1 L_k2_mask1_0
L_k2_maskret1_0:
v_mfma_f32_16x16x32_bf16 v[152:155], a[140:143], v[48:51], v[152:155]
v_exp_f32 v38, v38
v_mfma_f32_16x16x32_bf16 v[160:163], a[144:147], v[48:51], v[160:163]
v_cvt_pk_bf16_f32 v52, v36, v37
v_max3_f32 v9, v16, v17, v18
v_mfma_f32_16x16x32_bf16 v[168:171], a[148:151], v[48:51], v[168:171]
v_exp_f32 v39, v39
v_mfma_f32_16x16x32_bf16 v[176:179], a[152:155], v[48:51], v[176:179]
s_waitcnt lgkmcnt(0)
v_max3_f32 v10, v19, v24, v25
v_mfma_f32_16x16x32_bf16 v[184:187], a[156:159], v[48:51], v[184:187]
v_exp_f32 v44, v44
v_mfma_f32_16x16x32_bf16 v[192:195], a[160:163], v[48:51], v[192:195]
v_cvt_pk_bf16_f32 v53, v38, v39
v_max3_f32 v11, v26, v27, v20
v_mfma_f32_16x16x32_bf16 v[200:203], a[164:167], v[48:51], v[200:203]
v_exp_f32 v45, v45
v_mfma_f32_16x16x32_bf16 v[208:211], a[168:171], v[48:51], v[208:211]
v_max3_f32 v9, v9, v21, v22
v_max3_f32 v10, v10, v23, v28
v_mfma_f32_16x16x32_bf16 v[216:219], a[172:175], v[48:51], v[216:219]
v_exp_f32 v46, v46
v_mfma_f32_16x16x32_bf16 v[224:227], a[176:179], v[48:51], v[224:227]
v_cvt_pk_bf16_f32 v54, v44, v45
v_max3_f32 v11, v11, v29, v30
v_mfma_f32_16x16x32_bf16 v[232:235], a[180:183], v[48:51], v[232:235]
v_exp_f32 v47, v47
v_mfma_f32_16x16x32_bf16 v[240:243], a[184:187], v[48:51], v[240:243]
v_cvt_pk_bf16_f32 v55, v46, v47
v_max3_f32 v9, v9, v10, v31
v_mfma_f32_16x16x32_bf16 v[248:251], a[188:191], v[48:51], v[248:251]
v_max_f32 v9, v9, v11
v_cmp_lt_f32 vcc, 0x41c00000, v9
v_mfma_f32_16x16x32_bf16 v[132:135], a[128:131], v[52:55], v[132:135]
ds_read_b128 a[128:131], v3 offset:0
v_mfma_f32_16x16x32_bf16 v[140:143], a[132:135], v[52:55], v[140:143]
ds_read_b128 a[132:135], v3 offset:8192
v_mfma_f32_16x16x32_bf16 v[68:71], v[72:75], v[52:55], v[68:71]
s_add_u32 m0, s25, 0x10000
s_add_u32 s27, s27, 1
v_mfma_f32_16x16x32_bf16 v[148:151], a[136:139], v[52:55], v[148:151]
ds_read_b128 a[136:139], v3 offset:1024
buffer_load_dwordx4 v6, s[8:11], s20 offen offset:0 sc1 lds
v_mfma_f32_16x16x32_bf16 v[156:159], a[140:143], v[52:55], v[156:159]
ds_read_b128 a[140:143], v3 offset:9216
s_add_u32 s25, s26, 16384
v_mfma_f32_16x16x32_bf16 v[164:167], a[144:147], v[52:55], v[164:167]
ds_read_b128 a[144:147], v3 offset:2048
buffer_load_dwordx4 v6, s[8:11], s20 offen offset:1024 sc1 lds
v_mfma_f32_16x16x32_bf16 v[172:175], a[148:151], v[52:55], v[172:175]
ds_read_b128 a[148:151], v3 offset:10240
s_and_b32 s25, s25, 0xffff
v_mfma_f32_16x16x32_bf16 v[180:183], a[152:155], v[52:55], v[180:183]
ds_read_b128 a[152:155], v3 offset:3072
buffer_load_dwordx4 v6, s[8:11], s20 offen offset:2048 sc1 lds
v_mfma_f32_16x16x32_bf16 v[188:191], a[156:159], v[52:55], v[188:191]
ds_read_b128 a[156:159], v3 offset:11264
v_mfma_f32_16x16x32_bf16 v[196:199], a[160:163], v[52:55], v[196:199]
ds_read_b128 a[160:163], v3 offset:4096
buffer_load_dwordx4 v6, s[8:11], s20 offen offset:3072 sc1 lds
v_mfma_f32_16x16x32_bf16 v[204:207], a[164:167], v[52:55], v[204:207]
ds_read_b128 a[164:167], v3 offset:12288
s_add_u32 s20, s21, 16384
v_mfma_f32_16x16x32_bf16 v[212:215], a[168:171], v[52:55], v[212:215]
ds_read_b128 a[168:171], v3 offset:5120
s_sub_u32 s22, s22, 1
v_mfma_f32_16x16x32_bf16 v[220:223], a[172:175], v[52:55], v[220:223]
ds_read_b128 a[172:175], v3 offset:13312
s_cmp_eq_u32 s22, 0
v_mfma_f32_16x16x32_bf16 v[228:231], a[176:179], v[52:55], v[228:231]
ds_read_b128 a[176:179], v3 offset:6144
s_waitcnt vmcnt(12)
s_barrier
s_cselect_b32 s20, s23, s20
v_mfma_f32_16x16x32_bf16 v[236:239], a[180:183], v[52:55], v[236:239]
ds_read_b128 a[180:183], v3 offset:14336
s_cselect_b32 s22, s24, s22
v_mfma_f32_16x16x32_bf16 v[244:247], a[184:187], v[52:55], v[244:247]
ds_read_b128 a[184:187], v3 offset:7168
s_cselect_b32 s23, s62, s23
v_mfma_f32_16x16x32_bf16 v[252:255], a[188:191], v[52:55], v[252:255]
ds_read_b128 a[188:191], v3 offset:15360
s_waitcnt lgkmcnt(8)
s_cbranch_vccnz L_k2_resc1_0
L_k2_rescret1_0:
s_branch L_k2_loop_0
L_k2_final_0:
s_cmp_eq_u32 s65, 2
s_cbranch_scc1 L_k2_ec_0
L_k2_ecret_0:
s_waitcnt lgkmcnt(0)
v_add_u32 v4, s26, v5
s_mov_b32 m0, s26
ds_read_b128 a[128:131], v4 offset:0
ds_read_b128 a[132:135], v4 offset:1024
ds_read_b128 a[136:139], v4 offset:2048
ds_read_b128 a[140:143], v4 offset:3072
ds_read_b128 a[144:147], v4 offset:4096
ds_read_b128 a[148:151], v4 offset:5120
ds_read_b128 a[152:155], v4 offset:6144
ds_read_b128 a[156:159], v4 offset:7168
ds_read_b128 a[160:163], v4 offset:8192
ds_read_b128 a[164:167], v4 offset:9216
ds_read_b128 a[168:171], v4 offset:10240
ds_read_b128 a[172:175], v4 offset:11264
v_exp_f32 v32, v32
buffer_load_dwordx4 v6, s[4:7], s21 offen offset:0 sc1 lds
v_exp_f32 v33, v33
v_exp_f32 v34, v34
v_exp_f32 v35, v35
v_cvt_pk_bf16_f32 v48, v32, v33
v_exp_f32 v40, v40
buffer_load_dwordx4 v6, s[4:7], s21 offen offset:1024 sc1 lds
v_exp_f32 v41, v41
v_cvt_pk_bf16_f32 v49, v34, v35
v_exp_f32 v42, v42
v_exp_f32 v43, v43
v_cvt_pk_bf16_f32 v50, v40, v41
v_exp_f32 v36, v36
buffer_load_dwordx4 v6, s[4:7], s21 offen offset:2048 sc1 lds
v_exp_f32 v37, v37
v_cvt_pk_bf16_f32 v51, v42, v43
v_exp_f32 v38, v38
v_exp_f32 v39, v39
v_cvt_pk_bf16_f32 v52, v36, v37
v_exp_f32 v44, v44
buffer_load_dwordx4 v6, s[4:7], s21 offen offset:3072 sc1 lds
v_exp_f32 v45, v45
v_cvt_pk_bf16_f32 v53, v38, v39
v_exp_f32 v46, v46
v_exp_f32 v47, v47
v_cvt_pk_bf16_f32 v54, v44, v45
s_nop 0
s_waitcnt lgkmcnt(8)
v_mfma_f32_16x16x32_bf16 v[128:131], a[128:131], v[48:51], v[128:131]
v_cvt_pk_bf16_f32 v55, v46, v47
ds_read_b128 a[176:179], v4 offset:12288
v_mfma_f32_16x16x32_bf16 v[64:67], v[72:75], v[48:51], v[64:67]
v_mfma_f32_16x16x32_bf16 v[132:135], a[128:131], v[52:55], v[132:135]
v_mfma_f32_16x16x32_bf16 v[68:71], v[72:75], v[52:55], v[68:71]
v_mfma_f32_16x16x32_bf16 v[136:139], a[132:135], v[48:51], v[136:139]
ds_read_b128 a[180:183], v4 offset:13312
v_mfma_f32_16x16x32_bf16 v[140:143], a[132:135], v[52:55], v[140:143]
v_mfma_f32_16x16x32_bf16 v[144:147], a[136:139], v[48:51], v[144:147]
ds_read_b128 a[184:187], v4 offset:14336
s_add_u32 m0, s25, 0x10000
v_mfma_f32_16x16x32_bf16 v[148:151], a[136:139], v[52:55], v[148:151]
v_mfma_f32_16x16x32_bf16 v[152:155], a[140:143], v[48:51], v[152:155]
ds_read_b128 a[188:191], v4 offset:15360
v_mfma_f32_16x16x32_bf16 v[156:159], a[140:143], v[52:55], v[156:159]
buffer_load_dwordx4 v6, s[8:11], s20 offen offset:0 sc1 lds
s_waitcnt lgkmcnt(8)
v_mfma_f32_16x16x32_bf16 v[160:163], a[144:147], v[48:51], v[160:163]
v_mfma_f32_16x16x32_bf16 v[164:167], a[144:147], v[52:55], v[164:167]
v_mfma_f32_16x16x32_bf16 v[168:171], a[148:151], v[48:51], v[168:171]
v_mfma_f32_16x16x32_bf16 v[172:175], a[148:151], v[52:55], v[172:175]
v_mfma_f32_16x16x32_bf16 v[176:179], a[152:155], v[48:51], v[176:179]
v_mfma_f32_16x16x32_bf16 v[180:183], a[152:155], v[52:55], v[180:183]
buffer_load_dwordx4 v6, s[8:11], s20 offen offset:1024 sc1 lds
v_mfma_f32_16x16x32_bf16 v[184:187], a[156:159], v[48:51], v[184:187]
v_mfma_f32_16x16x32_bf16 v[188:191], a[156:159], v[52:55], v[188:191]
s_waitcnt lgkmcnt(4)
v_mfma_f32_16x16x32_bf16 v[192:195], a[160:163], v[48:51], v[192:195]
v_mfma_f32_16x16x32_bf16 v[196:199], a[160:163], v[52:55], v[196:199]
v_mfma_f32_16x16x32_bf16 v[200:203], a[164:167], v[48:51], v[200:203]
v_mfma_f32_16x16x32_bf16 v[204:207], a[164:167], v[52:55], v[204:207]
buffer_load_dwordx4 v6, s[8:11], s20 offen offset:2048 sc1 lds
v_mfma_f32_16x16x32_bf16 v[208:211], a[168:171], v[48:51], v[208:211]
v_mfma_f32_16x16x32_bf16 v[212:215], a[168:171], v[52:55], v[212:215]
s_add_u32 s27, s27, 1
v_mfma_f32_16x16x32_bf16 v[216:219], a[172:175], v[48:51], v[216:219]
v_mfma_f32_16x16x32_bf16 v[220:223], a[172:175], v[52:55], v[220:223]
s_waitcnt lgkmcnt(0)
v_mfma_f32_16x16x32_bf16 v[224:227], a[176:179], v[48:51], v[224:227]
v_mfma_f32_16x16x32_bf16 v[228:231], a[176:179], v[52:55], v[228:231]
buffer_load_dwordx4 v6, s[8:11], s20 offen offset:3072 sc1 lds
v_mfma_f32_16x16x32_bf16 v[232:235], a[180:183], v[48:51], v[232:235]
s_add_u32 s20, s21, 16384
v_mfma_f32_16x16x32_bf16 v[236:239], a[180:183], v[52:55], v[236:239]
s_sub_u32 s22, s22, 1
s_cmp_eq_u32 s22, 0
v_mfma_f32_16x16x32_bf16 v[240:243], a[184:187], v[48:51], v[240:243]
s_waitcnt vmcnt(12)
s_barrier
v_mfma_f32_16x16x32_bf16 v[244:247], a[184:187], v[52:55], v[244:247]
s_cselect_b32 s20, s23, s20
s_cselect_b32 s22, s24, s22
v_mfma_f32_16x16x32_bf16 v[248:251], a[188:191], v[48:51], v[248:251]
v_mfma_f32_16x16x32_bf16 v[252:255], a[188:191], v[52:55], v[252:255]
s_cselect_b32 s23, s62, s23
s_branch L_k2_segend
.p2align 6
L_k2_loop_1:
v_mfma_f32_16x16x32_bf16 v[32:35], a[128:131], a[0:3], v[56:59]
v_add_u32 v4, s25, v5
s_mov_b32 m0, s25
v_mfma_f32_16x16x32_bf16 v[36:39], a[128:131], a[32:35], v[60:63]
ds_read_b128 a[128:131], v4 offset:0
v_xor_b32 v2, 0x18000, v4
v_mfma_f32_16x16x32_bf16 v[40:43], a[132:135], a[0:3], v[56:59]
v_exp_f32 v16, v16
v_mfma_f32_16x16x32_bf16 v[44:47], a[132:135], a[32:35], v[60:63]
ds_read_b128 a[132:135], v4 offset:1024
v_mfma_f32_16x16x32_bf16 v[32:35], a[136:139], a[4:7], v[32:35]
v_exp_f32 v17, v17
v_mfma_f32_16x16x32_bf16 v[36:39], a[136:139], a[36:39], v[36:39]
ds_read_b128 a[136:139], v4 offset:2048
v_mfma_f32_16x16x32_bf16 v[40:43], a[140:143], a[4:7], v[40:43]
v_exp_f32 v18, v18
v_mfma_f32_16x16x32_bf16 v[44:47], a[140:143], a[36:39], v[44:47]
ds_read_b128 a[140:143], v4 offset:3072
v_cvt_pk_bf16_f32 v48, v16, v17
v_mfma_f32_16x16x32_bf16 v[32:35], a[144:147], a[8:11], v[32:35]
v_exp_f32 v19, v19
v_mfma_f32_16x16x32_bf16 v[36:39], a[144:147], a[40:43], v[36:39]
ds_read_b128 a[144:147], v4 offset:4096
v_mfma_f32_16x16x32_bf16 v[40:43], a[148:151], a[8:11], v[40:43]
v_exp_f32 v24, v24
v_mfma_f32_16x16x32_bf16 v[44:47], a[148:151], a[40:43], v[44:47]
ds_read_b128 a[148:151], v4 offset:5120
v_cvt_pk_bf16_f32 v49, v18, v19
v_mfma_f32_16x16x32_bf16 v[32:35], a[152:155], a[12:15], v[32:35]
v_exp_f32 v25, v25
v_mfma_f32_16x16x32_bf16 v[36:39], a[152:155], a[44:47], v[36:39]
ds_read_b128 a[152:155], v4 offset:6144
v_mfma_f32_16x16x32_bf16 v[40:43], a[156:159], a[12:15], v[40:43]
v_exp_f32 v26, v26
v_mfma_f32_16x16x32_bf16 v[44:47], a[156:159], a[44:47], v[44:47]
ds_read_b128 a[156:159], v4 offset:7168
s_waitcnt lgkmcnt(7)
v_mfma_f32_16x16x32_bf16 v[32:35], a[160:163], a[16:19], v[32:35]
v_exp_f32 v27, v27
v_mfma_f32_16x16x32_bf16 v[36:39], a[160:163], a[48:51], v[36:39]
ds_read_b128 a[160:163], v4 offset:8192
v_cvt_pk_bf16_f32 v50, v24, v25
v_mfma_f32_16x16x32_bf16 v[40:43], a[164:167], a[16:19], v[40:43]
buffer_load_dwordx4 v6, s[4:7], s20 offen offset:0 sc1 lds
v_mfma_f32_16x16x32_bf16 v[44:47], a[164:167], a[48:51], v[44:47]
ds_read_b128 a[164:167], v4 offset:9216
v_cvt_pk_bf16_f32 v51, v26, v27
v_mfma_f32_16x16x32_bf16 v[32:35], a[168:171], a[20:23], v[32:35]
s_cmp_eq_u32 s27, s90
s_cbranch_scc1 L_k2_fl_1
L_k2_flret_1:
v_mfma_f32_16x16x32_bf16 v[36:39], a[168:171], a[52:55], v[36:39]
ds_read_b128 a[168:171], v4 offset:10240
v_mfma_f32_16x16x32_bf16 v[40:43], a[172:175], a[20:23], v[40:43]
buffer_load_dwordx4 v6, s[4:7], s20 offen offset:1024 sc1 lds
v_mfma_f32_16x16x32_bf16 v[44:47], a[172:175], a[52:55], v[44:47]
ds_read_b128 a[172:175], v4 offset:11264
v_mfma_f32_16x16x32_bf16 v[32:35], a[176:179], a[24:27], v[32:35]
v_mfma_f32_16x16x32_bf16 v[36:39], a[176:179], a[56:59], v[36:39]
ds_read_b128 a[176:179], v4 offset:12288
v_mfma_f32_16x16x32_bf16 v[40:43], a[180:183], a[24:27], v[40:43]
buffer_load_dwordx4 v6, s[4:7], s20 offen offset:2048 sc1 lds
v_mfma_f32_16x16x32_bf16 v[44:47], a[180:183], a[56:59], v[44:47]
ds_read_b128 a[180:183], v4 offset:13312
v_mfma_f32_16x16x32_bf16 v[32:35], a[184:187], a[28:31], v[32:35]
v_mfma_f32_16x16x32_bf16 v[36:39], a[184:187], a[60:63], v[36:39]
ds_read_b128 a[184:187], v4 offset:14336
v_mfma_f32_16x16x32_bf16 v[40:43], a[188:191], a[28:31], v[40:43]
buffer_load_dwordx4 v6, s[4:7], s20 offen offset:3072 sc1 lds
v_mfma_f32_16x16x32_bf16 v[44:47], a[188:191], a[60:63], v[44:47]
ds_read_b128 a[188:191], v4 offset:15360
s_waitcnt lgkmcnt(8)
v_mfma_f32_16x16x32_bf16 v[128:131], a[128:131], v[48:51], v[128:131]
v_exp_f32 v20, v20
v_mfma_f32_16x16x32_bf16 v[136:139], a[132:135], v[48:51], v[136:139]
s_cmp_ge_u32 s27, s28
v_mfma_f32_16x16x32_bf16 v[64:67], v[72:75], v[48:51], v[64:67]
v_exp_f32 v21, v21
v_mfma_f32_16x16x32_bf16 v[144:147], a[136:139], v[48:51], v[144:147]
s_cbranch_scc1 L_k2_mask0_1
L_k2_maskret0_1:
v_mfma_f32_16x16x32_bf16 v[152:155], a[140:143], v[48:51], v[152:155]
v_exp_f32 v22, v22
v_mfma_f32_16x16x32_bf16 v[160:163], a[144:147], v[48:51], v[160:163]
v_cvt_pk_bf16_f32 v52, v20, v21
v_max3_f32 v9, v32, v33, v34
v_mfma_f32_16x16x32_bf16 v[168:171], a[148:151], v[48:51], v[168:171]
v_exp_f32 v23, v23
v_mfma_f32_16x16x32_bf16 v[176:179], a[152:155], v[48:51], v[176:179]
s_waitcnt lgkmcnt(0)
v_max3_f32 v10, v35, v40, v41
v_mfma_f32_16x16x32_bf16 v[184:187], a[156:159], v[48:51], v[184:187]
v_exp_f32 v28, v28
v_mfma_f32_16x16x32_bf16 v[192:195], a[160:163], v[48:51], v[192:195]
v_cvt_pk_bf16_f32 v53, v22, v23
v_max3_f32 v11, v42, v43, v36
v_mfma_f32_16x16x32_bf16 v[200:203], a[164:167], v[48:51], v[200:203]
v_exp_f32 v29, v29
v_mfma_f32_16x16x32_bf16 v[208:211], a[168:171], v[48:51], v[208:211]
v_max3_f32 v9, v9, v37, v38
v_max3_f32 v10, v10, v39, v44
v_mfma_f32_16x16x32_bf16 v[216:219], a[172:175], v[48:51], v[216:219]
v_exp_f32 v30, v30
v_mfma_f32_16x16x32_bf16 v[224:227], a[176:179], v[48:51], v[224:227]
v_cvt_pk_bf16_f32 v54, v28, v29
v_max3_f32 v11, v11, v45, v46
v_mfma_f32_16x16x32_bf16 v[232:235], a[180:183], v[48:51], v[232:235]
v_exp_f32 v31, v31
v_mfma_f32_16x16x32_bf16 v[240:243], a[184:187], v[48:51], v[240:243]
v_cvt_pk_bf16_f32 v55, v30, v31
v_max3_f32 v9, v9, v10, v47
v_mfma_f32_16x16x32_bf16 v[248:251], a[188:191], v[48:51], v[248:251]
v_max_f32 v9, v9, v11
v_cmp_lt_f32 vcc, 0x41c00000, v9
v_mfma_f32_16x16x32_bf16 v[132:135], a[128:131], v[52:55], v[132:135]
ds_read_b128 a[128:131], v2 offset:0
v_mfma_f32_16x16x32_bf16 v[140:143], a[132:135], v[52:55], v[140:143]
ds_read_b128 a[132:135], v2 offset:8192
v_mfma_f32_16x16x32_bf16 v[68:71], v[72:75], v[52:55], v[68:71]
s_add_u32 m0, s26, 0x10000
s_add_u32 s27, s27, 1
v_mfma_f32_16x16x32_bf16 v[148:151], a[136:139], v[52:55], v[148:151]
ds_read_b128 a[136:139], v2 offset:1024
buffer_load_dwordx4 v6, s[8:11], s21 offen offset:0 sc1 lds
v_mfma_f32_16x16x32_bf16 v[156:159], a[140:143], v[52:55], v[156:159]
ds_read_b128 a[140:143], v2 offset:9216
s_add_u32 s26, s25, 16384
v_mfma_f32_16x16x32_bf16 v[164:167], a[144:147], v[52:55], v[164:167]
ds_read_b128 a[144:147], v2 offset:2048
buffer_load_dwordx4 v6, s[8:11], s21 offen offset:1024 sc1 lds
v_mfma_f32_16x16x32_bf16 v[172:175], a[148:151], v[52:55], v[172:175]
ds_read_b128 a[148:151], v2 offset:10240
s_and_b32 s26, s26, 0xffff
v_mfma_f32_16x16x32_bf16 v[180:183], a[152:155], v[52:55], v[180:183]
ds_read_b128 a[152:155], v2 offset:3072
buffer_load_dwordx4 v6, s[8:11], s21 offen offset:2048 sc1 lds
v_mfma_f32_16x16x32_bf16 v[188:191], a[156:159], v[52:55], v[188:191]
ds_read_b128 a[156:159], v2 offset:11264
v_mfma_f32_16x16x32_bf16 v[196:199], a[160:163], v[52:55], v[196:199]
ds_read_b128 a[160:163], v2 offset:4096
buffer_load_dwordx4 v6, s[8:11], s21 offen offset:3072 sc1 lds
v_mfma_f32_16x16x32_bf16 v[204:207], a[164:167], v[52:55], v[204:207]
ds_read_b128 a[164:167], v2 offset:12288
s_add_u32 s21, s20, 16384
v_mfma_f32_16x16x32_bf16 v[212:215], a[168:171], v[52:55], v[212:215]
ds_read_b128 a[168:171], v2 offset:5120
s_sub_u32 s22, s22, 1
v_mfma_f32_16x16x32_bf16 v[220:223], a[172:175], v[52:55], v[220:223]
ds_read_b128 a[172:175], v2 offset:13312
s_cmp_eq_u32 s22, 0
v_mfma_f32_16x16x32_bf16 v[228:231], a[176:179], v[52:55], v[228:231]
ds_read_b128 a[176:179], v2 offset:6144
s_waitcnt vmcnt(12)
s_barrier
s_nop 0
s_cselect_b32 s21, s23, s21
v_mfma_f32_16x16x32_bf16 v[236:239], a[180:183], v[52:55], v[236:239]
ds_read_b128 a[180:183], v2 offset:14336
s_cselect_b32 s22, s24, s22
v_mfma_f32_16x16x32_bf16 v[244:247], a[184:187], v[52:55], v[244:247]
ds_read_b128 a[184:187], v2 offset:7168
s_cselect_b32 s23, s62, s23
v_mfma_f32_16x16x32_bf16 v[252:255], a[188:191], v[52:55], v[252:255]
ds_read_b128 a[188:191], v2 offset:15360
s_waitcnt lgkmcnt(8)
s_cmp_eq_u32 s27, s29
s_cbranch_vccnz L_k2_resc0_1
L_k2_rescret0_1:
s_cbranch_scc1 L_k2_final_1
v_mfma_f32_16x16x32_bf16 v[16:19], a[128:131], a[0:3], v[56:59]
v_add_u32 v4, s26, v5
s_mov_b32 m0, s26
v_mfma_f32_16x16x32_bf16 v[20:23], a[128:131], a[32:35], v[60:63]
ds_read_b128 a[128:131], v4 offset:0
v_xor_b32 v3, 0x18000, v4
v_mfma_f32_16x16x32_bf16 v[24:27], a[132:135], a[0:3], v[56:59]
v_exp_f32 v32, v32
v_mfma_f32_16x16x32_bf16 v[28:31], a[132:135], a[32:35], v[60:63]
ds_read_b128 a[132:135], v4 offset:1024
v_mfma_f32_16x16x32_bf16 v[16:19], a[136:139], a[4:7], v[16:19]
v_exp_f32 v33, v33
v_mfma_f32_16x16x32_bf16 v[20:23], a[136:139], a[36:39], v[20:23]
ds_read_b128 a[136:139], v4 offset:2048
v_mfma_f32_16x16x32_bf16 v[24:27], a[140:143], a[4:7], v[24:27]
v_exp_f32 v34, v34
v_mfma_f32_16x16x32_bf16 v[28:31], a[140:143], a[36:39], v[28:31]
ds_read_b128 a[140:143], v4 offset:3072
v_cvt_pk_bf16_f32 v48, v32, v33
v_mfma_f32_16x16x32_bf16 v[16:19], a[144:147], a[8:11], v[16:19]
v_exp_f32 v35, v35
v_mfma_f32_16x16x32_bf16 v[20:23], a[144:147], a[40:43], v[20:23]
ds_read_b128 a[144:147], v4 offset:4096
v_mfma_f32_16x16x32_bf16 v[24:27], a[148:151], a[8:11], v[24:27]
v_exp_f32 v40, v40
v_mfma_f32_16x16x32_bf16 v[28:31], a[148:151], a[40:43], v[28:31]
ds_read_b128 a[148:151], v4 offset:5120
v_cvt_pk_bf16_f32 v49, v34, v35
v_mfma_f32_16x16x32_bf16 v[16:19], a[152:155], a[12:15], v[16:19]
v_exp_f32 v41, v41
v_mfma_f32_16x16x32_bf16 v[20:23], a[152:155], a[44:47], v[20:23]
ds_read_b128 a[152:155], v4 offset:6144
v_mfma_f32_16x16x32_bf16 v[24:27], a[156:159], a[12:15], v[24:27]
v_exp_f32 v42, v42
v_mfma_f32_16x16x32_bf16 v[28:31], a[156:159], a[44:47], v[28:31]
ds_read_b128 a[156:159], v4 offset:7168
s_waitcnt lgkmcnt(7)
v_mfma_f32_16x16x32_bf16 v[16:19], a[160:163], a[16:19], v[16:19]
v_exp_f32 v43, v43
v_mfma_f32_16x16x32_bf16 v[20:23], a[160:163], a[48:51], v[20:23]
ds_read_b128 a[160:163], v4 offset:8192
v_cvt_pk_bf16_f32 v50, v40, v41
v_mfma_f32_16x16x32_bf16 v[24:27], a[164:167], a[16:19], v[24:27]
buffer_load_dwordx4 v6, s[4:7], s21 offen offset:0 sc1 lds
v_mfma_f32_16x16x32_bf16 v[28:31], a[164:167], a[48:51], v[28:31]
ds_read_b128 a[164:167], v4 offset:9216
v_cvt_pk_bf16_f32 v51, v42, v43
v_mfma_f32_16x16x32_bf16 v[16:19], a[168:171], a[20:23], v[16:19]
v_mfma_f32_16x16x32_bf16 v[20:23], a[168:171], a[52:55], v[20:23]
ds_read_b128 a[168:171], v4 offset:10240
v_mfma_f32_16x16x32_bf16 v[24:27], a[172:175], a[20:23], v[24:27]
buffer_load_dwordx4 v6, s[4:7], s21 offen offset:1024 sc1 lds
v_mfma_f32_16x16x32_bf16 v[28:31], a[172:175], a[52:55], v[28:31]
ds_read_b128 a[172:175], v4 offset:11264
v_mfma_f32_16x16x32_bf16 v[16:19], a[176:179], a[24:27], v[16:19]
v_mfma_f32_16x16x32_bf16 v[20:23], a[176:179], a[56:59], v[20:23]
ds_read_b128 a[176:179], v4 offset:12288
v_mfma_f32_16x16x32_bf16 v[24:27], a[180:183], a[24:27], v[24:27]
buffer_load_dwordx4 v6, s[4:7], s21 offen offset:2048 sc1 lds
v_mfma_f32_16x16x32_bf16 v[28:31], a[180:183], a[56:59], v[28:31]
ds_read_b128 a[180:183], v4 offset:13312
v_mfma_f32_16x16x32_bf16 v[16:19], a[184:187], a[28:31], v[16:19]
v_mfma_f32_16x16x32_bf16 v[20:23], a[184:187], a[60:63], v[20:23]
ds_read_b128 a[184:187], v4 offset:14336
v_mfma_f32_16x16x32_bf16 v[24:27], a[188:191], a[28:31], v[24:27]
buffer_load_dwordx4 v6, s[4:7], s21 offen offset:3072 sc1 lds
v_mfma_f32_16x16x32_bf16 v[28:31], a[188:191], a[60:63], v[28:31]
ds_read_b128 a[188:191], v4 offset:15360
s_waitcnt lgkmcnt(8)
v_mfma_f32_16x16x32_bf16 v[128:131], a[128:131], v[48:51], v[128:131]
v_exp_f32 v36, v36
v_mfma_f32_16x16x32_bf16 v[136:139], a[132:135], v[48:51], v[136:139]
s_cmp_ge_u32 s27, s28
v_mfma_f32_16x16x32_bf16 v[64:67], v[72:75], v[48:51], v[64:67]
v_exp_f32 v37, v37
v_mfma_f32_16x16x32_bf16 v[144:147], a[136:139], v[48:51], v[144:147]
s_cbranch_scc1 L_k2_mask1_1
L_k2_maskret1_1:
v_mfma_f32_16x16x32_bf16 v[152:155], a[140:143], v[48:51], v[152:155]
v_exp_f32 v38, v38
v_mfma_f32_16x16x32_bf16 v[160:163], a[144:147], v[48:51], v[160:163]
v_cvt_pk_bf16_f32 v52, v36, v37
v_max3_f32 v9, v16, v17, v18
v_mfma_f32_16x16x32_bf16 v[168:171], a[148:151], v[48:51], v[168:171]
v_exp_f32 v39, v39
v_mfma_f32_16x16x32_bf16 v[176:179], a[152:155], v[48:51], v[176:179]
s_waitcnt lgkmcnt(0)
v_max3_f32 v10, v19, v24, v25
v_mfma_f32_16x16x32_bf16 v[184:187], a[156:159], v[48:51], v[184:187]
v_exp_f32 v44, v44
v_mfma_f32_16x16x32_bf16 v[192:195], a[160:163], v[48:51], v[192:195]
v_cvt_pk_bf16_f32 v53, v38, v39
v_max3_f32 v11, v26, v27, v20
v_mfma_f32_16x16x32_bf16 v[200:203], a[164:167], v[48:51], v[200:203]
v_exp_f32 v45, v45
v_mfma_f32_16x16x32_bf16 v[208:211], a[168:171], v[48:51], v[208:211]
v_max3_f32 v9, v9, v21, v22
v_max3_f32 v10, v10, v23, v28
v_mfma_f32_16x16x32_bf16 v[216:219], a[172:175], v[48:51], v[216:219]
v_exp_f32 v46, v46
v_mfma_f32_16x16x32_bf16 v[224:227], a[176:179], v[48:51], v[224:227]
v_cvt_pk_bf16_f32 v54, v44, v45
v_max3_f32 v11, v11, v29, v30
v_mfma_f32_16x16x32_bf16 v[232:235], a[180:183], v[48:51], v[232:235]
v_exp_f32 v47, v47
v_mfma_f32_16x16x32_bf16 v[240:243], a[184:187], v[48:51], v[240:243]
v_cvt_pk_bf16_f32 v55, v46, v47
v_max3_f32 v9, v9, v10, v31
v_mfma_f32_16x16x32_bf16 v[248:251], a[188:191], v[48:51], v[248:251]
v_max_f32 v9, v9, v11
v_cmp_lt_f32 vcc, 0x41c00000, v9
v_mfma_f32_16x16x32_bf16 v[132:135], a[128:131], v[52:55], v[132:135]
ds_read_b128 a[128:131], v3 offset:0
v_mfma_f32_16x16x32_bf16 v[140:143], a[132:135], v[52:55], v[140:143]
ds_read_b128 a[132:135], v3 offset:8192
v_mfma_f32_16x16x32_bf16 v[68:71], v[72:75], v[52:55], v[68:71]
s_add_u32 m0, s25, 0x10000
s_add_u32 s27, s27, 1
v_mfma_f32_16x16x32_bf16 v[148:151], a[136:139], v[52:55], v[148:151]
ds_read_b128 a[136:139], v3 offset:1024
buffer_load_dwordx4 v6, s[8:11], s20 offen offset:0 sc1 lds
v_mfma_f32_16x16x32_bf16 v[156:159], a[140:143], v[52:55], v[156:159]
ds_read_b128 a[140:143], v3 offset:9216
s_add_u32 s25, s26, 16384
v_mfma_f32_16x16x32_bf16 v[164:167], a[144:147], v[52:55], v[164:167]
ds_read_b128 a[144:147], v3 offset:2048
buffer_load_dwordx4 v6, s[8:11], s20 offen offset:1024 sc1 lds
v_mfma_f32_16x16x32_bf16 v[172:175], a[148:151], v[52:55], v[172:175]
ds_read_b128 a[148:151], v3 offset:10240
s_and_b32 s25, s25, 0xffff
v_mfma_f32_16x16x32_bf16 v[180:183], a[152:155], v[52:55], v[180:183]
ds_read_b128 a[152:155], v3 offset:3072
buffer_load_dwordx4 v6, s[8:11], s20 offen offset:2048 sc1 lds
v_mfma_f32_16x16x32_bf16 v[188:191], a[156:159], v[52:55], v[188:191]
ds_read_b128 a[156:159], v3 offset:11264
v_mfma_f32_16x16x32_bf16 v[196:199], a[160:163], v[52:55], v[196:199]
ds_read_b128 a[160:163], v3 offset:4096
buffer_load_dwordx4 v6, s[8:11], s20 offen offset:3072 sc1 lds
v_mfma_f32_16x16x32_bf16 v[204:207], a[164:167], v[52:55], v[204:207]
ds_read_b128 a[164:167], v3 offset:12288
s_add_u32 s20, s21, 16384
v_mfma_f32_16x16x32_bf16 v[212:215], a[168:171], v[52:55], v[212:215]
ds_read_b128 a[168:171], v3 offset:5120
s_sub_u32 s22, s22, 1
v_mfma_f32_16x16x32_bf16 v[220:223], a[172:175], v[52:55], v[220:223]
ds_read_b128 a[172:175], v3 offset:13312
s_cmp_eq_u32 s22, 0
v_mfma_f32_16x16x32_bf16 v[228:231], a[176:179], v[52:55], v[228:231]
ds_read_b128 a[176:179], v3 offset:6144
s_waitcnt vmcnt(12)
s_barrier
s_nop 0
s_cselect_b32 s20, s23, s20
v_mfma_f32_16x16x32_bf16 v[236:239], a[180:183], v[52:55], v[236:239]
ds_read_b128 a[180:183], v3 offset:14336
s_cselect_b32 s22, s24, s22
v_mfma_f32_16x16x32_bf16 v[244:247], a[184:187], v[52:55], v[244:247]
ds_read_b128 a[184:187], v3 offset:7168
s_cselect_b32 s23, s62, s23
v_mfma_f32_16x16x32_bf16 v[252:255], a[188:191], v[52:55], v[252:255]
ds_read_b128 a[188:191], v3 offset:15360
s_waitcnt lgkmcnt(8)
s_cbranch_vccnz L_k2_resc1_1
L_k2_rescret1_1:
s_branch L_k2_loop_1
L_k2_final_1:
s_cmp_eq_u32 s65, 2
s_cbranch_scc1 L_k2_ec_1
L_k2_ecret_1:
s_waitcnt lgkmcnt(0)
v_add_u32 v4, s26, v5
s_mov_b32 m0, s26
ds_read_b128 a[128:131], v4 offset:0
ds_read_b128 a[132:135], v4 offset:1024
ds_read_b128 a[136:139], v4 offset:2048
ds_read_b128 a[140:143], v4 offset:3072
ds_read_b128 a[144:147], v4 offset:4096
ds_read_b128 a[148:151], v4 offset:5120
ds_read_b128 a[152:155], v4 offset:6144
ds_read_b128 a[156:159], v4 offset:7168
ds_read_b128 a[160:163], v4 offset:8192
ds_read_b128 a[164:167], v4 offset:9216
ds_read_b128 a[168:171], v4 offset:10240
ds_read_b128 a[172:175], v4 offset:11264
v_exp_f32 v32, v32
buffer_load_dwordx4 v6, s[4:7], s21 offen offset:0 sc1 lds
v_exp_f32 v33, v33
v_exp_f32 v34, v34
v_exp_f32 v35, v35
v_cvt_pk_bf16_f32 v48, v32, v33
v_exp_f32 v40, v40
buffer_load_dwordx4 v6, s[4:7], s21 offen offset:1024 sc1 lds
v_exp_f32 v41, v41
v_cvt_pk_bf16_f32 v49, v34, v35
v_exp_f32 v42, v42
v_exp_f32 v43, v43
v_cvt_pk_bf16_f32 v50, v40, v41
v_exp_f32 v36, v36
buffer_load_dwordx4 v6, s[4:7], s21 offen offset:2048 sc1 lds
v_exp_f32 v37, v37
v_cvt_pk_bf16_f32 v51, v42, v43
v_exp_f32 v38, v38
v_exp_f32 v39, v39
v_cvt_pk_bf16_f32 v52, v36, v37
v_exp_f32 v44, v44
buffer_load_dwordx4 v6, s[4:7], s21 offen offset:3072 sc1 lds
v_exp_f32 v45, v45
v_cvt_pk_bf16_f32 v53, v38, v39
v_exp_f32 v46, v46
v_exp_f32 v47, v47
v_cvt_pk_bf16_f32 v54, v44, v45
s_nop 0
s_waitcnt lgkmcnt(8)
v_mfma_f32_16x16x32_bf16 v[128:131], a[128:131], v[48:51], v[128:131]
v_cvt_pk_bf16_f32 v55, v46, v47
ds_read_b128 a[176:179], v4 offset:12288
v_mfma_f32_16x16x32_bf16 v[64:67], v[72:75], v[48:51], v[64:67]
v_mfma_f32_16x16x32_bf16 v[132:135], a[128:131], v[52:55], v[132:135]
v_mfma_f32_16x16x32_bf16 v[68:71], v[72:75], v[52:55], v[68:71]
v_mfma_f32_16x16x32_bf16 v[136:139], a[132:135], v[48:51], v[136:139]
ds_read_b128 a[180:183], v4 offset:13312
v_mfma_f32_16x16x32_bf16 v[140:143], a[132:135], v[52:55], v[140:143]
v_mfma_f32_16x16x32_bf16 v[144:147], a[136:139], v[48:51], v[144:147]
ds_read_b128 a[184:187], v4 offset:14336
s_add_u32 m0, s25, 0x10000
v_mfma_f32_16x16x32_bf16 v[148:151], a[136:139], v[52:55], v[148:151]
v_mfma_f32_16x16x32_bf16 v[152:155], a[140:143], v[48:51], v[152:155]
ds_read_b128 a[188:191], v4 offset:15360
v_mfma_f32_16x16x32_bf16 v[156:159], a[140:143], v[52:55], v[156:159]
buffer_load_dwordx4 v6, s[8:11], s20 offen offset:0 sc1 lds
s_waitcnt lgkmcnt(8)
v_mfma_f32_16x16x32_bf16 v[160:163], a[144:147], v[48:51], v[160:163]
v_mfma_f32_16x16x32_bf16 v[164:167], a[144:147], v[52:55], v[164:167]
v_mfma_f32_16x16x32_bf16 v[168:171], a[148:151], v[48:51], v[168:171]
v_mfma_f32_16x16x32_bf16 v[172:175], a[148:151], v[52:55], v[172:175]
v_mfma_f32_16x16x32_bf16 v[176:179], a[152:155], v[48:51], v[176:179]
v_mfma_f32_16x16x32_bf16 v[180:183], a[152:155], v[52:55], v[180:183]
buffer_load_dwordx4 v6, s[8:11], s20 offen offset:1024 sc1 lds
v_mfma_f32_16x16x32_bf16 v[184:187], a[156:159], v[48:51], v[184:187]
v_mfma_f32_16x16x32_bf16 v[188:191], a[156:159], v[52:55], v[188:191]
s_waitcnt lgkmcnt(4)
v_mfma_f32_16x16x32_bf16 v[192:195], a[160:163], v[48:51], v[192:195]
v_mfma_f32_16x16x32_bf16 v[196:199], a[160:163], v[52:55], v[196:199]
v_mfma_f32_16x16x32_bf16 v[200:203], a[164:167], v[48:51], v[200:203]
v_mfma_f32_16x16x32_bf16 v[204:207], a[164:167], v[52:55], v[204:207]
buffer_load_dwordx4 v6, s[8:11], s20 offen offset:2048 sc1 lds
v_mfma_f32_16x16x32_bf16 v[208:211], a[168:171], v[48:51], v[208:211]
v_mfma_f32_16x16x32_bf16 v[212:215], a[168:171], v[52:55], v[212:215]
s_add_u32 s27, s27, 1
v_mfma_f32_16x16x32_bf16 v[216:219], a[172:175], v[48:51], v[216:219]
v_mfma_f32_16x16x32_bf16 v[220:223], a[172:175], v[52:55], v[220:223]
s_waitcnt lgkmcnt(0)
v_mfma_f32_16x16x32_bf16 v[224:227], a[176:179], v[48:51], v[224:227]
v_mfma_f32_16x16x32_bf16 v[228:231], a[176:179], v[52:55], v[228:231]
buffer_load_dwordx4 v6, s[8:11], s20 offen offset:3072 sc1 lds
v_mfma_f32_16x16x32_bf16 v[232:235], a[180:183], v[48:51], v[232:235]
s_add_u32 s20, s21, 16384
v_mfma_f32_16x16x32_bf16 v[236:239], a[180:183], v[52:55], v[236:239]
s_sub_u32 s22, s22, 1
s_cmp_eq_u32 s22, 0
v_mfma_f32_16x16x32_bf16 v[240:243], a[184:187], v[48:51], v[240:243]
s_waitcnt vmcnt(12)
s_barrier
s_nop 0
v_mfma_f32_16x16x32_bf16 v[244:247], a[184:187], v[52:55], v[244:247]
s_cselect_b32 s20, s23, s20
s_cselect_b32 s22, s24, s22
v_mfma_f32_16x16x32_bf16 v[248:251], a[188:191], v[48:51], v[248:251]
v_mfma_f32_16x16x32_bf16 v[252:255], a[188:191], v[52:55], v[252:255]
s_cselect_b32 s23, s62, s23
s_branch L_k2_segend
.p2align 6
L_k2_loop_2:
v_mfma_f32_16x16x32_bf16 v[32:35], a[128:131], a[0:3], v[56:59]
v_add_u32 v4, s25, v5
s_mov_b32 m0, s25
v_mfma_f32_16x16x32_bf16 v[36:39], a[128:131], a[32:35], v[60:63]
ds_read_b128 a[128:131], v4 offset:0
v_xor_b32 v2, 0x18000, v4
v_mfma_f32_16x16x32_bf16 v[40:43], a[132:135], a[0:3], v[56:59]
v_exp_f32 v16, v16
v_mfma_f32_16x16x32_bf16 v[44:47], a[132:135], a[32:35], v[60:63]
ds_read_b128 a[132:135], v4 offset:1024
v_mfma_f32_16x16x32_bf16 v[32:35], a[136:139], a[4:7], v[32:35]
v_exp_f32 v17, v17
v_mfma_f32_16x16x32_bf16 v[36:39], a[136:139], a[36:39], v[36:39]
ds_read_b128 a[136:139], v4 offset:2048
v_mfma_f32_16x16x32_bf16 v[40:43], a[140:143], a[4:7], v[40:43]
v_exp_f32 v18, v18
v_mfma_f32_16x16x32_bf16 v[44:47], a[140:143], a[36:39], v[44:47]
ds_read_b128 a[140:143], v4 offset:3072
v_cvt_pk_bf16_f32 v48, v16, v17
v_mfma_f32_16x16x32_bf16 v[32:35], a[144:147], a[8:11], v[32:35]
v_exp_f32 v19, v19
v_mfma_f32_16x16x32_bf16 v[36:39], a[144:147], a[40:43], v[36:39]
ds_read_b128 a[144:147], v4 offset:4096
v_mfma_f32_16x16x32_bf16 v[40:43], a[148:151], a[8:11], v[40:43]
v_exp_f32 v24, v24
v_mfma_f32_16x16x32_bf16 v[44:47], a[148:151], a[40:43], v[44:47]
ds_read_b128 a[148:151], v4 offset:5120
v_cvt_pk_bf16_f32 v49, v18, v19
v_mfma_f32_16x16x32_bf16 v[32:35], a[152:155], a[12:15], v[32:35]
v_exp_f32 v25, v25
v_mfma_f32_16x16x32_bf16 v[36:39], a[152:155], a[44:47], v[36:39]
ds_read_b128 a[152:155], v4 offset:6144
v_mfma_f32_16x16x32_bf16 v[40:43], a[156:159], a[12:15], v[40:43]
v_exp_f32 v26, v26
v_mfma_f32_16x16x32_bf16 v[44:47], a[156:159], a[44:47], v[44:47]
ds_read_b128 a[156:159], v4 offset:7168
s_waitcnt lgkmcnt(7)
v_mfma_f32_16x16x32_bf16 v[32:35], a[160:163], a[16:19], v[32:35]
v_exp_f32 v27, v27
v_mfma_f32_16x16x32_bf16 v[36:39], a[160:163], a[48:51], v[36:39]
ds_read_b128 a[160:163], v4 offset:8192
v_cvt_pk_bf16_f32 v50, v24, v25
v_mfma_f32_16x16x32_bf16 v[40:43], a[164:167], a[16:19], v[40:43]
buffer_load_dwordx4 v6, s[4:7], s20 offen offset:0 sc1 lds
v_mfma_f32_16x16x32_bf16 v[44:47], a[164:167], a[48:51], v[44:47]
ds_read_b128 a[164:167], v4 offset:9216
v_cvt_pk_bf16_f32 v51, v26, v27
v_mfma_f32_16x16x32_bf16 v[32:35], a[168:171], a[20:23], v[32:35]
s_cmp_eq_u32 s27, s90
s_cbranch_scc1 L_k2_fl_2
L_k2_flret_2:
v_mfma_f32_16x16x32_bf16 v[36:39], a[168:171], a[52:55], v[36:39]
ds_read_b128 a[168:171], v4 offset:10240
v_mfma_f32_16x16x32_bf16 v[40:43], a[172:175], a[20:23], v[40:43]
buffer_load_dwordx4 v6, s[4:7], s20 offen offset:1024 sc1 lds
v_mfma_f32_16x16x32_bf16 v[44:47], a[172:175], a[52:55], v[44:47]
ds_read_b128 a[172:175], v4 offset:11264
v_mfma_f32_16x16x32_bf16 v[32:35], a[176:179], a[24:27], v[32:35]
v_mfma_f32_16x16x32_bf16 v[36:39], a[176:179], a[56:59], v[36:39]
ds_read_b128 a[176:179], v4 offset:12288
v_mfma_f32_16x16x32_bf16 v[40:43], a[180:183], a[24:27], v[40:43]
buffer_load_dwordx4 v6, s[4:7], s20 offen offset:2048 sc1 lds
v_mfma_f32_16x16x32_bf16 v[44:47], a[180:183], a[56:59], v[44:47]
ds_read_b128 a[180:183], v4 offset:13312
v_mfma_f32_16x16x32_bf16 v[32:35], a[184:187], a[28:31], v[32:35]
v_mfma_f32_16x16x32_bf16 v[36:39], a[184:187], a[60:63], v[36:39]
ds_read_b128 a[184:187], v4 offset:14336
v_mfma_f32_16x16x32_bf16 v[40:43], a[188:191], a[28:31], v[40:43]
buffer_load_dwordx4 v6, s[4:7], s20 offen offset:3072 sc1 lds
v_mfma_f32_16x16x32_bf16 v[44:47], a[188:191], a[60:63], v[44:47]
ds_read_b128 a[188:191], v4 offset:15360
s_waitcnt lgkmcnt(8)
v_mfma_f32_16x16x32_bf16 v[128:131], a[128:131], v[48:51], v[128:131]
v_exp_f32 v20, v20
v_mfma_f32_16x16x32_bf16 v[136:139], a[132:135], v[48:51], v[136:139]
s_cmp_ge_u32 s27, s28
v_mfma_f32_16x16x32_bf16 v[64:67], v[72:75], v[48:51], v[64:67]
v_exp_f32 v21, v21
v_mfma_f32_16x16x32_bf16 v[144:147], a[136:139], v[48:51], v[144:147]
s_cbranch_scc1 L_k2_mask0_2
L_k2_maskret0_2:
v_mfma_f32_16x16x32_bf16 v[152:155], a[140:143], v[48:51], v[152:155]
v_exp_f32 v22, v22
v_mfma_f32_16x16x32_bf16 v[160:163], a[144:147], v[48:51], v[160:163]
v_cvt_pk_bf16_f32 v52, v20, v21
v_max3_f32 v9, v32, v33, v34
v_mfma_f32_16x16x32_bf16 v[168:171], a[148:151], v[48:51], v[168:171]
v_exp_f32 v23, v23
v_mfma_f32_16x16x32_bf16 v[176:179], a[152:155], v[48:51], v[176:179]
s_waitcnt lgkmcnt(0)
v_max3_f32 v10, v35, v40, v41
v_mfma_f32_16x16x32_bf16 v[184:187], a[156:159], v[48:51], v[184:187]
v_exp_f32 v28, v28
v_mfma_f32_16x16x32_bf16 v[192:195], a[160:163], v[48:51], v[192:195]
v_cvt_pk_bf16_f32 v53, v22, v23
v_max3_f32 v11, v42, v43, v36
v_mfma_f32_16x16x32_bf16 v[200:203], a[164:167], v[48:51], v[200:203]
v_exp_f32 v29, v29
v_mfma_f32_16x16x32_bf16 v[208:211], a[168:171], v[48:51], v[208:211]
v_max3_f32 v9, v9, v37, v38
v_max3_f32 v10, v10, v39, v44
v_mfma_f32_16x16x32_bf16 v[216:219], a[172:175], v[48:51], v[216:219]
v_exp_f32 v30, v30
v_mfma_f32_16x16x32_bf16 v[224:227], a[176:179], v[48:51], v[224:227]
v_cvt_pk_bf16_f32 v54, v28, v29
v_max3_f32 v11, v11, v45, v46
v_mfma_f32_16x16x32_bf16 v[232:235], a[180:183], v[48:51], v[232:235]
v_exp_f32 v31, v31
v_mfma_f32_16x16x32_bf16 v[240:243], a[184:187], v[48:51], v[240:243]
v_cvt_pk_bf16_f32 v55, v30, v31
v_max3_f32 v9, v9, v10, v47
v_mfma_f32_16x16x32_bf16 v[248:251], a[188:191], v[48:51], v[248:251]
v_max_f32 v9, v9, v11
v_cmp_lt_f32 vcc, 0x41c00000, v9
v_mfma_f32_16x16x32_bf16 v[132:135], a[128:131], v[52:55], v[132:135]
ds_read_b128 a[128:131], v2 offset:0
v_mfma_f32_16x16x32_bf16 v[140:143], a[132:135], v[52:55], v[140:143]
ds_read_b128 a[132:135], v2 offset:8192
v_mfma_f32_16x16x32_bf16 v[68:71], v[72:75], v[52:55], v[68:71]
s_add_u32 m0, s26, 0x10000
s_add_u32 s27, s27, 1
v_mfma_f32_16x16x32_bf16 v[148:151], a[136:139], v[52:55], v[148:151]
ds_read_b128 a[136:139], v2 offset:1024
buffer_load_dwordx4 v6, s[8:11], s21 offen offset:0 sc1 lds
v_mfma_f32_16x16x32_bf16 v[156:159], a[140:143], v[52:55], v[156:159]
ds_read_b128 a[140:143], v2 offset:9216
s_add_u32 s26, s25, 16384
v_mfma_f32_16x16x32_bf16 v[164:167], a[144:147], v[52:55], v[164:167]
ds_read_b128 a[144:147], v2 offset:2048
buffer_load_dwordx4 v6, s[8:11], s21 offen offset:1024 sc1 lds
v_mfma_f32_16x16x32_bf16 v[172:175], a[148:151], v[52:55], v[172:175]
ds_read_b128 a[148:151], v2 offset:10240
s_and_b32 s26, s26, 0xffff
v_mfma_f32_16x16x32_bf16 v[180:183], a[152:155], v[52:55], v[180:183]
ds_read_b128 a[152:155], v2 offset:3072
buffer_load_dwordx4 v6, s[8:11], s21 offen offset:2048 sc1 lds
v_mfma_f32_16x16x32_bf16 v[188:191], a[156:159], v[52:55], v[188:191]
ds_read_b128 a[156:159], v2 offset:11264
v_mfma_f32_16x16x32_bf16 v[196:199], a[160:163], v[52:55], v[196:199]
ds_read_b128 a[160:163], v2 offset:4096
buffer_load_dwordx4 v6, s[8:11], s21 offen offset:3072 sc1 lds
v_mfma_f32_16x16x32_bf16 v[204:207], a[164:167], v[52:55], v[204:207]
ds_read_b128 a[164:167], v2 offset:12288
s_add_u32 s21, s20, 16384
v_mfma_f32_16x16x32_bf16 v[212:215], a[168:171], v[52:55], v[212:215]
ds_read_b128 a[168:171], v2 offset:5120
s_sub_u32 s22, s22, 1
v_mfma_f32_16x16x32_bf16 v[220:223], a[172:175], v[52:55], v[220:223]
ds_read_b128 a[172:175], v2 offset:13312
s_cmp_eq_u32 s22, 0
v_mfma_f32_16x16x32_bf16 v[228:231], a[176:179], v[52:55], v[228:231]
ds_read_b128 a[176:179], v2 offset:6144
s_waitcnt vmcnt(12)
s_barrier
s_nop 1
s_cselect_b32 s21, s23, s21
v_mfma_f32_16x16x32_bf16 v[236:239], a[180:183], v[52:55], v[236:239]
ds_read_b128 a[180:183], v2 offset:14336
s_cselect_b32 s22, s24, s22
v_mfma_f32_16x16x32_bf16 v[244:247], a[184:187], v[52:55], v[244:247]
ds_read_b128 a[184:187], v2 offset:7168
s_cselect_b32 s23, s62, s23
v_mfma_f32_16x16x32_bf16 v[252:255], a[188:191], v[52:55], v[252:255]
ds_read_b128 a[188:191], v2 offset:15360
s_waitcnt lgkmcnt(8)
s_cmp_eq_u32 s27, s29
s_cbranch_vccnz L_k2_resc0_2
L_k2_rescret0_2:
s_cbranch_scc1 L_k2_final_2
v_mfma_f32_16x16x32_bf16 v[16:19], a[128:131], a[0:3], v[56:59]
v_add_u32 v4, s26, v5
s_mov_b32 m0, s26
v_mfma_f32_16x16x32_bf16 v[20:23], a[128:131], a[32:35], v[60:63]
ds_read_b128 a[128:131], v4 offset:0
v_xor_b32 v3, 0x18000, v4
v_mfma_f32_16x16x32_bf16 v[24:27], a[132:135], a[0:3], v[56:59]
v_exp_f32 v32, v32
v_mfma_f32_16x16x32_bf16 v[28:31], a[132:135], a[32:35], v[60:63]
ds_read_b128 a[132:135], v4 offset:1024
v_mfma_f32_16x16x32_bf16 v[16:19], a[136:139], a[4:7], v[16:19]
v_exp_f32 v33, v33
v_mfma_f32_16x16x32_bf16 v[20:23], a[136:139], a[36:39], v[20:23]
ds_read_b128 a[136:139], v4 offset:2048
v_mfma_f32_16x16x32_bf16 v[24:27], a[140:143], a[4:7], v[24:27]
v_exp_f32 v34, v34
v_mfma_f32_16x16x32_bf16 v[28:31], a[140:143], a[36:39], v[28:31]
ds_read_b128 a[140:143], v4 offset:3072
v_cvt_pk_bf16_f32 v48, v32, v33
v_mfma_f32_16x16x32_bf16 v[16:19], a[144:147], a[8:11], v[16:19]
v_exp_f32 v35, v35
v_mfma_f32_16x16x32_bf16 v[20:23], a[144:147], a[40:43], v[20:23]
ds_read_b128 a[144:147], v4 offset:4096
v_mfma_f32_16x16x32_bf16 v[24:27], a[148:151], a[8:11], v[24:27]
v_exp_f32 v40, v40
v_mfma_f32_16x16x32_bf16 v[28:31], a[148:151], a[40:43], v[28:31]
ds_read_b128 a[148:151], v4 offset:5120
v_cvt_pk_bf16_f32 v49, v34, v35
v_mfma_f32_16x16x32_bf16 v[16:19], a[152:155], a[12:15], v[16:19]
v_exp_f32 v41, v41
v_mfma_f32_16x16x32_bf16 v[20:23], a[152:155], a[44:47], v[20:23]
ds_read_b128 a[152:155], v4 offset:6144
v_mfma_f32_16x16x32_bf16 v[24:27], a[156:159], a[12:15], v[24:27]
v_exp_f32 v42, v42
v_mfma_f32_16x16x32_bf16 v[28:31], a[156:159], a[44:47], v[28:31]
ds_read_b128 a[156:159], v4 offset:7168
s_waitcnt lgkmcnt(7)
v_mfma_f32_16x16x32_bf16 v[16:19], a[160:163], a[16:19], v[16:19]
v_exp_f32 v43, v43
v_mfma_f32_16x16x32_bf16 v[20:23], a[160:163], a[48:51], v[20:23]
ds_read_b128 a[160:163], v4 offset:8192
v_cvt_pk_bf16_f32 v50, v40, v41
v_mfma_f32_16x16x32_bf16 v[24:27], a[164:167], a[16:19], v[24:27]
buffer_load_dwordx4 v6, s[4:7], s21 offen offset:0 sc1 lds
v_mfma_f32_16x16x32_bf16 v[28:31], a[164:167], a[48:51], v[28:31]
ds_read_b128 a[164:167], v4 offset:9216
v_cvt_pk_bf16_f32 v51, v42, v43
v_mfma_f32_16x16x32_bf16 v[16:19], a[168:171], a[20:23], v[16:19]
v_mfma_f32_16x16x32_bf16 v[20:23], a[168:171], a[52:55], v[20:23]
ds_read_b128 a[168:171], v4 offset:10240
v_mfma_f32_16x16x32_bf16 v[24:27], a[172:175], a[20:23], v[24:27]
buffer_load_dwordx4 v6, s[4:7], s21 offen offset:1024 sc1 lds
v_mfma_f32_16x16x32_bf16 v[28:31], a[172:175], a[52:55], v[28:31]
ds_read_b128 a[172:175], v4 offset:11264
v_mfma_f32_16x16x32_bf16 v[16:19], a[176:179], a[24:27], v[16:19]
v_mfma_f32_16x16x32_bf16 v[20:23], a[176:179], a[56:59], v[20:23]
ds_read_b128 a[176:179], v4 offset:12288
v_mfma_f32_16x16x32_bf16 v[24:27], a[180:183], a[24:27], v[24:27]
buffer_load_dwordx4 v6, s[4:7], s21 offen offset:2048 sc1 lds
v_mfma_f32_16x16x32_bf16 v[28:31], a[180:183], a[56:59], v[28:31]
ds_read_b128 a[180:183], v4 offset:13312
v_mfma_f32_16x16x32_bf16 v[16:19], a[184:187], a[28:31], v[16:19]
v_mfma_f32_16x16x32_bf16 v[20:23], a[184:187], a[60:63], v[20:23]
ds_read_b128 a[184:187], v4 offset:14336
v_mfma_f32_16x16x32_bf16 v[24:27], a[188:191], a[28:31], v[24:27]
buffer_load_dwordx4 v6, s[4:7], s21 offen offset:3072 sc1 lds
v_mfma_f32_16x16x32_bf16 v[28:31], a[188:191], a[60:63], v[28:31]
ds_read_b128 a[188:191], v4 offset:15360
s_waitcnt lgkmcnt(8)
v_mfma_f32_16x16x32_bf16 v[128:131], a[128:131], v[48:51], v[128:131]
v_exp_f32 v36, v36
v_mfma_f32_16x16x32_bf16 v[136:139], a[132:135], v[48:51], v[136:139]
s_cmp_ge_u32 s27, s28
v_mfma_f32_16x16x32_bf16 v[64:67], v[72:75], v[48:51], v[64:67]
v_exp_f32 v37, v37
v_mfma_f32_16x16x32_bf16 v[144:147], a[136:139], v[48:51], v[144:147]
s_cbranch_scc1 L_k2_mask1_2
L_k2_maskret1_2:
v_mfma_f32_16x16x32_bf16 v[152:155], a[140:143], v[48:51], v[152:155]
v_exp_f32 v38, v38
v_mfma_f32_16x16x32_bf16 v[160:163], a[144:147], v[48:51], v[160:163]
v_cvt_pk_bf16_f32 v52, v36, v37
v_max3_f32 v9, v16, v17, v18
v_mfma_f32_16x16x32_bf16 v[168:171], a[148:151], v[48:51], v[168:171]
v_exp_f32 v39, v39
v_mfma_f32_16x16x32_bf16 v[176:179], a[152:155], v[48:51], v[176:179]
s_waitcnt lgkmcnt(0)
v_max3_f32 v10, v19, v24, v25
v_mfma_f32_16x16x32_bf16 v[184:187], a[156:159], v[48:51], v[184:187]
v_exp_f32 v44, v44
v_mfma_f32_16x16x32_bf16 v[192:195], a[160:163], v[48:51], v[192:195]
v_cvt_pk_bf16_f32 v53, v38, v39
v_max3_f32 v11, v26, v27, v20
v_mfma_f32_16x16x32_bf16 v[200:203], a[164:167], v[48:51], v[200:203]
v_exp_f32 v45, v45
v_mfma_f32_16x16x32_bf16 v[208:211], a[168:171], v[48:51], v[208:211]
v_max3_f32 v9, v9, v21, v22
v_max3_f32 v10, v10, v23, v28
v_mfma_f32_16x16x32_bf16 v[216:219], a[172:175], v[48:51], v[216:219]
v_exp_f32 v46, v46
v_mfma_f32_16x16x32_bf16 v[224:227], a[176:179], v[48:51], v[224:227]
v_cvt_pk_bf16_f32 v54, v44, v45
v_max3_f32 v11, v11, v29, v30
v_mfma_f32_16x16x32_bf16 v[232:235], a[180:183], v[48:51], v[232:235]
v_exp_f32 v47, v47
v_mfma_f32_16x16x32_bf16 v[240:243], a[184:187], v[48:51], v[240:243]
v_cvt_pk_bf16_f32 v55, v46, v47
v_max3_f32 v9, v9, v10, v31
v_mfma_f32_16x16x32_bf16 v[248:251], a[188:191], v[48:51], v[248:251]
v_max_f32 v9, v9, v11
v_cmp_lt_f32 vcc, 0x41c00000, v9
v_mfma_f32_16x16x32_bf16 v[132:135], a[128:131], v[52:55], v[132:135]
ds_read_b128 a[128:131], v3 offset:0
v_mfma_f32_16x16x32_bf16 v[140:143], a[132:135], v[52:55], v[140:143]
ds_read_b128 a[132:135], v3 offset:8192
v_mfma_f32_16x16x32_bf16 v[68:71], v[72:75], v[52:55], v[68:71]
s_add_u32 m0, s25, 0x10000
s_add_u32 s27, s27, 1
v_mfma_f32_16x16x32_bf16 v[148:151], a[136:139], v[52:55], v[148:151]
ds_read_b128 a[136:139], v3 offset:1024
buffer_load_dwordx4 v6, s[8:11], s20 offen offset:0 sc1 lds
v_mfma_f32_16x16x32_bf16 v[156:159], a[140:143], v[52:55], v[156:159]
ds_read_b128 a[140:143], v3 offset:9216
s_add_u32 s25, s26, 16384
v_mfma_f32_16x16x32_bf16 v[164:167], a[144:147], v[52:55], v[164:167]
ds_read_b128 a[144:147], v3 offset:2048
buffer_load_dwordx4 v6, s[8:11], s20 offen offset:1024 sc1 lds
v_mfma_f32_16x16x32_bf16 v[172:175], a[148:151], v[52:55], v[172:175]
ds_read_b128 a[148:151], v3 offset:10240
s_and_b32 s25, s25, 0xffff
v_mfma_f32_16x16x32_bf16 v[180:183], a[152:155], v[52:55], v[180:183]
ds_read_b128 a[152:155], v3 offset:3072
buffer_load_dwordx4 v6, s[8:11], s20 offen offset:2048 sc1 lds
v_mfma_f32_16x16x32_bf16 v[188:191], a[156:159], v[52:55], v[188:191]
ds_read_b128 a[156:159], v3 offset:11264
v_mfma_f32_16x16x32_bf16 v[196:199], a[160:163], v[52:55], v[196:199]
ds_read_b128 a[160:163], v3 offset:4096
buffer_load_dwordx4 v6, s[8:11], s20 offen offset:3072 sc1 lds
v_mfma_f32_16x16x32_bf16 v[204:207], a[164:167], v[52:55], v[204:207]
ds_read_b128 a[164:167], v3 offset:12288
s_add_u32 s20, s21, 16384
v_mfma_f32_16x16x32_bf16 v[212:215], a[168:171], v[52:55], v[212:215]
ds_read_b128 a[168:171], v3 offset:5120
s_sub_u32 s22, s22, 1
v_mfma_f32_16x16x32_bf16 v[220:223], a[172:175], v[52:55], v[220:223]
ds_read_b128 a[172:175], v3 offset:13312
s_cmp_eq_u32 s22, 0
v_mfma_f32_16x16x32_bf16 v[228:231], a[176:179], v[52:55], v[228:231]
ds_read_b128 a[176:179], v3 offset:6144
s_waitcnt vmcnt(12)
s_barrier
s_nop 1
s_cselect_b32 s20, s23, s20
v_mfma_f32_16x16x32_bf16 v[236:239], a[180:183], v[52:55], v[236:239]
ds_read_b128 a[180:183], v3 offset:14336
s_cselect_b32 s22, s24, s22
v_mfma_f32_16x16x32_bf16 v[244:247], a[184:187], v[52:55], v[244:247]
ds_read_b128 a[184:187], v3 offset:7168
s_cselect_b32 s23, s62, s23
v_mfma_f32_16x16x32_bf16 v[252:255], a[188:191], v[52:55], v[252:255]
ds_read_b128 a[188:191], v3 offset:15360
s_waitcnt lgkmcnt(8)
s_cbranch_vccnz L_k2_resc1_2
L_k2_rescret1_2:
s_branch L_k2_loop_2
L_k2_final_2:
s_cmp_eq_u32 s65, 2
s_cbranch_scc1 L_k2_ec_2
L_k2_ecret_2:
s_waitcnt lgkmcnt(0)
v_add_u32 v4, s26, v5
s_mov_b32 m0, s26
ds_read_b128 a[128:131], v4 offset:0
ds_read_b128 a[132:135], v4 offset:1024
ds_read_b128 a[136:139], v4 offset:2048
ds_read_b128 a[140:143], v4 offset:3072
ds_read_b128 a[144:147], v4 offset:4096
ds_read_b128 a[148:151], v4 offset:5120
ds_read_b128 a[152:155], v4 offset:6144
ds_read_b128 a[156:159], v4 offset:7168
ds_read_b128 a[160:163], v4 offset:8192
ds_read_b128 a[164:167], v4 offset:9216
ds_read_b128 a[168:171], v4 offset:10240
ds_read_b128 a[172:175], v4 offset:11264
v_exp_f32 v32, v32
buffer_load_dwordx4 v6, s[4:7], s21 offen offset:0 sc1 lds
v_exp_f32 v33, v33
v_exp_f32 v34, v34
v_exp_f32 v35, v35
v_cvt_pk_bf16_f32 v48, v32, v33
v_exp_f32 v40, v40
buffer_load_dwordx4 v6, s[4:7], s21 offen offset:1024 sc1 lds
v_exp_f32 v41, v41
v_cvt_pk_bf16_f32 v49, v34, v35
v_exp_f32 v42, v42
v_exp_f32 v43, v43
v_cvt_pk_bf16_f32 v50, v40, v41
v_exp_f32 v36, v36
buffer_load_dwordx4 v6, s[4:7], s21 offen offset:2048 sc1 lds
v_exp_f32 v37, v37
v_cvt_pk_bf16_f32 v51, v42, v43
v_exp_f32 v38, v38
v_exp_f32 v39, v39
v_cvt_pk_bf16_f32 v52, v36, v37
v_exp_f32 v44, v44
buffer_load_dwordx4 v6, s[4:7], s21 offen offset:3072 sc1 lds
v_exp_f32 v45, v45
v_cvt_pk_bf16_f32 v53, v38, v39
v_exp_f32 v46, v46
v_exp_f32 v47, v47
v_cvt_pk_bf16_f32 v54, v44, v45
s_nop 0
s_waitcnt lgkmcnt(8)
v_mfma_f32_16x16x32_bf16 v[128:131], a[128:131], v[48:51], v[128:131]
v_cvt_pk_bf16_f32 v55, v46, v47
ds_read_b128 a[176:179], v4 offset:12288
v_mfma_f32_16x16x32_bf16 v[64:67], v[72:75], v[48:51], v[64:67]
v_mfma_f32_16x16x32_bf16 v[132:135], a[128:131], v[52:55], v[132:135]
v_mfma_f32_16x16x32_bf16 v[68:71], v[72:75], v[52:55], v[68:71]
v_mfma_f32_16x16x32_bf16 v[136:139], a[132:135], v[48:51], v[136:139]
ds_read_b128 a[180:183], v4 offset:13312
v_mfma_f32_16x16x32_bf16 v[140:143], a[132:135], v[52:55], v[140:143]
v_mfma_f32_16x16x32_bf16 v[144:147], a[136:139], v[48:51], v[144:147]
ds_read_b128 a[184:187], v4 offset:14336
s_add_u32 m0, s25, 0x10000
v_mfma_f32_16x16x32_bf16 v[148:151], a[136:139], v[52:55], v[148:151]
v_mfma_f32_16x16x32_bf16 v[152:155], a[140:143], v[48:51], v[152:155]
ds_read_b128 a[188:191], v4 offset:15360
v_mfma_f32_16x16x32_bf16 v[156:159], a[140:143], v[52:55], v[156:159]
buffer_load_dwordx4 v6, s[8:11], s20 offen offset:0 sc1 lds
s_waitcnt lgkmcnt(8)
v_mfma_f32_16x16x32_bf16 v[160:163], a[144:147], v[48:51], v[160:163]
v_mfma_f32_16x16x32_bf16 v[164:167], a[144:147], v[52:55], v[164:167]
v_mfma_f32_16x16x32_bf16 v[168:171], a[148:151], v[48:51], v[168:171]
v_mfma_f32_16x16x32_bf16 v[172:175], a[148:151], v[52:55], v[172:175]
v_mfma_f32_16x16x32_bf16 v[176:179], a[152:155], v[48:51], v[176:179]
v_mfma_f32_16x16x32_bf16 v[180:183], a[152:155], v[52:55], v[180:183]
buffer_load_dwordx4 v6, s[8:11], s20 offen offset:1024 sc1 lds
v_mfma_f32_16x16x32_bf16 v[184:187], a[156:159], v[48:51], v[184:187]
v_mfma_f32_16x16x32_bf16 v[188:191], a[156:159], v[52:55], v[188:191]
s_waitcnt lgkmcnt(4)
v_mfma_f32_16x16x32_bf16 v[192:195], a[160:163], v[48:51], v[192:195]
v_mfma_f32_16x16x32_bf16 v[196:199], a[160:163], v[52:55], v[196:199]
v_mfma_f32_16x16x32_bf16 v[200:203], a[164:167], v[48:51], v[200:203]
v_mfma_f32_16x16x32_bf16 v[204:207], a[164:167], v[52:55], v[204:207]
buffer_load_dwordx4 v6, s[8:11], s20 offen offset:2048 sc1 lds
v_mfma_f32_16x16x32_bf16 v[208:211], a[168:171], v[48:51], v[208:211]
v_mfma_f32_16x16x32_bf16 v[212:215], a[168:171], v[52:55], v[212:215]
s_add_u32 s27, s27, 1
v_mfma_f32_16x16x32_bf16 v[216:219], a[172:175], v[48:51], v[216:219]
v_mfma_f32_16x16x32_bf16 v[220:223], a[172:175], v[52:55], v[220:223]
s_waitcnt lgkmcnt(0)
v_mfma_f32_16x16x32_bf16 v[224:227], a[176:179], v[48:51], v[224:227]
v_mfma_f32_16x16x32_bf16 v[228:231], a[176:179], v[52:55], v[228:231]
buffer_load_dwordx4 v6, s[8:11], s20 offen offset:3072 sc1 lds
v_mfma_f32_16x16x32_bf16 v[232:235], a[180:183], v[48:51], v[232:235]
s_add_u32 s20, s21, 16384
v_mfma_f32_16x16x32_bf16 v[236:239], a[180:183], v[52:55], v[236:239]
s_sub_u32 s22, s22, 1
s_cmp_eq_u32 s22, 0
v_mfma_f32_16x16x32_bf16 v[240:243], a[184:187], v[48:51], v[240:243]
s_waitcnt vmcnt(12)
s_barrier
s_nop 1
v_mfma_f32_16x16x32_bf16 v[244:247], a[184:187], v[52:55], v[244:247]
s_cselect_b32 s20, s23, s20
s_cselect_b32 s22, s24, s22
v_mfma_f32_16x16x32_bf16 v[248:251], a[188:191], v[48:51], v[248:251]
v_mfma_f32_16x16x32_bf16 v[252:255], a[188:191], v[52:55], v[252:255]
s_cselect_b32 s23, s62, s23
s_branch L_k2_segend
.p2align 6
L_k2_loop_3:
v_mfma_f32_16x16x32_bf16 v[32:35], a[128:131], a[0:3], v[56:59]
v_add_u32 v4, s25, v5
s_mov_b32 m0, s25
v_mfma_f32_16x16x32_bf16 v[36:39], a[128:131], a[32:35], v[60:63]
ds_read_b128 a[128:131], v4 offset:0
v_xor_b32 v2, 0x18000, v4
v_mfma_f32_16x16x32_bf16 v[40:43], a[132:135], a[0:3], v[56:59]
v_exp_f32 v16, v16
v_mfma_f32_16x16x32_bf16 v[44:47], a[132:135], a[32:35], v[60:63]
ds_read_b128 a[132:135], v4 offset:1024
v_mfma_f32_16x16x32_bf16 v[32:35], a[136:139], a[4:7], v[32:35]
v_exp_f32 v17, v17
v_mfma_f32_16x16x32_bf16 v[36:39], a[136:139], a[36:39], v[36:39]
ds_read_b128 a[136:139], v4 offset:2048
v_mfma_f32_16x16x32_bf16 v[40:43], a[140:143], a[4:7], v[40:43]
v_exp_f32 v18, v18
v_mfma_f32_16x16x32_bf16 v[44:47], a[140:143], a[36:39], v[44:47]
ds_read_b128 a[140:143], v4 offset:3072
v_cvt_pk_bf16_f32 v48, v16, v17
v_mfma_f32_16x16x32_bf16 v[32:35], a[144:147], a[8:11], v[32:35]
v_exp_f32 v19, v19
v_mfma_f32_16x16x32_bf16 v[36:39], a[144:147], a[40:43], v[36:39]
ds_read_b128 a[144:147], v4 offset:4096
v_mfma_f32_16x16x32_bf16 v[40:43], a[148:151], a[8:11], v[40:43]
v_exp_f32 v24, v24
v_mfma_f32_16x16x32_bf16 v[44:47], a[148:151], a[40:43], v[44:47]
ds_read_b128 a[148:151], v4 offset:5120
v_cvt_pk_bf16_f32 v49, v18, v19
v_mfma_f32_16x16x32_bf16 v[32:35], a[152:155], a[12:15], v[32:35]
v_exp_f32 v25, v25
v_mfma_f32_16x16x32_bf16 v[36:39], a[152:155], a[44:47], v[36:39]
ds_read_b128 a[152:155], v4 offset:6144
v_mfma_f32_16x16x32_bf16 v[40:43], a[156:159], a[12:15], v[40:43]
v_exp_f32 v26, v26
v_mfma_f32_16x16x32_bf16 v[44:47], a[156:159], a[44:47], v[44:47]
ds_read_b128 a[156:159], v4 offset:7168
s_waitcnt lgkmcnt(7)
v_mfma_f32_16x16x32_bf16 v[32:35], a[160:163], a[16:19], v[32:35]
v_exp_f32 v27, v27
v_mfma_f32_16x16x32_bf16 v[36:39], a[160:163], a[48:51], v[36:39]
ds_read_b128 a[160:163], v4 offset:8192
v_cvt_pk_bf16_f32 v50, v24, v25
v_mfma_f32_16x16x32_bf16 v[40:43], a[164:167], a[16:19], v[40:43]
buffer_load_dwordx4 v6, s[4:7], s20 offen offset:0 sc1 lds
v_mfma_f32_16x16x32_bf16 v[44:47], a[164:167], a[48:51], v[44:47]
ds_read_b128 a[164:167], v4 offset:9216
v_cvt_pk_bf16_f32 v51, v26, v27
v_mfma_f32_16x16x32_bf16 v[32:35], a[168:171], a[20:23], v[32:35]
s_cmp_eq_u32 s27, s90
s_cbranch_scc1 L_k2_fl_3
L_k2_flret_3:
v_mfma_f32_16x16x32_bf16 v[36:39], a[168:171], a[52:55], v[36:39]
ds_read_b128 a[168:171], v4 offset:10240
v_mfma_f32_16x16x32_bf16 v[40:43], a[172:175], a[20:23], v[40:43]
buffer_load_dwordx4 v6, s[4:7], s20 offen offset:1024 sc1 lds
v_mfma_f32_16x16x32_bf16 v[44:47], a[172:175], a[52:55], v[44:47]
ds_read_b128 a[172:175], v4 offset:11264
v_mfma_f32_16x16x32_bf16 v[32:35], a[176:179], a[24:27], v[32:35]
v_mfma_f32_16x16x32_bf16 v[36:39], a[176:179], a[56:59], v[36:39]
ds_read_b128 a[176:179], v4 offset:12288
v_mfma_f32_16x16x32_bf16 v[40:43], a[180:183], a[24:27], v[40:43]
buffer_load_dwordx4 v6, s[4:7], s20 offen offset:2048 sc1 lds
v_mfma_f32_16x16x32_bf16 v[44:47], a[180:183], a[56:59], v[44:47]
ds_read_b128 a[180:183], v4 offset:13312
v_mfma_f32_16x16x32_bf16 v[32:35], a[184:187], a[28:31], v[32:35]
v_mfma_f32_16x16x32_bf16 v[36:39], a[184:187], a[60:63], v[36:39]
ds_read_b128 a[184:187], v4 offset:14336
v_mfma_f32_16x16x32_bf16 v[40:43], a[188:191], a[28:31], v[40:43]
buffer_load_dwordx4 v6, s[4:7], s20 offen offset:3072 sc1 lds
v_mfma_f32_16x16x32_bf16 v[44:47], a[188:191], a[60:63], v[44:47]
ds_read_b128 a[188:191], v4 offset:15360
s_waitcnt lgkmcnt(8)
v_mfma_f32_16x16x32_bf16 v[128:131], a[128:131], v[48:51], v[128:131]
v_exp_f32 v20, v20
v_mfma_f32_16x16x32_bf16 v[136:139], a[132:135], v[48:51], v[136:139]
s_cmp_ge_u32 s27, s28
v_mfma_f32_16x16x32_bf16 v[64:67], v[72:75], v[48:51], v[64:67]
v_exp_f32 v21, v21
v_mfma_f32_16x16x32_bf16 v[144:147], a[136:139], v[48:51], v[144:147]
s_cbranch_scc1 L_k2_mask0_3
L_k2_maskret0_3:
v_mfma_f32_16x16x32_bf16 v[152:155], a[140:143], v[48:51], v[152:155]
v_exp_f32 v22, v22
v_mfma_f32_16x16x32_bf16 v[160:163], a[144:147], v[48:51], v[160:163]
v_cvt_pk_bf16_f32 v52, v20, v21
v_max3_f32 v9, v32, v33, v34
v_mfma_f32_16x16x32_bf16 v[168:171], a[148:151], v[48:51], v[168:171]
v_exp_f32 v23, v23
v_mfma_f32_16x16x32_bf16 v[176:179], a[152:155], v[48:51], v[176:179]
s_waitcnt lgkmcnt(0)
v_max3_f32 v10, v35, v40, v41
v_mfma_f32_16x16x32_bf16 v[184:187], a[156:159], v[48:51], v[184:187]
v_exp_f32 v28, v28
v_mfma_f32_16x16x32_bf16 v[192:195], a[160:163], v[48:51], v[192:195]
v_cvt_pk_bf16_f32 v53, v22, v23
v_max3_f32 v11, v42, v43, v36
v_mfma_f32_16x16x32_bf16 v[200:203], a[164:167], v[48:51], v[200:203]
v_exp_f32 v29, v29
v_mfma_f32_16x16x32_bf16 v[208:211], a[168:171], v[48:51], v[208:211]
v_max3_f32 v9, v9, v37, v38
v_max3_f32 v10, v10, v39, v44
v_mfma_f32_16x16x32_bf16 v[216:219], a[172:175], v[48:51], v[216:219]
v_exp_f32 v30, v30
v_mfma_f32_16x16x32_bf16 v[224:227], a[176:179], v[48:51], v[224:227]
v_cvt_pk_bf16_f32 v54, v28, v29
v_max3_f32 v11, v11, v45, v46
v_mfma_f32_16x16x32_bf16 v[232:235], a[180:183], v[48:51], v[232:235]
v_exp_f32 v31, v31
v_mfma_f32_16x16x32_bf16 v[240:243], a[184:187], v[48:51], v[240:243]
v_cvt_pk_bf16_f32 v55, v30, v31
v_max3_f32 v9, v9, v10, v47
v_mfma_f32_16x16x32_bf16 v[248:251], a[188:191], v[48:51], v[248:251]
v_max_f32 v9, v9, v11
v_cmp_lt_f32 vcc, 0x41c00000, v9
v_mfma_f32_16x16x32_bf16 v[132:135], a[128:131], v[52:55], v[132:135]
ds_read_b128 a[128:131], v2 offset:0
v_mfma_f32_16x16x32_bf16 v[140:143], a[132:135], v[52:55], v[140:143]
ds_read_b128 a[132:135], v2 offset:8192
v_mfma_f32_16x16x32_bf16 v[68:71], v[72:75], v[52:55], v[68:71]
s_add_u32 m0, s26, 0x10000
s_add_u32 s27, s27, 1
v_mfma_f32_16x16x32_bf16 v[148:151], a[136:139], v[52:55], v[148:151]
ds_read_b128 a[136:139], v2 offset:1024
buffer_load_dwordx4 v6, s[8:11], s21 offen offset:0 sc1 lds
v_mfma_f32_16x16x32_bf16 v[156:159], a[140:143], v[52:55], v[156:159]
ds_read_b128 a[140:143], v2 offset:9216
s_add_u32 s26, s25, 16384
v_mfma_f32_16x16x32_bf16 v[164:167], a[144:147], v[52:55], v[164:167]
ds_read_b128 a[144:147], v2 offset:2048
buffer_load_dwordx4 v6, s[8:11], s21 offen offset:1024 sc1 lds
v_mfma_f32_16x16x32_bf16 v[172:175], a[148:151], v[52:55], v[172:175]
ds_read_b128 a[148:151], v2 offset:10240
s_and_b32 s26, s26, 0xffff
v_mfma_f32_16x16x32_bf16 v[180:183], a[152:155], v[52:55], v[180:183]
ds_read_b128 a[152:155], v2 offset:3072
buffer_load_dwordx4 v6, s[8:11], s21 offen offset:2048 sc1 lds
v_mfma_f32_16x16x32_bf16 v[188:191], a[156:159], v[52:55], v[188:191]
ds_read_b128 a[156:159], v2 offset:11264
v_mfma_f32_16x16x32_bf16 v[196:199], a[160:163], v[52:55], v[196:199]
ds_read_b128 a[160:163], v2 offset:4096
buffer_load_dwordx4 v6, s[8:11], s21 offen offset:3072 sc1 lds
v_mfma_f32_16x16x32_bf16 v[204:207], a[164:167], v[52:55], v[204:207]
ds_read_b128 a[164:167], v2 offset:12288
s_add_u32 s21, s20, 16384
v_mfma_f32_16x16x32_bf16 v[212:215], a[168:171], v[52:55], v[212:215]
ds_read_b128 a[168:171], v2 offset:5120
s_sub_u32 s22, s22, 1
v_mfma_f32_16x16x32_bf16 v[220:223], a[172:175], v[52:55], v[220:223]
ds_read_b128 a[172:175], v2 offset:13312
s_cmp_eq_u32 s22, 0
v_mfma_f32_16x16x32_bf16 v[228:231], a[176:179], v[52:55], v[228:231]
ds_read_b128 a[176:179], v2 offset:6144
s_waitcnt vmcnt(12)
s_barrier
s_nop 2
s_cselect_b32 s21, s23, s21
v_mfma_f32_16x16x32_bf16 v[236:239], a[180:183], v[52:55], v[236:239]
ds_read_b128 a[180:183], v2 offset:14336
s_cselect_b32 s22, s24, s22
v_mfma_f32_16x16x32_bf16 v[244:247], a[184:187], v[52:55], v[244:247]
ds_read_b128 a[184:187], v2 offset:7168
s_cselect_b32 s23, s62, s23
v_mfma_f32_16x16x32_bf16 v[252:255], a[188:191], v[52:55], v[252:255]
ds_read_b128 a[188:191], v2 offset:15360
s_waitcnt lgkmcnt(8)
s_cmp_eq_u32 s27, s29
s_cbranch_vccnz L_k2_resc0_3
L_k2_rescret0_3:
s_cbranch_scc1 L_k2_final_3
v_mfma_f32_16x16x32_bf16 v[16:19], a[128:131], a[0:3], v[56:59]
v_add_u32 v4, s26, v5
s_mov_b32 m0, s26
v_mfma_f32_16x16x32_bf16 v[20:23], a[128:131], a[32:35], v[60:63]
ds_read_b128 a[128:131], v4 offset:0
v_xor_b32 v3, 0x18000, v4
v_mfma_f32_16x16x32_bf16 v[24:27], a[132:135], a[0:3], v[56:59]
v_exp_f32 v32, v32
v_mfma_f32_16x16x32_bf16 v[28:31], a[132:135], a[32:35], v[60:63]
ds_read_b128 a[132:135], v4 offset:1024
v_mfma_f32_16x16x32_bf16 v[16:19], a[136:139], a[4:7], v[16:19]
v_exp_f32 v33, v33
v_mfma_f32_16x16x32_bf16 v[20:23], a[136:139], a[36:39], v[20:23]
ds_read_b128 a[136:139], v4 offset:2048
v_mfma_f32_16x16x32_bf16 v[24:27], a[140:143], a[4:7], v[24:27]
v_exp_f32 v34, v34
v_mfma_f32_16x16x32_bf16 v[28:31], a[140:143], a[36:39], v[28:31]
ds_read_b128 a[140:143], v4 offset:3072
v_cvt_pk_bf16_f32 v48, v32, v33
v_mfma_f32_16x16x32_bf16 v[16:19], a[144:147], a[8:11], v[16:19]
v_exp_f32 v35, v35
v_mfma_f32_16x16x32_bf16 v[20:23], a[144:147], a[40:43], v[20:23]
ds_read_b128 a[144:147], v4 offset:4096
v_mfma_f32_16x16x32_bf16 v[24:27], a[148:151], a[8:11], v[24:27]
v_exp_f32 v40, v40
v_mfma_f32_16x16x32_bf16 v[28:31], a[148:151], a[40:43], v[28:31]
ds_read_b128 a[148:151], v4 offset:5120
v_cvt_pk_bf16_f32 v49, v34, v35
v_mfma_f32_16x16x32_bf16 v[16:19], a[152:155], a[12:15], v[16:19]
v_exp_f32 v41, v41
v_mfma_f32_16x16x32_bf16 v[20:23], a[152:155], a[44:47], v[20:23]
ds_read_b128 a[152:155], v4 offset:6144
v_mfma_f32_16x16x32_bf16 v[24:27], a[156:159], a[12:15], v[24:27]
v_exp_f32 v42, v42
v_mfma_f32_16x16x32_bf16 v[28:31], a[156:159], a[44:47], v[28:31]
ds_read_b128 a[156:159], v4 offset:7168
s_waitcnt lgkmcnt(7)
v_mfma_f32_16x16x32_bf16 v[16:19], a[160:163], a[16:19], v[16:19]
v_exp_f32 v43, v43
v_mfma_f32_16x16x32_bf16 v[20:23], a[160:163], a[48:51], v[20:23]
ds_read_b128 a[160:163], v4 offset:8192
v_cvt_pk_bf16_f32 v50, v40, v41
v_mfma_f32_16x16x32_bf16 v[24:27], a[164:167], a[16:19], v[24:27]
buffer_load_dwordx4 v6, s[4:7], s21 offen offset:0 sc1 lds
v_mfma_f32_16x16x32_bf16 v[28:31], a[164:167], a[48:51], v[28:31]
ds_read_b128 a[164:167], v4 offset:9216
v_cvt_pk_bf16_f32 v51, v42, v43
v_mfma_f32_16x16x32_bf16 v[16:19], a[168:171], a[20:23], v[16:19]
v_mfma_f32_16x16x32_bf16 v[20:23], a[168:171], a[52:55], v[20:23]
ds_read_b128 a[168:171], v4 offset:10240
v_mfma_f32_16x16x32_bf16 v[24:27], a[172:175], a[20:23], v[24:27]
buffer_load_dwordx4 v6, s[4:7], s21 offen offset:1024 sc1 lds
v_mfma_f32_16x16x32_bf16 v[28:31], a[172:175], a[52:55], v[28:31]
ds_read_b128 a[172:175], v4 offset:11264
v_mfma_f32_16x16x32_bf16 v[16:19], a[176:179], a[24:27], v[16:19]
v_mfma_f32_16x16x32_bf16 v[20:23], a[176:179], a[56:59], v[20:23]
ds_read_b128 a[176:179], v4 offset:12288
v_mfma_f32_16x16x32_bf16 v[24:27], a[180:183], a[24:27], v[24:27]
buffer_load_dwordx4 v6, s[4:7], s21 offen offset:2048 sc1 lds
v_mfma_f32_16x16x32_bf16 v[28:31], a[180:183], a[56:59], v[28:31]
ds_read_b128 a[180:183], v4 offset:13312
v_mfma_f32_16x16x32_bf16 v[16:19], a[184:187], a[28:31], v[16:19]
v_mfma_f32_16x16x32_bf16 v[20:23], a[184:187], a[60:63], v[20:23]
ds_read_b128 a[184:187], v4 offset:14336
v_mfma_f32_16x16x32_bf16 v[24:27], a[188:191], a[28:31], v[24:27]
buffer_load_dwordx4 v6, s[4:7], s21 offen offset:3072 sc1 lds
v_mfma_f32_16x16x32_bf16 v[28:31], a[188:191], a[60:63], v[28:31]
ds_read_b128 a[188:191], v4 offset:15360
s_waitcnt lgkmcnt(8)
v_mfma_f32_16x16x32_bf16 v[128:131], a[128:131], v[48:51], v[128:131]
v_exp_f32 v36, v36
v_mfma_f32_16x16x32_bf16 v[136:139], a[132:135], v[48:51], v[136:139]
s_cmp_ge_u32 s27, s28
v_mfma_f32_16x16x32_bf16 v[64:67], v[72:75], v[48:51], v[64:67]
v_exp_f32 v37, v37
v_mfma_f32_16x16x32_bf16 v[144:147], a[136:139], v[48:51], v[144:147]
s_cbranch_scc1 L_k2_mask1_3
L_k2_maskret1_3:
v_mfma_f32_16x16x32_bf16 v[152:155], a[140:143], v[48:51], v[152:155]
v_exp_f32 v38, v38
v_mfma_f32_16x16x32_bf16 v[160:163], a[144:147], v[48:51], v[160:163]
v_cvt_pk_bf16_f32 v52, v36, v37
v_max3_f32 v9, v16, v17, v18
v_mfma_f32_16x16x32_bf16 v[168:171], a[148:151], v[48:51], v[168:171]
v_exp_f32 v39, v39
v_mfma_f32_16x16x32_bf16 v[176:179], a[152:155], v[48:51], v[176:179]
s_waitcnt lgkmcnt(0)
v_max3_f32 v10, v19, v24, v25
v_mfma_f32_16x16x32_bf16 v[184:187], a[156:159], v[48:51], v[184:187]
v_exp_f32 v44, v44
v_mfma_f32_16x16x32_bf16 v[192:195], a[160:163], v[48:51], v[192:195]
v_cvt_pk_bf16_f32 v53, v38, v39
v_max3_f32 v11, v26, v27, v20
v_mfma_f32_16x16x32_bf16 v[200:203], a[164:167], v[48:51], v[200:203]
v_exp_f32 v45, v45
v_mfma_f32_16x16x32_bf16 v[208:211], a[168:171], v[48:51], v[208:211]
v_max3_f32 v9, v9, v21, v22
v_max3_f32 v10, v10, v23, v28
v_mfma_f32_16x16x32_bf16 v[216:219], a[172:175], v[48:51], v[216:219]
v_exp_f32 v46, v46
v_mfma_f32_16x16x32_bf16 v[224:227], a[176:179], v[48:51], v[224:227]
v_cvt_pk_bf16_f32 v54, v44, v45
v_max3_f32 v11, v11, v29, v30
v_mfma_f32_16x16x32_bf16 v[232:235], a[180:183], v[48:51], v[232:235]
v_exp_f32 v47, v47
v_mfma_f32_16x16x32_bf16 v[240:243], a[184:187], v[48:51], v[240:243]
v_cvt_pk_bf16_f32 v55, v46, v47
v_max3_f32 v9, v9, v10, v31
v_mfma_f32_16x16x32_bf16 v[248:251], a[188:191], v[48:51], v[248:251]
v_max_f32 v9, v9, v11
v_cmp_lt_f32 vcc, 0x41c00000, v9
v_mfma_f32_16x16x32_bf16 v[132:135], a[128:131], v[52:55], v[132:135]
ds_read_b128 a[128:131], v3 offset:0
v_mfma_f32_16x16x32_bf16 v[140:143], a[132:135], v[52:55], v[140:143]
ds_read_b128 a[132:135], v3 offset:8192
v_mfma_f32_16x16x32_bf16 v[68:71], v[72:75], v[52:55], v[68:71]
s_add_u32 m0, s25, 0x10000
s_add_u32 s27, s27, 1
v_mfma_f32_16x16x32_bf16 v[148:151], a[136:139], v[52:55], v[148:151]
ds_read_b128 a[136:139], v3 offset:1024
buffer_load_dwordx4 v6, s[8:11], s20 offen offset:0 sc1 lds
v_mfma_f32_16x16x32_bf16 v[156:159], a[140:143], v[52:55], v[156:159]
ds_read_b128 a[140:143], v3 offset:9216
s_add_u32 s25, s26, 16384
v_mfma_f32_16x16x32_bf16 v[164:167], a[144:147], v[52:55], v[164:167]
ds_read_b128 a[144:147], v3 offset:2048
buffer_load_dwordx4 v6, s[8:11], s20 offen offset:1024 sc1 lds
v_mfma_f32_16x16x32_bf16 v[172:175], a[148:151], v[52:55], v[172:175]
ds_read_b128 a[148:151], v3 offset:10240
s_and_b32 s25, s25, 0xffff
v_mfma_f32_16x16x32_bf16 v[180:183], a[152:155], v[52:55], v[180:183]
ds_read_b128 a[152:155], v3 offset:3072
buffer_load_dwordx4 v6, s[8:11], s20 offen offset:2048 sc1 lds
v_mfma_f32_16x16x32_bf16 v[188:191], a[156:159], v[52:55], v[188:191]
ds_read_b128 a[156:159], v3 offset:11264
v_mfma_f32_16x16x32_bf16 v[196:199], a[160:163], v[52:55], v[196:199]
ds_read_b128 a[160:163], v3 offset:4096
buffer_load_dwordx4 v6, s[8:11], s20 offen offset:3072 sc1 lds
v_mfma_f32_16x16x32_bf16 v[204:207], a[164:167], v[52:55], v[204:207]
ds_read_b128 a[164:167], v3 offset:12288
s_add_u32 s20, s21, 16384
v_mfma_f32_16x16x32_bf16 v[212:215], a[168:171], v[52:55], v[212:215]
ds_read_b128 a[168:171], v3 offset:5120
s_sub_u32 s22, s22, 1
v_mfma_f32_16x16x32_bf16 v[220:223], a[172:175], v[52:55], v[220:223]
ds_read_b128 a[172:175], v3 offset:13312
s_cmp_eq_u32 s22, 0
v_mfma_f32_16x16x32_bf16 v[228:231], a[176:179], v[52:55], v[228:231]
ds_read_b128 a[176:179], v3 offset:6144
s_waitcnt vmcnt(12)
s_barrier
s_nop 2
s_cselect_b32 s20, s23, s20
v_mfma_f32_16x16x32_bf16 v[236:239], a[180:183], v[52:55], v[236:239]
ds_read_b128 a[180:183], v3 offset:14336
s_cselect_b32 s22, s24, s22
v_mfma_f32_16x16x32_bf16 v[244:247], a[184:187], v[52:55], v[244:247]
ds_read_b128 a[184:187], v3 offset:7168
s_cselect_b32 s23, s62, s23
v_mfma_f32_16x16x32_bf16 v[252:255], a[188:191], v[52:55], v[252:255]
ds_read_b128 a[188:191], v3 offset:15360
s_waitcnt lgkmcnt(8)
s_cbranch_vccnz L_k2_resc1_3
L_k2_rescret1_3:
s_branch L_k2_loop_3
L_k2_final_3:
s_cmp_eq_u32 s65, 2
s_cbranch_scc1 L_k2_ec_3
L_k2_ecret_3:
s_waitcnt lgkmcnt(0)
v_add_u32 v4, s26, v5
s_mov_b32 m0, s26
ds_read_b128 a[128:131], v4 offset:0
ds_read_b128 a[132:135], v4 offset:1024
ds_read_b128 a[136:139], v4 offset:2048
ds_read_b128 a[140:143], v4 offset:3072
ds_read_b128 a[144:147], v4 offset:4096
ds_read_b128 a[148:151], v4 offset:5120
ds_read_b128 a[152:155], v4 offset:6144
ds_read_b128 a[156:159], v4 offset:7168
ds_read_b128 a[160:163], v4 offset:8192
ds_read_b128 a[164:167], v4 offset:9216
ds_read_b128 a[168:171], v4 offset:10240
ds_read_b128 a[172:175], v4 offset:11264
v_exp_f32 v32, v32
buffer_load_dwordx4 v6, s[4:7], s21 offen offset:0 sc1 lds
v_exp_f32 v33, v33
v_exp_f32 v34, v34
v_exp_f32 v35, v35
v_cvt_pk_bf16_f32 v48, v32, v33
v_exp_f32 v40, v40
buffer_load_dwordx4 v6, s[4:7], s21 offen offset:1024 sc1 lds
v_exp_f32 v41, v41
v_cvt_pk_bf16_f32 v49, v34, v35
v_exp_f32 v42, v42
v_exp_f32 v43, v43
v_cvt_pk_bf16_f32 v50, v40, v41
v_exp_f32 v36, v36
buffer_load_dwordx4 v6, s[4:7], s21 offen offset:2048 sc1 lds
v_exp_f32 v37, v37
v_cvt_pk_bf16_f32 v51, v42, v43
v_exp_f32 v38, v38
v_exp_f32 v39, v39
v_cvt_pk_bf16_f32 v52, v36, v37
v_exp_f32 v44, v44
buffer_load_dwordx4 v6, s[4:7], s21 offen offset:3072 sc1 lds
v_exp_f32 v45, v45
v_cvt_pk_bf16_f32 v53, v38, v39
v_exp_f32 v46, v46
v_exp_f32 v47, v47
v_cvt_pk_bf16_f32 v54, v44, v45
s_nop 0
s_waitcnt lgkmcnt(8)
v_mfma_f32_16x16x32_bf16 v[128:131], a[128:131], v[48:51], v[128:131]
v_cvt_pk_bf16_f32 v55, v46, v47
ds_read_b128 a[176:179], v4 offset:12288
v_mfma_f32_16x16x32_bf16 v[64:67], v[72:75], v[48:51], v[64:67]
v_mfma_f32_16x16x32_bf16 v[132:135], a[128:131], v[52:55], v[132:135]
v_mfma_f32_16x16x32_bf16 v[68:71], v[72:75], v[52:55], v[68:71]
v_mfma_f32_16x16x32_bf16 v[136:139], a[132:135], v[48:51], v[136:139]
ds_read_b128 a[180:183], v4 offset:13312
v_mfma_f32_16x16x32_bf16 v[140:143], a[132:135], v[52:55], v[140:143]
v_mfma_f32_16x16x32_bf16 v[144:147], a[136:139], v[48:51], v[144:147]
ds_read_b128 a[184:187], v4 offset:14336
s_add_u32 m0, s25, 0x10000
v_mfma_f32_16x16x32_bf16 v[148:151], a[136:139], v[52:55], v[148:151]
v_mfma_f32_16x16x32_bf16 v[152:155], a[140:143], v[48:51], v[152:155]
ds_read_b128 a[188:191], v4 offset:15360
v_mfma_f32_16x16x32_bf16 v[156:159], a[140:143], v[52:55], v[156:159]
buffer_load_dwordx4 v6, s[8:11], s20 offen offset:0 sc1 lds
s_waitcnt lgkmcnt(8)
v_mfma_f32_16x16x32_bf16 v[160:163], a[144:147], v[48:51], v[160:163]
v_mfma_f32_16x16x32_bf16 v[164:167], a[144:147], v[52:55], v[164:167]
v_mfma_f32_16x16x32_bf16 v[168:171], a[148:151], v[48:51], v[168:171]
v_mfma_f32_16x16x32_bf16 v[172:175], a[148:151], v[52:55], v[172:175]
v_mfma_f32_16x16x32_bf16 v[176:179], a[152:155], v[48:51], v[176:179]
v_mfma_f32_16x16x32_bf16 v[180:183], a[152:155], v[52:55], v[180:183]
buffer_load_dwordx4 v6, s[8:11], s20 offen offset:1024 sc1 lds
v_mfma_f32_16x16x32_bf16 v[184:187], a[156:159], v[48:51], v[184:187]
v_mfma_f32_16x16x32_bf16 v[188:191], a[156:159], v[52:55], v[188:191]
s_waitcnt lgkmcnt(4)
v_mfma_f32_16x16x32_bf16 v[192:195], a[160:163], v[48:51], v[192:195]
v_mfma_f32_16x16x32_bf16 v[196:199], a[160:163], v[52:55], v[196:199]
v_mfma_f32_16x16x32_bf16 v[200:203], a[164:167], v[48:51], v[200:203]
v_mfma_f32_16x16x32_bf16 v[204:207], a[164:167], v[52:55], v[204:207]
buffer_load_dwordx4 v6, s[8:11], s20 offen offset:2048 sc1 lds
v_mfma_f32_16x16x32_bf16 v[208:211], a[168:171], v[48:51], v[208:211]
v_mfma_f32_16x16x32_bf16 v[212:215], a[168:171], v[52:55], v[212:215]
s_add_u32 s27, s27, 1
v_mfma_f32_16x16x32_bf16 v[216:219], a[172:175], v[48:51], v[216:219]
v_mfma_f32_16x16x32_bf16 v[220:223], a[172:175], v[52:55], v[220:223]
s_waitcnt lgkmcnt(0)
v_mfma_f32_16x16x32_bf16 v[224:227], a[176:179], v[48:51], v[224:227]
v_mfma_f32_16x16x32_bf16 v[228:231], a[176:179], v[52:55], v[228:231]
buffer_load_dwordx4 v6, s[8:11], s20 offen offset:3072 sc1 lds
v_mfma_f32_16x16x32_bf16 v[232:235], a[180:183], v[48:51], v[232:235]
s_add_u32 s20, s21, 16384
v_mfma_f32_16x16x32_bf16 v[236:239], a[180:183], v[52:55], v[236:239]
s_sub_u32 s22, s22, 1
s_cmp_eq_u32 s22, 0
v_mfma_f32_16x16x32_bf16 v[240:243], a[184:187], v[48:51], v[240:243]
s_waitcnt vmcnt(12)
s_barrier
s_nop 2
v_mfma_f32_16x16x32_bf16 v[244:247], a[184:187], v[52:55], v[244:247]
s_cselect_b32 s20, s23, s20
s_cselect_b32 s22, s24, s22
v_mfma_f32_16x16x32_bf16 v[248:251], a[188:191], v[48:51], v[248:251]
v_mfma_f32_16x16x32_bf16 v[252:255], a[188:191], v[52:55], v[252:255]
s_cselect_b32 s23, s62, s23
L_k2_segend:
s_nop 7
s_nop 1
s_cmp_eq_u32 s65, 1
s_cbranch_scc1 L_k2_pub
s_cmp_eq_u32 s65, 2
s_cbranch_scc0 L_k2_fin0
s_cmp_eq_u32 s89, 1
s_cbranch_scc1 L_k2_polled
s_mov_b32 s67, 0
L_k2_poll:
buffer_load_dword v113, v114, s[12:15], s97 offen sc1
s_waitcnt vmcnt(0)
v_readfirstlane_b32 s57, v113
s_add_u32 s67, s67, 1
s_cmp_eq_u32 s57, s3
s_cbranch_scc1 L_k2_pollok
s_sleep 2
s_cmp_lt_u32 s67, 200000
s_cbranch_scc1 L_k2_poll
L_k2_pollok:
s_lshl_b32 s56, s17, 3
s_add_u32 s56, s56, s19
s_mul_i32 s56, s56, 69632
s_mul_i32 s57, s16, 17408
s_add_u32 s56, s56, s57
s_add_u32 s56, s56, 83886080
s_add_u32 s57, s56, 16384
buffer_load_dwordx4 v[84:87], v1, s[12:15], s57 offen sc1
s_add_u32 s57, s56, 0
buffer_load_dwordx4 a[64:67], v1, s[12:15], s57 offen offset:0 sc1
buffer_load_dwordx4 a[68:71], v1, s[12:15], s57 offen offset:1024 sc1
buffer_load_dwordx4 a[72:75], v1, s[12:15], s57 offen offset:2048 sc1
buffer_load_dwordx4 a[76:79], v1, s[12:15], s57 offen offset:3072 sc1
s_add_u32 s57, s56, 4096
buffer_load_dwordx4 a[80:83], v1, s[12:15], s57 offen offset:0 sc1
buffer_load_dwordx4 a[84:87], v1, s[12:15], s57 offen offset:1024 sc1
buffer_load_dwordx4 a[88:91], v1, s[12:15], s57 offen offset:2048 sc1
buffer_load_dwordx4 a[92:95], v1, s[12:15], s57 offen offset:3072 sc1
s_add_u32 s57, s56, 8192
buffer_load_dwordx4 a[96:99], v1, s[12:15], s57 offen offset:0 sc1
buffer_load_dwordx4 a[100:103], v1, s[12:15], s57 offen offset:1024 sc1
buffer_load_dwordx4 a[104:107], v1, s[12:15], s57 offen offset:2048 sc1
buffer_load_dwordx4 a[108:111], v1, s[12:15], s57 offen offset:3072 sc1
s_add_u32 s57, s56, 12288
buffer_load_dwordx4 a[112:115], v1, s[12:15], s57 offen offset:0 sc1
buffer_load_dwordx4 a[116:119], v1, s[12:15], s57 offen offset:1024 sc1
buffer_load_dwordx4 a[120:123], v1, s[12:15], s57 offen offset:2048 sc1
buffer_load_dwordx4 a[124:127], v1, s[12:15], s57 offen offset:3072 sc1
L_k2_polled:
s_waitcnt vmcnt(0)
s_lshl_b32 s56, s30, 3
s_lshl_b32 s57, s16, 1
s_add_u32 s56, s56, s57
s_lshl_b32 s56, s56, 4
s_add_u32 s56, s56, s17
s_lshl_b32 s56, s56, 13
s_add_u32 s56, s56, 50331648
v_sub_f32 v76, 0, v56
v_max_f32 v77, v76, v84
v_sub_f32 v76, v76, v77
v_sub_f32 v78, v84, v77
v_exp_f32 v76, v76
v_exp_f32 v78, v78
s_nop 0
v_mul_f32 v77, v76, v64
v_fmac_f32 v77, v78, v86
v_rcp_f32 v77, v77
s_nop 0
v_mul_f32 v80, v76, v77
v_mul_f32 v78, v78, v86
v_mul_f32 v82, v78, v77
v_sub_f32 v76, 0, v60
v_max_f32 v77, v76, v85
v_sub_f32 v76, v76, v77
v_sub_f32 v78, v85, v77
v_exp_f32 v76, v76
v_exp_f32 v78, v78
s_nop 0
v_mul_f32 v77, v76, v68
v_fmac_f32 v77, v78, v87
v_rcp_f32 v77, v77
s_nop 0
v_mul_f32 v81, v76, v77
v_mul_f32 v78, v78, v87
v_mul_f32 v83, v78, v77
s_nop 0
v_accvgpr_read_b32 v96, a64
v_accvgpr_read_b32 v97, a65
v_accvgpr_read_b32 v98, a66
v_accvgpr_read_b32 v99, a67
v_lshlrev_b32 v88, 16, v96
v_and_b32 v89, 0xffff0000, v96
v_lshlrev_b32 v90, 16, v97
v_and_b32 v91, 0xffff0000, v97
v_lshlrev_b32 v92, 16, v98
v_and_b32 v93, 0xffff0000, v98
v_lshlrev_b32 v94, 16, v99
v_and_b32 v95, 0xffff0000, v99
v_mul_f32 v128, v128, v80
v_fma_f32 v88, v88, v82, v128
v_mul_f32 v129, v129, v80
v_fma_f32 v89, v89, v82, v129
v_mul_f32 v130, v130, v80
v_fma_f32 v90, v90, v82, v130
v_mul_f32 v131, v131, v80
v_fma_f32 v91, v91, v82, v131
v_mul_f32 v136, v136, v80
v_fma_f32 v92, v92, v82, v136
v_mul_f32 v137, v137, v80
v_fma_f32 v93, v93, v82, v137
v_mul_f32 v138, v138, v80
v_fma_f32 v94, v94, v82, v138
v_mul_f32 v139, v139, v80
v_fma_f32 v95, v95, v82, v139
v_cvt_pk_bf16_f32 v96, v88, v89
v_cvt_pk_bf16_f32 v97, v90, v91
v_cvt_pk_bf16_f32 v98, v92, v93
v_cvt_pk_bf16_f32 v99, v94, v95
s_add_u32 s57, s56, 0
buffer_store_dwordx4 v[96:99], v1, s[12:15], s57 offen offset:0 sc1
v_accvgpr_read_b32 v108, a68
v_accvgpr_read_b32 v109, a69
v_accvgpr_read_b32 v110, a70
v_accvgpr_read_b32 v111, a71
v_lshlrev_b32 v100, 16, v108
v_and_b32 v101, 0xffff0000, v108
v_lshlrev_b32 v102, 16, v109
v_and_b32 v103, 0xffff0000, v109
v_lshlrev_b32 v104, 16, v110
v_and_b32 v105, 0xffff0000, v110
v_lshlrev_b32 v106, 16, v111
v_and_b32 v107, 0xffff0000, v111
v_mul_f32 v144, v144, v80
v_fma_f32 v100, v100, v82, v144
v_mul_f32 v145, v145, v80
v_fma_f32 v101, v101, v82, v145
v_mul_f32 v146, v146, v80
v_fma_f32 v102, v102, v82, v146
v_mul_f32 v147, v147, v80
v_fma_f32 v103, v103, v82, v147
v_mul_f32 v152, v152, v80
v_fma_f32 v104, v104, v82, v152
v_mul_f32 v153, v153, v80
v_fma_f32 v105, v105, v82, v153
v_mul_f32 v154, v154, v80
v_fma_f32 v106, v106, v82, v154
v_mul_f32 v155, v155, v80
v_fma_f32 v107, v107, v82, v155
v_cvt_pk_bf16_f32 v108, v100, v101
v_cvt_pk_bf16_f32 v109, v102, v103
v_cvt_pk_bf16_f32 v110, v104, v105
v_cvt_pk_bf16_f32 v111, v106, v107
buffer_store_dwordx4 v[108:111], v1, s[12:15], s57 offen offset:1024 sc1
v_accvgpr_read_b32 v96, a72
v_accvgpr_read_b32 v97, a73
v_accvgpr_read_b32 v98, a74
v_accvgpr_read_b32 v99, a75
v_lshlrev_b32 v88, 16, v96
v_and_b32 v89, 0xffff0000, v96
v_lshlrev_b32 v90, 16, v97
v_and_b32 v91, 0xffff0000, v97
v_lshlrev_b32 v92, 16, v98
v_and_b32 v93, 0xffff0000, v98
v_lshlrev_b32 v94, 16, v99
v_and_b32 v95, 0xffff0000, v99
v_mul_f32 v160, v160, v80
v_fma_f32 v88, v88, v82, v160
v_mul_f32 v161, v161, v80
v_fma_f32 v89, v89, v82, v161
v_mul_f32 v162, v162, v80
v_fma_f32 v90, v90, v82, v162
v_mul_f32 v163, v163, v80
v_fma_f32 v91, v91, v82, v163
v_mul_f32 v168, v168, v80
v_fma_f32 v92, v92, v82, v168
v_mul_f32 v169, v169, v80
v_fma_f32 v93, v93, v82, v169
v_mul_f32 v170, v170, v80
v_fma_f32 v94, v94, v82, v170
v_mul_f32 v171, v171, v80
v_fma_f32 v95, v95, v82, v171
v_cvt_pk_bf16_f32 v96, v88, v89
v_cvt_pk_bf16_f32 v97, v90, v91
v_cvt_pk_bf16_f32 v98, v92, v93
v_cvt_pk_bf16_f32 v99, v94, v95
buffer_store_dwordx4 v[96:99], v1, s[12:15], s57 offen offset:2048 sc1
v_accvgpr_read_b32 v108, a76
v_accvgpr_read_b32 v109, a77
v_accvgpr_read_b32 v110, a78
v_accvgpr_read_b32 v111, a79
v_lshlrev_b32 v100, 16, v108
v_and_b32 v101, 0xffff0000, v108
v_lshlrev_b32 v102, 16, v109
v_and_b32 v103, 0xffff0000, v109
v_lshlrev_b32 v104, 16, v110
v_and_b32 v105, 0xffff0000, v110
v_lshlrev_b32 v106, 16, v111
v_and_b32 v107, 0xffff0000, v111
v_mul_f32 v176, v176, v80
v_fma_f32 v100, v100, v82, v176
v_mul_f32 v177, v177, v80
v_fma_f32 v101, v101, v82, v177
v_mul_f32 v178, v178, v80
v_fma_f32 v102, v102, v82, v178
v_mul_f32 v179, v179, v80
v_fma_f32 v103, v103, v82, v179
v_mul_f32 v184, v184, v80
v_fma_f32 v104, v104, v82, v184
v_mul_f32 v185, v185, v80
v_fma_f32 v105, v105, v82, v185
v_mul_f32 v186, v186, v80
v_fma_f32 v106, v106, v82, v186
v_mul_f32 v187, v187, v80
v_fma_f32 v107, v107, v82, v187
v_cvt_pk_bf16_f32 v108, v100, v101
v_cvt_pk_bf16_f32 v109, v102, v103
v_cvt_pk_bf16_f32 v110, v104, v105
v_cvt_pk_bf16_f32 v111, v106, v107
buffer_store_dwordx4 v[108:111], v1, s[12:15], s57 offen offset:3072 sc1
v_accvgpr_read_b32 v96, a80
v_accvgpr_read_b32 v97, a81
v_accvgpr_read_b32 v98, a82
v_accvgpr_read_b32 v99, a83
v_lshlrev_b32 v88, 16, v96
v_and_b32 v89, 0xffff0000, v96
v_lshlrev_b32 v90, 16, v97
v_and_b32 v91, 0xffff0000, v97
v_lshlrev_b32 v92, 16, v98
v_and_b32 v93, 0xffff0000, v98
v_lshlrev_b32 v94, 16, v99
v_and_b32 v95, 0xffff0000, v99
v_mul_f32 v192, v192, v80
v_fma_f32 v88, v88, v82, v192
v_mul_f32 v193, v193, v80
v_fma_f32 v89, v89, v82, v193
v_mul_f32 v194, v194, v80
v_fma_f32 v90, v90, v82, v194
v_mul_f32 v195, v195, v80
v_fma_f32 v91, v91, v82, v195
v_mul_f32 v200, v200, v80
v_fma_f32 v92, v92, v82, v200
v_mul_f32 v201, v201, v80
v_fma_f32 v93, v93, v82, v201
v_mul_f32 v202, v202, v80
v_fma_f32 v94, v94, v82, v202
v_mul_f32 v203, v203, v80
v_fma_f32 v95, v95, v82, v203
v_cvt_pk_bf16_f32 v96, v88, v89
v_cvt_pk_bf16_f32 v97, v90, v91
v_cvt_pk_bf16_f32 v98, v92, v93
v_cvt_pk_bf16_f32 v99, v94, v95
s_add_u32 s57, s56, 4096
buffer_store_dwordx4 v[96:99], v1, s[12:15], s57 offen offset:0 sc1
v_accvgpr_read_b32 v108, a84
v_accvgpr_read_b32 v109, a85
v_accvgpr_read_b32 v110, a86
v_accvgpr_read_b32 v111, a87
v_lshlrev_b32 v100, 16, v108
v_and_b32 v101, 0xffff0000, v108
v_lshlrev_b32 v102, 16, v109
v_and_b32 v103, 0xffff0000, v109
v_lshlrev_b32 v104, 16, v110
v_and_b32 v105, 0xffff0000, v110
v_lshlrev_b32 v106, 16, v111
v_and_b32 v107, 0xffff0000, v111
v_mul_f32 v208, v208, v80
v_fma_f32 v100, v100, v82, v208
v_mul_f32 v209, v209, v80
v_fma_f32 v101, v101, v82, v209
v_mul_f32 v210, v210, v80
v_fma_f32 v102, v102, v82, v210
v_mul_f32 v211, v211, v80
v_fma_f32 v103, v103, v82, v211
v_mul_f32 v216, v216, v80
v_fma_f32 v104, v104, v82, v216
v_mul_f32 v217, v217, v80
v_fma_f32 v105, v105, v82, v217
v_mul_f32 v218, v218, v80
v_fma_f32 v106, v106, v82, v218
v_mul_f32 v219, v219, v80
v_fma_f32 v107, v107, v82, v219
v_cvt_pk_bf16_f32 v108, v100, v101
v_cvt_pk_bf16_f32 v109, v102, v103
v_cvt_pk_bf16_f32 v110, v104, v105
v_cvt_pk_bf16_f32 v111, v106, v107
buffer_store_dwordx4 v[108:111], v1, s[12:15], s57 offen offset:1024 sc1
v_accvgpr_read_b32 v96, a88
v_accvgpr_read_b32 v97, a89
v_accvgpr_read_b32 v98, a90
v_accvgpr_read_b32 v99, a91
v_lshlrev_b32 v88, 16, v96
v_and_b32 v89, 0xffff0000, v96
v_lshlrev_b32 v90, 16, v97
v_and_b32 v91, 0xffff0000, v97
v_lshlrev_b32 v92, 16, v98
v_and_b32 v93, 0xffff0000, v98
v_lshlrev_b32 v94, 16, v99
v_and_b32 v95, 0xffff0000, v99
v_mul_f32 v224, v224, v80
v_fma_f32 v88, v88, v82, v224
v_mul_f32 v225, v225, v80
v_fma_f32 v89, v89, v82, v225
v_mul_f32 v226, v226, v80
v_fma_f32 v90, v90, v82, v226
v_mul_f32 v227, v227, v80
v_fma_f32 v91, v91, v82, v227
v_mul_f32 v232, v232, v80
v_fma_f32 v92, v92, v82, v232
v_mul_f32 v233, v233, v80
v_fma_f32 v93, v93, v82, v233
v_mul_f32 v234, v234, v80
v_fma_f32 v94, v94, v82, v234
v_mul_f32 v235, v235, v80
v_fma_f32 v95, v95, v82, v235
v_cvt_pk_bf16_f32 v96, v88, v89
v_cvt_pk_bf16_f32 v97, v90, v91
v_cvt_pk_bf16_f32 v98, v92, v93
v_cvt_pk_bf16_f32 v99, v94, v95
buffer_store_dwordx4 v[96:99], v1, s[12:15], s57 offen offset:2048 sc1
v_accvgpr_read_b32 v108, a92
v_accvgpr_read_b32 v109, a93
v_accvgpr_read_b32 v110, a94
v_accvgpr_read_b32 v111, a95
v_lshlrev_b32 v100, 16, v108
v_and_b32 v101, 0xffff0000, v108
v_lshlrev_b32 v102, 16, v109
v_and_b32 v103, 0xffff0000, v109
v_lshlrev_b32 v104, 16, v110
v_and_b32 v105, 0xffff0000, v110
v_lshlrev_b32 v106, 16, v111
v_and_b32 v107, 0xffff0000, v111
v_mul_f32 v240, v240, v80
v_fma_f32 v100, v100, v82, v240
v_mul_f32 v241, v241, v80
v_fma_f32 v101, v101, v82, v241
v_mul_f32 v242, v242, v80
v_fma_f32 v102, v102, v82, v242
v_mul_f32 v243, v243, v80
v_fma_f32 v103, v103, v82, v243
v_mul_f32 v248, v248, v80
v_fma_f32 v104, v104, v82, v248
v_mul_f32 v249, v249, v80
v_fma_f32 v105, v105, v82, v249
v_mul_f32 v250, v250, v80
v_fma_f32 v106, v106, v82, v250
v_mul_f32 v251, v251, v80
v_fma_f32 v107, v107, v82, v251
v_cvt_pk_bf16_f32 v108, v100, v101
v_cvt_pk_bf16_f32 v109, v102, v103
v_cvt_pk_bf16_f32 v110, v104, v105
v_cvt_pk_bf16_f32 v111, v106, v107
buffer_store_dwordx4 v[108:111], v1, s[12:15], s57 offen offset:3072 sc1
v_accvgpr_read_b32 v96, a96
v_accvgpr_read_b32 v97, a97
v_accvgpr_read_b32 v98, a98
v_accvgpr_read_b32 v99, a99
v_lshlrev_b32 v88, 16, v96
v_and_b32 v89, 0xffff0000, v96
v_lshlrev_b32 v90, 16, v97
v_and_b32 v91, 0xffff0000, v97
v_lshlrev_b32 v92, 16, v98
v_and_b32 v93, 0xffff0000, v98
v_lshlrev_b32 v94, 16, v99
v_and_b32 v95, 0xffff0000, v99
v_mul_f32 v132, v132, v81
v_fma_f32 v88, v88, v83, v132
v_mul_f32 v133, v133, v81
v_fma_f32 v89, v89, v83, v133
v_mul_f32 v134, v134, v81
v_fma_f32 v90, v90, v83, v134
v_mul_f32 v135, v135, v81
v_fma_f32 v91, v91, v83, v135
v_mul_f32 v140, v140, v81
v_fma_f32 v92, v92, v83, v140
v_mul_f32 v141, v141, v81
v_fma_f32 v93, v93, v83, v141
v_mul_f32 v142, v142, v81
v_fma_f32 v94, v94, v83, v142
v_mul_f32 v143, v143, v81
v_fma_f32 v95, v95, v83, v143
v_cvt_pk_bf16_f32 v96, v88, v89
v_cvt_pk_bf16_f32 v97, v90, v91
v_cvt_pk_bf16_f32 v98, v92, v93
v_cvt_pk_bf16_f32 v99, v94, v95
s_add_u32 s57, s56, 131072
buffer_store_dwordx4 v[96:99], v1, s[12:15], s57 offen offset:0 sc1
v_accvgpr_read_b32 v108, a100
v_accvgpr_read_b32 v109, a101
v_accvgpr_read_b32 v110, a102
v_accvgpr_read_b32 v111, a103
v_lshlrev_b32 v100, 16, v108
v_and_b32 v101, 0xffff0000, v108
v_lshlrev_b32 v102, 16, v109
v_and_b32 v103, 0xffff0000, v109
v_lshlrev_b32 v104, 16, v110
v_and_b32 v105, 0xffff0000, v110
v_lshlrev_b32 v106, 16, v111
v_and_b32 v107, 0xffff0000, v111
v_mul_f32 v148, v148, v81
v_fma_f32 v100, v100, v83, v148
v_mul_f32 v149, v149, v81
v_fma_f32 v101, v101, v83, v149
v_mul_f32 v150, v150, v81
v_fma_f32 v102, v102, v83, v150
v_mul_f32 v151, v151, v81
v_fma_f32 v103, v103, v83, v151
v_mul_f32 v156, v156, v81
v_fma_f32 v104, v104, v83, v156
v_mul_f32 v157, v157, v81
v_fma_f32 v105, v105, v83, v157
v_mul_f32 v158, v158, v81
v_fma_f32 v106, v106, v83, v158
v_mul_f32 v159, v159, v81
v_fma_f32 v107, v107, v83, v159
v_cvt_pk_bf16_f32 v108, v100, v101
v_cvt_pk_bf16_f32 v109, v102, v103
v_cvt_pk_bf16_f32 v110, v104, v105
v_cvt_pk_bf16_f32 v111, v106, v107
buffer_store_dwordx4 v[108:111], v1, s[12:15], s57 offen offset:1024 sc1
v_accvgpr_read_b32 v96, a104
v_accvgpr_read_b32 v97, a105
v_accvgpr_read_b32 v98, a106
v_accvgpr_read_b32 v99, a107
v_lshlrev_b32 v88, 16, v96
v_and_b32 v89, 0xffff0000, v96
v_lshlrev_b32 v90, 16, v97
v_and_b32 v91, 0xffff0000, v97
v_lshlrev_b32 v92, 16, v98
v_and_b32 v93, 0xffff0000, v98
v_lshlrev_b32 v94, 16, v99
v_and_b32 v95, 0xffff0000, v99
v_mul_f32 v164, v164, v81
v_fma_f32 v88, v88, v83, v164
v_mul_f32 v165, v165, v81
v_fma_f32 v89, v89, v83, v165
v_mul_f32 v166, v166, v81
v_fma_f32 v90, v90, v83, v166
v_mul_f32 v167, v167, v81
v_fma_f32 v91, v91, v83, v167
v_mul_f32 v172, v172, v81
v_fma_f32 v92, v92, v83, v172
v_mul_f32 v173, v173, v81
v_fma_f32 v93, v93, v83, v173
v_mul_f32 v174, v174, v81
v_fma_f32 v94, v94, v83, v174
v_mul_f32 v175, v175, v81
v_fma_f32 v95, v95, v83, v175
v_cvt_pk_bf16_f32 v96, v88, v89
v_cvt_pk_bf16_f32 v97, v90, v91
v_cvt_pk_bf16_f32 v98, v92, v93
v_cvt_pk_bf16_f32 v99, v94, v95
buffer_store_dwordx4 v[96:99], v1, s[12:15], s57 offen offset:2048 sc1
v_accvgpr_read_b32 v108, a108
v_accvgpr_read_b32 v109, a109
v_accvgpr_read_b32 v110, a110
v_accvgpr_read_b32 v111, a111
v_lshlrev_b32 v100, 16, v108
v_and_b32 v101, 0xffff0000, v108
v_lshlrev_b32 v102, 16, v109
v_and_b32 v103, 0xffff0000, v109
v_lshlrev_b32 v104, 16, v110
v_and_b32 v105, 0xffff0000, v110
v_lshlrev_b32 v106, 16, v111
v_and_b32 v107, 0xffff0000, v111
v_mul_f32 v180, v180, v81
v_fma_f32 v100, v100, v83, v180
v_mul_f32 v181, v181, v81
v_fma_f32 v101, v101, v83, v181
v_mul_f32 v182, v182, v81
v_fma_f32 v102, v102, v83, v182
v_mul_f32 v183, v183, v81
v_fma_f32 v103, v103, v83, v183
v_mul_f32 v188, v188, v81
v_fma_f32 v104, v104, v83, v188
v_mul_f32 v189, v189, v81
v_fma_f32 v105, v105, v83, v189
v_mul_f32 v190, v190, v81
v_fma_f32 v106, v106, v83, v190
v_mul_f32 v191, v191, v81
v_fma_f32 v107, v107, v83, v191
v_cvt_pk_bf16_f32 v108, v100, v101
v_cvt_pk_bf16_f32 v109, v102, v103
v_cvt_pk_bf16_f32 v110, v104, v105
v_cvt_pk_bf16_f32 v111, v106, v107
buffer_store_dwordx4 v[108:111], v1, s[12:15], s57 offen offset:3072 sc1
v_accvgpr_read_b32 v96, a112
v_accvgpr_read_b32 v97, a113
v_accvgpr_read_b32 v98, a114
v_accvgpr_read_b32 v99, a115
v_lshlrev_b32 v88, 16, v96
v_and_b32 v89, 0xffff0000, v96
v_lshlrev_b32 v90, 16, v97
v_and_b32 v91, 0xffff0000, v97
v_lshlrev_b32 v92, 16, v98
v_and_b32 v93, 0xffff0000, v98
v_lshlrev_b32 v94, 16, v99
v_and_b32 v95, 0xffff0000, v99
v_mul_f32 v196, v196, v81
v_fma_f32 v88, v88, v83, v196
v_mul_f32 v197, v197, v81
v_fma_f32 v89, v89, v83, v197
v_mul_f32 v198, v198, v81
v_fma_f32 v90, v90, v83, v198
v_mul_f32 v199, v199, v81
v_fma_f32 v91, v91, v83, v199
v_mul_f32 v204, v204, v81
v_fma_f32 v92, v92, v83, v204
v_mul_f32 v205, v205, v81
v_fma_f32 v93, v93, v83, v205
v_mul_f32 v206, v206, v81
v_fma_f32 v94, v94, v83, v206
v_mul_f32 v207, v207, v81
v_fma_f32 v95, v95, v83, v207
v_cvt_pk_bf16_f32 v96, v88, v89
v_cvt_pk_bf16_f32 v97, v90, v91
v_cvt_pk_bf16_f32 v98, v92, v93
v_cvt_pk_bf16_f32 v99, v94, v95
s_add_u32 s57, s56, 135168
buffer_store_dwordx4 v[96:99], v1, s[12:15], s57 offen offset:0 sc1
v_accvgpr_read_b32 v108, a116
v_accvgpr_read_b32 v109, a117
v_accvgpr_read_b32 v110, a118
v_accvgpr_read_b32 v111, a119
v_lshlrev_b32 v100, 16, v108
v_and_b32 v101, 0xffff0000, v108
v_lshlrev_b32 v102, 16, v109
v_and_b32 v103, 0xffff0000, v109
v_lshlrev_b32 v104, 16, v110
v_and_b32 v105, 0xffff0000, v110
v_lshlrev_b32 v106, 16, v111
v_and_b32 v107, 0xffff0000, v111
v_mul_f32 v212, v212, v81
v_fma_f32 v100, v100, v83, v212
v_mul_f32 v213, v213, v81
v_fma_f32 v101, v101, v83, v213
v_mul_f32 v214, v214, v81
v_fma_f32 v102, v102, v83, v214
v_mul_f32 v215, v215, v81
v_fma_f32 v103, v103, v83, v215
v_mul_f32 v220, v220, v81
v_fma_f32 v104, v104, v83, v220
v_mul_f32 v221, v221, v81
v_fma_f32 v105, v105, v83, v221
v_mul_f32 v222, v222, v81
v_fma_f32 v106, v106, v83, v222
v_mul_f32 v223, v223, v81
v_fma_f32 v107, v107, v83, v223
v_cvt_pk_bf16_f32 v108, v100, v101
v_cvt_pk_bf16_f32 v109, v102, v103
v_cvt_pk_bf16_f32 v110, v104, v105
v_cvt_pk_bf16_f32 v111, v106, v107
buffer_store_dwordx4 v[108:111], v1, s[12:15], s57 offen offset:1024 sc1
v_accvgpr_read_b32 v96, a120
v_accvgpr_read_b32 v97, a121
v_accvgpr_read_b32 v98, a122
v_accvgpr_read_b32 v99, a123
v_lshlrev_b32 v88, 16, v96
v_and_b32 v89, 0xffff0000, v96
v_lshlrev_b32 v90, 16, v97
v_and_b32 v91, 0xffff0000, v97
v_lshlrev_b32 v92, 16, v98
v_and_b32 v93, 0xffff0000, v98
v_lshlrev_b32 v94, 16, v99
v_and_b32 v95, 0xffff0000, v99
v_mul_f32 v228, v228, v81
v_fma_f32 v88, v88, v83, v228
v_mul_f32 v229, v229, v81
v_fma_f32 v89, v89, v83, v229
v_mul_f32 v230, v230, v81
v_fma_f32 v90, v90, v83, v230
v_mul_f32 v231, v231, v81
v_fma_f32 v91, v91, v83, v231
v_mul_f32 v236, v236, v81
v_fma_f32 v92, v92, v83, v236
v_mul_f32 v237, v237, v81
v_fma_f32 v93, v93, v83, v237
v_mul_f32 v238, v238, v81
v_fma_f32 v94, v94, v83, v238
v_mul_f32 v239, v239, v81
v_fma_f32 v95, v95, v83, v239
v_cvt_pk_bf16_f32 v96, v88, v89
v_cvt_pk_bf16_f32 v97, v90, v91
v_cvt_pk_bf16_f32 v98, v92, v93
v_cvt_pk_bf16_f32 v99, v94, v95
buffer_store_dwordx4 v[96:99], v1, s[12:15], s57 offen offset:2048 sc1
v_accvgpr_read_b32 v108, a124
v_accvgpr_read_b32 v109, a125
v_accvgpr_read_b32 v110, a126
v_accvgpr_read_b32 v111, a127
v_lshlrev_b32 v100, 16, v108
v_and_b32 v101, 0xffff0000, v108
v_lshlrev_b32 v102, 16, v109
v_and_b32 v103, 0xffff0000, v109
v_lshlrev_b32 v104, 16, v110
v_and_b32 v105, 0xffff0000, v110
v_lshlrev_b32 v106, 16, v111
v_and_b32 v107, 0xffff0000, v111
v_mul_f32 v244, v244, v81
v_fma_f32 v100, v100, v83, v244
v_mul_f32 v245, v245, v81
v_fma_f32 v101, v101, v83, v245
v_mul_f32 v246, v246, v81
v_fma_f32 v102, v102, v83, v246
v_mul_f32 v247, v247, v81
v_fma_f32 v103, v103, v83, v247
v_mul_f32 v252, v252, v81
v_fma_f32 v104, v104, v83, v252
v_mul_f32 v253, v253, v81
v_fma_f32 v105, v105, v83, v253
v_mul_f32 v254, v254, v81
v_fma_f32 v106, v106, v83, v254
v_mul_f32 v255, v255, v81
v_fma_f32 v107, v107, v83, v255
v_cvt_pk_bf16_f32 v108, v100, v101
v_cvt_pk_bf16_f32 v109, v102, v103
v_cvt_pk_bf16_f32 v110, v104, v105
v_cvt_pk_bf16_f32 v111, v106, v107
buffer_store_dwordx4 v[108:111], v1, s[12:15], s57 offen offset:3072 sc1
s_branch L_k2_done
L_k2_fin0:
s_lshl_b32 s56, s30, 3
s_lshl_b32 s57, s16, 1
s_add_u32 s56, s56, s57
s_lshl_b32 s56, s56, 4
s_add_u32 s56, s56, s17
s_lshl_b32 s56, s56, 13
s_add_u32 s56, s56, 50331648
v_rcp_f32 v80, v64
v_rcp_f32 v81, v68
s_nop 0
v_mul_f32 v88, v128, v80
v_mul_f32 v89, v129, v80
v_mul_f32 v90, v130, v80
v_mul_f32 v91, v131, v80
v_mul_f32 v92, v136, v80
v_mul_f32 v93, v137, v80
v_mul_f32 v94, v138, v80
v_mul_f32 v95, v139, v80
v_cvt_pk_bf16_f32 v96, v88, v89
v_cvt_pk_bf16_f32 v97, v90, v91
v_cvt_pk_bf16_f32 v98, v92, v93
v_cvt_pk_bf16_f32 v99, v94, v95
s_add_u32 s57, s56, 0
buffer_store_dwordx4 v[96:99], v1, s[12:15], s57 offen offset:0 sc1
v_mul_f32 v100, v144, v80
v_mul_f32 v101, v145, v80
v_mul_f32 v102, v146, v80
v_mul_f32 v103, v147, v80
v_mul_f32 v104, v152, v80
v_mul_f32 v105, v153, v80
v_mul_f32 v106, v154, v80
v_mul_f32 v107, v155, v80
v_cvt_pk_bf16_f32 v108, v100, v101
v_cvt_pk_bf16_f32 v109, v102, v103
v_cvt_pk_bf16_f32 v110, v104, v105
v_cvt_pk_bf16_f32 v111, v106, v107
buffer_store_dwordx4 v[108:111], v1, s[12:15], s57 offen offset:1024 sc1
v_mul_f32 v88, v160, v80
v_mul_f32 v89, v161, v80
v_mul_f32 v90, v162, v80
v_mul_f32 v91, v163, v80
v_mul_f32 v92, v168, v80
v_mul_f32 v93, v169, v80
v_mul_f32 v94, v170, v80
v_mul_f32 v95, v171, v80
v_cvt_pk_bf16_f32 v96, v88, v89
v_cvt_pk_bf16_f32 v97, v90, v91
v_cvt_pk_bf16_f32 v98, v92, v93
v_cvt_pk_bf16_f32 v99, v94, v95
buffer_store_dwordx4 v[96:99], v1, s[12:15], s57 offen offset:2048 sc1
v_mul_f32 v100, v176, v80
v_mul_f32 v101, v177, v80
v_mul_f32 v102, v178, v80
v_mul_f32 v103, v179, v80
v_mul_f32 v104, v184, v80
v_mul_f32 v105, v185, v80
v_mul_f32 v106, v186, v80
v_mul_f32 v107, v187, v80
v_cvt_pk_bf16_f32 v108, v100, v101
v_cvt_pk_bf16_f32 v109, v102, v103
v_cvt_pk_bf16_f32 v110, v104, v105
v_cvt_pk_bf16_f32 v111, v106, v107
buffer_store_dwordx4 v[108:111], v1, s[12:15], s57 offen offset:3072 sc1
v_mul_f32 v88, v192, v80
v_mul_f32 v89, v193, v80
v_mul_f32 v90, v194, v80
v_mul_f32 v91, v195, v80
v_mul_f32 v92, v200, v80
v_mul_f32 v93, v201, v80
v_mul_f32 v94, v202, v80
v_mul_f32 v95, v203, v80
v_cvt_pk_bf16_f32 v96, v88, v89
v_cvt_pk_bf16_f32 v97, v90, v91
v_cvt_pk_bf16_f32 v98, v92, v93
v_cvt_pk_bf16_f32 v99, v94, v95
s_add_u32 s57, s56, 4096
buffer_store_dwordx4 v[96:99], v1, s[12:15], s57 offen offset:0 sc1
v_mul_f32 v100, v208, v80
v_mul_f32 v101, v209, v80
v_mul_f32 v102, v210, v80
v_mul_f32 v103, v211, v80
v_mul_f32 v104, v216, v80
v_mul_f32 v105, v217, v80
v_mul_f32 v106, v218, v80
v_mul_f32 v107, v219, v80
v_cvt_pk_bf16_f32 v108, v100, v101
v_cvt_pk_bf16_f32 v109, v102, v103
v_cvt_pk_bf16_f32 v110, v104, v105
v_cvt_pk_bf16_f32 v111, v106, v107
buffer_store_dwordx4 v[108:111], v1, s[12:15], s57 offen offset:1024 sc1
v_mul_f32 v88, v224, v80
v_mul_f32 v89, v225, v80
v_mul_f32 v90, v226, v80
v_mul_f32 v91, v227, v80
v_mul_f32 v92, v232, v80
v_mul_f32 v93, v233, v80
v_mul_f32 v94, v234, v80
v_mul_f32 v95, v235, v80
v_cvt_pk_bf16_f32 v96, v88, v89
v_cvt_pk_bf16_f32 v97, v90, v91
v_cvt_pk_bf16_f32 v98, v92, v93
v_cvt_pk_bf16_f32 v99, v94, v95
buffer_store_dwordx4 v[96:99], v1, s[12:15], s57 offen offset:2048 sc1
v_mul_f32 v100, v240, v80
v_mul_f32 v101, v241, v80
v_mul_f32 v102, v242, v80
v_mul_f32 v103, v243, v80
v_mul_f32 v104, v248, v80
v_mul_f32 v105, v249, v80
v_mul_f32 v106, v250, v80
v_mul_f32 v107, v251, v80
v_cvt_pk_bf16_f32 v108, v100, v101
v_cvt_pk_bf16_f32 v109, v102, v103
v_cvt_pk_bf16_f32 v110, v104, v105
v_cvt_pk_bf16_f32 v111, v106, v107
buffer_store_dwordx4 v[108:111], v1, s[12:15], s57 offen offset:3072 sc1
v_mul_f32 v88, v132, v81
v_mul_f32 v89, v133, v81
v_mul_f32 v90, v134, v81
v_mul_f32 v91, v135, v81
v_mul_f32 v92, v140, v81
v_mul_f32 v93, v141, v81
v_mul_f32 v94, v142, v81
v_mul_f32 v95, v143, v81
v_cvt_pk_bf16_f32 v96, v88, v89
v_cvt_pk_bf16_f32 v97, v90, v91
v_cvt_pk_bf16_f32 v98, v92, v93
v_cvt_pk_bf16_f32 v99, v94, v95
s_add_u32 s57, s56, 131072
buffer_store_dwordx4 v[96:99], v1, s[12:15], s57 offen offset:0 sc1
v_mul_f32 v100, v148, v81
v_mul_f32 v101, v149, v81
v_mul_f32 v102, v150, v81
v_mul_f32 v103, v151, v81
v_mul_f32 v104, v156, v81
v_mul_f32 v105, v157, v81
v_mul_f32 v106, v158, v81
v_mul_f32 v107, v159, v81
v_cvt_pk_bf16_f32 v108, v100, v101
v_cvt_pk_bf16_f32 v109, v102, v103
v_cvt_pk_bf16_f32 v110, v104, v105
v_cvt_pk_bf16_f32 v111, v106, v107
buffer_store_dwordx4 v[108:111], v1, s[12:15], s57 offen offset:1024 sc1
v_mul_f32 v88, v164, v81
v_mul_f32 v89, v165, v81
v_mul_f32 v90, v166, v81
v_mul_f32 v91, v167, v81
v_mul_f32 v92, v172, v81
v_mul_f32 v93, v173, v81
v_mul_f32 v94, v174, v81
v_mul_f32 v95, v175, v81
v_cvt_pk_bf16_f32 v96, v88, v89
v_cvt_pk_bf16_f32 v97, v90, v91
v_cvt_pk_bf16_f32 v98, v92, v93
v_cvt_pk_bf16_f32 v99, v94, v95
buffer_store_dwordx4 v[96:99], v1, s[12:15], s57 offen offset:2048 sc1
v_mul_f32 v100, v180, v81
v_mul_f32 v101, v181, v81
v_mul_f32 v102, v182, v81
v_mul_f32 v103, v183, v81
v_mul_f32 v104, v188, v81
v_mul_f32 v105, v189, v81
v_mul_f32 v106, v190, v81
v_mul_f32 v107, v191, v81
v_cvt_pk_bf16_f32 v108, v100, v101
v_cvt_pk_bf16_f32 v109, v102, v103
v_cvt_pk_bf16_f32 v110, v104, v105
v_cvt_pk_bf16_f32 v111, v106, v107
buffer_store_dwordx4 v[108:111], v1, s[12:15], s57 offen offset:3072 sc1
v_mul_f32 v88, v196, v81
v_mul_f32 v89, v197, v81
v_mul_f32 v90, v198, v81
v_mul_f32 v91, v199, v81
v_mul_f32 v92, v204, v81
v_mul_f32 v93, v205, v81
v_mul_f32 v94, v206, v81
v_mul_f32 v95, v207, v81
v_cvt_pk_bf16_f32 v96, v88, v89
v_cvt_pk_bf16_f32 v97, v90, v91
v_cvt_pk_bf16_f32 v98, v92, v93
v_cvt_pk_bf16_f32 v99, v94, v95
s_add_u32 s57, s56, 135168
buffer_store_dwordx4 v[96:99], v1, s[12:15], s57 offen offset:0 sc1
v_mul_f32 v100, v212, v81
v_mul_f32 v101, v213, v81
v_mul_f32 v102, v214, v81
v_mul_f32 v103, v215, v81
v_mul_f32 v104, v220, v81
v_mul_f32 v105, v221, v81
v_mul_f32 v106, v222, v81
v_mul_f32 v107, v223, v81
v_cvt_pk_bf16_f32 v108, v100, v101
v_cvt_pk_bf16_f32 v109, v102, v103
v_cvt_pk_bf16_f32 v110, v104, v105
v_cvt_pk_bf16_f32 v111, v106, v107
buffer_store_dwordx4 v[108:111], v1, s[12:15], s57 offen offset:1024 sc1
v_mul_f32 v88, v228, v81
v_mul_f32 v89, v229, v81
v_mul_f32 v90, v230, v81
v_mul_f32 v91, v231, v81
v_mul_f32 v92, v236, v81
v_mul_f32 v93, v237, v81
v_mul_f32 v94, v238, v81
v_mul_f32 v95, v239, v81
v_cvt_pk_bf16_f32 v96, v88, v89
v_cvt_pk_bf16_f32 v97, v90, v91
v_cvt_pk_bf16_f32 v98, v92, v93
v_cvt_pk_bf16_f32 v99, v94, v95
buffer_store_dwordx4 v[96:99], v1, s[12:15], s57 offen offset:2048 sc1
v_mul_f32 v100, v244, v81
v_mul_f32 v101, v245, v81
v_mul_f32 v102, v246, v81
v_mul_f32 v103, v247, v81
v_mul_f32 v104, v252, v81
v_mul_f32 v105, v253, v81
v_mul_f32 v106, v254, v81
v_mul_f32 v107, v255, v81
v_cvt_pk_bf16_f32 v108, v100, v101
v_cvt_pk_bf16_f32 v109, v102, v103
v_cvt_pk_bf16_f32 v110, v104, v105
v_cvt_pk_bf16_f32 v111, v106, v107
buffer_store_dwordx4 v[108:111], v1, s[12:15], s57 offen offset:3072 sc1
s_branch L_k2_done
L_k2_pub:
s_lshl_b32 s56, s17, 3
s_add_u32 s56, s56, s19
s_mul_i32 s56, s56, 69632
s_mul_i32 s57, s16, 17408
s_add_u32 s56, s56, s57
s_add_u32 s56, s56, 83886080
v_sub_f32 v76, 0, v56
v_mov_b32 v78, v64
v_rcp_f32 v80, v64
v_sub_f32 v77, 0, v60
v_mov_b32 v79, v68
v_rcp_f32 v81, v68
s_add_u32 s57, s56, 16384
buffer_store_dwordx4 v[76:79], v1, s[12:15], s57 offen sc1
v_mul_f32 v88, v128, v80
v_mul_f32 v89, v129, v80
v_mul_f32 v90, v130, v80
v_mul_f32 v91, v131, v80
v_mul_f32 v92, v136, v80
v_mul_f32 v93, v137, v80
v_mul_f32 v94, v138, v80
v_mul_f32 v95, v139, v80
v_cvt_pk_bf16_f32 v96, v88, v89
v_cvt_pk_bf16_f32 v97, v90, v91
v_cvt_pk_bf16_f32 v98, v92, v93
v_cvt_pk_bf16_f32 v99, v94, v95
s_add_u32 s57, s56, 0
buffer_store_dwordx4 v[96:99], v1, s[12:15], s57 offen offset:0 sc1
v_mul_f32 v100, v144, v80
v_mul_f32 v101, v145, v80
v_mul_f32 v102, v146, v80
v_mul_f32 v103, v147, v80
v_mul_f32 v104, v152, v80
v_mul_f32 v105, v153, v80
v_mul_f32 v106, v154, v80
v_mul_f32 v107, v155, v80
v_cvt_pk_bf16_f32 v108, v100, v101
v_cvt_pk_bf16_f32 v109, v102, v103
v_cvt_pk_bf16_f32 v110, v104, v105
v_cvt_pk_bf16_f32 v111, v106, v107
buffer_store_dwordx4 v[108:111], v1, s[12:15], s57 offen offset:1024 sc1
v_mul_f32 v88, v160, v80
v_mul_f32 v89, v161, v80
v_mul_f32 v90, v162, v80
v_mul_f32 v91, v163, v80
v_mul_f32 v92, v168, v80
v_mul_f32 v93, v169, v80
v_mul_f32 v94, v170, v80
v_mul_f32 v95, v171, v80
v_cvt_pk_bf16_f32 v96, v88, v89
v_cvt_pk_bf16_f32 v97, v90, v91
v_cvt_pk_bf16_f32 v98, v92, v93
v_cvt_pk_bf16_f32 v99, v94, v95
buffer_store_dwordx4 v[96:99], v1, s[12:15], s57 offen offset:2048 sc1
v_mul_f32 v100, v176, v80
v_mul_f32 v101, v177, v80
v_mul_f32 v102, v178, v80
v_mul_f32 v103, v179, v80
v_mul_f32 v104, v184, v80
v_mul_f32 v105, v185, v80
v_mul_f32 v106, v186, v80
v_mul_f32 v107, v187, v80
v_cvt_pk_bf16_f32 v108, v100, v101
v_cvt_pk_bf16_f32 v109, v102, v103
v_cvt_pk_bf16_f32 v110, v104, v105
v_cvt_pk_bf16_f32 v111, v106, v107
buffer_store_dwordx4 v[108:111], v1, s[12:15], s57 offen offset:3072 sc1
v_mul_f32 v88, v192, v80
v_mul_f32 v89, v193, v80
v_mul_f32 v90, v194, v80
v_mul_f32 v91, v195, v80
v_mul_f32 v92, v200, v80
v_mul_f32 v93, v201, v80
v_mul_f32 v94, v202, v80
v_mul_f32 v95, v203, v80
v_cvt_pk_bf16_f32 v96, v88, v89
v_cvt_pk_bf16_f32 v97, v90, v91
v_cvt_pk_bf16_f32 v98, v92, v93
v_cvt_pk_bf16_f32 v99, v94, v95
s_add_u32 s57, s56, 4096
buffer_store_dwordx4 v[96:99], v1, s[12:15], s57 offen offset:0 sc1
v_mul_f32 v100, v208, v80
v_mul_f32 v101, v209, v80
v_mul_f32 v102, v210, v80
v_mul_f32 v103, v211, v80
v_mul_f32 v104, v216, v80
v_mul_f32 v105, v217, v80
v_mul_f32 v106, v218, v80
v_mul_f32 v107, v219, v80
v_cvt_pk_bf16_f32 v108, v100, v101
v_cvt_pk_bf16_f32 v109, v102, v103
v_cvt_pk_bf16_f32 v110, v104, v105
v_cvt_pk_bf16_f32 v111, v106, v107
buffer_store_dwordx4 v[108:111], v1, s[12:15], s57 offen offset:1024 sc1
v_mul_f32 v88, v224, v80
v_mul_f32 v89, v225, v80
v_mul_f32 v90, v226, v80
v_mul_f32 v91, v227, v80
v_mul_f32 v92, v232, v80
v_mul_f32 v93, v233, v80
v_mul_f32 v94, v234, v80
v_mul_f32 v95, v235, v80
v_cvt_pk_bf16_f32 v96, v88, v89
v_cvt_pk_bf16_f32 v97, v90, v91
v_cvt_pk_bf16_f32 v98, v92, v93
v_cvt_pk_bf16_f32 v99, v94, v95
buffer_store_dwordx4 v[96:99], v1, s[12:15], s57 offen offset:2048 sc1
v_mul_f32 v100, v240, v80
v_mul_f32 v101, v241, v80
v_mul_f32 v102, v242, v80
v_mul_f32 v103, v243, v80
v_mul_f32 v104, v248, v80
v_mul_f32 v105, v249, v80
v_mul_f32 v106, v250, v80
v_mul_f32 v107, v251, v80
v_cvt_pk_bf16_f32 v108, v100, v101
v_cvt_pk_bf16_f32 v109, v102, v103
v_cvt_pk_bf16_f32 v110, v104, v105
v_cvt_pk_bf16_f32 v111, v106, v107
buffer_store_dwordx4 v[108:111], v1, s[12:15], s57 offen offset:3072 sc1
v_mul_f32 v88, v132, v81
v_mul_f32 v89, v133, v81
v_mul_f32 v90, v134, v81
v_mul_f32 v91, v135, v81
v_mul_f32 v92, v140, v81
v_mul_f32 v93, v141, v81
v_mul_f32 v94, v142, v81
v_mul_f32 v95, v143, v81
v_cvt_pk_bf16_f32 v96, v88, v89
v_cvt_pk_bf16_f32 v97, v90, v91
v_cvt_pk_bf16_f32 v98, v92, v93
v_cvt_pk_bf16_f32 v99, v94, v95
s_add_u32 s57, s56, 8192
buffer_store_dwordx4 v[96:99], v1, s[12:15], s57 offen offset:0 sc1
v_mul_f32 v100, v148, v81
v_mul_f32 v101, v149, v81
v_mul_f32 v102, v150, v81
v_mul_f32 v103, v151, v81
v_mul_f32 v104, v156, v81
v_mul_f32 v105, v157, v81
v_mul_f32 v106, v158, v81
v_mul_f32 v107, v159, v81
v_cvt_pk_bf16_f32 v108, v100, v101
v_cvt_pk_bf16_f32 v109, v102, v103
v_cvt_pk_bf16_f32 v110, v104, v105
v_cvt_pk_bf16_f32 v111, v106, v107
buffer_store_dwordx4 v[108:111], v1, s[12:15], s57 offen offset:1024 sc1
v_mul_f32 v88, v164, v81
v_mul_f32 v89, v165, v81
v_mul_f32 v90, v166, v81
v_mul_f32 v91, v167, v81
v_mul_f32 v92, v172, v81
v_mul_f32 v93, v173, v81
v_mul_f32 v94, v174, v81
v_mul_f32 v95, v175, v81
v_cvt_pk_bf16_f32 v96, v88, v89
v_cvt_pk_bf16_f32 v97, v90, v91
v_cvt_pk_bf16_f32 v98, v92, v93
v_cvt_pk_bf16_f32 v99, v94, v95
buffer_store_dwordx4 v[96:99], v1, s[12:15], s57 offen offset:2048 sc1
v_mul_f32 v100, v180, v81
v_mul_f32 v101, v181, v81
v_mul_f32 v102, v182, v81
v_mul_f32 v103, v183, v81
v_mul_f32 v104, v188, v81
v_mul_f32 v105, v189, v81
v_mul_f32 v106, v190, v81
v_mul_f32 v107, v191, v81
v_cvt_pk_bf16_f32 v108, v100, v101
v_cvt_pk_bf16_f32 v109, v102, v103
v_cvt_pk_bf16_f32 v110, v104, v105
v_cvt_pk_bf16_f32 v111, v106, v107
buffer_store_dwordx4 v[108:111], v1, s[12:15], s57 offen offset:3072 sc1
v_mul_f32 v88, v196, v81
v_mul_f32 v89, v197, v81
v_mul_f32 v90, v198, v81
v_mul_f32 v91, v199, v81
v_mul_f32 v92, v204, v81
v_mul_f32 v93, v205, v81
v_mul_f32 v94, v206, v81
v_mul_f32 v95, v207, v81
v_cvt_pk_bf16_f32 v96, v88, v89
v_cvt_pk_bf16_f32 v97, v90, v91
v_cvt_pk_bf16_f32 v98, v92, v93
v_cvt_pk_bf16_f32 v99, v94, v95
s_add_u32 s57, s56, 12288
buffer_store_dwordx4 v[96:99], v1, s[12:15], s57 offen offset:0 sc1
v_mul_f32 v100, v212, v81
v_mul_f32 v101, v213, v81
v_mul_f32 v102, v214, v81
v_mul_f32 v103, v215, v81
v_mul_f32 v104, v220, v81
v_mul_f32 v105, v221, v81
v_mul_f32 v106, v222, v81
v_mul_f32 v107, v223, v81
v_cvt_pk_bf16_f32 v108, v100, v101
v_cvt_pk_bf16_f32 v109, v102, v103
v_cvt_pk_bf16_f32 v110, v104, v105
v_cvt_pk_bf16_f32 v111, v106, v107
buffer_store_dwordx4 v[108:111], v1, s[12:15], s57 offen offset:1024 sc1
v_mul_f32 v88, v228, v81
v_mul_f32 v89, v229, v81
v_mul_f32 v90, v230, v81
v_mul_f32 v91, v231, v81
v_mul_f32 v92, v236, v81
v_mul_f32 v93, v237, v81
v_mul_f32 v94, v238, v81
v_mul_f32 v95, v239, v81
v_cvt_pk_bf16_f32 v96, v88, v89
v_cvt_pk_bf16_f32 v97, v90, v91
v_cvt_pk_bf16_f32 v98, v92, v93
v_cvt_pk_bf16_f32 v99, v94, v95
buffer_store_dwordx4 v[96:99], v1, s[12:15], s57 offen offset:2048 sc1
v_mul_f32 v100, v244, v81
v_mul_f32 v101, v245, v81
v_mul_f32 v102, v246, v81
v_mul_f32 v103, v247, v81
v_mul_f32 v104, v252, v81
v_mul_f32 v105, v253, v81
v_mul_f32 v106, v254, v81
v_mul_f32 v107, v255, v81
v_cvt_pk_bf16_f32 v108, v100, v101
v_cvt_pk_bf16_f32 v109, v102, v103
v_cvt_pk_bf16_f32 v110, v104, v105
v_cvt_pk_bf16_f32 v111, v106, v107
buffer_store_dwordx4 v[108:111], v1, s[12:15], s57 offen offset:3072 sc1
s_mov_b32 s88, 1
s_mov_b32 s30, s19
s_mov_b32 s27, 0
s_mov_b32 s29, s61
s_mov_b32 s65, 0
v_accvgpr_mov_b32 a0, a64
v_accvgpr_mov_b32 a1, a65
v_accvgpr_mov_b32 a2, a66
v_accvgpr_mov_b32 a3, a67
v_accvgpr_mov_b32 a4, a68
v_accvgpr_mov_b32 a5, a69
v_accvgpr_mov_b32 a6, a70
v_accvgpr_mov_b32 a7, a71
v_accvgpr_mov_b32 a8, a72
v_accvgpr_mov_b32 a9, a73
v_accvgpr_mov_b32 a10, a74
v_accvgpr_mov_b32 a11, a75
v_accvgpr_mov_b32 a12, a76
v_accvgpr_mov_b32 a13, a77
v_accvgpr_mov_b32 a14, a78
v_accvgpr_mov_b32 a15, a79
v_accvgpr_mov_b32 a16, a80
v_accvgpr_mov_b32 a17, a81
v_accvgpr_mov_b32 a18, a82
v_accvgpr_mov_b32 a19, a83
v_accvgpr_mov_b32 a20, a84
v_accvgpr_mov_b32 a21, a85
v_accvgpr_mov_b32 a22, a86
v_accvgpr_mov_b32 a23, a87
v_accvgpr_mov_b32 a24, a88
v_accvgpr_mov_b32 a25, a89
v_accvgpr_mov_b32 a26, a90
v_accvgpr_mov_b32 a27, a91
v_accvgpr_mov_b32 a28, a92
v_accvgpr_mov_b32 a29, a93
v_accvgpr_mov_b32 a30, a94
v_accvgpr_mov_b32 a31, a95
v_accvgpr_mov_b32 a32, a96
v_accvgpr_mov_b32 a33, a97
v_accvgpr_mov_b32 a34, a98
v_accvgpr_mov_b32 a35, a99
v_accvgpr_mov_b32 a36, a100
v_accvgpr_mov_b32 a37, a101
v_accvgpr_mov_b32 a38, a102
v_accvgpr_mov_b32 a39, a103
v_accvgpr_mov_b32 a40, a104
v_accvgpr_mov_b32 a41, a105
v_accvgpr_mov_b32 a42, a106
v_accvgpr_mov_b32 a43, a107
v_accvgpr_mov_b32 a44, a108
v_accvgpr_mov_b32 a45, a109
v_accvgpr_mov_b32 a46, a110
v_accvgpr_mov_b32 a47, a111
v_accvgpr_mov_b32 a48, a112
v_accvgpr_mov_b32 a49, a113
v_accvgpr_mov_b32 a50, a114
v_accvgpr_mov_b32 a51, a115
v_accvgpr_mov_b32 a52, a116
v_accvgpr_mov_b32 a53, a117
v_accvgpr_mov_b32 a54, a118
v_accvgpr_mov_b32 a55, a119
v_accvgpr_mov_b32 a56, a120
v_accvgpr_mov_b32 a57, a121
v_accvgpr_mov_b32 a58, a122
v_accvgpr_mov_b32 a59, a123
v_accvgpr_mov_b32 a60, a124
v_accvgpr_mov_b32 a61, a125
v_accvgpr_mov_b32 a62, a126
v_accvgpr_mov_b32 a63, a127
s_add_u32 s56, s26, 16384
s_and_b32 s56, s56, 0xffff
v_add_u32 v2, s56, v5
v_subrev_u32 v2, 0x10000, v2
s_add_u32 s56, s56, 16384
s_and_b32 s56, s56, 0xffff
v_add_u32 v3, s56, v5
v_subrev_u32 v3, 0x10000, v3
s_branch L_k2_seg
L_k2_done:
s_lshl_b32 s60, s30, 4
s_add_u32 s60, s60, s17
s_lshl_b32 s60, s60, 7
s_add_u32 s60, s60, 104988672
v_and_b32 v1, 63, v0
v_lshlrev_b32 v1, 4, v1
s_mov_b32 s8, s50
s_mov_b32 s9, s51
s_mov_b32 s10, 3670016
s_mov_b32 s11, 0x20000
s_cmp_ge_u32 s2, 224
s_cbranch_scc1 L_k3_B
s_and_b32 s19, s2, 7
s_lshr_b32 s20, s2, 3
s_lshl_b32 s23, s19, 2
s_and_b32 s21, s20, 3
s_add_u32 s23, s23, s21
s_lshr_b32 s22, s20, 2
v_add_u32 v2, 0, v1
v_add_u32 v3, 131072, v1
v_add_u32 v4, 262144, v1
v_add_u32 v5, 393216, v1
s_lshl_b32 s17, s22, 19
s_lshl_b32 s19, s16, 15
s_add_u32 s17, s17, s19
s_add_u32 s17, s17, 75497472
s_lshl_b32 s18, s23, 19
s_add_u32 s18, s18, s19
s_add_u32 s18, s18, 50331648
buffer_load_dwordx4 a[0:3], v2, s[12:15], s17 offen sc1
buffer_load_dwordx4 a[4:7], v3, s[12:15], s17 offen sc1
buffer_load_dwordx4 a[8:11], v4, s[12:15], s17 offen sc1
buffer_load_dwordx4 a[12:15], v5, s[12:15], s17 offen sc1
s_add_u32 s17, s17, 1024
buffer_load_dwordx4 a[32:35], v2, s[12:15], s17 offen sc1
buffer_load_dwordx4 a[36:39], v3, s[12:15], s17 offen sc1
buffer_load_dwordx4 a[40:43], v4, s[12:15], s17 offen sc1
buffer_load_dwordx4 a[44:47], v5, s[12:15], s17 offen sc1
s_add_u32 s17, s17, 1024
buffer_load_dwordx4 a[64:67], v2, s[12:15], s17 offen sc1
buffer_load_dwordx4 a[68:71], v3, s[12:15], s17 offen sc1
buffer_load_dwordx4 a[72:75], v4, s[12:15], s17 offen sc1
buffer_load_dwordx4 a[76:79], v5, s[12:15], s17 offen sc1
s_add_u32 s17, s17, 1024
buffer_load_dwordx4 a[96:99], v2, s[12:15], s17 offen sc1
buffer_load_dwordx4 a[100:103], v3, s[12:15], s17 offen sc1
buffer_load_dwordx4 a[104:107], v4, s[12:15], s17 offen sc1
buffer_load_dwordx4 a[108:111], v5, s[12:15], s17 offen sc1
s_add_u32 s17, s17, 1024
buffer_load_dwordx4 a[128:131], v2, s[12:15], s17 offen sc1
buffer_load_dwordx4 a[132:135], v3, s[12:15], s17 offen sc1
buffer_load_dwordx4 a[136:139], v4, s[12:15], s17 offen sc1
buffer_load_dwordx4 a[140:143], v5, s[12:15], s17 offen sc1
s_add_u32 s17, s17, 1024
buffer_load_dwordx4 a[160:163], v2, s[12:15], s17 offen sc1
buffer_load_dwordx4 a[164:167], v3, s[12:15], s17 offen sc1
buffer_load_dwordx4 a[168:171], v4, s[12:15], s17 offen sc1
buffer_load_dwordx4 a[172:175], v5, s[12:15], s17 offen sc1
s_add_u32 s17, s17, 1024
buffer_load_dwordx4 a[192:195], v2, s[12:15], s17 offen sc1
buffer_load_dwordx4 a[196:199], v3, s[12:15], s17 offen sc1
buffer_load_dwordx4 a[200:203], v4, s[12:15], s17 offen sc1
buffer_load_dwordx4 a[204:207], v5, s[12:15], s17 offen sc1
s_add_u32 s17, s17, 1024
s_waitcnt vmcnt(28)
s_barrier
s_cmp_lg_u32 s16, 0
s_cbranch_scc1 L_k2_ctxsig28
v_mov_b32 v10, 0
v_mov_b32 v11, s3
s_mov_b64 exec, 1
buffer_store_dword v11, v10, s[12:15], s60 offen sc1
s_mov_b64 exec, -1
L_k2_ctxsig28:
v_and_b32 v12, 3, v0
v_lshlrev_b32 v12, 7, v12
s_lshr_b32 s19, s23, 1
s_lshl_b32 s19, s19, 11
s_lshl_b32 s20, s16, 9
s_add_u32 s19, s19, s20
s_add_u32 s19, s19, 104988672
s_mov_b32 s24, 0
L_poll_ctx:
buffer_load_dword v13, v12, s[12:15], s19 offen sc1
s_waitcnt vmcnt(0)
v_cmp_ne_u32 vcc, s3, v13
s_nop 4
s_cbranch_vccz L_pollok_ctx
s_add_u32 s24, s24, 1
s_sleep 1
s_cmp_lt_u32 s24, 400000
s_cbranch_scc1 L_poll_ctx
L_pollok_ctx:
buffer_load_dwordx4 a[16:19], v2, s[12:15], s18 offen sc1
buffer_load_dwordx4 a[20:23], v3, s[12:15], s18 offen sc1
buffer_load_dwordx4 a[24:27], v4, s[12:15], s18 offen sc1
buffer_load_dwordx4 a[28:31], v5, s[12:15], s18 offen sc1
s_add_u32 s18, s18, 1024
buffer_load_dwordx4 a[48:51], v2, s[12:15], s18 offen sc1
buffer_load_dwordx4 a[52:55], v3, s[12:15], s18 offen sc1
buffer_load_dwordx4 a[56:59], v4, s[12:15], s18 offen sc1
buffer_load_dwordx4 a[60:63], v5, s[12:15], s18 offen sc1
s_add_u32 s18, s18, 1024
buffer_load_dwordx4 a[80:83], v2, s[12:15], s18 offen sc1
buffer_load_dwordx4 a[84:87], v3, s[12:15], s18 offen sc1
buffer_load_dwordx4 a[88:91], v4, s[12:15], s18 offen sc1
buffer_load_dwordx4 a[92:95], v5, s[12:15], s18 offen sc1
s_add_u32 s18, s18, 1024
buffer_load_dwordx4 a[112:115], v2, s[12:15], s18 offen sc1
buffer_load_dwordx4 a[116:119], v3, s[12:15], s18 offen sc1
buffer_load_dwordx4 a[120:123], v4, s[12:15], s18 offen sc1
buffer_load_dwordx4 a[124:127], v5, s[12:15], s18 offen sc1
s_add_u32 s18, s18, 1024
buffer_load_dwordx4 a[144:147], v2, s[12:15], s18 offen sc1
buffer_load_dwordx4 a[148:151], v3, s[12:15], s18 offen sc1
buffer_load_dwordx4 a[152:155], v4, s[12:15], s18 offen sc1
buffer_load_dwordx4 a[156:159], v5, s[12:15], s18 offen sc1
s_add_u32 s18, s18, 1024
buffer_load_dwordx4 a[176:179], v2, s[12:15], s18 offen sc1
buffer_load_dwordx4 a[180:183], v3, s[12:15], s18 offen sc1
buffer_load_dwordx4 a[184:187], v4, s[12:15], s18 offen sc1
buffer_load_dwordx4 a[188:191], v5, s[12:15], s18 offen sc1
s_add_u32 s18, s18, 1024
buffer_load_dwordx4 a[208:211], v2, s[12:15], s18 offen sc1
buffer_load_dwordx4 a[212:215], v3, s[12:15], s18 offen sc1
buffer_load_dwordx4 a[216:219], v4, s[12:15], s18 offen sc1
buffer_load_dwordx4 a[220:223], v5, s[12:15], s18 offen sc1
s_add_u32 s18, s18, 1024
s_waitcnt vmcnt(24)
v_mfma_f32_16x16x32_bf16 v[16:19], a[0:3], a[16:19], 0
v_mfma_f32_16x16x32_bf16 v[20:23], a[0:3], a[20:23], 0
v_mfma_f32_16x16x32_bf16 v[24:27], a[0:3], a[24:27], 0
v_mfma_f32_16x16x32_bf16 v[28:31], a[0:3], a[28:31], 0
v_mfma_f32_16x16x32_bf16 v[32:35], a[4:7], a[16:19], 0
v_mfma_f32_16x16x32_bf16 v[36:39], a[4:7], a[20:23], 0
v_mfma_f32_16x16x32_bf16 v[40:43], a[4:7], a[24:27], 0
v_mfma_f32_16x16x32_bf16 v[44:47], a[4:7], a[28:31], 0
v_mfma_f32_16x16x32_bf16 v[48:51], a[8:11], a[16:19], 0
v_mfma_f32_16x16x32_bf16 v[52:55], a[8:11], a[20:23], 0
v_mfma_f32_16x16x32_bf16 v[56:59], a[8:11], a[24:27], 0
v_mfma_f32_16x16x32_bf16 v[60:63], a[8:11], a[28:31], 0
v_mfma_f32_16x16x32_bf16 v[64:67], a[12:15], a[16:19], 0
v_mfma_f32_16x16x32_bf16 v[68:71], a[12:15], a[20:23], 0
v_mfma_f32_16x16x32_bf16 v[72:75], a[12:15], a[24:27], 0
v_mfma_f32_16x16x32_bf16 v[76:79], a[12:15], a[28:31], 0
buffer_load_dwordx4 a[0:3], v2, s[12:15], s17 offen sc1
buffer_load_dwordx4 a[4:7], v3, s[12:15], s17 offen sc1
buffer_load_dwordx4 a[8:11], v4, s[12:15], s17 offen sc1
buffer_load_dwordx4 a[12:15], v5, s[12:15], s17 offen sc1
s_add_u32 s17, s17, 1024
buffer_load_dwordx4 a[16:19], v2, s[12:15], s18 offen sc1
buffer_load_dwordx4 a[20:23], v3, s[12:15], s18 offen sc1
buffer_load_dwordx4 a[24:27], v4, s[12:15], s18 offen sc1
buffer_load_dwordx4 a[28:31], v5, s[12:15], s18 offen sc1
s_add_u32 s18, s18, 1024
s_waitcnt vmcnt(28)
v_mfma_f32_16x16x32_bf16 v[16:19], a[32:35], a[48:51], v[16:19]
v_mfma_f32_16x16x32_bf16 v[20:23], a[32:35], a[52:55], v[20:23]
v_mfma_f32_16x16x32_bf16 v[24:27], a[32:35], a[56:59], v[24:27]
v_mfma_f32_16x16x32_bf16 v[28:31], a[32:35], a[60:63], v[28:31]
v_mfma_f32_16x16x32_bf16 v[32:35], a[36:39], a[48:51], v[32:35]
v_mfma_f32_16x16x32_bf16 v[36:39], a[36:39], a[52:55], v[36:39]
v_mfma_f32_16x16x32_bf16 v[40:43], a[36:39], a[56:59], v[40:43]
v_mfma_f32_16x16x32_bf16 v[44:47], a[36:39], a[60:63], v[44:47]
v_mfma_f32_16x16x32_bf16 v[48:51], a[40:43], a[48:51], v[48:51]
v_mfma_f32_16x16x32_bf16 v[52:55], a[40:43], a[52:55], v[52:55]
v_mfma_f32_16x16x32_bf16 v[56:59], a[40:43], a[56:59], v[56:59]
v_mfma_f32_16x16x32_bf16 v[60:63], a[40:43], a[60:63], v[60:63]
v_mfma_f32_16x16x32_bf16 v[64:67], a[44:47], a[48:51], v[64:67]
v_mfma_f32_16x16x32_bf16 v[68:71], a[44:47], a[52:55], v[68:71]
v_mfma_f32_16x16x32_bf16 v[72:75], a[44:47], a[56:59], v[72:75]
v_mfma_f32_16x16x32_bf16 v[76:79], a[44:47], a[60:63], v[76:79]
buffer_load_dwordx4 a[32:35], v2, s[12:15], s17 offen sc1
buffer_load_dwordx4 a[36:39], v3, s[12:15], s17 offen sc1
buffer_load_dwordx4 a[40:43], v4, s[12:15], s17 offen sc1
buffer_load_dwordx4 a[44:47], v5, s[12:15], s17 offen sc1
s_add_u32 s17, s17, 1024
buffer_load_dwordx4 a[48:51], v2, s[12:15], s18 offen sc1
buffer_load_dwordx4 a[52:55], v3, s[12:15], s18 offen sc1
buffer_load_dwordx4 a[56:59], v4, s[12:15], s18 offen sc1
buffer_load_dwordx4 a[60:63], v5, s[12:15], s18 offen sc1
s_add_u32 s18, s18, 1024
s_waitcnt vmcnt(32)
v_mfma_f32_16x16x32_bf16 v[16:19], a[64:67], a[80:83], v[16:19]
v_mfma_f32_16x16x32_bf16 v[20:23], a[64:67], a[84:87], v[20:23]
v_mfma_f32_16x16x32_bf16 v[24:27], a[64:67], a[88:91], v[24:27]
v_mfma_f32_16x16x32_bf16 v[28:31], a[64:67], a[92:95], v[28:31]
v_mfma_f32_16x16x32_bf16 v[32:35], a[68:71], a[80:83], v[32:35]
v_mfma_f32_16x16x32_bf16 v[36:39], a[68:71], a[84:87], v[36:39]
v_mfma_f32_16x16x32_bf16 v[40:43], a[68:71], a[88:91], v[40:43]
v_mfma_f32_16x16x32_bf16 v[44:47], a[68:71], a[92:95], v[44:47]
v_mfma_f32_16x16x32_bf16 v[48:51], a[72:75], a[80:83], v[48:51]
v_mfma_f32_16x16x32_bf16 v[52:55], a[72:75], a[84:87], v[52:55]
v_mfma_f32_16x16x32_bf16 v[56:59], a[72:75], a[88:91], v[56:59]
v_mfma_f32_16x16x32_bf16 v[60:63], a[72:75], a[92:95], v[60:63]
v_mfma_f32_16x16x32_bf16 v[64:67], a[76:79], a[80:83], v[64:67]
v_mfma_f32_16x16x32_bf16 v[68:71], a[76:79], a[84:87], v[68:71]
v_mfma_f32_16x16x32_bf16 v[72:75], a[76:79], a[88:91], v[72:75]
v_mfma_f32_16x16x32_bf16 v[76:79], a[76:79], a[92:95], v[76:79]
buffer_load_dwordx4 a[64:67], v2, s[12:15], s17 offen sc1
buffer_load_dwordx4 a[68:71], v3, s[12:15], s17 offen sc1
buffer_load_dwordx4 a[72:75], v4, s[12:15], s17 offen sc1
buffer_load_dwordx4 a[76:79], v5, s[12:15], s17 offen sc1
s_add_u32 s17, s17, 1024
buffer_load_dwordx4 a[80:83], v2, s[12:15], s18 offen sc1
buffer_load_dwordx4 a[84:87], v3, s[12:15], s18 offen sc1
buffer_load_dwordx4 a[88:91], v4, s[12:15], s18 offen sc1
buffer_load_dwordx4 a[92:95], v5, s[12:15], s18 offen sc1
s_add_u32 s18, s18, 1024
s_waitcnt vmcnt(36)
v_mfma_f32_16x16x32_bf16 v[16:19], a[96:99], a[112:115], v[16:19]
v_mfma_f32_16x16x32_bf16 v[20:23], a[96:99], a[116:119], v[20:23]
v_mfma_f32_16x16x32_bf16 v[24:27], a[96:99], a[120:123], v[24:27]
v_mfma_f32_16x16x32_bf16 v[28:31], a[96:99], a[124:127], v[28:31]
v_mfma_f32_16x16x32_bf16 v[32:35], a[100:103], a[112:115], v[32:35]
v_mfma_f32_16x16x32_bf16 v[36:39], a[100:103], a[116:119], v[36:39]
v_mfma_f32_16x16x32_bf16 v[40:43], a[100:103], a[120:123], v[40:43]
v_mfma_f32_16x16x32_bf16 v[44:47], a[100:103], a[124:127], v[44:47]
v_mfma_f32_16x16x32_bf16 v[48:51], a[104:107], a[112:115], v[48:51]
v_mfma_f32_16x16x32_bf16 v[52:55], a[104:107], a[116:119], v[52:55]
v_mfma_f32_16x16x32_bf16 v[56:59], a[104:107], a[120:123], v[56:59]
v_mfma_f32_16x16x32_bf16 v[60:63], a[104:107], a[124:127], v[60:63]
v_mfma_f32_16x16x32_bf16 v[64:67], a[108:111], a[112:115], v[64:67]
v_mfma_f32_16x16x32_bf16 v[68:71], a[108:111], a[116:119], v[68:71]
v_mfma_f32_16x16x32_bf16 v[72:75], a[108:111], a[120:123], v[72:75]
v_mfma_f32_16x16x32_bf16 v[76:79], a[108:111], a[124:127], v[76:79]
buffer_load_dwordx4 a[96:99], v2, s[12:15], s17 offen sc1
buffer_load_dwordx4 a[100:103], v3, s[12:15], s17 offen sc1
buffer_load_dwordx4 a[104:107], v4, s[12:15], s17 offen sc1
buffer_load_dwordx4 a[108:111], v5, s[12:15], s17 offen sc1
s_add_u32 s17, s17, 1024
buffer_load_dwordx4 a[112:115], v2, s[12:15], s18 offen sc1
buffer_load_dwordx4 a[116:119], v3, s[12:15], s18 offen sc1
buffer_load_dwordx4 a[120:123], v4, s[12:15], s18 offen sc1
buffer_load_dwordx4 a[124:127], v5, s[12:15], s18 offen sc1
s_add_u32 s18, s18, 1024
s_waitcnt vmcnt(40)
v_mfma_f32_16x16x32_bf16 v[16:19], a[128:131], a[144:147], v[16:19]
v_mfma_f32_16x16x32_bf16 v[20:23], a[128:131], a[148:151], v[20:23]
v_mfma_f32_16x16x32_bf16 v[24:27], a[128:131], a[152:155], v[24:27]
v_mfma_f32_16x16x32_bf16 v[28:31], a[128:131], a[156:159], v[28:31]
v_mfma_f32_16x16x32_bf16 v[32:35], a[132:135], a[144:147], v[32:35]
v_mfma_f32_16x16x32_bf16 v[36:39], a[132:135], a[148:151], v[36:39]
v_mfma_f32_16x16x32_bf16 v[40:43], a[132:135], a[152:155], v[40:43]
v_mfma_f32_16x16x32_bf16 v[44:47], a[132:135], a[156:159], v[44:47]
v_mfma_f32_16x16x32_bf16 v[48:51], a[136:139], a[144:147], v[48:51]
v_mfma_f32_16x16x32_bf16 v[52:55], a[136:139], a[148:151], v[52:55]
v_mfma_f32_16x16x32_bf16 v[56:59], a[136:139], a[152:155], v[56:59]
v_mfma_f32_16x16x32_bf16 v[60:63], a[136:139], a[156:159], v[60:63]
v_mfma_f32_16x16x32_bf16 v[64:67], a[140:143], a[144:147], v[64:67]
v_mfma_f32_16x16x32_bf16 v[68:71], a[140:143], a[148:151], v[68:71]
v_mfma_f32_16x16x32_bf16 v[72:75], a[140:143], a[152:155], v[72:75]
v_mfma_f32_16x16x32_bf16 v[76:79], a[140:143], a[156:159], v[76:79]
buffer_load_dwordx4 a[128:131], v2, s[12:15], s17 offen sc1
buffer_load_dwordx4 a[132:135], v3, s[12:15], s17 offen sc1
buffer_load_dwordx4 a[136:139], v4, s[12:15], s17 offen sc1
buffer_load_dwordx4 a[140:143], v5, s[12:15], s17 offen sc1
s_add_u32 s17, s17, 1024
buffer_load_dwordx4 a[144:147], v2, s[12:15], s18 offen sc1
buffer_load_dwordx4 a[148:151], v3, s[12:15], s18 offen sc1
buffer_load_dwordx4 a[152:155], v4, s[12:15], s18 offen sc1
buffer_load_dwordx4 a[156:159], v5, s[12:15], s18 offen sc1
s_add_u32 s18, s18, 1024
s_waitcnt vmcnt(44)
v_mfma_f32_16x16x32_bf16 v[16:19], a[160:163], a[176:179], v[16:19]
v_mfma_f32_16x16x32_bf16 v[20:23], a[160:163], a[180:183], v[20:23]
v_mfma_f32_16x16x32_bf16 v[24:27], a[160:163], a[184:187], v[24:27]
v_mfma_f32_16x16x32_bf16 v[28:31], a[160:163], a[188:191], v[28:31]
v_mfma_f32_16x16x32_bf16 v[32:35], a[164:167], a[176:179], v[32:35]
v_mfma_f32_16x16x32_bf16 v[36:39], a[164:167], a[180:183], v[36:39]
v_mfma_f32_16x16x32_bf16 v[40:43], a[164:167], a[184:187], v[40:43]
v_mfma_f32_16x16x32_bf16 v[44:47], a[164:167], a[188:191], v[44:47]
v_mfma_f32_16x16x32_bf16 v[48:51], a[168:171], a[176:179], v[48:51]
v_mfma_f32_16x16x32_bf16 v[52:55], a[168:171], a[180:183], v[52:55]
v_mfma_f32_16x16x32_bf16 v[56:59], a[168:171], a[184:187], v[56:59]
v_mfma_f32_16x16x32_bf16 v[60:63], a[168:171], a[188:191], v[60:63]
v_mfma_f32_16x16x32_bf16 v[64:67], a[172:175], a[176:179], v[64:67]
v_mfma_f32_16x16x32_bf16 v[68:71], a[172:175], a[180:183], v[68:71]
v_mfma_f32_16x16x32_bf16 v[72:75], a[172:175], a[184:187], v[72:75]
v_mfma_f32_16x16x32_bf16 v[76:79], a[172:175], a[188:191], v[76:79]
buffer_load_dwordx4 a[160:163], v2, s[12:15], s17 offen sc1
buffer_load_dwordx4 a[164:167], v3, s[12:15], s17 offen sc1
buffer_load_dwordx4 a[168:171], v4, s[12:15], s17 offen sc1
buffer_load_dwordx4 a[172:175], v5, s[12:15], s17 offen sc1
s_add_u32 s17, s17, 1024
buffer_load_dwordx4 a[176:179], v2, s[12:15], s18 offen sc1
buffer_load_dwordx4 a[180:183], v3, s[12:15], s18 offen sc1
buffer_load_dwordx4 a[184:187], v4, s[12:15], s18 offen sc1
buffer_load_dwordx4 a[188:191], v5, s[12:15], s18 offen sc1
s_add_u32 s18, s18, 1024
s_waitcnt vmcnt(48)
v_mfma_f32_16x16x32_bf16 v[16:19], a[192:195], a[208:211], v[16:19]
v_mfma_f32_16x16x32_bf16 v[20:23], a[192:195], a[212:215], v[20:23]
v_mfma_f32_16x16x32_bf16 v[24:27], a[192:195], a[216:219], v[24:27]
v_mfma_f32_16x16x32_bf16 v[28:31], a[192:195], a[220:223], v[28:31]
v_mfma_f32_16x16x32_bf16 v[32:35], a[196:199], a[208:211], v[32:35]
v_mfma_f32_16x16x32_bf16 v[36:39], a[196:199], a[212:215], v[36:39]
v_mfma_f32_16x16x32_bf16 v[40:43], a[196:199], a[216:219], v[40:43]
v_mfma_f32_16x16x32_bf16 v[44:47], a[196:199], a[220:223], v[44:47]
v_mfma_f32_16x16x32_bf16 v[48:51], a[200:203], a[208:211], v[48:51]
v_mfma_f32_16x16x32_bf16 v[52:55], a[200:203], a[212:215], v[52:55]
v_mfma_f32_16x16x32_bf16 v[56:59], a[200:203], a[216:219], v[56:59]
v_mfma_f32_16x16x32_bf16 v[60:63], a[200:203], a[220:223], v[60:63]
v_mfma_f32_16x16x32_bf16 v[64:67], a[204:207], a[208:211], v[64:67]
v_mfma_f32_16x16x32_bf16 v[68:71], a[204:207], a[212:215], v[68:71]
v_mfma_f32_16x16x32_bf16 v[72:75], a[204:207], a[216:219], v[72:75]
v_mfma_f32_16x16x32_bf16 v[76:79], a[204:207], a[220:223], v[76:79]
buffer_load_dwordx4 a[192:195], v2, s[12:15], s17 offen sc1
buffer_load_dwordx4 a[196:199], v3, s[12:15], s17 offen sc1
buffer_load_dwordx4 a[200:203], v4, s[12:15], s17 offen sc1
buffer_load_dwordx4 a[204:207], v5, s[12:15], s17 offen sc1
s_add_u32 s17, s17, 1024
buffer_load_dwordx4 a[208:211], v2, s[12:15], s18 offen sc1
buffer_load_dwordx4 a[212:215], v3, s[12:15], s18 offen sc1
buffer_load_dwordx4 a[216:219], v4, s[12:15], s18 offen sc1
buffer_load_dwordx4 a[220:223], v5, s[12:15], s18 offen sc1
s_add_u32 s18, s18, 1024
s_waitcnt vmcnt(48)
v_mfma_f32_16x16x32_bf16 v[16:19], a[0:3], a[16:19], v[16:19]
v_mfma_f32_16x16x32_bf16 v[20:23], a[0:3], a[20:23], v[20:23]
v_mfma_f32_16x16x32_bf16 v[24:27], a[0:3], a[24:27], v[24:27]
v_mfma_f32_16x16x32_bf16 v[28:31], a[0:3], a[28:31], v[28:31]
v_mfma_f32_16x16x32_bf16 v[32:35], a[4:7], a[16:19], v[32:35]
v_mfma_f32_16x16x32_bf16 v[36:39], a[4:7], a[20:23], v[36:39]
v_mfma_f32_16x16x32_bf16 v[40:43], a[4:7], a[24:27], v[40:43]
v_mfma_f32_16x16x32_bf16 v[44:47], a[4:7], a[28:31], v[44:47]
v_mfma_f32_16x16x32_bf16 v[48:51], a[8:11], a[16:19], v[48:51]
v_mfma_f32_16x16x32_bf16 v[52:55], a[8:11], a[20:23], v[52:55]
v_mfma_f32_16x16x32_bf16 v[56:59], a[8:11], a[24:27], v[56:59]
v_mfma_f32_16x16x32_bf16 v[60:63], a[8:11], a[28:31], v[60:63]
v_mfma_f32_16x16x32_bf16 v[64:67], a[12:15], a[16:19], v[64:67]
v_mfma_f32_16x16x32_bf16 v[68:71], a[12:15], a[20:23], v[68:71]
v_mfma_f32_16x16x32_bf16 v[72:75], a[12:15], a[24:27], v[72:75]
v_mfma_f32_16x16x32_bf16 v[76:79], a[12:15], a[28:31], v[76:79]
buffer_load_dwordx4 a[0:3], v2, s[12:15], s17 offen sc1
buffer_load_dwordx4 a[4:7], v3, s[12:15], s17 offen sc1
buffer_load_dwordx4 a[8:11], v4, s[12:15], s17 offen sc1
buffer_load_dwordx4 a[12:15], v5, s[12:15], s17 offen sc1
s_add_u32 s17, s17, 1024
buffer_load_dwordx4 a[16:19], v2, s[12:15], s18 offen sc1
buffer_load_dwordx4 a[20:23], v3, s[12:15], s18 offen sc1
buffer_load_dwordx4 a[24:27], v4, s[12:15], s18 offen sc1
buffer_load_dwordx4 a[28:31], v5, s[12:15], s18 offen sc1
s_add_u32 s18, s18, 1024
s_waitcnt vmcnt(48)
v_mfma_f32_16x16x32_bf16 v[16:19], a[32:35], a[48:51], v[16:19]
v_mfma_f32_16x16x32_bf16 v[20:23], a[32:35], a[52:55], v[20:23]
v_mfma_f32_16x16x32_bf16 v[24:27], a[32:35], a[56:59], v[24:27]
v_mfma_f32_16x16x32_bf16 v[28:31], a[32:35], a[60:63], v[28:31]
v_mfma_f32_16x16x32_bf16 v[32:35], a[36:39], a[48:51], v[32:35]
v_mfma_f32_16x16x32_bf16 v[36:39], a[36:39], a[52:55], v[36:39]
v_mfma_f32_16x16x32_bf16 v[40:43], a[36:39], a[56:59], v[40:43]
v_mfma_f32_16x16x32_bf16 v[44:47], a[36:39], a[60:63], v[44:47]
v_mfma_f32_16x16x32_bf16 v[48:51], a[40:43], a[48:51], v[48:51]
v_mfma_f32_16x16x32_bf16 v[52:55], a[40:43], a[52:55], v[52:55]
v_mfma_f32_16x16x32_bf16 v[56:59], a[40:43], a[56:59], v[56:59]
v_mfma_f32_16x16x32_bf16 v[60:63], a[40:43], a[60:63], v[60:63]
v_mfma_f32_16x16x32_bf16 v[64:67], a[44:47], a[48:51], v[64:67]
v_mfma_f32_16x16x32_bf16 v[68:71], a[44:47], a[52:55], v[68:71]
v_mfma_f32_16x16x32_bf16 v[72:75], a[44:47], a[56:59], v[72:75]
v_mfma_f32_16x16x32_bf16 v[76:79], a[44:47], a[60:63], v[76:79]
buffer_load_dwordx4 a[32:35], v2, s[12:15], s17 offen sc1
buffer_load_dwordx4 a[36:39], v3, s[12:15], s17 offen sc1
buffer_load_dwordx4 a[40:43], v4, s[12:15], s17 offen sc1
buffer_load_dwordx4 a[44:47], v5, s[12:15], s17 offen sc1
s_add_u32 s17, s17, 1024
buffer_load_dwordx4 a[48:51], v2, s[12:15], s18 offen sc1
buffer_load_dwordx4 a[52:55], v3, s[12:15], s18 offen sc1
buffer_load_dwordx4 a[56:59], v4, s[12:15], s18 offen sc1
buffer_load_dwordx4 a[60:63], v5, s[12:15], s18 offen sc1
s_add_u32 s18, s18, 1024
s_waitcnt vmcnt(48)
v_mfma_f32_16x16x32_bf16 v[16:19], a[64:67], a[80:83], v[16:19]
v_mfma_f32_16x16x32_bf16 v[20:23], a[64:67], a[84:87], v[20:23]
v_mfma_f32_16x16x32_bf16 v[24:27], a[64:67], a[88:91], v[24:27]
v_mfma_f32_16x16x32_bf16 v[28:31], a[64:67], a[92:95], v[28:31]
v_mfma_f32_16x16x32_bf16 v[32:35], a[68:71], a[80:83], v[32:35]
v_mfma_f32_16x16x32_bf16 v[36:39], a[68:71], a[84:87], v[36:39]
v_mfma_f32_16x16x32_bf16 v[40:43], a[68:71], a[88:91], v[40:43]
v_mfma_f32_16x16x32_bf16 v[44:47], a[68:71], a[92:95], v[44:47]
v_mfma_f32_16x16x32_bf16 v[48:51], a[72:75], a[80:83], v[48:51]
v_mfma_f32_16x16x32_bf16 v[52:55], a[72:75], a[84:87], v[52:55]
v_mfma_f32_16x16x32_bf16 v[56:59], a[72:75], a[88:91], v[56:59]
v_mfma_f32_16x16x32_bf16 v[60:63], a[72:75], a[92:95], v[60:63]
v_mfma_f32_16x16x32_bf16 v[64:67], a[76:79], a[80:83], v[64:67]
v_mfma_f32_16x16x32_bf16 v[68:71], a[76:79], a[84:87], v[68:71]
v_mfma_f32_16x16x32_bf16 v[72:75], a[76:79], a[88:91], v[72:75]
v_mfma_f32_16x16x32_bf16 v[76:79], a[76:79], a[92:95], v[76:79]
buffer_load_dwordx4 a[64:67], v2, s[12:15], s17 offen sc1
buffer_load_dwordx4 a[68:71], v3, s[12:15], s17 offen sc1
buffer_load_dwordx4 a[72:75], v4, s[12:15], s17 offen sc1
buffer_load_dwordx4 a[76:79], v5, s[12:15], s17 offen sc1
s_add_u32 s17, s17, 1024
buffer_load_dwordx4 a[80:83], v2, s[12:15], s18 offen sc1
buffer_load_dwordx4 a[84:87], v3, s[12:15], s18 offen sc1
buffer_load_dwordx4 a[88:91], v4, s[12:15], s18 offen sc1
buffer_load_dwordx4 a[92:95], v5, s[12:15], s18 offen sc1
s_add_u32 s18, s18, 1024
s_waitcnt vmcnt(48)
v_mfma_f32_16x16x32_bf16 v[16:19], a[96:99], a[112:115], v[16:19]
v_mfma_f32_16x16x32_bf16 v[20:23], a[96:99], a[116:119], v[20:23]
v_mfma_f32_16x16x32_bf16 v[24:27], a[96:99], a[120:123], v[24:27]
v_mfma_f32_16x16x32_bf16 v[28:31], a[96:99], a[124:127], v[28:31]
v_mfma_f32_16x16x32_bf16 v[32:35], a[100:103], a[112:115], v[32:35]
v_mfma_f32_16x16x32_bf16 v[36:39], a[100:103], a[116:119], v[36:39]
v_mfma_f32_16x16x32_bf16 v[40:43], a[100:103], a[120:123], v[40:43]
v_mfma_f32_16x16x32_bf16 v[44:47], a[100:103], a[124:127], v[44:47]
v_mfma_f32_16x16x32_bf16 v[48:51], a[104:107], a[112:115], v[48:51]
v_mfma_f32_16x16x32_bf16 v[52:55], a[104:107], a[116:119], v[52:55]
v_mfma_f32_16x16x32_bf16 v[56:59], a[104:107], a[120:123], v[56:59]
v_mfma_f32_16x16x32_bf16 v[60:63], a[104:107], a[124:127], v[60:63]
v_mfma_f32_16x16x32_bf16 v[64:67], a[108:111], a[112:115], v[64:67]
v_mfma_f32_16x16x32_bf16 v[68:71], a[108:111], a[116:119], v[68:71]
v_mfma_f32_16x16x32_bf16 v[72:75], a[108:111], a[120:123], v[72:75]
v_mfma_f32_16x16x32_bf16 v[76:79], a[108:111], a[124:127], v[76:79]
buffer_load_dwordx4 a[96:99], v2, s[12:15], s17 offen sc1
buffer_load_dwordx4 a[100:103], v3, s[12:15], s17 offen sc1
buffer_load_dwordx4 a[104:107], v4, s[12:15], s17 offen sc1
buffer_load_dwordx4 a[108:111], v5, s[12:15], s17 offen sc1
s_add_u32 s17, s17, 1024
buffer_load_dwordx4 a[112:115], v2, s[12:15], s18 offen sc1
buffer_load_dwordx4 a[116:119], v3, s[12:15], s18 offen sc1
buffer_load_dwordx4 a[120:123], v4, s[12:15], s18 offen sc1
buffer_load_dwordx4 a[124:127], v5, s[12:15], s18 offen sc1
s_add_u32 s18, s18, 1024
s_waitcnt vmcnt(48)
v_mfma_f32_16x16x32_bf16 v[16:19], a[128:131], a[144:147], v[16:19]
v_mfma_f32_16x16x32_bf16 v[20:23], a[128:131], a[148:151], v[20:23]
v_mfma_f32_16x16x32_bf16 v[24:27], a[128:131], a[152:155], v[24:27]
v_mfma_f32_16x16x32_bf16 v[28:31], a[128:131], a[156:159], v[28:31]
v_mfma_f32_16x16x32_bf16 v[32:35], a[132:135], a[144:147], v[32:35]
v_mfma_f32_16x16x32_bf16 v[36:39], a[132:135], a[148:151], v[36:39]
v_mfma_f32_16x16x32_bf16 v[40:43], a[132:135], a[152:155], v[40:43]
v_mfma_f32_16x16x32_bf16 v[44:47], a[132:135], a[156:159], v[44:47]
v_mfma_f32_16x16x32_bf16 v[48:51], a[136:139], a[144:147], v[48:51]
v_mfma_f32_16x16x32_bf16 v[52:55], a[136:139], a[148:151], v[52:55]
v_mfma_f32_16x16x32_bf16 v[56:59], a[136:139], a[152:155], v[56:59]
v_mfma_f32_16x16x32_bf16 v[60:63], a[136:139], a[156:159], v[60:63]
v_mfma_f32_16x16x32_bf16 v[64:67], a[140:143], a[144:147], v[64:67]
v_mfma_f32_16x16x32_bf16 v[68:71], a[140:143], a[148:151], v[68:71]
v_mfma_f32_16x16x32_bf16 v[72:75], a[140:143], a[152:155], v[72:75]
v_mfma_f32_16x16x32_bf16 v[76:79], a[140:143], a[156:159], v[76:79]
buffer_load_dwordx4 a[128:131], v2, s[12:15], s17 offen sc1
buffer_load_dwordx4 a[132:135], v3, s[12:15], s17 offen sc1
buffer_load_dwordx4 a[136:139], v4, s[12:15], s17 offen sc1
buffer_load_dwordx4 a[140:143], v5, s[12:15], s17 offen sc1
s_add_u32 s17, s17, 1024
buffer_load_dwordx4 a[144:147], v2, s[12:15], s18 offen sc1
buffer_load_dwordx4 a[148:151], v3, s[12:15], s18 offen sc1
buffer_load_dwordx4 a[152:155], v4, s[12:15], s18 offen sc1
buffer_load_dwordx4 a[156:159], v5, s[12:15], s18 offen sc1
s_add_u32 s18, s18, 1024
s_waitcnt vmcnt(48)
v_mfma_f32_16x16x32_bf16 v[16:19], a[160:163], a[176:179], v[16:19]
v_mfma_f32_16x16x32_bf16 v[20:23], a[160:163], a[180:183], v[20:23]
v_mfma_f32_16x16x32_bf16 v[24:27], a[160:163], a[184:187], v[24:27]
v_mfma_f32_16x16x32_bf16 v[28:31], a[160:163], a[188:191], v[28:31]
v_mfma_f32_16x16x32_bf16 v[32:35], a[164:167], a[176:179], v[32:35]
v_mfma_f32_16x16x32_bf16 v[36:39], a[164:167], a[180:183], v[36:39]
v_mfma_f32_16x16x32_bf16 v[40:43], a[164:167], a[184:187], v[40:43]
v_mfma_f32_16x16x32_bf16 v[44:47], a[164:167], a[188:191], v[44:47]
v_mfma_f32_16x16x32_bf16 v[48:51], a[168:171], a[176:179], v[48:51]
v_mfma_f32_16x16x32_bf16 v[52:55], a[168:171], a[180:183], v[52:55]
v_mfma_f32_16x16x32_bf16 v[56:59], a[168:171], a[184:187], v[56:59]
v_mfma_f32_16x16x32_bf16 v[60:63], a[168:171], a[188:191], v[60:63]
v_mfma_f32_16x16x32_bf16 v[64:67], a[172:175], a[176:179], v[64:67]
v_mfma_f32_16x16x32_bf16 v[68:71], a[172:175], a[180:183], v[68:71]
v_mfma_f32_16x16x32_bf16 v[72:75], a[172:175], a[184:187], v[72:75]
v_mfma_f32_16x16x32_bf16 v[76:79], a[172:175], a[188:191], v[76:79]
buffer_load_dwordx4 a[160:163], v2, s[12:15], s17 offen sc1
buffer_load_dwordx4 a[164:167], v3, s[12:15], s17 offen sc1
buffer_load_dwordx4 a[168:171], v4, s[12:15], s17 offen sc1
buffer_load_dwordx4 a[172:175], v5, s[12:15], s17 offen sc1
s_add_u32 s17, s17, 1024
buffer_load_dwordx4 a[176:179], v2, s[12:15], s18 offen sc1
buffer_load_dwordx4 a[180:183], v3, s[12:15], s18 offen sc1
buffer_load_dwordx4 a[184:187], v4, s[12:15], s18 offen sc1
buffer_load_dwordx4 a[188:191], v5, s[12:15], s18 offen sc1
s_add_u32 s18, s18, 1024
s_waitcnt vmcnt(48)
v_mfma_f32_16x16x32_bf16 v[16:19], a[192:195], a[208:211], v[16:19]
v_mfma_f32_16x16x32_bf16 v[20:23], a[192:195], a[212:215], v[20:23]
v_mfma_f32_16x16x32_bf16 v[24:27], a[192:195], a[216:219], v[24:27]
v_mfma_f32_16x16x32_bf16 v[28:31], a[192:195], a[220:223], v[28:31]
v_mfma_f32_16x16x32_bf16 v[32:35], a[196:199], a[208:211], v[32:35]
v_mfma_f32_16x16x32_bf16 v[36:39], a[196:199], a[212:215], v[36:39]
v_mfma_f32_16x16x32_bf16 v[40:43], a[196:199], a[216:219], v[40:43]
v_mfma_f32_16x16x32_bf16 v[44:47], a[196:199], a[220:223], v[44:47]
v_mfma_f32_16x16x32_bf16 v[48:51], a[200:203], a[208:211], v[48:51]
v_mfma_f32_16x16x32_bf16 v[52:55], a[200:203], a[212:215], v[52:55]
v_mfma_f32_16x16x32_bf16 v[56:59], a[200:203], a[216:219], v[56:59]
v_mfma_f32_16x16x32_bf16 v[60:63], a[200:203], a[220:223], v[60:63]
v_mfma_f32_16x16x32_bf16 v[64:67], a[204:207], a[208:211], v[64:67]
v_mfma_f32_16x16x32_bf16 v[68:71], a[204:207], a[212:215], v[68:71]
v_mfma_f32_16x16x32_bf16 v[72:75], a[204:207], a[216:219], v[72:75]
v_mfma_f32_16x16x32_bf16 v[76:79], a[204:207], a[220:223], v[76:79]
buffer_load_dwordx4 a[192:195], v2, s[12:15], s17 offen sc1
buffer_load_dwordx4 a[196:199], v3, s[12:15], s17 offen sc1
buffer_load_dwordx4 a[200:203], v4, s[12:15], s17 offen sc1
buffer_load_dwordx4 a[204:207], v5, s[12:15], s17 offen sc1
s_add_u32 s17, s17, 1024
buffer_load_dwordx4 a[208:211], v2, s[12:15], s18 offen sc1
buffer_load_dwordx4 a[212:215], v3, s[12:15], s18 offen sc1
buffer_load_dwordx4 a[216:219], v4, s[12:15], s18 offen sc1
buffer_load_dwordx4 a[220:223], v5, s[12:15], s18 offen sc1
s_add_u32 s18, s18, 1024
s_waitcnt vmcnt(48)
v_mfma_f32_16x16x32_bf16 v[16:19], a[0:3], a[16:19], v[16:19]
v_mfma_f32_16x16x32_bf16 v[20:23], a[0:3], a[20:23], v[20:23]
v_mfma_f32_16x16x32_bf16 v[24:27], a[0:3], a[24:27], v[24:27]
v_mfma_f32_16x16x32_bf16 v[28:31], a[0:3], a[28:31], v[28:31]
v_mfma_f32_16x16x32_bf16 v[32:35], a[4:7], a[16:19], v[32:35]
v_mfma_f32_16x16x32_bf16 v[36:39], a[4:7], a[20:23], v[36:39]
v_mfma_f32_16x16x32_bf16 v[40:43], a[4:7], a[24:27], v[40:43]
v_mfma_f32_16x16x32_bf16 v[44:47], a[4:7], a[28:31], v[44:47]
v_mfma_f32_16x16x32_bf16 v[48:51], a[8:11], a[16:19], v[48:51]
v_mfma_f32_16x16x32_bf16 v[52:55], a[8:11], a[20:23], v[52:55]
v_mfma_f32_16x16x32_bf16 v[56:59], a[8:11], a[24:27], v[56:59]
v_mfma_f32_16x16x32_bf16 v[60:63], a[8:11], a[28:31], v[60:63]
v_mfma_f32_16x16x32_bf16 v[64:67], a[12:15], a[16:19], v[64:67]
v_mfma_f32_16x16x32_bf16 v[68:71], a[12:15], a[20:23], v[68:71]
v_mfma_f32_16x16x32_bf16 v[72:75], a[12:15], a[24:27], v[72:75]
v_mfma_f32_16x16x32_bf16 v[76:79], a[12:15], a[28:31], v[76:79]
buffer_load_dwordx4 a[0:3], v2, s[12:15], s17 offen sc1
buffer_load_dwordx4 a[4:7], v3, s[12:15], s17 offen sc1
buffer_load_dwordx4 a[8:11], v4, s[12:15], s17 offen sc1
buffer_load_dwordx4 a[12:15], v5, s[12:15], s17 offen sc1
s_add_u32 s17, s17, 1024
buffer_load_dwordx4 a[16:19], v2, s[12:15], s18 offen sc1
buffer_load_dwordx4 a[20:23], v3, s[12:15], s18 offen sc1
buffer_load_dwordx4 a[24:27], v4, s[12:15], s18 offen sc1
buffer_load_dwordx4 a[28:31], v5, s[12:15], s18 offen sc1
s_add_u32 s18, s18, 1024
s_waitcnt vmcnt(48)
v_mfma_f32_16x16x32_bf16 v[16:19], a[32:35], a[48:51], v[16:19]
v_mfma_f32_16x16x32_bf16 v[20:23], a[32:35], a[52:55], v[20:23]
v_mfma_f32_16x16x32_bf16 v[24:27], a[32:35], a[56:59], v[24:27]
v_mfma_f32_16x16x32_bf16 v[28:31], a[32:35], a[60:63], v[28:31]
v_mfma_f32_16x16x32_bf16 v[32:35], a[36:39], a[48:51], v[32:35]
v_mfma_f32_16x16x32_bf16 v[36:39], a[36:39], a[52:55], v[36:39]
v_mfma_f32_16x16x32_bf16 v[40:43], a[36:39], a[56:59], v[40:43]
v_mfma_f32_16x16x32_bf16 v[44:47], a[36:39], a[60:63], v[44:47]
v_mfma_f32_16x16x32_bf16 v[48:51], a[40:43], a[48:51], v[48:51]
v_mfma_f32_16x16x32_bf16 v[52:55], a[40:43], a[52:55], v[52:55]
v_mfma_f32_16x16x32_bf16 v[56:59], a[40:43], a[56:59], v[56:59]
v_mfma_f32_16x16x32_bf16 v[60:63], a[40:43], a[60:63], v[60:63]
v_mfma_f32_16x16x32_bf16 v[64:67], a[44:47], a[48:51], v[64:67]
v_mfma_f32_16x16x32_bf16 v[68:71], a[44:47], a[52:55], v[68:71]
v_mfma_f32_16x16x32_bf16 v[72:75], a[44:47], a[56:59], v[72:75]
v_mfma_f32_16x16x32_bf16 v[76:79], a[44:47], a[60:63], v[76:79]
buffer_load_dwordx4 a[32:35], v2, s[12:15], s17 offen sc1
buffer_load_dwordx4 a[36:39], v3, s[12:15], s17 offen sc1
buffer_load_dwordx4 a[40:43], v4, s[12:15], s17 offen sc1
buffer_load_dwordx4 a[44:47], v5, s[12:15], s17 offen sc1
s_add_u32 s17, s17, 1024
buffer_load_dwordx4 a[48:51], v2, s[12:15], s18 offen sc1
buffer_load_dwordx4 a[52:55], v3, s[12:15], s18 offen sc1
buffer_load_dwordx4 a[56:59], v4, s[12:15], s18 offen sc1
buffer_load_dwordx4 a[60:63], v5, s[12:15], s18 offen sc1
s_add_u32 s18, s18, 1024
s_waitcnt vmcnt(48)
v_mfma_f32_16x16x32_bf16 v[16:19], a[64:67], a[80:83], v[16:19]
v_mfma_f32_16x16x32_bf16 v[20:23], a[64:67], a[84:87], v[20:23]
v_mfma_f32_16x16x32_bf16 v[24:27], a[64:67], a[88:91], v[24:27]
v_mfma_f32_16x16x32_bf16 v[28:31], a[64:67], a[92:95], v[28:31]
v_mfma_f32_16x16x32_bf16 v[32:35], a[68:71], a[80:83], v[32:35]
v_mfma_f32_16x16x32_bf16 v[36:39], a[68:71], a[84:87], v[36:39]
v_mfma_f32_16x16x32_bf16 v[40:43], a[68:71], a[88:91], v[40:43]
v_mfma_f32_16x16x32_bf16 v[44:47], a[68:71], a[92:95], v[44:47]
v_mfma_f32_16x16x32_bf16 v[48:51], a[72:75], a[80:83], v[48:51]
v_mfma_f32_16x16x32_bf16 v[52:55], a[72:75], a[84:87], v[52:55]
v_mfma_f32_16x16x32_bf16 v[56:59], a[72:75], a[88:91], v[56:59]
v_mfma_f32_16x16x32_bf16 v[60:63], a[72:75], a[92:95], v[60:63]
v_mfma_f32_16x16x32_bf16 v[64:67], a[76:79], a[80:83], v[64:67]
v_mfma_f32_16x16x32_bf16 v[68:71], a[76:79], a[84:87], v[68:71]
v_mfma_f32_16x16x32_bf16 v[72:75], a[76:79], a[88:91], v[72:75]
v_mfma_f32_16x16x32_bf16 v[76:79], a[76:79], a[92:95], v[76:79]
buffer_load_dwordx4 a[64:67], v2, s[12:15], s17 offen sc1
buffer_load_dwordx4 a[68:71], v3, s[12:15], s17 offen sc1
buffer_load_dwordx4 a[72:75], v4, s[12:15], s17 offen sc1
buffer_load_dwordx4 a[76:79], v5, s[12:15], s17 offen sc1
s_add_u32 s17, s17, 1024
buffer_load_dwordx4 a[80:83], v2, s[12:15], s18 offen sc1
buffer_load_dwordx4 a[84:87], v3, s[12:15], s18 offen sc1
buffer_load_dwordx4 a[88:91], v4, s[12:15], s18 offen sc1
buffer_load_dwordx4 a[92:95], v5, s[12:15], s18 offen sc1
s_add_u32 s18, s18, 1024
s_waitcnt vmcnt(48)
v_mfma_f32_16x16x32_bf16 v[16:19], a[96:99], a[112:115], v[16:19]
v_mfma_f32_16x16x32_bf16 v[20:23], a[96:99], a[116:119], v[20:23]
v_mfma_f32_16x16x32_bf16 v[24:27], a[96:99], a[120:123], v[24:27]
v_mfma_f32_16x16x32_bf16 v[28:31], a[96:99], a[124:127], v[28:31]
v_mfma_f32_16x16x32_bf16 v[32:35], a[100:103], a[112:115], v[32:35]
v_mfma_f32_16x16x32_bf16 v[36:39], a[100:103], a[116:119], v[36:39]
v_mfma_f32_16x16x32_bf16 v[40:43], a[100:103], a[120:123], v[40:43]
v_mfma_f32_16x16x32_bf16 v[44:47], a[100:103], a[124:127], v[44:47]
v_mfma_f32_16x16x32_bf16 v[48:51], a[104:107], a[112:115], v[48:51]
v_mfma_f32_16x16x32_bf16 v[52:55], a[104:107], a[116:119], v[52:55]
v_mfma_f32_16x16x32_bf16 v[56:59], a[104:107], a[120:123], v[56:59]
v_mfma_f32_16x16x32_bf16 v[60:63], a[104:107], a[124:127], v[60:63]
v_mfma_f32_16x16x32_bf16 v[64:67], a[108:111], a[112:115], v[64:67]
v_mfma_f32_16x16x32_bf16 v[68:71], a[108:111], a[116:119], v[68:71]
v_mfma_f32_16x16x32_bf16 v[72:75], a[108:111], a[120:123], v[72:75]
v_mfma_f32_16x16x32_bf16 v[76:79], a[108:111], a[124:127], v[76:79]
buffer_load_dwordx4 a[96:99], v2, s[12:15], s17 offen sc1
buffer_load_dwordx4 a[100:103], v3, s[12:15], s17 offen sc1
buffer_load_dwordx4 a[104:107], v4, s[12:15], s17 offen sc1
buffer_load_dwordx4 a[108:111], v5, s[12:15], s17 offen sc1
s_add_u32 s17, s17, 1024
buffer_load_dwordx4 a[112:115], v2, s[12:15], s18 offen sc1
buffer_load_dwordx4 a[116:119], v3, s[12:15], s18 offen sc1
buffer_load_dwordx4 a[120:123], v4, s[12:15], s18 offen sc1
buffer_load_dwordx4 a[124:127], v5, s[12:15], s18 offen sc1
s_add_u32 s18, s18, 1024
s_waitcnt vmcnt(48)
v_mfma_f32_16x16x32_bf16 v[16:19], a[128:131], a[144:147], v[16:19]
v_mfma_f32_16x16x32_bf16 v[20:23], a[128:131], a[148:151], v[20:23]
v_mfma_f32_16x16x32_bf16 v[24:27], a[128:131], a[152:155], v[24:27]
v_mfma_f32_16x16x32_bf16 v[28:31], a[128:131], a[156:159], v[28:31]
v_mfma_f32_16x16x32_bf16 v[32:35], a[132:135], a[144:147], v[32:35]
v_mfma_f32_16x16x32_bf16 v[36:39], a[132:135], a[148:151], v[36:39]
v_mfma_f32_16x16x32_bf16 v[40:43], a[132:135], a[152:155], v[40:43]
v_mfma_f32_16x16x32_bf16 v[44:47], a[132:135], a[156:159], v[44:47]
v_mfma_f32_16x16x32_bf16 v[48:51], a[136:139], a[144:147], v[48:51]
v_mfma_f32_16x16x32_bf16 v[52:55], a[136:139], a[148:151], v[52:55]
v_mfma_f32_16x16x32_bf16 v[56:59], a[136:139], a[152:155], v[56:59]
v_mfma_f32_16x16x32_bf16 v[60:63], a[136:139], a[156:159], v[60:63]
v_mfma_f32_16x16x32_bf16 v[64:67], a[140:143], a[144:147], v[64:67]
v_mfma_f32_16x16x32_bf16 v[68:71], a[140:143], a[148:151], v[68:71]
v_mfma_f32_16x16x32_bf16 v[72:75], a[140:143], a[152:155], v[72:75]
v_mfma_f32_16x16x32_bf16 v[76:79], a[140:143], a[156:159], v[76:79]
buffer_load_dwordx4 a[128:131], v2, s[12:15], s17 offen sc1
buffer_load_dwordx4 a[132:135], v3, s[12:15], s17 offen sc1
buffer_load_dwordx4 a[136:139], v4, s[12:15], s17 offen sc1
buffer_load_dwordx4 a[140:143], v5, s[12:15], s17 offen sc1
s_add_u32 s17, s17, 1024
buffer_load_dwordx4 a[144:147], v2, s[12:15], s18 offen sc1
buffer_load_dwordx4 a[148:151], v3, s[12:15], s18 offen sc1
buffer_load_dwordx4 a[152:155], v4, s[12:15], s18 offen sc1
buffer_load_dwordx4 a[156:159], v5, s[12:15], s18 offen sc1
s_add_u32 s18, s18, 1024
s_waitcnt vmcnt(48)
v_mfma_f32_16x16x32_bf16 v[16:19], a[160:163], a[176:179], v[16:19]
v_mfma_f32_16x16x32_bf16 v[20:23], a[160:163], a[180:183], v[20:23]
v_mfma_f32_16x16x32_bf16 v[24:27], a[160:163], a[184:187], v[24:27]
v_mfma_f32_16x16x32_bf16 v[28:31], a[160:163], a[188:191], v[28:31]
v_mfma_f32_16x16x32_bf16 v[32:35], a[164:167], a[176:179], v[32:35]
v_mfma_f32_16x16x32_bf16 v[36:39], a[164:167], a[180:183], v[36:39]
v_mfma_f32_16x16x32_bf16 v[40:43], a[164:167], a[184:187], v[40:43]
v_mfma_f32_16x16x32_bf16 v[44:47], a[164:167], a[188:191], v[44:47]
v_mfma_f32_16x16x32_bf16 v[48:51], a[168:171], a[176:179], v[48:51]
v_mfma_f32_16x16x32_bf16 v[52:55], a[168:171], a[180:183], v[52:55]
v_mfma_f32_16x16x32_bf16 v[56:59], a[168:171], a[184:187], v[56:59]
v_mfma_f32_16x16x32_bf16 v[60:63], a[168:171], a[188:191], v[60:63]
v_mfma_f32_16x16x32_bf16 v[64:67], a[172:175], a[176:179], v[64:67]
v_mfma_f32_16x16x32_bf16 v[68:71], a[172:175], a[180:183], v[68:71]
v_mfma_f32_16x16x32_bf16 v[72:75], a[172:175], a[184:187], v[72:75]
v_mfma_f32_16x16x32_bf16 v[76:79], a[172:175], a[188:191], v[76:79]
buffer_load_dwordx4 a[160:163], v2, s[12:15], s17 offen sc1
buffer_load_dwordx4 a[164:167], v3, s[12:15], s17 offen sc1
buffer_load_dwordx4 a[168:171], v4, s[12:15], s17 offen sc1
buffer_load_dwordx4 a[172:175], v5, s[12:15], s17 offen sc1
s_add_u32 s17, s17, 1024
buffer_load_dwordx4 a[176:179], v2, s[12:15], s18 offen sc1
buffer_load_dwordx4 a[180:183], v3, s[12:15], s18 offen sc1
buffer_load_dwordx4 a[184:187], v4, s[12:15], s18 offen sc1
buffer_load_dwordx4 a[188:191], v5, s[12:15], s18 offen sc1
s_add_u32 s18, s18, 1024
s_waitcnt vmcnt(48)
v_mfma_f32_16x16x32_bf16 v[16:19], a[192:195], a[208:211], v[16:19]
v_mfma_f32_16x16x32_bf16 v[20:23], a[192:195], a[212:215], v[20:23]
v_mfma_f32_16x16x32_bf16 v[24:27], a[192:195], a[216:219], v[24:27]
v_mfma_f32_16x16x32_bf16 v[28:31], a[192:195], a[220:223], v[28:31]
v_mfma_f32_16x16x32_bf16 v[32:35], a[196:199], a[208:211], v[32:35]
v_mfma_f32_16x16x32_bf16 v[36:39], a[196:199], a[212:215], v[36:39]
v_mfma_f32_16x16x32_bf16 v[40:43], a[196:199], a[216:219], v[40:43]
v_mfma_f32_16x16x32_bf16 v[44:47], a[196:199], a[220:223], v[44:47]
v_mfma_f32_16x16x32_bf16 v[48:51], a[200:203], a[208:211], v[48:51]
v_mfma_f32_16x16x32_bf16 v[52:55], a[200:203], a[212:215], v[52:55]
v_mfma_f32_16x16x32_bf16 v[56:59], a[200:203], a[216:219], v[56:59]
v_mfma_f32_16x16x32_bf16 v[60:63], a[200:203], a[220:223], v[60:63]
v_mfma_f32_16x16x32_bf16 v[64:67], a[204:207], a[208:211], v[64:67]
v_mfma_f32_16x16x32_bf16 v[68:71], a[204:207], a[212:215], v[68:71]
v_mfma_f32_16x16x32_bf16 v[72:75], a[204:207], a[216:219], v[72:75]
v_mfma_f32_16x16x32_bf16 v[76:79], a[204:207], a[220:223], v[76:79]
buffer_load_dwordx4 a[192:195], v2, s[12:15], s17 offen sc1
buffer_load_dwordx4 a[196:199], v3, s[12:15], s17 offen sc1
buffer_load_dwordx4 a[200:203], v4, s[12:15], s17 offen sc1
buffer_load_dwordx4 a[204:207], v5, s[12:15], s17 offen sc1
s_add_u32 s17, s17, 1024
buffer_load_dwordx4 a[208:211], v2, s[12:15], s18 offen sc1
buffer_load_dwordx4 a[212:215], v3, s[12:15], s18 offen sc1
buffer_load_dwordx4 a[216:219], v4, s[12:15], s18 offen sc1
buffer_load_dwordx4 a[220:223], v5, s[12:15], s18 offen sc1
s_add_u32 s18, s18, 1024
s_waitcnt vmcnt(48)
v_mfma_f32_16x16x32_bf16 v[16:19], a[0:3], a[16:19], v[16:19]
v_mfma_f32_16x16x32_bf16 v[20:23], a[0:3], a[20:23], v[20:23]
v_mfma_f32_16x16x32_bf16 v[24:27], a[0:3], a[24:27], v[24:27]
v_mfma_f32_16x16x32_bf16 v[28:31], a[0:3], a[28:31], v[28:31]
v_mfma_f32_16x16x32_bf16 v[32:35], a[4:7], a[16:19], v[32:35]
v_mfma_f32_16x16x32_bf16 v[36:39], a[4:7], a[20:23], v[36:39]
v_mfma_f32_16x16x32_bf16 v[40:43], a[4:7], a[24:27], v[40:43]
v_mfma_f32_16x16x32_bf16 v[44:47], a[4:7], a[28:31], v[44:47]
v_mfma_f32_16x16x32_bf16 v[48:51], a[8:11], a[16:19], v[48:51]
v_mfma_f32_16x16x32_bf16 v[52:55], a[8:11], a[20:23], v[52:55]
v_mfma_f32_16x16x32_bf16 v[56:59], a[8:11], a[24:27], v[56:59]
v_mfma_f32_16x16x32_bf16 v[60:63], a[8:11], a[28:31], v[60:63]
v_mfma_f32_16x16x32_bf16 v[64:67], a[12:15], a[16:19], v[64:67]
v_mfma_f32_16x16x32_bf16 v[68:71], a[12:15], a[20:23], v[68:71]
v_mfma_f32_16x16x32_bf16 v[72:75], a[12:15], a[24:27], v[72:75]
v_mfma_f32_16x16x32_bf16 v[76:79], a[12:15], a[28:31], v[76:79]
buffer_load_dwordx4 a[0:3], v2, s[12:15], s17 offen sc1
buffer_load_dwordx4 a[4:7], v3, s[12:15], s17 offen sc1
buffer_load_dwordx4 a[8:11], v4, s[12:15], s17 offen sc1
buffer_load_dwordx4 a[12:15], v5, s[12:15], s17 offen sc1
s_add_u32 s17, s17, 1024
buffer_load_dwordx4 a[16:19], v2, s[12:15], s18 offen sc1
buffer_load_dwordx4 a[20:23], v3, s[12:15], s18 offen sc1
buffer_load_dwordx4 a[24:27], v4, s[12:15], s18 offen sc1
buffer_load_dwordx4 a[28:31], v5, s[12:15], s18 offen sc1
s_add_u32 s18, s18, 1024
s_waitcnt vmcnt(48)
v_mfma_f32_16x16x32_bf16 v[16:19], a[32:35], a[48:51], v[16:19]
v_mfma_f32_16x16x32_bf16 v[20:23], a[32:35], a[52:55], v[20:23]
v_mfma_f32_16x16x32_bf16 v[24:27], a[32:35], a[56:59], v[24:27]
v_mfma_f32_16x16x32_bf16 v[28:31], a[32:35], a[60:63], v[28:31]
v_mfma_f32_16x16x32_bf16 v[32:35], a[36:39], a[48:51], v[32:35]
v_mfma_f32_16x16x32_bf16 v[36:39], a[36:39], a[52:55], v[36:39]
v_mfma_f32_16x16x32_bf16 v[40:43], a[36:39], a[56:59], v[40:43]
v_mfma_f32_16x16x32_bf16 v[44:47], a[36:39], a[60:63], v[44:47]
v_mfma_f32_16x16x32_bf16 v[48:51], a[40:43], a[48:51], v[48:51]
v_mfma_f32_16x16x32_bf16 v[52:55], a[40:43], a[52:55], v[52:55]
v_mfma_f32_16x16x32_bf16 v[56:59], a[40:43], a[56:59], v[56:59]
v_mfma_f32_16x16x32_bf16 v[60:63], a[40:43], a[60:63], v[60:63]
v_mfma_f32_16x16x32_bf16 v[64:67], a[44:47], a[48:51], v[64:67]
v_mfma_f32_16x16x32_bf16 v[68:71], a[44:47], a[52:55], v[68:71]
v_mfma_f32_16x16x32_bf16 v[72:75], a[44:47], a[56:59], v[72:75]
v_mfma_f32_16x16x32_bf16 v[76:79], a[44:47], a[60:63], v[76:79]
buffer_load_dwordx4 a[32:35], v2, s[12:15], s17 offen sc1
buffer_load_dwordx4 a[36:39], v3, s[12:15], s17 offen sc1
buffer_load_dwordx4 a[40:43], v4, s[12:15], s17 offen sc1
buffer_load_dwordx4 a[44:47], v5, s[12:15], s17 offen sc1
s_add_u32 s17, s17, 1024
buffer_load_dwordx4 a[48:51], v2, s[12:15], s18 offen sc1
buffer_load_dwordx4 a[52:55], v3, s[12:15], s18 offen sc1
buffer_load_dwordx4 a[56:59], v4, s[12:15], s18 offen sc1
buffer_load_dwordx4 a[60:63], v5, s[12:15], s18 offen sc1
s_add_u32 s18, s18, 1024
s_waitcnt vmcnt(48)
v_mfma_f32_16x16x32_bf16 v[16:19], a[64:67], a[80:83], v[16:19]
v_mfma_f32_16x16x32_bf16 v[20:23], a[64:67], a[84:87], v[20:23]
v_mfma_f32_16x16x32_bf16 v[24:27], a[64:67], a[88:91], v[24:27]
v_mfma_f32_16x16x32_bf16 v[28:31], a[64:67], a[92:95], v[28:31]
v_mfma_f32_16x16x32_bf16 v[32:35], a[68:71], a[80:83], v[32:35]
v_mfma_f32_16x16x32_bf16 v[36:39], a[68:71], a[84:87], v[36:39]
v_mfma_f32_16x16x32_bf16 v[40:43], a[68:71], a[88:91], v[40:43]
v_mfma_f32_16x16x32_bf16 v[44:47], a[68:71], a[92:95], v[44:47]
v_mfma_f32_16x16x32_bf16 v[48:51], a[72:75], a[80:83], v[48:51]
v_mfma_f32_16x16x32_bf16 v[52:55], a[72:75], a[84:87], v[52:55]
v_mfma_f32_16x16x32_bf16 v[56:59], a[72:75], a[88:91], v[56:59]
v_mfma_f32_16x16x32_bf16 v[60:63], a[72:75], a[92:95], v[60:63]
v_mfma_f32_16x16x32_bf16 v[64:67], a[76:79], a[80:83], v[64:67]
v_mfma_f32_16x16x32_bf16 v[68:71], a[76:79], a[84:87], v[68:71]
v_mfma_f32_16x16x32_bf16 v[72:75], a[76:79], a[88:91], v[72:75]
v_mfma_f32_16x16x32_bf16 v[76:79], a[76:79], a[92:95], v[76:79]
buffer_load_dwordx4 a[64:67], v2, s[12:15], s17 offen sc1
buffer_load_dwordx4 a[68:71], v3, s[12:15], s17 offen sc1
buffer_load_dwordx4 a[72:75], v4, s[12:15], s17 offen sc1
buffer_load_dwordx4 a[76:79], v5, s[12:15], s17 offen sc1
s_add_u32 s17, s17, 1024
buffer_load_dwordx4 a[80:83], v2, s[12:15], s18 offen sc1
buffer_load_dwordx4 a[84:87], v3, s[12:15], s18 offen sc1
buffer_load_dwordx4 a[88:91], v4, s[12:15], s18 offen sc1
buffer_load_dwordx4 a[92:95], v5, s[12:15], s18 offen sc1
s_add_u32 s18, s18, 1024
s_waitcnt vmcnt(48)
v_mfma_f32_16x16x32_bf16 v[16:19], a[96:99], a[112:115], v[16:19]
v_mfma_f32_16x16x32_bf16 v[20:23], a[96:99], a[116:119], v[20:23]
v_mfma_f32_16x16x32_bf16 v[24:27], a[96:99], a[120:123], v[24:27]
v_mfma_f32_16x16x32_bf16 v[28:31], a[96:99], a[124:127], v[28:31]
v_mfma_f32_16x16x32_bf16 v[32:35], a[100:103], a[112:115], v[32:35]
v_mfma_f32_16x16x32_bf16 v[36:39], a[100:103], a[116:119], v[36:39]
v_mfma_f32_16x16x32_bf16 v[40:43], a[100:103], a[120:123], v[40:43]
v_mfma_f32_16x16x32_bf16 v[44:47], a[100:103], a[124:127], v[44:47]
v_mfma_f32_16x16x32_bf16 v[48:51], a[104:107], a[112:115], v[48:51]
v_mfma_f32_16x16x32_bf16 v[52:55], a[104:107], a[116:119], v[52:55]
v_mfma_f32_16x16x32_bf16 v[56:59], a[104:107], a[120:123], v[56:59]
v_mfma_f32_16x16x32_bf16 v[60:63], a[104:107], a[124:127], v[60:63]
v_mfma_f32_16x16x32_bf16 v[64:67], a[108:111], a[112:115], v[64:67]
v_mfma_f32_16x16x32_bf16 v[68:71], a[108:111], a[116:119], v[68:71]
v_mfma_f32_16x16x32_bf16 v[72:75], a[108:111], a[120:123], v[72:75]
v_mfma_f32_16x16x32_bf16 v[76:79], a[108:111], a[124:127], v[76:79]
buffer_load_dwordx4 a[96:99], v2, s[12:15], s17 offen sc1
buffer_load_dwordx4 a[100:103], v3, s[12:15], s17 offen sc1
buffer_load_dwordx4 a[104:107], v4, s[12:15], s17 offen sc1
buffer_load_dwordx4 a[108:111], v5, s[12:15], s17 offen sc1
s_add_u32 s17, s17, 1024
buffer_load_dwordx4 a[112:115], v2, s[12:15], s18 offen sc1
buffer_load_dwordx4 a[116:119], v3, s[12:15], s18 offen sc1
buffer_load_dwordx4 a[120:123], v4, s[12:15], s18 offen sc1
buffer_load_dwordx4 a[124:127], v5, s[12:15], s18 offen sc1
s_add_u32 s18, s18, 1024
s_waitcnt vmcnt(48)
v_mfma_f32_16x16x32_bf16 v[16:19], a[128:131], a[144:147], v[16:19]
v_mfma_f32_16x16x32_bf16 v[20:23], a[128:131], a[148:151], v[20:23]
v_mfma_f32_16x16x32_bf16 v[24:27], a[128:131], a[152:155], v[24:27]
v_mfma_f32_16x16x32_bf16 v[28:31], a[128:131], a[156:159], v[28:31]
v_mfma_f32_16x16x32_bf16 v[32:35], a[132:135], a[144:147], v[32:35]
v_mfma_f32_16x16x32_bf16 v[36:39], a[132:135], a[148:151], v[36:39]
v_mfma_f32_16x16x32_bf16 v[40:43], a[132:135], a[152:155], v[40:43]
v_mfma_f32_16x16x32_bf16 v[44:47], a[132:135], a[156:159], v[44:47]
v_mfma_f32_16x16x32_bf16 v[48:51], a[136:139], a[144:147], v[48:51]
v_mfma_f32_16x16x32_bf16 v[52:55], a[136:139], a[148:151], v[52:55]
v_mfma_f32_16x16x32_bf16 v[56:59], a[136:139], a[152:155], v[56:59]
v_mfma_f32_16x16x32_bf16 v[60:63], a[136:139], a[156:159], v[60:63]
v_mfma_f32_16x16x32_bf16 v[64:67], a[140:143], a[144:147], v[64:67]
v_mfma_f32_16x16x32_bf16 v[68:71], a[140:143], a[148:151], v[68:71]
v_mfma_f32_16x16x32_bf16 v[72:75], a[140:143], a[152:155], v[72:75]
v_mfma_f32_16x16x32_bf16 v[76:79], a[140:143], a[156:159], v[76:79]
s_waitcnt vmcnt(40)
v_mfma_f32_16x16x32_bf16 v[16:19], a[160:163], a[176:179], v[16:19]
v_mfma_f32_16x16x32_bf16 v[20:23], a[160:163], a[180:183], v[20:23]
v_mfma_f32_16x16x32_bf16 v[24:27], a[160:163], a[184:187], v[24:27]
v_mfma_f32_16x16x32_bf16 v[28:31], a[160:163], a[188:191], v[28:31]
v_mfma_f32_16x16x32_bf16 v[32:35], a[164:167], a[176:179], v[32:35]
v_mfma_f32_16x16x32_bf16 v[36:39], a[164:167], a[180:183], v[36:39]
v_mfma_f32_16x16x32_bf16 v[40:43], a[164:167], a[184:187], v[40:43]
v_mfma_f32_16x16x32_bf16 v[44:47], a[164:167], a[188:191], v[44:47]
v_mfma_f32_16x16x32_bf16 v[48:51], a[168:171], a[176:179], v[48:51]
v_mfma_f32_16x16x32_bf16 v[52:55], a[168:171], a[180:183], v[52:55]
v_mfma_f32_16x16x32_bf16 v[56:59], a[168:171], a[184:187], v[56:59]
v_mfma_f32_16x16x32_bf16 v[60:63], a[168:171], a[188:191], v[60:63]
v_mfma_f32_16x16x32_bf16 v[64:67], a[172:175], a[176:179], v[64:67]
v_mfma_f32_16x16x32_bf16 v[68:71], a[172:175], a[180:183], v[68:71]
v_mfma_f32_16x16x32_bf16 v[72:75], a[172:175], a[184:187], v[72:75]
v_mfma_f32_16x16x32_bf16 v[76:79], a[172:175], a[188:191], v[76:79]
s_waitcnt vmcnt(32)
v_mfma_f32_16x16x32_bf16 v[16:19], a[192:195], a[208:211], v[16:19]
v_mfma_f32_16x16x32_bf16 v[20:23], a[192:195], a[212:215], v[20:23]
v_mfma_f32_16x16x32_bf16 v[24:27], a[192:195], a[216:219], v[24:27]
v_mfma_f32_16x16x32_bf16 v[28:31], a[192:195], a[220:223], v[28:31]
v_mfma_f32_16x16x32_bf16 v[32:35], a[196:199], a[208:211], v[32:35]
v_mfma_f32_16x16x32_bf16 v[36:39], a[196:199], a[212:215], v[36:39]
v_mfma_f32_16x16x32_bf16 v[40:43], a[196:199], a[216:219], v[40:43]
v_mfma_f32_16x16x32_bf16 v[44:47], a[196:199], a[220:223], v[44:47]
v_mfma_f32_16x16x32_bf16 v[48:51], a[200:203], a[208:211], v[48:51]
v_mfma_f32_16x16x32_bf16 v[52:55], a[200:203], a[212:215], v[52:55]
v_mfma_f32_16x16x32_bf16 v[56:59], a[200:203], a[216:219], v[56:59]
v_mfma_f32_16x16x32_bf16 v[60:63], a[200:203], a[220:223], v[60:63]
v_mfma_f32_16x16x32_bf16 v[64:67], a[204:207], a[208:211], v[64:67]
v_mfma_f32_16x16x32_bf16 v[68:71], a[204:207], a[212:215], v[68:71]
v_mfma_f32_16x16x32_bf16 v[72:75], a[204:207], a[216:219], v[72:75]
v_mfma_f32_16x16x32_bf16 v[76:79], a[204:207], a[220:223], v[76:79]
s_waitcnt vmcnt(24)
v_mfma_f32_16x16x32_bf16 v[16:19], a[0:3], a[16:19], v[16:19]
v_mfma_f32_16x16x32_bf16 v[20:23], a[0:3], a[20:23], v[20:23]
v_mfma_f32_16x16x32_bf16 v[24:27], a[0:3], a[24:27], v[24:27]
v_mfma_f32_16x16x32_bf16 v[28:31], a[0:3], a[28:31], v[28:31]
v_mfma_f32_16x16x32_bf16 v[32:35], a[4:7], a[16:19], v[32:35]
v_mfma_f32_16x16x32_bf16 v[36:39], a[4:7], a[20:23], v[36:39]
v_mfma_f32_16x16x32_bf16 v[40:43], a[4:7], a[24:27], v[40:43]
v_mfma_f32_16x16x32_bf16 v[44:47], a[4:7], a[28:31], v[44:47]
v_mfma_f32_16x16x32_bf16 v[48:51], a[8:11], a[16:19], v[48:51]
v_mfma_f32_16x16x32_bf16 v[52:55], a[8:11], a[20:23], v[52:55]
v_mfma_f32_16x16x32_bf16 v[56:59], a[8:11], a[24:27], v[56:59]
v_mfma_f32_16x16x32_bf16 v[60:63], a[8:11], a[28:31], v[60:63]
v_mfma_f32_16x16x32_bf16 v[64:67], a[12:15], a[16:19], v[64:67]
v_mfma_f32_16x16x32_bf16 v[68:71], a[12:15], a[20:23], v[68:71]
v_mfma_f32_16x16x32_bf16 v[72:75], a[12:15], a[24:27], v[72:75]
v_mfma_f32_16x16x32_bf16 v[76:79], a[12:15], a[28:31], v[76:79]
s_waitcnt vmcnt(16)
v_mfma_f32_16x16x32_bf16 v[16:19], a[32:35], a[48:51], v[16:19]
v_mfma_f32_16x16x32_bf16 v[20:23], a[32:35], a[52:55], v[20:23]
v_mfma_f32_16x16x32_bf16 v[24:27], a[32:35], a[56:59], v[24:27]
v_mfma_f32_16x16x32_bf16 v[28:31], a[32:35], a[60:63], v[28:31]
v_mfma_f32_16x16x32_bf16 v[32:35], a[36:39], a[48:51], v[32:35]
v_mfma_f32_16x16x32_bf16 v[36:39], a[36:39], a[52:55], v[36:39]
v_mfma_f32_16x16x32_bf16 v[40:43], a[36:39], a[56:59], v[40:43]
v_mfma_f32_16x16x32_bf16 v[44:47], a[36:39], a[60:63], v[44:47]
v_mfma_f32_16x16x32_bf16 v[48:51], a[40:43], a[48:51], v[48:51]
v_mfma_f32_16x16x32_bf16 v[52:55], a[40:43], a[52:55], v[52:55]
v_mfma_f32_16x16x32_bf16 v[56:59], a[40:43], a[56:59], v[56:59]
v_mfma_f32_16x16x32_bf16 v[60:63], a[40:43], a[60:63], v[60:63]
v_mfma_f32_16x16x32_bf16 v[64:67], a[44:47], a[48:51], v[64:67]
v_mfma_f32_16x16x32_bf16 v[68:71], a[44:47], a[52:55], v[68:71]
v_mfma_f32_16x16x32_bf16 v[72:75], a[44:47], a[56:59], v[72:75]
v_mfma_f32_16x16x32_bf16 v[76:79], a[44:47], a[60:63], v[76:79]
s_waitcnt vmcnt(8)
v_mfma_f32_16x16x32_bf16 v[16:19], a[64:67], a[80:83], v[16:19]
v_mfma_f32_16x16x32_bf16 v[20:23], a[64:67], a[84:87], v[20:23]
v_mfma_f32_16x16x32_bf16 v[24:27], a[64:67], a[88:91], v[24:27]
v_mfma_f32_16x16x32_bf16 v[28:31], a[64:67], a[92:95], v[28:31]
v_mfma_f32_16x16x32_bf16 v[32:35], a[68:71], a[80:83], v[32:35]
v_mfma_f32_16x16x32_bf16 v[36:39], a[68:71], a[84:87], v[36:39]
v_mfma_f32_16x16x32_bf16 v[40:43], a[68:71], a[88:91], v[40:43]
v_mfma_f32_16x16x32_bf16 v[44:47], a[68:71], a[92:95], v[44:47]
v_mfma_f32_16x16x32_bf16 v[48:51], a[72:75], a[80:83], v[48:51]
v_mfma_f32_16x16x32_bf16 v[52:55], a[72:75], a[84:87], v[52:55]
v_mfma_f32_16x16x32_bf16 v[56:59], a[72:75], a[88:91], v[56:59]
v_mfma_f32_16x16x32_bf16 v[60:63], a[72:75], a[92:95], v[60:63]
v_mfma_f32_16x16x32_bf16 v[64:67], a[76:79], a[80:83], v[64:67]
v_mfma_f32_16x16x32_bf16 v[68:71], a[76:79], a[84:87], v[68:71]
v_mfma_f32_16x16x32_bf16 v[72:75], a[76:79], a[88:91], v[72:75]
v_mfma_f32_16x16x32_bf16 v[76:79], a[76:79], a[92:95], v[76:79]
s_waitcnt vmcnt(0)
v_mfma_f32_16x16x32_bf16 v[16:19], a[96:99], a[112:115], v[16:19]
v_mfma_f32_16x16x32_bf16 v[20:23], a[96:99], a[116:119], v[20:23]
v_mfma_f32_16x16x32_bf16 v[24:27], a[96:99], a[120:123], v[24:27]
v_mfma_f32_16x16x32_bf16 v[28:31], a[96:99], a[124:127], v[28:31]
v_mfma_f32_16x16x32_bf16 v[32:35], a[100:103], a[112:115], v[32:35]
v_mfma_f32_16x16x32_bf16 v[36:39], a[100:103], a[116:119], v[36:39]
v_mfma_f32_16x16x32_bf16 v[40:43], a[100:103], a[120:123], v[40:43]
v_mfma_f32_16x16x32_bf16 v[44:47], a[100:103], a[124:127], v[44:47]
v_mfma_f32_16x16x32_bf16 v[48:51], a[104:107], a[112:115], v[48:51]
v_mfma_f32_16x16x32_bf16 v[52:55], a[104:107], a[116:119], v[52:55]
v_mfma_f32_16x16x32_bf16 v[56:59], a[104:107], a[120:123], v[56:59]
v_mfma_f32_16x16x32_bf16 v[60:63], a[104:107], a[124:127], v[60:63]
v_mfma_f32_16x16x32_bf16 v[64:67], a[108:111], a[112:115], v[64:67]
v_mfma_f32_16x16x32_bf16 v[68:71], a[108:111], a[116:119], v[68:71]
v_mfma_f32_16x16x32_bf16 v[72:75], a[108:111], a[120:123], v[72:75]
v_mfma_f32_16x16x32_bf16 v[76:79], a[108:111], a[124:127], v[76:79]
s_nop 7
s_lshl_b32 s19, s16, 14
v_add_u32 v6, s19, v1
ds_write_b128 v6, v[16:19] offset:0
ds_write_b128 v6, v[20:23] offset:1024
ds_write_b128 v6, v[24:27] offset:2048
ds_write_b128 v6, v[28:31] offset:3072
ds_write_b128 v6, v[32:35] offset:4096
ds_write_b128 v6, v[36:39] offset:5120
ds_write_b128 v6, v[40:43] offset:6144
ds_write_b128 v6, v[44:47] offset:7168
ds_write_b128 v6, v[48:51] offset:8192
ds_write_b128 v6, v[52:55] offset:9216
ds_write_b128 v6, v[56:59] offset:10240
ds_write_b128 v6, v[60:63] offset:11264
ds_write_b128 v6, v[64:67] offset:12288
ds_write_b128 v6, v[68:71] offset:13312
ds_write_b128 v6, v[72:75] offset:14336
ds_write_b128 v6, v[76:79] offset:15360
s_waitcnt lgkmcnt(0)
s_barrier
s_lshl_b32 s19, s16, 10
v_add_u32 v6, s19, v1
ds_read_b128 v[128:131], v6 offset:0
ds_read_b128 v[132:135], v6 offset:16384
ds_read_b128 v[136:139], v6 offset:32768
ds_read_b128 v[140:143], v6 offset:49152
ds_read_b128 v[144:147], v6 offset:4096
ds_read_b128 v[148:151], v6 offset:20480
ds_read_b128 v[152:155], v6 offset:36864
ds_read_b128 v[156:159], v6 offset:53248
ds_read_b128 v[160:163], v6 offset:8192
ds_read_b128 v[164:167], v6 offset:24576
ds_read_b128 v[168:171], v6 offset:40960
ds_read_b128 v[172:175], v6 offset:57344
ds_read_b128 v[176:179], v6 offset:12288
ds_read_b128 v[180:183], v6 offset:28672
ds_read_b128 v[184:187], v6 offset:45056
ds_read_b128 v[188:191], v6 offset:61440
v_lshrrev_b32 v7, 4, v1
v_and_b32 v8, 15, v7
v_lshrrev_b32 v7, 4, v7
s_lshl_b32 s19, s23, 6
s_lshl_b32 s20, s16, 4
s_add_u32 s19, s19, s20
v_add_u32 v8, s19, v8
v_mul_u32_u24 v8, 1792, v8
v_lshl_add_u32 v8, v7, 3, v8
s_lshl_b32 s19, s22, 7
s_waitcnt lgkmcnt(0)
v_add_f32 v128, v128, v132
v_add_f32 v136, v136, v140
v_add_f32 v129, v129, v133
v_add_f32 v137, v137, v141
v_add_f32 v130, v130, v134
v_add_f32 v138, v138, v142
v_add_f32 v131, v131, v135
v_add_f32 v139, v139, v143
v_add_f32 v128, v128, v136
v_add_f32 v129, v129, v137
v_add_f32 v130, v130, v138
v_add_f32 v131, v131, v139
v_cvt_pk_bf16_f32 v132, v128, v129
v_cvt_pk_bf16_f32 v133, v130, v131
buffer_store_dwordx2 v[132:133], v8, s[8:11], s19 offen offset:0
v_add_f32 v144, v144, v148
v_add_f32 v152, v152, v156
v_add_f32 v145, v145, v149
v_add_f32 v153, v153, v157
v_add_f32 v146, v146, v150
v_add_f32 v154, v154, v158
v_add_f32 v147, v147, v151
v_add_f32 v155, v155, v159
v_add_f32 v144, v144, v152
v_add_f32 v145, v145, v153
v_add_f32 v146, v146, v154
v_add_f32 v147, v147, v155
v_cvt_pk_bf16_f32 v148, v144, v145
v_cvt_pk_bf16_f32 v149, v146, v147
buffer_store_dwordx2 v[148:149], v8, s[8:11], s19 offen offset:32
v_add_f32 v160, v160, v164
v_add_f32 v168, v168, v172
v_add_f32 v161, v161, v165
v_add_f32 v169, v169, v173
v_add_f32 v162, v162, v166
v_add_f32 v170, v170, v174
v_add_f32 v163, v163, v167
v_add_f32 v171, v171, v175
v_add_f32 v160, v160, v168
v_add_f32 v161, v161, v169
v_add_f32 v162, v162, v170
v_add_f32 v163, v163, v171
v_cvt_pk_bf16_f32 v164, v160, v161
v_cvt_pk_bf16_f32 v165, v162, v163
buffer_store_dwordx2 v[164:165], v8, s[8:11], s19 offen offset:64
v_add_f32 v176, v176, v180
v_add_f32 v184, v184, v188
v_add_f32 v177, v177, v181
v_add_f32 v185, v185, v189
v_add_f32 v178, v178, v182
v_add_f32 v186, v186, v190
v_add_f32 v179, v179, v183
v_add_f32 v187, v187, v191
v_add_f32 v176, v176, v184
v_add_f32 v177, v177, v185
v_add_f32 v178, v178, v186
v_add_f32 v179, v179, v187
v_cvt_pk_bf16_f32 v180, v176, v177
v_cvt_pk_bf16_f32 v181, v178, v179
buffer_store_dwordx2 v[180:181], v8, s[8:11], s19 offen offset:96
s_branch L_k3_done
L_k3_B:
s_sub_u32 s23, s2, 224
s_mul_i32 s17, s16, 114688
s_add_u32 s17, s17, 79691776
s_lshl_b32 s18, s23, 16
s_add_u32 s18, s18, 73400320
v_add_u32 v2, 0, v1
v_add_u32 v3, 16384, v1
v_add_u32 v4, 32768, v1
v_add_u32 v5, 49152, v1
v_add_u32 v6, 65536, v1
v_add_u32 v7, 81920, v1
v_add_u32 v8, 98304, v1
s_waitcnt vmcnt(0)
s_barrier
s_cmp_lg_u32 s16, 0
s_cbranch_scc1 L_k2_ctxsig0
v_mov_b32 v10, 0
v_mov_b32 v11, s3
s_mov_b64 exec, 1
buffer_store_dword v11, v10, s[12:15], s60 offen sc1
s_mov_b64 exec, -1
L_k2_ctxsig0:
v_and_b32 v12, 15, v0
v_lshlrev_b32 v12, 7, v12
s_lshr_b32 s19, s23, 1
s_lshl_b32 s19, s19, 11
s_add_u32 s19, s19, 105021440
s_mov_b32 s24, 0
L_poll_cb:
buffer_load_dword v13, v12, s[12:15], s19 offen sc1
s_waitcnt vmcnt(0)
v_cmp_ne_u32 vcc, s3, v13
s_nop 4
s_cbranch_vccz L_pollok_cb
s_add_u32 s24, s24, 1
s_sleep 1
s_cmp_lt_u32 s24, 400000
s_cbranch_scc1 L_poll_cb
L_pollok_cb:
buffer_load_dwordx4 a[0:3], v2, s[12:15], s17 offen sc1
buffer_load_dwordx4 a[4:7], v3, s[12:15], s17 offen sc1
buffer_load_dwordx4 a[8:11], v4, s[12:15], s17 offen sc1
buffer_load_dwordx4 a[12:15], v5, s[12:15], s17 offen sc1
buffer_load_dwordx4 a[16:19], v6, s[12:15], s17 offen sc1
buffer_load_dwordx4 a[20:23], v7, s[12:15], s17 offen sc1
buffer_load_dwordx4 a[24:27], v8, s[12:15], s17 offen sc1
buffer_load_dwordx4 a[28:31], v2, s[12:15], s18 offen sc1
buffer_load_dwordx4 a[32:35], v3, s[12:15], s18 offen sc1
buffer_load_dwordx4 a[36:39], v4, s[12:15], s18 offen sc1
buffer_load_dwordx4 a[40:43], v5, s[12:15], s18 offen sc1
s_add_u32 s17, s17, 1024
s_add_u32 s18, s18, 1024
buffer_load_dwordx4 a[44:47], v2, s[12:15], s17 offen sc1
buffer_load_dwordx4 a[48:51], v3, s[12:15], s17 offen sc1
buffer_load_dwordx4 a[52:55], v4, s[12:15], s17 offen sc1
buffer_load_dwordx4 a[56:59], v5, s[12:15], s17 offen sc1
buffer_load_dwordx4 a[60:63], v6, s[12:15], s17 offen sc1
buffer_load_dwordx4 a[64:67], v7, s[12:15], s17 offen sc1
buffer_load_dwordx4 a[68:71], v8, s[12:15], s17 offen sc1
buffer_load_dwordx4 a[72:75], v2, s[12:15], s18 offen sc1
buffer_load_dwordx4 a[76:79], v3, s[12:15], s18 offen sc1
buffer_load_dwordx4 a[80:83], v4, s[12:15], s18 offen sc1
buffer_load_dwordx4 a[84:87], v5, s[12:15], s18 offen sc1
s_add_u32 s17, s17, 1024
s_add_u32 s18, s18, 1024
buffer_load_dwordx4 a[88:91], v2, s[12:15], s17 offen sc1
buffer_load_dwordx4 a[92:95], v3, s[12:15], s17 offen sc1
buffer_load_dwordx4 a[96:99], v4, s[12:15], s17 offen sc1
buffer_load_dwordx4 a[100:103], v5, s[12:15], s17 offen sc1
buffer_load_dwordx4 a[104:107], v6, s[12:15], s17 offen sc1
buffer_load_dwordx4 a[108:111], v7, s[12:15], s17 offen sc1
buffer_load_dwordx4 a[112:115], v8, s[12:15], s17 offen sc1
buffer_load_dwordx4 a[116:119], v2, s[12:15], s18 offen sc1
buffer_load_dwordx4 a[120:123], v3, s[12:15], s18 offen sc1
buffer_load_dwordx4 a[124:127], v4, s[12:15], s18 offen sc1
buffer_load_dwordx4 a[128:131], v5, s[12:15], s18 offen sc1
s_add_u32 s17, s17, 1024
s_add_u32 s18, s18, 1024
buffer_load_dwordx4 a[132:135], v2, s[12:15], s17 offen sc1
buffer_load_dwordx4 a[136:139], v3, s[12:15], s17 offen sc1
buffer_load_dwordx4 a[140:143], v4, s[12:15], s17 offen sc1
buffer_load_dwordx4 a[144:147], v5, s[12:15], s17 offen sc1
buffer_load_dwordx4 a[148:151], v6, s[12:15], s17 offen sc1
buffer_load_dwordx4 a[152:155], v7, s[12:15], s17 offen sc1
buffer_load_dwordx4 a[156:159], v8, s[12:15], s17 offen sc1
buffer_load_dwordx4 a[160:163], v2, s[12:15], s18 offen sc1
buffer_load_dwordx4 a[164:167], v3, s[12:15], s18 offen sc1
buffer_load_dwordx4 a[168:171], v4, s[12:15], s18 offen sc1
buffer_load_dwordx4 a[172:175], v5, s[12:15], s18 offen sc1
s_add_u32 s17, s17, 1024
s_add_u32 s18, s18, 1024
buffer_load_dwordx4 a[176:179], v2, s[12:15], s17 offen sc1
buffer_load_dwordx4 a[180:183], v3, s[12:15], s17 offen sc1
buffer_load_dwordx4 a[184:187], v4, s[12:15], s17 offen sc1
buffer_load_dwordx4 a[188:191], v5, s[12:15], s17 offen sc1
buffer_load_dwordx4 a[192:195], v6, s[12:15], s17 offen sc1
buffer_load_dwordx4 a[196:199], v7, s[12:15], s17 offen sc1
buffer_load_dwordx4 a[200:203], v8, s[12:15], s17 offen sc1
buffer_load_dwordx4 a[204:207], v2, s[12:15], s18 offen sc1
buffer_load_dwordx4 a[208:211], v3, s[12:15], s18 offen sc1
buffer_load_dwordx4 a[212:215], v4, s[12:15], s18 offen sc1
buffer_load_dwordx4 a[216:219], v5, s[12:15], s18 offen sc1
s_add_u32 s17, s17, 1024
s_add_u32 s18, s18, 1024
s_waitcnt vmcnt(44)
v_mfma_f32_16x16x32_bf16 v[16:19], a[0:3], a[28:31], 0
v_mfma_f32_16x16x32_bf16 v[20:23], a[0:3], a[32:35], 0
v_mfma_f32_16x16x32_bf16 v[24:27], a[0:3], a[36:39], 0
v_mfma_f32_16x16x32_bf16 v[28:31], a[0:3], a[40:43], 0
v_mfma_f32_16x16x32_bf16 v[32:35], a[4:7], a[28:31], 0
v_mfma_f32_16x16x32_bf16 v[36:39], a[4:7], a[32:35], 0
v_mfma_f32_16x16x32_bf16 v[40:43], a[4:7], a[36:39], 0
v_mfma_f32_16x16x32_bf16 v[44:47], a[4:7], a[40:43], 0
v_mfma_f32_16x16x32_bf16 v[48:51], a[8:11], a[28:31], 0
v_mfma_f32_16x16x32_bf16 v[52:55], a[8:11], a[32:35], 0
v_mfma_f32_16x16x32_bf16 v[56:59], a[8:11], a[36:39], 0
v_mfma_f32_16x16x32_bf16 v[60:63], a[8:11], a[40:43], 0
v_mfma_f32_16x16x32_bf16 v[64:67], a[12:15], a[28:31], 0
v_mfma_f32_16x16x32_bf16 v[68:71], a[12:15], a[32:35], 0
v_mfma_f32_16x16x32_bf16 v[72:75], a[12:15], a[36:39], 0
v_mfma_f32_16x16x32_bf16 v[76:79], a[12:15], a[40:43], 0
v_mfma_f32_16x16x32_bf16 v[80:83], a[16:19], a[28:31], 0
v_mfma_f32_16x16x32_bf16 v[84:87], a[16:19], a[32:35], 0
v_mfma_f32_16x16x32_bf16 v[88:91], a[16:19], a[36:39], 0
v_mfma_f32_16x16x32_bf16 v[92:95], a[16:19], a[40:43], 0
v_mfma_f32_16x16x32_bf16 v[96:99], a[20:23], a[28:31], 0
v_mfma_f32_16x16x32_bf16 v[100:103], a[20:23], a[32:35], 0
v_mfma_f32_16x16x32_bf16 v[104:107], a[20:23], a[36:39], 0
v_mfma_f32_16x16x32_bf16 v[108:111], a[20:23], a[40:43], 0
v_mfma_f32_16x16x32_bf16 v[112:115], a[24:27], a[28:31], 0
v_mfma_f32_16x16x32_bf16 v[116:119], a[24:27], a[32:35], 0
v_mfma_f32_16x16x32_bf16 v[120:123], a[24:27], a[36:39], 0
v_mfma_f32_16x16x32_bf16 v[124:127], a[24:27], a[40:43], 0
buffer_load_dwordx4 a[0:3], v2, s[12:15], s17 offen sc1
buffer_load_dwordx4 a[4:7], v3, s[12:15], s17 offen sc1
buffer_load_dwordx4 a[8:11], v4, s[12:15], s17 offen sc1
buffer_load_dwordx4 a[12:15], v5, s[12:15], s17 offen sc1
buffer_load_dwordx4 a[16:19], v6, s[12:15], s17 offen sc1
buffer_load_dwordx4 a[20:23], v7, s[12:15], s17 offen sc1
buffer_load_dwordx4 a[24:27], v8, s[12:15], s17 offen sc1
buffer_load_dwordx4 a[28:31], v2, s[12:15], s18 offen sc1
buffer_load_dwordx4 a[32:35], v3, s[12:15], s18 offen sc1
buffer_load_dwordx4 a[36:39], v4, s[12:15], s18 offen sc1
buffer_load_dwordx4 a[40:43], v5, s[12:15], s18 offen sc1
s_add_u32 s17, s17, 1024
s_add_u32 s18, s18, 1024
s_waitcnt vmcnt(44)
v_mfma_f32_16x16x32_bf16 v[16:19], a[44:47], a[72:75], v[16:19]
v_mfma_f32_16x16x32_bf16 v[20:23], a[44:47], a[76:79], v[20:23]
v_mfma_f32_16x16x32_bf16 v[24:27], a[44:47], a[80:83], v[24:27]
v_mfma_f32_16x16x32_bf16 v[28:31], a[44:47], a[84:87], v[28:31]
v_mfma_f32_16x16x32_bf16 v[32:35], a[48:51], a[72:75], v[32:35]
v_mfma_f32_16x16x32_bf16 v[36:39], a[48:51], a[76:79], v[36:39]
v_mfma_f32_16x16x32_bf16 v[40:43], a[48:51], a[80:83], v[40:43]
v_mfma_f32_16x16x32_bf16 v[44:47], a[48:51], a[84:87], v[44:47]
v_mfma_f32_16x16x32_bf16 v[48:51], a[52:55], a[72:75], v[48:51]
v_mfma_f32_16x16x32_bf16 v[52:55], a[52:55], a[76:79], v[52:55]
v_mfma_f32_16x16x32_bf16 v[56:59], a[52:55], a[80:83], v[56:59]
v_mfma_f32_16x16x32_bf16 v[60:63], a[52:55], a[84:87], v[60:63]
v_mfma_f32_16x16x32_bf16 v[64:67], a[56:59], a[72:75], v[64:67]
v_mfma_f32_16x16x32_bf16 v[68:71], a[56:59], a[76:79], v[68:71]
v_mfma_f32_16x16x32_bf16 v[72:75], a[56:59], a[80:83], v[72:75]
v_mfma_f32_16x16x32_bf16 v[76:79], a[56:59], a[84:87], v[76:79]
v_mfma_f32_16x16x32_bf16 v[80:83], a[60:63], a[72:75], v[80:83]
v_mfma_f32_16x16x32_bf16 v[84:87], a[60:63], a[76:79], v[84:87]
v_mfma_f32_16x16x32_bf16 v[88:91], a[60:63], a[80:83], v[88:91]
v_mfma_f32_16x16x32_bf16 v[92:95], a[60:63], a[84:87], v[92:95]
v_mfma_f32_16x16x32_bf16 v[96:99], a[64:67], a[72:75], v[96:99]
v_mfma_f32_16x16x32_bf16 v[100:103], a[64:67], a[76:79], v[100:103]
v_mfma_f32_16x16x32_bf16 v[104:107], a[64:67], a[80:83], v[104:107]
v_mfma_f32_16x16x32_bf16 v[108:111], a[64:67], a[84:87], v[108:111]
v_mfma_f32_16x16x32_bf16 v[112:115], a[68:71], a[72:75], v[112:115]
v_mfma_f32_16x16x32_bf16 v[116:119], a[68:71], a[76:79], v[116:119]
v_mfma_f32_16x16x32_bf16 v[120:123], a[68:71], a[80:83], v[120:123]
v_mfma_f32_16x16x32_bf16 v[124:127], a[68:71], a[84:87], v[124:127]
buffer_load_dwordx4 a[44:47], v2, s[12:15], s17 offen sc1
buffer_load_dwordx4 a[48:51], v3, s[12:15], s17 offen sc1
buffer_load_dwordx4 a[52:55], v4, s[12:15], s17 offen sc1
buffer_load_dwordx4 a[56:59], v5, s[12:15], s17 offen sc1
buffer_load_dwordx4 a[60:63], v6, s[12:15], s17 offen sc1
buffer_load_dwordx4 a[64:67], v7, s[12:15], s17 offen sc1
buffer_load_dwordx4 a[68:71], v8, s[12:15], s17 offen sc1
buffer_load_dwordx4 a[72:75], v2, s[12:15], s18 offen sc1
buffer_load_dwordx4 a[76:79], v3, s[12:15], s18 offen sc1
buffer_load_dwordx4 a[80:83], v4, s[12:15], s18 offen sc1
buffer_load_dwordx4 a[84:87], v5, s[12:15], s18 offen sc1
s_add_u32 s17, s17, 1024
s_add_u32 s18, s18, 1024
s_waitcnt vmcnt(44)
v_mfma_f32_16x16x32_bf16 v[16:19], a[88:91], a[116:119], v[16:19]
v_mfma_f32_16x16x32_bf16 v[20:23], a[88:91], a[120:123], v[20:23]
v_mfma_f32_16x16x32_bf16 v[24:27], a[88:91], a[124:127], v[24:27]
v_mfma_f32_16x16x32_bf16 v[28:31], a[88:91], a[128:131], v[28:31]
v_mfma_f32_16x16x32_bf16 v[32:35], a[92:95], a[116:119], v[32:35]
v_mfma_f32_16x16x32_bf16 v[36:39], a[92:95], a[120:123], v[36:39]
v_mfma_f32_16x16x32_bf16 v[40:43], a[92:95], a[124:127], v[40:43]
v_mfma_f32_16x16x32_bf16 v[44:47], a[92:95], a[128:131], v[44:47]
v_mfma_f32_16x16x32_bf16 v[48:51], a[96:99], a[116:119], v[48:51]
v_mfma_f32_16x16x32_bf16 v[52:55], a[96:99], a[120:123], v[52:55]
v_mfma_f32_16x16x32_bf16 v[56:59], a[96:99], a[124:127], v[56:59]
v_mfma_f32_16x16x32_bf16 v[60:63], a[96:99], a[128:131], v[60:63]
v_mfma_f32_16x16x32_bf16 v[64:67], a[100:103], a[116:119], v[64:67]
v_mfma_f32_16x16x32_bf16 v[68:71], a[100:103], a[120:123], v[68:71]
v_mfma_f32_16x16x32_bf16 v[72:75], a[100:103], a[124:127], v[72:75]
v_mfma_f32_16x16x32_bf16 v[76:79], a[100:103], a[128:131], v[76:79]
v_mfma_f32_16x16x32_bf16 v[80:83], a[104:107], a[116:119], v[80:83]
v_mfma_f32_16x16x32_bf16 v[84:87], a[104:107], a[120:123], v[84:87]
v_mfma_f32_16x16x32_bf16 v[88:91], a[104:107], a[124:127], v[88:91]
v_mfma_f32_16x16x32_bf16 v[92:95], a[104:107], a[128:131], v[92:95]
v_mfma_f32_16x16x32_bf16 v[96:99], a[108:111], a[116:119], v[96:99]
v_mfma_f32_16x16x32_bf16 v[100:103], a[108:111], a[120:123], v[100:103]
v_mfma_f32_16x16x32_bf16 v[104:107], a[108:111], a[124:127], v[104:107]
v_mfma_f32_16x16x32_bf16 v[108:111], a[108:111], a[128:131], v[108:111]
v_mfma_f32_16x16x32_bf16 v[112:115], a[112:115], a[116:119], v[112:115]
v_mfma_f32_16x16x32_bf16 v[116:119], a[112:115], a[120:123], v[116:119]
v_mfma_f32_16x16x32_bf16 v[120:123], a[112:115], a[124:127], v[120:123]
v_mfma_f32_16x16x32_bf16 v[124:127], a[112:115], a[128:131], v[124:127]
buffer_load_dwordx4 a[88:91], v2, s[12:15], s17 offen sc1
buffer_load_dwordx4 a[92:95], v3, s[12:15], s17 offen sc1
buffer_load_dwordx4 a[96:99], v4, s[12:15], s17 offen sc1
buffer_load_dwordx4 a[100:103], v5, s[12:15], s17 offen sc1
buffer_load_dwordx4 a[104:107], v6, s[12:15], s17 offen sc1
buffer_load_dwordx4 a[108:111], v7, s[12:15], s17 offen sc1
buffer_load_dwordx4 a[112:115], v8, s[12:15], s17 offen sc1
buffer_load_dwordx4 a[116:119], v2, s[12:15], s18 offen sc1
buffer_load_dwordx4 a[120:123], v3, s[12:15], s18 offen sc1
buffer_load_dwordx4 a[124:127], v4, s[12:15], s18 offen sc1
buffer_load_dwordx4 a[128:131], v5, s[12:15], s18 offen sc1
s_add_u32 s17, s17, 1024
s_add_u32 s18, s18, 1024
s_waitcnt vmcnt(44)
v_mfma_f32_16x16x32_bf16 v[16:19], a[132:135], a[160:163], v[16:19]
v_mfma_f32_16x16x32_bf16 v[20:23], a[132:135], a[164:167], v[20:23]
v_mfma_f32_16x16x32_bf16 v[24:27], a[132:135], a[168:171], v[24:27]
v_mfma_f32_16x16x32_bf16 v[28:31], a[132:135], a[172:175], v[28:31]
v_mfma_f32_16x16x32_bf16 v[32:35], a[136:139], a[160:163], v[32:35]
v_mfma_f32_16x16x32_bf16 v[36:39], a[136:139], a[164:167], v[36:39]
v_mfma_f32_16x16x32_bf16 v[40:43], a[136:139], a[168:171], v[40:43]
v_mfma_f32_16x16x32_bf16 v[44:47], a[136:139], a[172:175], v[44:47]
v_mfma_f32_16x16x32_bf16 v[48:51], a[140:143], a[160:163], v[48:51]
v_mfma_f32_16x16x32_bf16 v[52:55], a[140:143], a[164:167], v[52:55]
v_mfma_f32_16x16x32_bf16 v[56:59], a[140:143], a[168:171], v[56:59]
v_mfma_f32_16x16x32_bf16 v[60:63], a[140:143], a[172:175], v[60:63]
v_mfma_f32_16x16x32_bf16 v[64:67], a[144:147], a[160:163], v[64:67]
v_mfma_f32_16x16x32_bf16 v[68:71], a[144:147], a[164:167], v[68:71]
v_mfma_f32_16x16x32_bf16 v[72:75], a[144:147], a[168:171], v[72:75]
v_mfma_f32_16x16x32_bf16 v[76:79], a[144:147], a[172:175], v[76:79]
v_mfma_f32_16x16x32_bf16 v[80:83], a[148:151], a[160:163], v[80:83]
v_mfma_f32_16x16x32_bf16 v[84:87], a[148:151], a[164:167], v[84:87]
v_mfma_f32_16x16x32_bf16 v[88:91], a[148:151], a[168:171], v[88:91]
v_mfma_f32_16x16x32_bf16 v[92:95], a[148:151], a[172:175], v[92:95]
v_mfma_f32_16x16x32_bf16 v[96:99], a[152:155], a[160:163], v[96:99]
v_mfma_f32_16x16x32_bf16 v[100:103], a[152:155], a[164:167], v[100:103]
v_mfma_f32_16x16x32_bf16 v[104:107], a[152:155], a[168:171], v[104:107]
v_mfma_f32_16x16x32_bf16 v[108:111], a[152:155], a[172:175], v[108:111]
v_mfma_f32_16x16x32_bf16 v[112:115], a[156:159], a[160:163], v[112:115]
v_mfma_f32_16x16x32_bf16 v[116:119], a[156:159], a[164:167], v[116:119]
v_mfma_f32_16x16x32_bf16 v[120:123], a[156:159], a[168:171], v[120:123]
v_mfma_f32_16x16x32_bf16 v[124:127], a[156:159], a[172:175], v[124:127]
buffer_load_dwordx4 a[132:135], v2, s[12:15], s17 offen sc1
buffer_load_dwordx4 a[136:139], v3, s[12:15], s17 offen sc1
buffer_load_dwordx4 a[140:143], v4, s[12:15], s17 offen sc1
buffer_load_dwordx4 a[144:147], v5, s[12:15], s17 offen sc1
buffer_load_dwordx4 a[148:151], v6, s[12:15], s17 offen sc1
buffer_load_dwordx4 a[152:155], v7, s[12:15], s17 offen sc1
buffer_load_dwordx4 a[156:159], v8, s[12:15], s17 offen sc1
buffer_load_dwordx4 a[160:163], v2, s[12:15], s18 offen sc1
buffer_load_dwordx4 a[164:167], v3, s[12:15], s18 offen sc1
buffer_load_dwordx4 a[168:171], v4, s[12:15], s18 offen sc1
buffer_load_dwordx4 a[172:175], v5, s[12:15], s18 offen sc1
s_add_u32 s17, s17, 1024
s_add_u32 s18, s18, 1024
s_waitcnt vmcnt(44)
v_mfma_f32_16x16x32_bf16 v[16:19], a[176:179], a[204:207], v[16:19]
v_mfma_f32_16x16x32_bf16 v[20:23], a[176:179], a[208:211], v[20:23]
v_mfma_f32_16x16x32_bf16 v[24:27], a[176:179], a[212:215], v[24:27]
v_mfma_f32_16x16x32_bf16 v[28:31], a[176:179], a[216:219], v[28:31]
v_mfma_f32_16x16x32_bf16 v[32:35], a[180:183], a[204:207], v[32:35]
v_mfma_f32_16x16x32_bf16 v[36:39], a[180:183], a[208:211], v[36:39]
v_mfma_f32_16x16x32_bf16 v[40:43], a[180:183], a[212:215], v[40:43]
v_mfma_f32_16x16x32_bf16 v[44:47], a[180:183], a[216:219], v[44:47]
v_mfma_f32_16x16x32_bf16 v[48:51], a[184:187], a[204:207], v[48:51]
v_mfma_f32_16x16x32_bf16 v[52:55], a[184:187], a[208:211], v[52:55]
v_mfma_f32_16x16x32_bf16 v[56:59], a[184:187], a[212:215], v[56:59]
v_mfma_f32_16x16x32_bf16 v[60:63], a[184:187], a[216:219], v[60:63]
v_mfma_f32_16x16x32_bf16 v[64:67], a[188:191], a[204:207], v[64:67]
v_mfma_f32_16x16x32_bf16 v[68:71], a[188:191], a[208:211], v[68:71]
v_mfma_f32_16x16x32_bf16 v[72:75], a[188:191], a[212:215], v[72:75]
v_mfma_f32_16x16x32_bf16 v[76:79], a[188:191], a[216:219], v[76:79]
v_mfma_f32_16x16x32_bf16 v[80:83], a[192:195], a[204:207], v[80:83]
v_mfma_f32_16x16x32_bf16 v[84:87], a[192:195], a[208:211], v[84:87]
v_mfma_f32_16x16x32_bf16 v[88:91], a[192:195], a[212:215], v[88:91]
v_mfma_f32_16x16x32_bf16 v[92:95], a[192:195], a[216:219], v[92:95]
v_mfma_f32_16x16x32_bf16 v[96:99], a[196:199], a[204:207], v[96:99]
v_mfma_f32_16x16x32_bf16 v[100:103], a[196:199], a[208:211], v[100:103]
v_mfma_f32_16x16x32_bf16 v[104:107], a[196:199], a[212:215], v[104:107]
v_mfma_f32_16x16x32_bf16 v[108:111], a[196:199], a[216:219], v[108:111]
v_mfma_f32_16x16x32_bf16 v[112:115], a[200:203], a[204:207], v[112:115]
v_mfma_f32_16x16x32_bf16 v[116:119], a[200:203], a[208:211], v[116:119]
v_mfma_f32_16x16x32_bf16 v[120:123], a[200:203], a[212:215], v[120:123]
v_mfma_f32_16x16x32_bf16 v[124:127], a[200:203], a[216:219], v[124:127]
buffer_load_dwordx4 a[176:179], v2, s[12:15], s17 offen sc1
buffer_load_dwordx4 a[180:183], v3, s[12:15], s17 offen sc1
buffer_load_dwordx4 a[184:187], v4, s[12:15], s17 offen sc1
buffer_load_dwordx4 a[188:191], v5, s[12:15], s17 offen sc1
buffer_load_dwordx4 a[192:195], v6, s[12:15], s17 offen sc1
buffer_load_dwordx4 a[196:199], v7, s[12:15], s17 offen sc1
buffer_load_dwordx4 a[200:203], v8, s[12:15], s17 offen sc1
buffer_load_dwordx4 a[204:207], v2, s[12:15], s18 offen sc1
buffer_load_dwordx4 a[208:211], v3, s[12:15], s18 offen sc1
buffer_load_dwordx4 a[212:215], v4, s[12:15], s18 offen sc1
buffer_load_dwordx4 a[216:219], v5, s[12:15], s18 offen sc1
s_add_u32 s17, s17, 1024
s_add_u32 s18, s18, 1024
s_waitcnt vmcnt(44)
v_mfma_f32_16x16x32_bf16 v[16:19], a[0:3], a[28:31], v[16:19]
v_mfma_f32_16x16x32_bf16 v[20:23], a[0:3], a[32:35], v[20:23]
v_mfma_f32_16x16x32_bf16 v[24:27], a[0:3], a[36:39], v[24:27]
v_mfma_f32_16x16x32_bf16 v[28:31], a[0:3], a[40:43], v[28:31]
v_mfma_f32_16x16x32_bf16 v[32:35], a[4:7], a[28:31], v[32:35]
v_mfma_f32_16x16x32_bf16 v[36:39], a[4:7], a[32:35], v[36:39]
v_mfma_f32_16x16x32_bf16 v[40:43], a[4:7], a[36:39], v[40:43]
v_mfma_f32_16x16x32_bf16 v[44:47], a[4:7], a[40:43], v[44:47]
v_mfma_f32_16x16x32_bf16 v[48:51], a[8:11], a[28:31], v[48:51]
v_mfma_f32_16x16x32_bf16 v[52:55], a[8:11], a[32:35], v[52:55]
v_mfma_f32_16x16x32_bf16 v[56:59], a[8:11], a[36:39], v[56:59]
v_mfma_f32_16x16x32_bf16 v[60:63], a[8:11], a[40:43], v[60:63]
v_mfma_f32_16x16x32_bf16 v[64:67], a[12:15], a[28:31], v[64:67]
v_mfma_f32_16x16x32_bf16 v[68:71], a[12:15], a[32:35], v[68:71]
v_mfma_f32_16x16x32_bf16 v[72:75], a[12:15], a[36:39], v[72:75]
v_mfma_f32_16x16x32_bf16 v[76:79], a[12:15], a[40:43], v[76:79]
v_mfma_f32_16x16x32_bf16 v[80:83], a[16:19], a[28:31], v[80:83]
v_mfma_f32_16x16x32_bf16 v[84:87], a[16:19], a[32:35], v[84:87]
v_mfma_f32_16x16x32_bf16 v[88:91], a[16:19], a[36:39], v[88:91]
v_mfma_f32_16x16x32_bf16 v[92:95], a[16:19], a[40:43], v[92:95]
v_mfma_f32_16x16x32_bf16 v[96:99], a[20:23], a[28:31], v[96:99]
v_mfma_f32_16x16x32_bf16 v[100:103], a[20:23], a[32:35], v[100:103]
v_mfma_f32_16x16x32_bf16 v[104:107], a[20:23], a[36:39], v[104:107]
v_mfma_f32_16x16x32_bf16 v[108:111], a[20:23], a[40:43], v[108:111]
v_mfma_f32_16x16x32_bf16 v[112:115], a[24:27], a[28:31], v[112:115]
v_mfma_f32_16x16x32_bf16 v[116:119], a[24:27], a[32:35], v[116:119]
v_mfma_f32_16x16x32_bf16 v[120:123], a[24:27], a[36:39], v[120:123]
v_mfma_f32_16x16x32_bf16 v[124:127], a[24:27], a[40:43], v[124:127]
buffer_load_dwordx4 a[0:3], v2, s[12:15], s17 offen sc1
buffer_load_dwordx4 a[4:7], v3, s[12:15], s17 offen sc1
buffer_load_dwordx4 a[8:11], v4, s[12:15], s17 offen sc1
buffer_load_dwordx4 a[12:15], v5, s[12:15], s17 offen sc1
buffer_load_dwordx4 a[16:19], v6, s[12:15], s17 offen sc1
buffer_load_dwordx4 a[20:23], v7, s[12:15], s17 offen sc1
buffer_load_dwordx4 a[24:27], v8, s[12:15], s17 offen sc1
buffer_load_dwordx4 a[28:31], v2, s[12:15], s18 offen sc1
buffer_load_dwordx4 a[32:35], v3, s[12:15], s18 offen sc1
buffer_load_dwordx4 a[36:39], v4, s[12:15], s18 offen sc1
buffer_load_dwordx4 a[40:43], v5, s[12:15], s18 offen sc1
s_add_u32 s17, s17, 1024
s_add_u32 s18, s18, 1024
s_waitcnt vmcnt(44)
v_mfma_f32_16x16x32_bf16 v[16:19], a[44:47], a[72:75], v[16:19]
v_mfma_f32_16x16x32_bf16 v[20:23], a[44:47], a[76:79], v[20:23]
v_mfma_f32_16x16x32_bf16 v[24:27], a[44:47], a[80:83], v[24:27]
v_mfma_f32_16x16x32_bf16 v[28:31], a[44:47], a[84:87], v[28:31]
v_mfma_f32_16x16x32_bf16 v[32:35], a[48:51], a[72:75], v[32:35]
v_mfma_f32_16x16x32_bf16 v[36:39], a[48:51], a[76:79], v[36:39]
v_mfma_f32_16x16x32_bf16 v[40:43], a[48:51], a[80:83], v[40:43]
v_mfma_f32_16x16x32_bf16 v[44:47], a[48:51], a[84:87], v[44:47]
v_mfma_f32_16x16x32_bf16 v[48:51], a[52:55], a[72:75], v[48:51]
v_mfma_f32_16x16x32_bf16 v[52:55], a[52:55], a[76:79], v[52:55]
v_mfma_f32_16x16x32_bf16 v[56:59], a[52:55], a[80:83], v[56:59]
v_mfma_f32_16x16x32_bf16 v[60:63], a[52:55], a[84:87], v[60:63]
v_mfma_f32_16x16x32_bf16 v[64:67], a[56:59], a[72:75], v[64:67]
v_mfma_f32_16x16x32_bf16 v[68:71], a[56:59], a[76:79], v[68:71]
v_mfma_f32_16x16x32_bf16 v[72:75], a[56:59], a[80:83], v[72:75]
v_mfma_f32_16x16x32_bf16 v[76:79], a[56:59], a[84:87], v[76:79]
v_mfma_f32_16x16x32_bf16 v[80:83], a[60:63], a[72:75], v[80:83]
v_mfma_f32_16x16x32_bf16 v[84:87], a[60:63], a[76:79], v[84:87]
v_mfma_f32_16x16x32_bf16 v[88:91], a[60:63], a[80:83], v[88:91]
v_mfma_f32_16x16x32_bf16 v[92:95], a[60:63], a[84:87], v[92:95]
v_mfma_f32_16x16x32_bf16 v[96:99], a[64:67], a[72:75], v[96:99]
v_mfma_f32_16x16x32_bf16 v[100:103], a[64:67], a[76:79], v[100:103]
v_mfma_f32_16x16x32_bf16 v[104:107], a[64:67], a[80:83], v[104:107]
v_mfma_f32_16x16x32_bf16 v[108:111], a[64:67], a[84:87], v[108:111]
v_mfma_f32_16x16x32_bf16 v[112:115], a[68:71], a[72:75], v[112:115]
v_mfma_f32_16x16x32_bf16 v[116:119], a[68:71], a[76:79], v[116:119]
v_mfma_f32_16x16x32_bf16 v[120:123], a[68:71], a[80:83], v[120:123]
v_mfma_f32_16x16x32_bf16 v[124:127], a[68:71], a[84:87], v[124:127]
buffer_load_dwordx4 a[44:47], v2, s[12:15], s17 offen sc1
buffer_load_dwordx4 a[48:51], v3, s[12:15], s17 offen sc1
buffer_load_dwordx4 a[52:55], v4, s[12:15], s17 offen sc1
buffer_load_dwordx4 a[56:59], v5, s[12:15], s17 offen sc1
buffer_load_dwordx4 a[60:63], v6, s[12:15], s17 offen sc1
buffer_load_dwordx4 a[64:67], v7, s[12:15], s17 offen sc1
buffer_load_dwordx4 a[68:71], v8, s[12:15], s17 offen sc1
buffer_load_dwordx4 a[72:75], v2, s[12:15], s18 offen sc1
buffer_load_dwordx4 a[76:79], v3, s[12:15], s18 offen sc1
buffer_load_dwordx4 a[80:83], v4, s[12:15], s18 offen sc1
buffer_load_dwordx4 a[84:87], v5, s[12:15], s18 offen sc1
s_add_u32 s17, s17, 1024
s_add_u32 s18, s18, 1024
s_waitcnt vmcnt(44)
v_mfma_f32_16x16x32_bf16 v[16:19], a[88:91], a[116:119], v[16:19]
v_mfma_f32_16x16x32_bf16 v[20:23], a[88:91], a[120:123], v[20:23]
v_mfma_f32_16x16x32_bf16 v[24:27], a[88:91], a[124:127], v[24:27]
v_mfma_f32_16x16x32_bf16 v[28:31], a[88:91], a[128:131], v[28:31]
v_mfma_f32_16x16x32_bf16 v[32:35], a[92:95], a[116:119], v[32:35]
v_mfma_f32_16x16x32_bf16 v[36:39], a[92:95], a[120:123], v[36:39]
v_mfma_f32_16x16x32_bf16 v[40:43], a[92:95], a[124:127], v[40:43]
v_mfma_f32_16x16x32_bf16 v[44:47], a[92:95], a[128:131], v[44:47]
v_mfma_f32_16x16x32_bf16 v[48:51], a[96:99], a[116:119], v[48:51]
v_mfma_f32_16x16x32_bf16 v[52:55], a[96:99], a[120:123], v[52:55]
v_mfma_f32_16x16x32_bf16 v[56:59], a[96:99], a[124:127], v[56:59]
v_mfma_f32_16x16x32_bf16 v[60:63], a[96:99], a[128:131], v[60:63]
v_mfma_f32_16x16x32_bf16 v[64:67], a[100:103], a[116:119], v[64:67]
v_mfma_f32_16x16x32_bf16 v[68:71], a[100:103], a[120:123], v[68:71]
v_mfma_f32_16x16x32_bf16 v[72:75], a[100:103], a[124:127], v[72:75]
v_mfma_f32_16x16x32_bf16 v[76:79], a[100:103], a[128:131], v[76:79]
v_mfma_f32_16x16x32_bf16 v[80:83], a[104:107], a[116:119], v[80:83]
v_mfma_f32_16x16x32_bf16 v[84:87], a[104:107], a[120:123], v[84:87]
v_mfma_f32_16x16x32_bf16 v[88:91], a[104:107], a[124:127], v[88:91]
v_mfma_f32_16x16x32_bf16 v[92:95], a[104:107], a[128:131], v[92:95]
v_mfma_f32_16x16x32_bf16 v[96:99], a[108:111], a[116:119], v[96:99]
v_mfma_f32_16x16x32_bf16 v[100:103], a[108:111], a[120:123], v[100:103]
v_mfma_f32_16x16x32_bf16 v[104:107], a[108:111], a[124:127], v[104:107]
v_mfma_f32_16x16x32_bf16 v[108:111], a[108:111], a[128:131], v[108:111]
v_mfma_f32_16x16x32_bf16 v[112:115], a[112:115], a[116:119], v[112:115]
v_mfma_f32_16x16x32_bf16 v[116:119], a[112:115], a[120:123], v[116:119]
v_mfma_f32_16x16x32_bf16 v[120:123], a[112:115], a[124:127], v[120:123]
v_mfma_f32_16x16x32_bf16 v[124:127], a[112:115], a[128:131], v[124:127]
buffer_load_dwordx4 a[88:91], v2, s[12:15], s17 offen sc1
buffer_load_dwordx4 a[92:95], v3, s[12:15], s17 offen sc1
buffer_load_dwordx4 a[96:99], v4, s[12:15], s17 offen sc1
buffer_load_dwordx4 a[100:103], v5, s[12:15], s17 offen sc1
buffer_load_dwordx4 a[104:107], v6, s[12:15], s17 offen sc1
buffer_load_dwordx4 a[108:111], v7, s[12:15], s17 offen sc1
buffer_load_dwordx4 a[112:115], v8, s[12:15], s17 offen sc1
buffer_load_dwordx4 a[116:119], v2, s[12:15], s18 offen sc1
buffer_load_dwordx4 a[120:123], v3, s[12:15], s18 offen sc1
buffer_load_dwordx4 a[124:127], v4, s[12:15], s18 offen sc1
buffer_load_dwordx4 a[128:131], v5, s[12:15], s18 offen sc1
s_add_u32 s17, s17, 1024
s_add_u32 s18, s18, 1024
s_waitcnt vmcnt(44)
v_mfma_f32_16x16x32_bf16 v[16:19], a[132:135], a[160:163], v[16:19]
v_mfma_f32_16x16x32_bf16 v[20:23], a[132:135], a[164:167], v[20:23]
v_mfma_f32_16x16x32_bf16 v[24:27], a[132:135], a[168:171], v[24:27]
v_mfma_f32_16x16x32_bf16 v[28:31], a[132:135], a[172:175], v[28:31]
v_mfma_f32_16x16x32_bf16 v[32:35], a[136:139], a[160:163], v[32:35]
v_mfma_f32_16x16x32_bf16 v[36:39], a[136:139], a[164:167], v[36:39]
v_mfma_f32_16x16x32_bf16 v[40:43], a[136:139], a[168:171], v[40:43]
v_mfma_f32_16x16x32_bf16 v[44:47], a[136:139], a[172:175], v[44:47]
v_mfma_f32_16x16x32_bf16 v[48:51], a[140:143], a[160:163], v[48:51]
v_mfma_f32_16x16x32_bf16 v[52:55], a[140:143], a[164:167], v[52:55]
v_mfma_f32_16x16x32_bf16 v[56:59], a[140:143], a[168:171], v[56:59]
v_mfma_f32_16x16x32_bf16 v[60:63], a[140:143], a[172:175], v[60:63]
v_mfma_f32_16x16x32_bf16 v[64:67], a[144:147], a[160:163], v[64:67]
v_mfma_f32_16x16x32_bf16 v[68:71], a[144:147], a[164:167], v[68:71]
v_mfma_f32_16x16x32_bf16 v[72:75], a[144:147], a[168:171], v[72:75]
v_mfma_f32_16x16x32_bf16 v[76:79], a[144:147], a[172:175], v[76:79]
v_mfma_f32_16x16x32_bf16 v[80:83], a[148:151], a[160:163], v[80:83]
v_mfma_f32_16x16x32_bf16 v[84:87], a[148:151], a[164:167], v[84:87]
v_mfma_f32_16x16x32_bf16 v[88:91], a[148:151], a[168:171], v[88:91]
v_mfma_f32_16x16x32_bf16 v[92:95], a[148:151], a[172:175], v[92:95]
v_mfma_f32_16x16x32_bf16 v[96:99], a[152:155], a[160:163], v[96:99]
v_mfma_f32_16x16x32_bf16 v[100:103], a[152:155], a[164:167], v[100:103]
v_mfma_f32_16x16x32_bf16 v[104:107], a[152:155], a[168:171], v[104:107]
v_mfma_f32_16x16x32_bf16 v[108:111], a[152:155], a[172:175], v[108:111]
v_mfma_f32_16x16x32_bf16 v[112:115], a[156:159], a[160:163], v[112:115]
v_mfma_f32_16x16x32_bf16 v[116:119], a[156:159], a[164:167], v[116:119]
v_mfma_f32_16x16x32_bf16 v[120:123], a[156:159], a[168:171], v[120:123]
v_mfma_f32_16x16x32_bf16 v[124:127], a[156:159], a[172:175], v[124:127]
buffer_load_dwordx4 a[132:135], v2, s[12:15], s17 offen sc1
buffer_load_dwordx4 a[136:139], v3, s[12:15], s17 offen sc1
buffer_load_dwordx4 a[140:143], v4, s[12:15], s17 offen sc1
buffer_load_dwordx4 a[144:147], v5, s[12:15], s17 offen sc1
buffer_load_dwordx4 a[148:151], v6, s[12:15], s17 offen sc1
buffer_load_dwordx4 a[152:155], v7, s[12:15], s17 offen sc1
buffer_load_dwordx4 a[156:159], v8, s[12:15], s17 offen sc1
buffer_load_dwordx4 a[160:163], v2, s[12:15], s18 offen sc1
buffer_load_dwordx4 a[164:167], v3, s[12:15], s18 offen sc1
buffer_load_dwordx4 a[168:171], v4, s[12:15], s18 offen sc1
buffer_load_dwordx4 a[172:175], v5, s[12:15], s18 offen sc1
s_add_u32 s17, s17, 1024
s_add_u32 s18, s18, 1024
s_waitcnt vmcnt(44)
v_mfma_f32_16x16x32_bf16 v[16:19], a[176:179], a[204:207], v[16:19]
v_mfma_f32_16x16x32_bf16 v[20:23], a[176:179], a[208:211], v[20:23]
v_mfma_f32_16x16x32_bf16 v[24:27], a[176:179], a[212:215], v[24:27]
v_mfma_f32_16x16x32_bf16 v[28:31], a[176:179], a[216:219], v[28:31]
v_mfma_f32_16x16x32_bf16 v[32:35], a[180:183], a[204:207], v[32:35]
v_mfma_f32_16x16x32_bf16 v[36:39], a[180:183], a[208:211], v[36:39]
v_mfma_f32_16x16x32_bf16 v[40:43], a[180:183], a[212:215], v[40:43]
v_mfma_f32_16x16x32_bf16 v[44:47], a[180:183], a[216:219], v[44:47]
v_mfma_f32_16x16x32_bf16 v[48:51], a[184:187], a[204:207], v[48:51]
v_mfma_f32_16x16x32_bf16 v[52:55], a[184:187], a[208:211], v[52:55]
v_mfma_f32_16x16x32_bf16 v[56:59], a[184:187], a[212:215], v[56:59]
v_mfma_f32_16x16x32_bf16 v[60:63], a[184:187], a[216:219], v[60:63]
v_mfma_f32_16x16x32_bf16 v[64:67], a[188:191], a[204:207], v[64:67]
v_mfma_f32_16x16x32_bf16 v[68:71], a[188:191], a[208:211], v[68:71]
v_mfma_f32_16x16x32_bf16 v[72:75], a[188:191], a[212:215], v[72:75]
v_mfma_f32_16x16x32_bf16 v[76:79], a[188:191], a[216:219], v[76:79]
v_mfma_f32_16x16x32_bf16 v[80:83], a[192:195], a[204:207], v[80:83]
v_mfma_f32_16x16x32_bf16 v[84:87], a[192:195], a[208:211], v[84:87]
v_mfma_f32_16x16x32_bf16 v[88:91], a[192:195], a[212:215], v[88:91]
v_mfma_f32_16x16x32_bf16 v[92:95], a[192:195], a[216:219], v[92:95]
v_mfma_f32_16x16x32_bf16 v[96:99], a[196:199], a[204:207], v[96:99]
v_mfma_f32_16x16x32_bf16 v[100:103], a[196:199], a[208:211], v[100:103]
v_mfma_f32_16x16x32_bf16 v[104:107], a[196:199], a[212:215], v[104:107]
v_mfma_f32_16x16x32_bf16 v[108:111], a[196:199], a[216:219], v[108:111]
v_mfma_f32_16x16x32_bf16 v[112:115], a[200:203], a[204:207], v[112:115]
v_mfma_f32_16x16x32_bf16 v[116:119], a[200:203], a[208:211], v[116:119]
v_mfma_f32_16x16x32_bf16 v[120:123], a[200:203], a[212:215], v[120:123]
v_mfma_f32_16x16x32_bf16 v[124:127], a[200:203], a[216:219], v[124:127]
buffer_load_dwordx4 a[176:179], v2, s[12:15], s17 offen sc1
buffer_load_dwordx4 a[180:183], v3, s[12:15], s17 offen sc1
buffer_load_dwordx4 a[184:187], v4, s[12:15], s17 offen sc1
buffer_load_dwordx4 a[188:191], v5, s[12:15], s17 offen sc1
buffer_load_dwordx4 a[192:195], v6, s[12:15], s17 offen sc1
buffer_load_dwordx4 a[196:199], v7, s[12:15], s17 offen sc1
buffer_load_dwordx4 a[200:203], v8, s[12:15], s17 offen sc1
buffer_load_dwordx4 a[204:207], v2, s[12:15], s18 offen sc1
buffer_load_dwordx4 a[208:211], v3, s[12:15], s18 offen sc1
buffer_load_dwordx4 a[212:215], v4, s[12:15], s18 offen sc1
buffer_load_dwordx4 a[216:219], v5, s[12:15], s18 offen sc1
s_add_u32 s17, s17, 1024
s_add_u32 s18, s18, 1024
s_waitcnt vmcnt(44)
v_mfma_f32_16x16x32_bf16 v[16:19], a[0:3], a[28:31], v[16:19]
v_mfma_f32_16x16x32_bf16 v[20:23], a[0:3], a[32:35], v[20:23]
v_mfma_f32_16x16x32_bf16 v[24:27], a[0:3], a[36:39], v[24:27]
v_mfma_f32_16x16x32_bf16 v[28:31], a[0:3], a[40:43], v[28:31]
v_mfma_f32_16x16x32_bf16 v[32:35], a[4:7], a[28:31], v[32:35]
v_mfma_f32_16x16x32_bf16 v[36:39], a[4:7], a[32:35], v[36:39]
v_mfma_f32_16x16x32_bf16 v[40:43], a[4:7], a[36:39], v[40:43]
v_mfma_f32_16x16x32_bf16 v[44:47], a[4:7], a[40:43], v[44:47]
v_mfma_f32_16x16x32_bf16 v[48:51], a[8:11], a[28:31], v[48:51]
v_mfma_f32_16x16x32_bf16 v[52:55], a[8:11], a[32:35], v[52:55]
v_mfma_f32_16x16x32_bf16 v[56:59], a[8:11], a[36:39], v[56:59]
v_mfma_f32_16x16x32_bf16 v[60:63], a[8:11], a[40:43], v[60:63]
v_mfma_f32_16x16x32_bf16 v[64:67], a[12:15], a[28:31], v[64:67]
v_mfma_f32_16x16x32_bf16 v[68:71], a[12:15], a[32:35], v[68:71]
v_mfma_f32_16x16x32_bf16 v[72:75], a[12:15], a[36:39], v[72:75]
v_mfma_f32_16x16x32_bf16 v[76:79], a[12:15], a[40:43], v[76:79]
v_mfma_f32_16x16x32_bf16 v[80:83], a[16:19], a[28:31], v[80:83]
v_mfma_f32_16x16x32_bf16 v[84:87], a[16:19], a[32:35], v[84:87]
v_mfma_f32_16x16x32_bf16 v[88:91], a[16:19], a[36:39], v[88:91]
v_mfma_f32_16x16x32_bf16 v[92:95], a[16:19], a[40:43], v[92:95]
v_mfma_f32_16x16x32_bf16 v[96:99], a[20:23], a[28:31], v[96:99]
v_mfma_f32_16x16x32_bf16 v[100:103], a[20:23], a[32:35], v[100:103]
v_mfma_f32_16x16x32_bf16 v[104:107], a[20:23], a[36:39], v[104:107]
v_mfma_f32_16x16x32_bf16 v[108:111], a[20:23], a[40:43], v[108:111]
v_mfma_f32_16x16x32_bf16 v[112:115], a[24:27], a[28:31], v[112:115]
v_mfma_f32_16x16x32_bf16 v[116:119], a[24:27], a[32:35], v[116:119]
v_mfma_f32_16x16x32_bf16 v[120:123], a[24:27], a[36:39], v[120:123]
v_mfma_f32_16x16x32_bf16 v[124:127], a[24:27], a[40:43], v[124:127]
buffer_load_dwordx4 a[0:3], v2, s[12:15], s17 offen sc1
buffer_load_dwordx4 a[4:7], v3, s[12:15], s17 offen sc1
buffer_load_dwordx4 a[8:11], v4, s[12:15], s17 offen sc1
buffer_load_dwordx4 a[12:15], v5, s[12:15], s17 offen sc1
buffer_load_dwordx4 a[16:19], v6, s[12:15], s17 offen sc1
buffer_load_dwordx4 a[20:23], v7, s[12:15], s17 offen sc1
buffer_load_dwordx4 a[24:27], v8, s[12:15], s17 offen sc1
buffer_load_dwordx4 a[28:31], v2, s[12:15], s18 offen sc1
buffer_load_dwordx4 a[32:35], v3, s[12:15], s18 offen sc1
buffer_load_dwordx4 a[36:39], v4, s[12:15], s18 offen sc1
buffer_load_dwordx4 a[40:43], v5, s[12:15], s18 offen sc1
s_add_u32 s17, s17, 1024
s_add_u32 s18, s18, 1024
s_waitcnt vmcnt(44)
v_mfma_f32_16x16x32_bf16 v[16:19], a[44:47], a[72:75], v[16:19]
v_mfma_f32_16x16x32_bf16 v[20:23], a[44:47], a[76:79], v[20:23]
v_mfma_f32_16x16x32_bf16 v[24:27], a[44:47], a[80:83], v[24:27]
v_mfma_f32_16x16x32_bf16 v[28:31], a[44:47], a[84:87], v[28:31]
v_mfma_f32_16x16x32_bf16 v[32:35], a[48:51], a[72:75], v[32:35]
v_mfma_f32_16x16x32_bf16 v[36:39], a[48:51], a[76:79], v[36:39]
v_mfma_f32_16x16x32_bf16 v[40:43], a[48:51], a[80:83], v[40:43]
v_mfma_f32_16x16x32_bf16 v[44:47], a[48:51], a[84:87], v[44:47]
v_mfma_f32_16x16x32_bf16 v[48:51], a[52:55], a[72:75], v[48:51]
v_mfma_f32_16x16x32_bf16 v[52:55], a[52:55], a[76:79], v[52:55]
v_mfma_f32_16x16x32_bf16 v[56:59], a[52:55], a[80:83], v[56:59]
v_mfma_f32_16x16x32_bf16 v[60:63], a[52:55], a[84:87], v[60:63]
v_mfma_f32_16x16x32_bf16 v[64:67], a[56:59], a[72:75], v[64:67]
v_mfma_f32_16x16x32_bf16 v[68:71], a[56:59], a[76:79], v[68:71]
v_mfma_f32_16x16x32_bf16 v[72:75], a[56:59], a[80:83], v[72:75]
v_mfma_f32_16x16x32_bf16 v[76:79], a[56:59], a[84:87], v[76:79]
v_mfma_f32_16x16x32_bf16 v[80:83], a[60:63], a[72:75], v[80:83]
v_mfma_f32_16x16x32_bf16 v[84:87], a[60:63], a[76:79], v[84:87]
v_mfma_f32_16x16x32_bf16 v[88:91], a[60:63], a[80:83], v[88:91]
v_mfma_f32_16x16x32_bf16 v[92:95], a[60:63], a[84:87], v[92:95]
v_mfma_f32_16x16x32_bf16 v[96:99], a[64:67], a[72:75], v[96:99]
v_mfma_f32_16x16x32_bf16 v[100:103], a[64:67], a[76:79], v[100:103]
v_mfma_f32_16x16x32_bf16 v[104:107], a[64:67], a[80:83], v[104:107]
v_mfma_f32_16x16x32_bf16 v[108:111], a[64:67], a[84:87], v[108:111]
v_mfma_f32_16x16x32_bf16 v[112:115], a[68:71], a[72:75], v[112:115]
v_mfma_f32_16x16x32_bf16 v[116:119], a[68:71], a[76:79], v[116:119]
v_mfma_f32_16x16x32_bf16 v[120:123], a[68:71], a[80:83], v[120:123]
v_mfma_f32_16x16x32_bf16 v[124:127], a[68:71], a[84:87], v[124:127]
s_waitcnt vmcnt(33)
v_mfma_f32_16x16x32_bf16 v[16:19], a[88:91], a[116:119], v[16:19]
v_mfma_f32_16x16x32_bf16 v[20:23], a[88:91], a[120:123], v[20:23]
v_mfma_f32_16x16x32_bf16 v[24:27], a[88:91], a[124:127], v[24:27]
v_mfma_f32_16x16x32_bf16 v[28:31], a[88:91], a[128:131], v[28:31]
v_mfma_f32_16x16x32_bf16 v[32:35], a[92:95], a[116:119], v[32:35]
v_mfma_f32_16x16x32_bf16 v[36:39], a[92:95], a[120:123], v[36:39]
v_mfma_f32_16x16x32_bf16 v[40:43], a[92:95], a[124:127], v[40:43]
v_mfma_f32_16x16x32_bf16 v[44:47], a[92:95], a[128:131], v[44:47]
v_mfma_f32_16x16x32_bf16 v[48:51], a[96:99], a[116:119], v[48:51]
v_mfma_f32_16x16x32_bf16 v[52:55], a[96:99], a[120:123], v[52:55]
v_mfma_f32_16x16x32_bf16 v[56:59], a[96:99], a[124:127], v[56:59]
v_mfma_f32_16x16x32_bf16 v[60:63], a[96:99], a[128:131], v[60:63]
v_mfma_f32_16x16x32_bf16 v[64:67], a[100:103], a[116:119], v[64:67]
v_mfma_f32_16x16x32_bf16 v[68:71], a[100:103], a[120:123], v[68:71]
v_mfma_f32_16x16x32_bf16 v[72:75], a[100:103], a[124:127], v[72:75]
v_mfma_f32_16x16x32_bf16 v[76:79], a[100:103], a[128:131], v[76:79]
v_mfma_f32_16x16x32_bf16 v[80:83], a[104:107], a[116:119], v[80:83]
v_mfma_f32_16x16x32_bf16 v[84:87], a[104:107], a[120:123], v[84:87]
v_mfma_f32_16x16x32_bf16 v[88:91], a[104:107], a[124:127], v[88:91]
v_mfma_f32_16x16x32_bf16 v[92:95], a[104:107], a[128:131], v[92:95]
v_mfma_f32_16x16x32_bf16 v[96:99], a[108:111], a[116:119], v[96:99]
v_mfma_f32_16x16x32_bf16 v[100:103], a[108:111], a[120:123], v[100:103]
v_mfma_f32_16x16x32_bf16 v[104:107], a[108:111], a[124:127], v[104:107]
v_mfma_f32_16x16x32_bf16 v[108:111], a[108:111], a[128:131], v[108:111]
v_mfma_f32_16x16x32_bf16 v[112:115], a[112:115], a[116:119], v[112:115]
v_mfma_f32_16x16x32_bf16 v[116:119], a[112:115], a[120:123], v[116:119]
v_mfma_f32_16x16x32_bf16 v[120:123], a[112:115], a[124:127], v[120:123]
v_mfma_f32_16x16x32_bf16 v[124:127], a[112:115], a[128:131], v[124:127]
s_waitcnt vmcnt(22)
v_mfma_f32_16x16x32_bf16 v[16:19], a[132:135], a[160:163], v[16:19]
v_mfma_f32_16x16x32_bf16 v[20:23], a[132:135], a[164:167], v[20:23]
v_mfma_f32_16x16x32_bf16 v[24:27], a[132:135], a[168:171], v[24:27]
v_mfma_f32_16x16x32_bf16 v[28:31], a[132:135], a[172:175], v[28:31]
v_mfma_f32_16x16x32_bf16 v[32:35], a[136:139], a[160:163], v[32:35]
v_mfma_f32_16x16x32_bf16 v[36:39], a[136:139], a[164:167], v[36:39]
v_mfma_f32_16x16x32_bf16 v[40:43], a[136:139], a[168:171], v[40:43]
v_mfma_f32_16x16x32_bf16 v[44:47], a[136:139], a[172:175], v[44:47]
v_mfma_f32_16x16x32_bf16 v[48:51], a[140:143], a[160:163], v[48:51]
v_mfma_f32_16x16x32_bf16 v[52:55], a[140:143], a[164:167], v[52:55]
v_mfma_f32_16x16x32_bf16 v[56:59], a[140:143], a[168:171], v[56:59]
v_mfma_f32_16x16x32_bf16 v[60:63], a[140:143], a[172:175], v[60:63]
v_mfma_f32_16x16x32_bf16 v[64:67], a[144:147], a[160:163], v[64:67]
v_mfma_f32_16x16x32_bf16 v[68:71], a[144:147], a[164:167], v[68:71]
v_mfma_f32_16x16x32_bf16 v[72:75], a[144:147], a[168:171], v[72:75]
v_mfma_f32_16x16x32_bf16 v[76:79], a[144:147], a[172:175], v[76:79]
v_mfma_f32_16x16x32_bf16 v[80:83], a[148:151], a[160:163], v[80:83]
v_mfma_f32_16x16x32_bf16 v[84:87], a[148:151], a[164:167], v[84:87]
v_mfma_f32_16x16x32_bf16 v[88:91], a[148:151], a[168:171], v[88:91]
v_mfma_f32_16x16x32_bf16 v[92:95], a[148:151], a[172:175], v[92:95]
v_mfma_f32_16x16x32_bf16 v[96:99], a[152:155], a[160:163], v[96:99]
v_mfma_f32_16x16x32_bf16 v[100:103], a[152:155], a[164:167], v[100:103]
v_mfma_f32_16x16x32_bf16 v[104:107], a[152:155], a[168:171], v[104:107]
v_mfma_f32_16x16x32_bf16 v[108:111], a[152:155], a[172:175], v[108:111]
v_mfma_f32_16x16x32_bf16 v[112:115], a[156:159], a[160:163], v[112:115]
v_mfma_f32_16x16x32_bf16 v[116:119], a[156:159], a[164:167], v[116:119]
v_mfma_f32_16x16x32_bf16 v[120:123], a[156:159], a[168:171], v[120:123]
v_mfma_f32_16x16x32_bf16 v[124:127], a[156:159], a[172:175], v[124:127]
s_waitcnt vmcnt(11)
v_mfma_f32_16x16x32_bf16 v[16:19], a[176:179], a[204:207], v[16:19]
v_mfma_f32_16x16x32_bf16 v[20:23], a[176:179], a[208:211], v[20:23]
v_mfma_f32_16x16x32_bf16 v[24:27], a[176:179], a[212:215], v[24:27]
v_mfma_f32_16x16x32_bf16 v[28:31], a[176:179], a[216:219], v[28:31]
v_mfma_f32_16x16x32_bf16 v[32:35], a[180:183], a[204:207], v[32:35]
v_mfma_f32_16x16x32_bf16 v[36:39], a[180:183], a[208:211], v[36:39]
v_mfma_f32_16x16x32_bf16 v[40:43], a[180:183], a[212:215], v[40:43]
v_mfma_f32_16x16x32_bf16 v[44:47], a[180:183], a[216:219], v[44:47]
v_mfma_f32_16x16x32_bf16 v[48:51], a[184:187], a[204:207], v[48:51]
v_mfma_f32_16x16x32_bf16 v[52:55], a[184:187], a[208:211], v[52:55]
v_mfma_f32_16x16x32_bf16 v[56:59], a[184:187], a[212:215], v[56:59]
v_mfma_f32_16x16x32_bf16 v[60:63], a[184:187], a[216:219], v[60:63]
v_mfma_f32_16x16x32_bf16 v[64:67], a[188:191], a[204:207], v[64:67]
v_mfma_f32_16x16x32_bf16 v[68:71], a[188:191], a[208:211], v[68:71]
v_mfma_f32_16x16x32_bf16 v[72:75], a[188:191], a[212:215], v[72:75]
v_mfma_f32_16x16x32_bf16 v[76:79], a[188:191], a[216:219], v[76:79]
v_mfma_f32_16x16x32_bf16 v[80:83], a[192:195], a[204:207], v[80:83]
v_mfma_f32_16x16x32_bf16 v[84:87], a[192:195], a[208:211], v[84:87]
v_mfma_f32_16x16x32_bf16 v[88:91], a[192:195], a[212:215], v[88:91]
v_mfma_f32_16x16x32_bf16 v[92:95], a[192:195], a[216:219], v[92:95]
v_mfma_f32_16x16x32_bf16 v[96:99], a[196:199], a[204:207], v[96:99]
v_mfma_f32_16x16x32_bf16 v[100:103], a[196:199], a[208:211], v[100:103]
v_mfma_f32_16x16x32_bf16 v[104:107], a[196:199], a[212:215], v[104:107]
v_mfma_f32_16x16x32_bf16 v[108:111], a[196:199], a[216:219], v[108:111]
v_mfma_f32_16x16x32_bf16 v[112:115], a[200:203], a[204:207], v[112:115]
v_mfma_f32_16x16x32_bf16 v[116:119], a[200:203], a[208:211], v[116:119]
v_mfma_f32_16x16x32_bf16 v[120:123], a[200:203], a[212:215], v[120:123]
v_mfma_f32_16x16x32_bf16 v[124:127], a[200:203], a[216:219], v[124:127]
s_waitcnt vmcnt(0)
v_mfma_f32_16x16x32_bf16 v[16:19], a[0:3], a[28:31], v[16:19]
v_mfma_f32_16x16x32_bf16 v[20:23], a[0:3], a[32:35], v[20:23]
v_mfma_f32_16x16x32_bf16 v[24:27], a[0:3], a[36:39], v[24:27]
v_mfma_f32_16x16x32_bf16 v[28:31], a[0:3], a[40:43], v[28:31]
v_mfma_f32_16x16x32_bf16 v[32:35], a[4:7], a[28:31], v[32:35]
v_mfma_f32_16x16x32_bf16 v[36:39], a[4:7], a[32:35], v[36:39]
v_mfma_f32_16x16x32_bf16 v[40:43], a[4:7], a[36:39], v[40:43]
v_mfma_f32_16x16x32_bf16 v[44:47], a[4:7], a[40:43], v[44:47]
v_mfma_f32_16x16x32_bf16 v[48:51], a[8:11], a[28:31], v[48:51]
v_mfma_f32_16x16x32_bf16 v[52:55], a[8:11], a[32:35], v[52:55]
v_mfma_f32_16x16x32_bf16 v[56:59], a[8:11], a[36:39], v[56:59]
v_mfma_f32_16x16x32_bf16 v[60:63], a[8:11], a[40:43], v[60:63]
v_mfma_f32_16x16x32_bf16 v[64:67], a[12:15], a[28:31], v[64:67]
v_mfma_f32_16x16x32_bf16 v[68:71], a[12:15], a[32:35], v[68:71]
v_mfma_f32_16x16x32_bf16 v[72:75], a[12:15], a[36:39], v[72:75]
v_mfma_f32_16x16x32_bf16 v[76:79], a[12:15], a[40:43], v[76:79]
v_mfma_f32_16x16x32_bf16 v[80:83], a[16:19], a[28:31], v[80:83]
v_mfma_f32_16x16x32_bf16 v[84:87], a[16:19], a[32:35], v[84:87]
v_mfma_f32_16x16x32_bf16 v[88:91], a[16:19], a[36:39], v[88:91]
v_mfma_f32_16x16x32_bf16 v[92:95], a[16:19], a[40:43], v[92:95]
v_mfma_f32_16x16x32_bf16 v[96:99], a[20:23], a[28:31], v[96:99]
v_mfma_f32_16x16x32_bf16 v[100:103], a[20:23], a[32:35], v[100:103]
v_mfma_f32_16x16x32_bf16 v[104:107], a[20:23], a[36:39], v[104:107]
v_mfma_f32_16x16x32_bf16 v[108:111], a[20:23], a[40:43], v[108:111]
v_mfma_f32_16x16x32_bf16 v[112:115], a[24:27], a[28:31], v[112:115]
v_mfma_f32_16x16x32_bf16 v[116:119], a[24:27], a[32:35], v[116:119]
v_mfma_f32_16x16x32_bf16 v[120:123], a[24:27], a[36:39], v[120:123]
v_mfma_f32_16x16x32_bf16 v[124:127], a[24:27], a[40:43], v[124:127]
s_nop 7
v_lshrrev_b32 v10, 4, v1
v_and_b32 v11, 15, v10
v_lshrrev_b32 v10, 4, v10
s_lshl_b32 s19, s23, 6
v_add_u32 v11, s19, v11
v_mul_u32_u24 v11, 1792, v11
v_lshl_add_u32 v11, v10, 3, v11
s_mul_i32 s19, s16, 224
s_add_u32 s19, s19, 896
s_add_u32 s20, s19, 0
v_cvt_pk_bf16_f32 v128, v16, v17
v_cvt_pk_bf16_f32 v129, v18, v19
buffer_store_dwordx2 v[128:129], v11, s[8:11], s20 offen offset:0
v_cvt_pk_bf16_f32 v130, v32, v33
v_cvt_pk_bf16_f32 v131, v34, v35
buffer_store_dwordx2 v[130:131], v11, s[8:11], s20 offen offset:32
v_cvt_pk_bf16_f32 v132, v48, v49
v_cvt_pk_bf16_f32 v133, v50, v51
buffer_store_dwordx2 v[132:133], v11, s[8:11], s20 offen offset:64
v_cvt_pk_bf16_f32 v134, v64, v65
v_cvt_pk_bf16_f32 v135, v66, v67
buffer_store_dwordx2 v[134:135], v11, s[8:11], s20 offen offset:96
v_cvt_pk_bf16_f32 v136, v80, v81
v_cvt_pk_bf16_f32 v137, v82, v83
buffer_store_dwordx2 v[136:137], v11, s[8:11], s20 offen offset:128
v_cvt_pk_bf16_f32 v138, v96, v97
v_cvt_pk_bf16_f32 v139, v98, v99
buffer_store_dwordx2 v[138:139], v11, s[8:11], s20 offen offset:160
v_cvt_pk_bf16_f32 v140, v112, v113
v_cvt_pk_bf16_f32 v141, v114, v115
buffer_store_dwordx2 v[140:141], v11, s[8:11], s20 offen offset:192
s_add_u32 s20, s19, 28672
v_cvt_pk_bf16_f32 v142, v20, v21
v_cvt_pk_bf16_f32 v143, v22, v23
buffer_store_dwordx2 v[142:143], v11, s[8:11], s20 offen offset:0
v_cvt_pk_bf16_f32 v128, v36, v37
v_cvt_pk_bf16_f32 v129, v38, v39
buffer_store_dwordx2 v[128:129], v11, s[8:11], s20 offen offset:32
v_cvt_pk_bf16_f32 v130, v52, v53
v_cvt_pk_bf16_f32 v131, v54, v55
buffer_store_dwordx2 v[130:131], v11, s[8:11], s20 offen offset:64
v_cvt_pk_bf16_f32 v132, v68, v69
v_cvt_pk_bf16_f32 v133, v70, v71
buffer_store_dwordx2 v[132:133], v11, s[8:11], s20 offen offset:96
v_cvt_pk_bf16_f32 v134, v84, v85
v_cvt_pk_bf16_f32 v135, v86, v87
buffer_store_dwordx2 v[134:135], v11, s[8:11], s20 offen offset:128
v_cvt_pk_bf16_f32 v136, v100, v101
v_cvt_pk_bf16_f32 v137, v102, v103
buffer_store_dwordx2 v[136:137], v11, s[8:11], s20 offen offset:160
v_cvt_pk_bf16_f32 v138, v116, v117
v_cvt_pk_bf16_f32 v139, v118, v119
buffer_store_dwordx2 v[138:139], v11, s[8:11], s20 offen offset:192
s_add_u32 s20, s19, 57344
v_cvt_pk_bf16_f32 v140, v24, v25
v_cvt_pk_bf16_f32 v141, v26, v27
buffer_store_dwordx2 v[140:141], v11, s[8:11], s20 offen offset:0
v_cvt_pk_bf16_f32 v142, v40, v41
v_cvt_pk_bf16_f32 v143, v42, v43
buffer_store_dwordx2 v[142:143], v11, s[8:11], s20 offen offset:32
v_cvt_pk_bf16_f32 v128, v56, v57
v_cvt_pk_bf16_f32 v129, v58, v59
buffer_store_dwordx2 v[128:129], v11, s[8:11], s20 offen offset:64
v_cvt_pk_bf16_f32 v130, v72, v73
v_cvt_pk_bf16_f32 v131, v74, v75
buffer_store_dwordx2 v[130:131], v11, s[8:11], s20 offen offset:96
v_cvt_pk_bf16_f32 v132, v88, v89
v_cvt_pk_bf16_f32 v133, v90, v91
buffer_store_dwordx2 v[132:133], v11, s[8:11], s20 offen offset:128
v_cvt_pk_bf16_f32 v134, v104, v105
v_cvt_pk_bf16_f32 v135, v106, v107
buffer_store_dwordx2 v[134:135], v11, s[8:11], s20 offen offset:160
v_cvt_pk_bf16_f32 v136, v120, v121
v_cvt_pk_bf16_f32 v137, v122, v123
buffer_store_dwordx2 v[136:137], v11, s[8:11], s20 offen offset:192
s_add_u32 s20, s19, 86016
v_cvt_pk_bf16_f32 v138, v28, v29
v_cvt_pk_bf16_f32 v139, v30, v31
buffer_store_dwordx2 v[138:139], v11, s[8:11], s20 offen offset:0
v_cvt_pk_bf16_f32 v140, v44, v45
v_cvt_pk_bf16_f32 v141, v46, v47
buffer_store_dwordx2 v[140:141], v11, s[8:11], s20 offen offset:32
v_cvt_pk_bf16_f32 v142, v60, v61
v_cvt_pk_bf16_f32 v143, v62, v63
buffer_store_dwordx2 v[142:143], v11, s[8:11], s20 offen offset:64
v_cvt_pk_bf16_f32 v128, v76, v77
v_cvt_pk_bf16_f32 v129, v78, v79
buffer_store_dwordx2 v[128:129], v11, s[8:11], s20 offen offset:96
v_cvt_pk_bf16_f32 v130, v92, v93
v_cvt_pk_bf16_f32 v131, v94, v95
buffer_store_dwordx2 v[130:131], v11, s[8:11], s20 offen offset:128
v_cvt_pk_bf16_f32 v132, v108, v109
v_cvt_pk_bf16_f32 v133, v110, v111
buffer_store_dwordx2 v[132:133], v11, s[8:11], s20 offen offset:160
v_cvt_pk_bf16_f32 v134, v124, v125
v_cvt_pk_bf16_f32 v135, v126, v127
buffer_store_dwordx2 v[134:135], v11, s[8:11], s20 offen offset:192
L_k3_done:
L_f_end:
s_endpgm
L_k2_mask0_0:
s_lshl_b32 s63, s27, 5
s_sub_u32 s63, s66, s63
v_add_u32 v76, s63, v7
v_add_u32 v77, s63, v8
v_mov_b32 v78, 0xff800000
s_nop 4
v_cmp_gt_i32 s[72:73], 0, v76
v_cmp_gt_i32 s[74:75], 1, v76
v_cmp_gt_i32 s[76:77], 2, v76
v_cmp_gt_i32 s[78:79], 3, v76
s_nop 0
v_cndmask_b32 v32, v32, v78, s[72:73]
v_cndmask_b32 v33, v33, v78, s[74:75]
v_cndmask_b32 v34, v34, v78, s[76:77]
v_cndmask_b32 v35, v35, v78, s[78:79]
v_cmp_gt_i32 s[72:73], 16, v76
v_cmp_gt_i32 s[74:75], 17, v76
v_cmp_gt_i32 s[76:77], 18, v76
v_cmp_gt_i32 s[78:79], 19, v76
v_cndmask_b32 v40, v40, v78, s[72:73]
v_cndmask_b32 v41, v41, v78, s[74:75]
v_cndmask_b32 v42, v42, v78, s[76:77]
v_cndmask_b32 v43, v43, v78, s[78:79]
v_cmp_gt_i32 s[72:73], 0, v77
v_cmp_gt_i32 s[74:75], 1, v77
v_cmp_gt_i32 s[76:77], 2, v77
v_cmp_gt_i32 s[78:79], 3, v77
v_cndmask_b32 v36, v36, v78, s[72:73]
v_cndmask_b32 v37, v37, v78, s[74:75]
v_cndmask_b32 v38, v38, v78, s[76:77]
v_cndmask_b32 v39, v39, v78, s[78:79]
v_cmp_gt_i32 s[72:73], 16, v77
v_cmp_gt_i32 s[74:75], 17, v77
v_cmp_gt_i32 s[76:77], 18, v77
v_cmp_gt_i32 s[78:79], 19, v77
v_cndmask_b32 v44, v44, v78, s[72:73]
v_cndmask_b32 v45, v45, v78, s[74:75]
v_cndmask_b32 v46, v46, v78, s[76:77]
v_cndmask_b32 v47, v47, v78, s[78:79]
s_nop 0
s_branch L_k2_maskret0_0
L_k2_resc0_0:
s_nop 7
s_nop 1
v_max3_f32 v76, v32, v33, v34
v_max3_f32 v77, v35, v40, v41
v_max3_f32 v76, v76, v42, v43
v_max_f32 v76, v76, v77
v_mov_b32 v77, v76
s_nop 1
v_permlane32_swap_b32 v76, v77
s_nop 1
v_max_f32 v76, v76, v77
v_mov_b32 v77, v76
s_nop 1
v_permlane16_swap_b32 v76, v77
s_nop 1
v_max_f32 v76, v76, v77
v_max_f32 v76, 0, v76
v_exp_f32 v78, -v76
v_sub_f32 v32, v32, v76
v_sub_f32 v33, v33, v76
v_sub_f32 v34, v34, v76
v_sub_f32 v35, v35, v76
v_sub_f32 v40, v40, v76
v_sub_f32 v41, v41, v76
v_sub_f32 v42, v42, v76
v_sub_f32 v43, v43, v76
v_sub_f32 v56, v56, v76
v_sub_f32 v57, v57, v76
v_sub_f32 v58, v58, v76
v_sub_f32 v59, v59, v76
v_mul_f32 v64, v64, v78
v_mul_f32 v65, v65, v78
v_mul_f32 v66, v66, v78
v_mul_f32 v67, v67, v78
v_mul_f32 v128, v128, v78
v_mul_f32 v129, v129, v78
v_mul_f32 v130, v130, v78
v_mul_f32 v131, v131, v78
v_mul_f32 v136, v136, v78
v_mul_f32 v137, v137, v78
v_mul_f32 v138, v138, v78
v_mul_f32 v139, v139, v78
v_mul_f32 v144, v144, v78
v_mul_f32 v145, v145, v78
v_mul_f32 v146, v146, v78
v_mul_f32 v147, v147, v78
v_mul_f32 v152, v152, v78
v_mul_f32 v153, v153, v78
v_mul_f32 v154, v154, v78
v_mul_f32 v155, v155, v78
v_mul_f32 v160, v160, v78
v_mul_f32 v161, v161, v78
v_mul_f32 v162, v162, v78
v_mul_f32 v163, v163, v78
v_mul_f32 v168, v168, v78
v_mul_f32 v169, v169, v78
v_mul_f32 v170, v170, v78
v_mul_f32 v171, v171, v78
v_mul_f32 v176, v176, v78
v_mul_f32 v177, v177, v78
v_mul_f32 v178, v178, v78
v_mul_f32 v179, v179, v78
v_mul_f32 v184, v184, v78
v_mul_f32 v185, v185, v78
v_mul_f32 v186, v186, v78
v_mul_f32 v187, v187, v78
v_mul_f32 v192, v192, v78
v_mul_f32 v193, v193, v78
v_mul_f32 v194, v194, v78
v_mul_f32 v195, v195, v78
v_mul_f32 v200, v200, v78
v_mul_f32 v201, v201, v78
v_mul_f32 v202, v202, v78
v_mul_f32 v203, v203, v78
v_mul_f32 v208, v208, v78
v_mul_f32 v209, v209, v78
v_mul_f32 v210, v210, v78
v_mul_f32 v211, v211, v78
v_mul_f32 v216, v216, v78
v_mul_f32 v217, v217, v78
v_mul_f32 v218, v218, v78
v_mul_f32 v219, v219, v78
v_mul_f32 v224, v224, v78
v_mul_f32 v225, v225, v78
v_mul_f32 v226, v226, v78
v_mul_f32 v227, v227, v78
v_mul_f32 v232, v232, v78
v_mul_f32 v233, v233, v78
v_mul_f32 v234, v234, v78
v_mul_f32 v235, v235, v78
v_mul_f32 v240, v240, v78
v_mul_f32 v241, v241, v78
v_mul_f32 v242, v242, v78
v_mul_f32 v243, v243, v78
v_mul_f32 v248, v248, v78
v_mul_f32 v249, v249, v78
v_mul_f32 v250, v250, v78
v_mul_f32 v251, v251, v78
v_max3_f32 v76, v36, v37, v38
v_max3_f32 v77, v39, v44, v45
v_max3_f32 v76, v76, v46, v47
v_max_f32 v76, v76, v77
v_mov_b32 v77, v76
s_nop 1
v_permlane32_swap_b32 v76, v77
s_nop 1
v_max_f32 v76, v76, v77
v_mov_b32 v77, v76
s_nop 1
v_permlane16_swap_b32 v76, v77
s_nop 1
v_max_f32 v76, v76, v77
v_max_f32 v76, 0, v76
v_exp_f32 v78, -v76
v_sub_f32 v36, v36, v76
v_sub_f32 v37, v37, v76
v_sub_f32 v38, v38, v76
v_sub_f32 v39, v39, v76
v_sub_f32 v44, v44, v76
v_sub_f32 v45, v45, v76
v_sub_f32 v46, v46, v76
v_sub_f32 v47, v47, v76
v_sub_f32 v60, v60, v76
v_sub_f32 v61, v61, v76
v_sub_f32 v62, v62, v76
v_sub_f32 v63, v63, v76
v_mul_f32 v68, v68, v78
v_mul_f32 v69, v69, v78
v_mul_f32 v70, v70, v78
v_mul_f32 v71, v71, v78
v_mul_f32 v132, v132, v78
v_mul_f32 v133, v133, v78
v_mul_f32 v134, v134, v78
v_mul_f32 v135, v135, v78
v_mul_f32 v140, v140, v78
v_mul_f32 v141, v141, v78
v_mul_f32 v142, v142, v78
v_mul_f32 v143, v143, v78
v_mul_f32 v148, v148, v78
v_mul_f32 v149, v149, v78
v_mul_f32 v150, v150, v78
v_mul_f32 v151, v151, v78
v_mul_f32 v156, v156, v78
v_mul_f32 v157, v157, v78
v_mul_f32 v158, v158, v78
v_mul_f32 v159, v159, v78
v_mul_f32 v164, v164, v78
v_mul_f32 v165, v165, v78
v_mul_f32 v166, v166, v78
v_mul_f32 v167, v167, v78
v_mul_f32 v172, v172, v78
v_mul_f32 v173, v173, v78
v_mul_f32 v174, v174, v78
v_mul_f32 v175, v175, v78
v_mul_f32 v180, v180, v78
v_mul_f32 v181, v181, v78
v_mul_f32 v182, v182, v78
v_mul_f32 v183, v183, v78
v_mul_f32 v188, v188, v78
v_mul_f32 v189, v189, v78
v_mul_f32 v190, v190, v78
v_mul_f32 v191, v191, v78
v_mul_f32 v196, v196, v78
v_mul_f32 v197, v197, v78
v_mul_f32 v198, v198, v78
v_mul_f32 v199, v199, v78
v_mul_f32 v204, v204, v78
v_mul_f32 v205, v205, v78
v_mul_f32 v206, v206, v78
v_mul_f32 v207, v207, v78
v_mul_f32 v212, v212, v78
v_mul_f32 v213, v213, v78
v_mul_f32 v214, v214, v78
v_mul_f32 v215, v215, v78
v_mul_f32 v220, v220, v78
v_mul_f32 v221, v221, v78
v_mul_f32 v222, v222, v78
v_mul_f32 v223, v223, v78
v_mul_f32 v228, v228, v78
v_mul_f32 v229, v229, v78
v_mul_f32 v230, v230, v78
v_mul_f32 v231, v231, v78
v_mul_f32 v236, v236, v78
v_mul_f32 v237, v237, v78
v_mul_f32 v238, v238, v78
v_mul_f32 v239, v239, v78
v_mul_f32 v244, v244, v78
v_mul_f32 v245, v245, v78
v_mul_f32 v246, v246, v78
v_mul_f32 v247, v247, v78
v_mul_f32 v252, v252, v78
v_mul_f32 v253, v253, v78
v_mul_f32 v254, v254, v78
v_mul_f32 v255, v255, v78
s_nop 1
s_branch L_k2_rescret0_0
L_k2_mask1_0:
s_lshl_b32 s63, s27, 5
s_sub_u32 s63, s66, s63
v_add_u32 v76, s63, v7
v_add_u32 v77, s63, v8
v_mov_b32 v78, 0xff800000
s_nop 4
v_cmp_gt_i32 s[72:73], 0, v76
v_cmp_gt_i32 s[74:75], 1, v76
v_cmp_gt_i32 s[76:77], 2, v76
v_cmp_gt_i32 s[78:79], 3, v76
s_nop 0
v_cndmask_b32 v16, v16, v78, s[72:73]
v_cndmask_b32 v17, v17, v78, s[74:75]
v_cndmask_b32 v18, v18, v78, s[76:77]
v_cndmask_b32 v19, v19, v78, s[78:79]
v_cmp_gt_i32 s[72:73], 16, v76
v_cmp_gt_i32 s[74:75], 17, v76
v_cmp_gt_i32 s[76:77], 18, v76
v_cmp_gt_i32 s[78:79], 19, v76
v_cndmask_b32 v24, v24, v78, s[72:73]
v_cndmask_b32 v25, v25, v78, s[74:75]
v_cndmask_b32 v26, v26, v78, s[76:77]
v_cndmask_b32 v27, v27, v78, s[78:79]
v_cmp_gt_i32 s[72:73], 0, v77
v_cmp_gt_i32 s[74:75], 1, v77
v_cmp_gt_i32 s[76:77], 2, v77
v_cmp_gt_i32 s[78:79], 3, v77
v_cndmask_b32 v20, v20, v78, s[72:73]
v_cndmask_b32 v21, v21, v78, s[74:75]
v_cndmask_b32 v22, v22, v78, s[76:77]
v_cndmask_b32 v23, v23, v78, s[78:79]
v_cmp_gt_i32 s[72:73], 16, v77
v_cmp_gt_i32 s[74:75], 17, v77
v_cmp_gt_i32 s[76:77], 18, v77
v_cmp_gt_i32 s[78:79], 19, v77
v_cndmask_b32 v28, v28, v78, s[72:73]
v_cndmask_b32 v29, v29, v78, s[74:75]
v_cndmask_b32 v30, v30, v78, s[76:77]
v_cndmask_b32 v31, v31, v78, s[78:79]
s_nop 0
s_branch L_k2_maskret1_0
L_k2_resc1_0:
s_nop 7
s_nop 1
v_max3_f32 v76, v16, v17, v18
v_max3_f32 v77, v19, v24, v25
v_max3_f32 v76, v76, v26, v27
v_max_f32 v76, v76, v77
v_mov_b32 v77, v76
s_nop 1
v_permlane32_swap_b32 v76, v77
s_nop 1
v_max_f32 v76, v76, v77
v_mov_b32 v77, v76
s_nop 1
v_permlane16_swap_b32 v76, v77
s_nop 1
v_max_f32 v76, v76, v77
v_max_f32 v76, 0, v76
v_exp_f32 v78, -v76
v_sub_f32 v16, v16, v76
v_sub_f32 v17, v17, v76
v_sub_f32 v18, v18, v76
v_sub_f32 v19, v19, v76
v_sub_f32 v24, v24, v76
v_sub_f32 v25, v25, v76
v_sub_f32 v26, v26, v76
v_sub_f32 v27, v27, v76
v_sub_f32 v56, v56, v76
v_sub_f32 v57, v57, v76
v_sub_f32 v58, v58, v76
v_sub_f32 v59, v59, v76
v_mul_f32 v64, v64, v78
v_mul_f32 v65, v65, v78
v_mul_f32 v66, v66, v78
v_mul_f32 v67, v67, v78
v_mul_f32 v128, v128, v78
v_mul_f32 v129, v129, v78
v_mul_f32 v130, v130, v78
v_mul_f32 v131, v131, v78
v_mul_f32 v136, v136, v78
v_mul_f32 v137, v137, v78
v_mul_f32 v138, v138, v78
v_mul_f32 v139, v139, v78
v_mul_f32 v144, v144, v78
v_mul_f32 v145, v145, v78
v_mul_f32 v146, v146, v78
v_mul_f32 v147, v147, v78
v_mul_f32 v152, v152, v78
v_mul_f32 v153, v153, v78
v_mul_f32 v154, v154, v78
v_mul_f32 v155, v155, v78
v_mul_f32 v160, v160, v78
v_mul_f32 v161, v161, v78
v_mul_f32 v162, v162, v78
v_mul_f32 v163, v163, v78
v_mul_f32 v168, v168, v78
v_mul_f32 v169, v169, v78
v_mul_f32 v170, v170, v78
v_mul_f32 v171, v171, v78
v_mul_f32 v176, v176, v78
v_mul_f32 v177, v177, v78
v_mul_f32 v178, v178, v78
v_mul_f32 v179, v179, v78
v_mul_f32 v184, v184, v78
v_mul_f32 v185, v185, v78
v_mul_f32 v186, v186, v78
v_mul_f32 v187, v187, v78
v_mul_f32 v192, v192, v78
v_mul_f32 v193, v193, v78
v_mul_f32 v194, v194, v78
v_mul_f32 v195, v195, v78
v_mul_f32 v200, v200, v78
v_mul_f32 v201, v201, v78
v_mul_f32 v202, v202, v78
v_mul_f32 v203, v203, v78
v_mul_f32 v208, v208, v78
v_mul_f32 v209, v209, v78
v_mul_f32 v210, v210, v78
v_mul_f32 v211, v211, v78
v_mul_f32 v216, v216, v78
v_mul_f32 v217, v217, v78
v_mul_f32 v218, v218, v78
v_mul_f32 v219, v219, v78
v_mul_f32 v224, v224, v78
v_mul_f32 v225, v225, v78
v_mul_f32 v226, v226, v78
v_mul_f32 v227, v227, v78
v_mul_f32 v232, v232, v78
v_mul_f32 v233, v233, v78
v_mul_f32 v234, v234, v78
v_mul_f32 v235, v235, v78
v_mul_f32 v240, v240, v78
v_mul_f32 v241, v241, v78
v_mul_f32 v242, v242, v78
v_mul_f32 v243, v243, v78
v_mul_f32 v248, v248, v78
v_mul_f32 v249, v249, v78
v_mul_f32 v250, v250, v78
v_mul_f32 v251, v251, v78
v_max3_f32 v76, v20, v21, v22
v_max3_f32 v77, v23, v28, v29
v_max3_f32 v76, v76, v30, v31
v_max_f32 v76, v76, v77
v_mov_b32 v77, v76
s_nop 1
v_permlane32_swap_b32 v76, v77
s_nop 1
v_max_f32 v76, v76, v77
v_mov_b32 v77, v76
s_nop 1
v_permlane16_swap_b32 v76, v77
s_nop 1
v_max_f32 v76, v76, v77
v_max_f32 v76, 0, v76
v_exp_f32 v78, -v76
v_sub_f32 v20, v20, v76
v_sub_f32 v21, v21, v76
v_sub_f32 v22, v22, v76
v_sub_f32 v23, v23, v76
v_sub_f32 v28, v28, v76
v_sub_f32 v29, v29, v76
v_sub_f32 v30, v30, v76
v_sub_f32 v31, v31, v76
v_sub_f32 v60, v60, v76
v_sub_f32 v61, v61, v76
v_sub_f32 v62, v62, v76
v_sub_f32 v63, v63, v76
v_mul_f32 v68, v68, v78
v_mul_f32 v69, v69, v78
v_mul_f32 v70, v70, v78
v_mul_f32 v71, v71, v78
v_mul_f32 v132, v132, v78
v_mul_f32 v133, v133, v78
v_mul_f32 v134, v134, v78
v_mul_f32 v135, v135, v78
v_mul_f32 v140, v140, v78
v_mul_f32 v141, v141, v78
v_mul_f32 v142, v142, v78
v_mul_f32 v143, v143, v78
v_mul_f32 v148, v148, v78
v_mul_f32 v149, v149, v78
v_mul_f32 v150, v150, v78
v_mul_f32 v151, v151, v78
v_mul_f32 v156, v156, v78
v_mul_f32 v157, v157, v78
v_mul_f32 v158, v158, v78
v_mul_f32 v159, v159, v78
v_mul_f32 v164, v164, v78
v_mul_f32 v165, v165, v78
v_mul_f32 v166, v166, v78
v_mul_f32 v167, v167, v78
v_mul_f32 v172, v172, v78
v_mul_f32 v173, v173, v78
v_mul_f32 v174, v174, v78
v_mul_f32 v175, v175, v78
v_mul_f32 v180, v180, v78
v_mul_f32 v181, v181, v78
v_mul_f32 v182, v182, v78
v_mul_f32 v183, v183, v78
v_mul_f32 v188, v188, v78
v_mul_f32 v189, v189, v78
v_mul_f32 v190, v190, v78
v_mul_f32 v191, v191, v78
v_mul_f32 v196, v196, v78
v_mul_f32 v197, v197, v78
v_mul_f32 v198, v198, v78
v_mul_f32 v199, v199, v78
v_mul_f32 v204, v204, v78
v_mul_f32 v205, v205, v78
v_mul_f32 v206, v206, v78
v_mul_f32 v207, v207, v78
v_mul_f32 v212, v212, v78
v_mul_f32 v213, v213, v78
v_mul_f32 v214, v214, v78
v_mul_f32 v215, v215, v78
v_mul_f32 v220, v220, v78
v_mul_f32 v221, v221, v78
v_mul_f32 v222, v222, v78
v_mul_f32 v223, v223, v78
v_mul_f32 v228, v228, v78
v_mul_f32 v229, v229, v78
v_mul_f32 v230, v230, v78
v_mul_f32 v231, v231, v78
v_mul_f32 v236, v236, v78
v_mul_f32 v237, v237, v78
v_mul_f32 v238, v238, v78
v_mul_f32 v239, v239, v78
v_mul_f32 v244, v244, v78
v_mul_f32 v245, v245, v78
v_mul_f32 v246, v246, v78
v_mul_f32 v247, v247, v78
v_mul_f32 v252, v252, v78
v_mul_f32 v253, v253, v78
v_mul_f32 v254, v254, v78
v_mul_f32 v255, v255, v78
s_nop 1
s_branch L_k2_rescret1_0
L_k2_mask0_1:
s_lshl_b32 s63, s27, 5
s_sub_u32 s63, s66, s63
v_add_u32 v76, s63, v7
v_add_u32 v77, s63, v8
v_mov_b32 v78, 0xff800000
s_nop 4
v_cmp_gt_i32 s[72:73], 0, v76
v_cmp_gt_i32 s[74:75], 1, v76
v_cmp_gt_i32 s[76:77], 2, v76
v_cmp_gt_i32 s[78:79], 3, v76
s_nop 0
v_cndmask_b32 v32, v32, v78, s[72:73]
v_cndmask_b32 v33, v33, v78, s[74:75]
v_cndmask_b32 v34, v34, v78, s[76:77]
v_cndmask_b32 v35, v35, v78, s[78:79]
v_cmp_gt_i32 s[72:73], 16, v76
v_cmp_gt_i32 s[74:75], 17, v76
v_cmp_gt_i32 s[76:77], 18, v76
v_cmp_gt_i32 s[78:79], 19, v76
v_cndmask_b32 v40, v40, v78, s[72:73]
v_cndmask_b32 v41, v41, v78, s[74:75]
v_cndmask_b32 v42, v42, v78, s[76:77]
v_cndmask_b32 v43, v43, v78, s[78:79]
v_cmp_gt_i32 s[72:73], 0, v77
v_cmp_gt_i32 s[74:75], 1, v77
v_cmp_gt_i32 s[76:77], 2, v77
v_cmp_gt_i32 s[78:79], 3, v77
v_cndmask_b32 v36, v36, v78, s[72:73]
v_cndmask_b32 v37, v37, v78, s[74:75]
v_cndmask_b32 v38, v38, v78, s[76:77]
v_cndmask_b32 v39, v39, v78, s[78:79]
v_cmp_gt_i32 s[72:73], 16, v77
v_cmp_gt_i32 s[74:75], 17, v77
v_cmp_gt_i32 s[76:77], 18, v77
v_cmp_gt_i32 s[78:79], 19, v77
v_cndmask_b32 v44, v44, v78, s[72:73]
v_cndmask_b32 v45, v45, v78, s[74:75]
v_cndmask_b32 v46, v46, v78, s[76:77]
v_cndmask_b32 v47, v47, v78, s[78:79]
s_nop 0
s_branch L_k2_maskret0_1
L_k2_resc0_1:
s_nop 7
s_nop 1
v_max3_f32 v76, v32, v33, v34
v_max3_f32 v77, v35, v40, v41
v_max3_f32 v76, v76, v42, v43
v_max_f32 v76, v76, v77
v_mov_b32 v77, v76
s_nop 1
v_permlane32_swap_b32 v76, v77
s_nop 1
v_max_f32 v76, v76, v77
v_mov_b32 v77, v76
s_nop 1
v_permlane16_swap_b32 v76, v77
s_nop 1
v_max_f32 v76, v76, v77
v_max_f32 v76, 0, v76
v_exp_f32 v78, -v76
v_sub_f32 v32, v32, v76
v_sub_f32 v33, v33, v76
v_sub_f32 v34, v34, v76
v_sub_f32 v35, v35, v76
v_sub_f32 v40, v40, v76
v_sub_f32 v41, v41, v76
v_sub_f32 v42, v42, v76
v_sub_f32 v43, v43, v76
v_sub_f32 v56, v56, v76
v_sub_f32 v57, v57, v76
v_sub_f32 v58, v58, v76
v_sub_f32 v59, v59, v76
v_mul_f32 v64, v64, v78
v_mul_f32 v65, v65, v78
v_mul_f32 v66, v66, v78
v_mul_f32 v67, v67, v78
v_mul_f32 v128, v128, v78
v_mul_f32 v129, v129, v78
v_mul_f32 v130, v130, v78
v_mul_f32 v131, v131, v78
v_mul_f32 v136, v136, v78
v_mul_f32 v137, v137, v78
v_mul_f32 v138, v138, v78
v_mul_f32 v139, v139, v78
v_mul_f32 v144, v144, v78
v_mul_f32 v145, v145, v78
v_mul_f32 v146, v146, v78
v_mul_f32 v147, v147, v78
v_mul_f32 v152, v152, v78
v_mul_f32 v153, v153, v78
v_mul_f32 v154, v154, v78
v_mul_f32 v155, v155, v78
v_mul_f32 v160, v160, v78
v_mul_f32 v161, v161, v78
v_mul_f32 v162, v162, v78
v_mul_f32 v163, v163, v78
v_mul_f32 v168, v168, v78
v_mul_f32 v169, v169, v78
v_mul_f32 v170, v170, v78
v_mul_f32 v171, v171, v78
v_mul_f32 v176, v176, v78
v_mul_f32 v177, v177, v78
v_mul_f32 v178, v178, v78
v_mul_f32 v179, v179, v78
v_mul_f32 v184, v184, v78
v_mul_f32 v185, v185, v78
v_mul_f32 v186, v186, v78
v_mul_f32 v187, v187, v78
v_mul_f32 v192, v192, v78
v_mul_f32 v193, v193, v78
v_mul_f32 v194, v194, v78
v_mul_f32 v195, v195, v78
v_mul_f32 v200, v200, v78
v_mul_f32 v201, v201, v78
v_mul_f32 v202, v202, v78
v_mul_f32 v203, v203, v78
v_mul_f32 v208, v208, v78
v_mul_f32 v209, v209, v78
v_mul_f32 v210, v210, v78
v_mul_f32 v211, v211, v78
v_mul_f32 v216, v216, v78
v_mul_f32 v217, v217, v78
v_mul_f32 v218, v218, v78
v_mul_f32 v219, v219, v78
v_mul_f32 v224, v224, v78
v_mul_f32 v225, v225, v78
v_mul_f32 v226, v226, v78
v_mul_f32 v227, v227, v78
v_mul_f32 v232, v232, v78
v_mul_f32 v233, v233, v78
v_mul_f32 v234, v234, v78
v_mul_f32 v235, v235, v78
v_mul_f32 v240, v240, v78
v_mul_f32 v241, v241, v78
v_mul_f32 v242, v242, v78
v_mul_f32 v243, v243, v78
v_mul_f32 v248, v248, v78
v_mul_f32 v249, v249, v78
v_mul_f32 v250, v250, v78
v_mul_f32 v251, v251, v78
v_max3_f32 v76, v36, v37, v38
v_max3_f32 v77, v39, v44, v45
v_max3_f32 v76, v76, v46, v47
v_max_f32 v76, v76, v77
v_mov_b32 v77, v76
s_nop 1
v_permlane32_swap_b32 v76, v77
s_nop 1
v_max_f32 v76, v76, v77
v_mov_b32 v77, v76
s_nop 1
v_permlane16_swap_b32 v76, v77
s_nop 1
v_max_f32 v76, v76, v77
v_max_f32 v76, 0, v76
v_exp_f32 v78, -v76
v_sub_f32 v36, v36, v76
v_sub_f32 v37, v37, v76
v_sub_f32 v38, v38, v76
v_sub_f32 v39, v39, v76
v_sub_f32 v44, v44, v76
v_sub_f32 v45, v45, v76
v_sub_f32 v46, v46, v76
v_sub_f32 v47, v47, v76
v_sub_f32 v60, v60, v76
v_sub_f32 v61, v61, v76
v_sub_f32 v62, v62, v76
v_sub_f32 v63, v63, v76
v_mul_f32 v68, v68, v78
v_mul_f32 v69, v69, v78
v_mul_f32 v70, v70, v78
v_mul_f32 v71, v71, v78
v_mul_f32 v132, v132, v78
v_mul_f32 v133, v133, v78
v_mul_f32 v134, v134, v78
v_mul_f32 v135, v135, v78
v_mul_f32 v140, v140, v78
v_mul_f32 v141, v141, v78
v_mul_f32 v142, v142, v78
v_mul_f32 v143, v143, v78
v_mul_f32 v148, v148, v78
v_mul_f32 v149, v149, v78
v_mul_f32 v150, v150, v78
v_mul_f32 v151, v151, v78
v_mul_f32 v156, v156, v78
v_mul_f32 v157, v157, v78
v_mul_f32 v158, v158, v78
v_mul_f32 v159, v159, v78
v_mul_f32 v164, v164, v78
v_mul_f32 v165, v165, v78
v_mul_f32 v166, v166, v78
v_mul_f32 v167, v167, v78
v_mul_f32 v172, v172, v78
v_mul_f32 v173, v173, v78
v_mul_f32 v174, v174, v78
v_mul_f32 v175, v175, v78
v_mul_f32 v180, v180, v78
v_mul_f32 v181, v181, v78
v_mul_f32 v182, v182, v78
v_mul_f32 v183, v183, v78
v_mul_f32 v188, v188, v78
v_mul_f32 v189, v189, v78
v_mul_f32 v190, v190, v78
v_mul_f32 v191, v191, v78
v_mul_f32 v196, v196, v78
v_mul_f32 v197, v197, v78
v_mul_f32 v198, v198, v78
v_mul_f32 v199, v199, v78
v_mul_f32 v204, v204, v78
v_mul_f32 v205, v205, v78
v_mul_f32 v206, v206, v78
v_mul_f32 v207, v207, v78
v_mul_f32 v212, v212, v78
v_mul_f32 v213, v213, v78
v_mul_f32 v214, v214, v78
v_mul_f32 v215, v215, v78
v_mul_f32 v220, v220, v78
v_mul_f32 v221, v221, v78
v_mul_f32 v222, v222, v78
v_mul_f32 v223, v223, v78
v_mul_f32 v228, v228, v78
v_mul_f32 v229, v229, v78
v_mul_f32 v230, v230, v78
v_mul_f32 v231, v231, v78
v_mul_f32 v236, v236, v78
v_mul_f32 v237, v237, v78
v_mul_f32 v238, v238, v78
v_mul_f32 v239, v239, v78
v_mul_f32 v244, v244, v78
v_mul_f32 v245, v245, v78
v_mul_f32 v246, v246, v78
v_mul_f32 v247, v247, v78
v_mul_f32 v252, v252, v78
v_mul_f32 v253, v253, v78
v_mul_f32 v254, v254, v78
v_mul_f32 v255, v255, v78
s_nop 1
s_branch L_k2_rescret0_1
L_k2_mask1_1:
s_lshl_b32 s63, s27, 5
s_sub_u32 s63, s66, s63
v_add_u32 v76, s63, v7
v_add_u32 v77, s63, v8
v_mov_b32 v78, 0xff800000
s_nop 4
v_cmp_gt_i32 s[72:73], 0, v76
v_cmp_gt_i32 s[74:75], 1, v76
v_cmp_gt_i32 s[76:77], 2, v76
v_cmp_gt_i32 s[78:79], 3, v76
s_nop 0
v_cndmask_b32 v16, v16, v78, s[72:73]
v_cndmask_b32 v17, v17, v78, s[74:75]
v_cndmask_b32 v18, v18, v78, s[76:77]
v_cndmask_b32 v19, v19, v78, s[78:79]
v_cmp_gt_i32 s[72:73], 16, v76
v_cmp_gt_i32 s[74:75], 17, v76
v_cmp_gt_i32 s[76:77], 18, v76
v_cmp_gt_i32 s[78:79], 19, v76
v_cndmask_b32 v24, v24, v78, s[72:73]
v_cndmask_b32 v25, v25, v78, s[74:75]
v_cndmask_b32 v26, v26, v78, s[76:77]
v_cndmask_b32 v27, v27, v78, s[78:79]
v_cmp_gt_i32 s[72:73], 0, v77
v_cmp_gt_i32 s[74:75], 1, v77
v_cmp_gt_i32 s[76:77], 2, v77
v_cmp_gt_i32 s[78:79], 3, v77
v_cndmask_b32 v20, v20, v78, s[72:73]
v_cndmask_b32 v21, v21, v78, s[74:75]
v_cndmask_b32 v22, v22, v78, s[76:77]
v_cndmask_b32 v23, v23, v78, s[78:79]
v_cmp_gt_i32 s[72:73], 16, v77
v_cmp_gt_i32 s[74:75], 17, v77
v_cmp_gt_i32 s[76:77], 18, v77
v_cmp_gt_i32 s[78:79], 19, v77
v_cndmask_b32 v28, v28, v78, s[72:73]
v_cndmask_b32 v29, v29, v78, s[74:75]
v_cndmask_b32 v30, v30, v78, s[76:77]
v_cndmask_b32 v31, v31, v78, s[78:79]
s_nop 0
s_branch L_k2_maskret1_1
L_k2_resc1_1:
s_nop 7
s_nop 1
v_max3_f32 v76, v16, v17, v18
v_max3_f32 v77, v19, v24, v25
v_max3_f32 v76, v76, v26, v27
v_max_f32 v76, v76, v77
v_mov_b32 v77, v76
s_nop 1
v_permlane32_swap_b32 v76, v77
s_nop 1
v_max_f32 v76, v76, v77
v_mov_b32 v77, v76
s_nop 1
v_permlane16_swap_b32 v76, v77
s_nop 1
v_max_f32 v76, v76, v77
v_max_f32 v76, 0, v76
v_exp_f32 v78, -v76
v_sub_f32 v16, v16, v76
v_sub_f32 v17, v17, v76
v_sub_f32 v18, v18, v76
v_sub_f32 v19, v19, v76
v_sub_f32 v24, v24, v76
v_sub_f32 v25, v25, v76
v_sub_f32 v26, v26, v76
v_sub_f32 v27, v27, v76
v_sub_f32 v56, v56, v76
v_sub_f32 v57, v57, v76
v_sub_f32 v58, v58, v76
v_sub_f32 v59, v59, v76
v_mul_f32 v64, v64, v78
v_mul_f32 v65, v65, v78
v_mul_f32 v66, v66, v78
v_mul_f32 v67, v67, v78
v_mul_f32 v128, v128, v78
v_mul_f32 v129, v129, v78
v_mul_f32 v130, v130, v78
v_mul_f32 v131, v131, v78
v_mul_f32 v136, v136, v78
v_mul_f32 v137, v137, v78
v_mul_f32 v138, v138, v78
v_mul_f32 v139, v139, v78
v_mul_f32 v144, v144, v78
v_mul_f32 v145, v145, v78
v_mul_f32 v146, v146, v78
v_mul_f32 v147, v147, v78
v_mul_f32 v152, v152, v78
v_mul_f32 v153, v153, v78
v_mul_f32 v154, v154, v78
v_mul_f32 v155, v155, v78
v_mul_f32 v160, v160, v78
v_mul_f32 v161, v161, v78
v_mul_f32 v162, v162, v78
v_mul_f32 v163, v163, v78
v_mul_f32 v168, v168, v78
v_mul_f32 v169, v169, v78
v_mul_f32 v170, v170, v78
v_mul_f32 v171, v171, v78
v_mul_f32 v176, v176, v78
v_mul_f32 v177, v177, v78
v_mul_f32 v178, v178, v78
v_mul_f32 v179, v179, v78
v_mul_f32 v184, v184, v78
v_mul_f32 v185, v185, v78
v_mul_f32 v186, v186, v78
v_mul_f32 v187, v187, v78
v_mul_f32 v192, v192, v78
v_mul_f32 v193, v193, v78
v_mul_f32 v194, v194, v78
v_mul_f32 v195, v195, v78
v_mul_f32 v200, v200, v78
v_mul_f32 v201, v201, v78
v_mul_f32 v202, v202, v78
v_mul_f32 v203, v203, v78
v_mul_f32 v208, v208, v78
v_mul_f32 v209, v209, v78
v_mul_f32 v210, v210, v78
v_mul_f32 v211, v211, v78
v_mul_f32 v216, v216, v78
v_mul_f32 v217, v217, v78
v_mul_f32 v218, v218, v78
v_mul_f32 v219, v219, v78
v_mul_f32 v224, v224, v78
v_mul_f32 v225, v225, v78
v_mul_f32 v226, v226, v78
v_mul_f32 v227, v227, v78
v_mul_f32 v232, v232, v78
v_mul_f32 v233, v233, v78
v_mul_f32 v234, v234, v78
v_mul_f32 v235, v235, v78
v_mul_f32 v240, v240, v78
v_mul_f32 v241, v241, v78
v_mul_f32 v242, v242, v78
v_mul_f32 v243, v243, v78
v_mul_f32 v248, v248, v78
v_mul_f32 v249, v249, v78
v_mul_f32 v250, v250, v78
v_mul_f32 v251, v251, v78
v_max3_f32 v76, v20, v21, v22
v_max3_f32 v77, v23, v28, v29
v_max3_f32 v76, v76, v30, v31
v_max_f32 v76, v76, v77
v_mov_b32 v77, v76
s_nop 1
v_permlane32_swap_b32 v76, v77
s_nop 1
v_max_f32 v76, v76, v77
v_mov_b32 v77, v76
s_nop 1
v_permlane16_swap_b32 v76, v77
s_nop 1
v_max_f32 v76, v76, v77
v_max_f32 v76, 0, v76
v_exp_f32 v78, -v76
v_sub_f32 v20, v20, v76
v_sub_f32 v21, v21, v76
v_sub_f32 v22, v22, v76
v_sub_f32 v23, v23, v76
v_sub_f32 v28, v28, v76
v_sub_f32 v29, v29, v76
v_sub_f32 v30, v30, v76
v_sub_f32 v31, v31, v76
v_sub_f32 v60, v60, v76
v_sub_f32 v61, v61, v76
v_sub_f32 v62, v62, v76
v_sub_f32 v63, v63, v76
v_mul_f32 v68, v68, v78
v_mul_f32 v69, v69, v78
v_mul_f32 v70, v70, v78
v_mul_f32 v71, v71, v78
v_mul_f32 v132, v132, v78
v_mul_f32 v133, v133, v78
v_mul_f32 v134, v134, v78
v_mul_f32 v135, v135, v78
v_mul_f32 v140, v140, v78
v_mul_f32 v141, v141, v78
v_mul_f32 v142, v142, v78
v_mul_f32 v143, v143, v78
v_mul_f32 v148, v148, v78
v_mul_f32 v149, v149, v78
v_mul_f32 v150, v150, v78
v_mul_f32 v151, v151, v78
v_mul_f32 v156, v156, v78
v_mul_f32 v157, v157, v78
v_mul_f32 v158, v158, v78
v_mul_f32 v159, v159, v78
v_mul_f32 v164, v164, v78
v_mul_f32 v165, v165, v78
v_mul_f32 v166, v166, v78
v_mul_f32 v167, v167, v78
v_mul_f32 v172, v172, v78
v_mul_f32 v173, v173, v78
v_mul_f32 v174, v174, v78
v_mul_f32 v175, v175, v78
v_mul_f32 v180, v180, v78
v_mul_f32 v181, v181, v78
v_mul_f32 v182, v182, v78
v_mul_f32 v183, v183, v78
v_mul_f32 v188, v188, v78
v_mul_f32 v189, v189, v78
v_mul_f32 v190, v190, v78
v_mul_f32 v191, v191, v78
v_mul_f32 v196, v196, v78
v_mul_f32 v197, v197, v78
v_mul_f32 v198, v198, v78
v_mul_f32 v199, v199, v78
v_mul_f32 v204, v204, v78
v_mul_f32 v205, v205, v78
v_mul_f32 v206, v206, v78
v_mul_f32 v207, v207, v78
v_mul_f32 v212, v212, v78
v_mul_f32 v213, v213, v78
v_mul_f32 v214, v214, v78
v_mul_f32 v215, v215, v78
v_mul_f32 v220, v220, v78
v_mul_f32 v221, v221, v78
v_mul_f32 v222, v222, v78
v_mul_f32 v223, v223, v78
v_mul_f32 v228, v228, v78
v_mul_f32 v229, v229, v78
v_mul_f32 v230, v230, v78
v_mul_f32 v231, v231, v78
v_mul_f32 v236, v236, v78
v_mul_f32 v237, v237, v78
v_mul_f32 v238, v238, v78
v_mul_f32 v239, v239, v78
v_mul_f32 v244, v244, v78
v_mul_f32 v245, v245, v78
v_mul_f32 v246, v246, v78
v_mul_f32 v247, v247, v78
v_mul_f32 v252, v252, v78
v_mul_f32 v253, v253, v78
v_mul_f32 v254, v254, v78
v_mul_f32 v255, v255, v78
s_nop 1
s_branch L_k2_rescret1_1
L_k2_mask0_2:
s_lshl_b32 s63, s27, 5
s_sub_u32 s63, s66, s63
v_add_u32 v76, s63, v7
v_add_u32 v77, s63, v8
v_mov_b32 v78, 0xff800000
s_nop 4
v_cmp_gt_i32 s[72:73], 0, v76
v_cmp_gt_i32 s[74:75], 1, v76
v_cmp_gt_i32 s[76:77], 2, v76
v_cmp_gt_i32 s[78:79], 3, v76
s_nop 0
v_cndmask_b32 v32, v32, v78, s[72:73]
v_cndmask_b32 v33, v33, v78, s[74:75]
v_cndmask_b32 v34, v34, v78, s[76:77]
v_cndmask_b32 v35, v35, v78, s[78:79]
v_cmp_gt_i32 s[72:73], 16, v76
v_cmp_gt_i32 s[74:75], 17, v76
v_cmp_gt_i32 s[76:77], 18, v76
v_cmp_gt_i32 s[78:79], 19, v76
v_cndmask_b32 v40, v40, v78, s[72:73]
v_cndmask_b32 v41, v41, v78, s[74:75]
v_cndmask_b32 v42, v42, v78, s[76:77]
v_cndmask_b32 v43, v43, v78, s[78:79]
v_cmp_gt_i32 s[72:73], 0, v77
v_cmp_gt_i32 s[74:75], 1, v77
v_cmp_gt_i32 s[76:77], 2, v77
v_cmp_gt_i32 s[78:79], 3, v77
v_cndmask_b32 v36, v36, v78, s[72:73]
v_cndmask_b32 v37, v37, v78, s[74:75]
v_cndmask_b32 v38, v38, v78, s[76:77]
v_cndmask_b32 v39, v39, v78, s[78:79]
v_cmp_gt_i32 s[72:73], 16, v77
v_cmp_gt_i32 s[74:75], 17, v77
v_cmp_gt_i32 s[76:77], 18, v77
v_cmp_gt_i32 s[78:79], 19, v77
v_cndmask_b32 v44, v44, v78, s[72:73]
v_cndmask_b32 v45, v45, v78, s[74:75]
v_cndmask_b32 v46, v46, v78, s[76:77]
v_cndmask_b32 v47, v47, v78, s[78:79]
s_nop 0
s_branch L_k2_maskret0_2
L_k2_resc0_2:
s_nop 7
s_nop 1
v_max3_f32 v76, v32, v33, v34
v_max3_f32 v77, v35, v40, v41
v_max3_f32 v76, v76, v42, v43
v_max_f32 v76, v76, v77
v_mov_b32 v77, v76
s_nop 1
v_permlane32_swap_b32 v76, v77
s_nop 1
v_max_f32 v76, v76, v77
v_mov_b32 v77, v76
s_nop 1
v_permlane16_swap_b32 v76, v77
s_nop 1
v_max_f32 v76, v76, v77
v_max_f32 v76, 0, v76
v_exp_f32 v78, -v76
v_sub_f32 v32, v32, v76
v_sub_f32 v33, v33, v76
v_sub_f32 v34, v34, v76
v_sub_f32 v35, v35, v76
v_sub_f32 v40, v40, v76
v_sub_f32 v41, v41, v76
v_sub_f32 v42, v42, v76
v_sub_f32 v43, v43, v76
v_sub_f32 v56, v56, v76
v_sub_f32 v57, v57, v76
v_sub_f32 v58, v58, v76
v_sub_f32 v59, v59, v76
v_mul_f32 v64, v64, v78
v_mul_f32 v65, v65, v78
v_mul_f32 v66, v66, v78
v_mul_f32 v67, v67, v78
v_mul_f32 v128, v128, v78
v_mul_f32 v129, v129, v78
v_mul_f32 v130, v130, v78
v_mul_f32 v131, v131, v78
v_mul_f32 v136, v136, v78
v_mul_f32 v137, v137, v78
v_mul_f32 v138, v138, v78
v_mul_f32 v139, v139, v78
v_mul_f32 v144, v144, v78
v_mul_f32 v145, v145, v78
v_mul_f32 v146, v146, v78
v_mul_f32 v147, v147, v78
v_mul_f32 v152, v152, v78
v_mul_f32 v153, v153, v78
v_mul_f32 v154, v154, v78
v_mul_f32 v155, v155, v78
v_mul_f32 v160, v160, v78
v_mul_f32 v161, v161, v78
v_mul_f32 v162, v162, v78
v_mul_f32 v163, v163, v78
v_mul_f32 v168, v168, v78
v_mul_f32 v169, v169, v78
v_mul_f32 v170, v170, v78
v_mul_f32 v171, v171, v78
v_mul_f32 v176, v176, v78
v_mul_f32 v177, v177, v78
v_mul_f32 v178, v178, v78
v_mul_f32 v179, v179, v78
v_mul_f32 v184, v184, v78
v_mul_f32 v185, v185, v78
v_mul_f32 v186, v186, v78
v_mul_f32 v187, v187, v78
v_mul_f32 v192, v192, v78
v_mul_f32 v193, v193, v78
v_mul_f32 v194, v194, v78
v_mul_f32 v195, v195, v78
v_mul_f32 v200, v200, v78
v_mul_f32 v201, v201, v78
v_mul_f32 v202, v202, v78
v_mul_f32 v203, v203, v78
v_mul_f32 v208, v208, v78
v_mul_f32 v209, v209, v78
v_mul_f32 v210, v210, v78
v_mul_f32 v211, v211, v78
v_mul_f32 v216, v216, v78
v_mul_f32 v217, v217, v78
v_mul_f32 v218, v218, v78
v_mul_f32 v219, v219, v78
v_mul_f32 v224, v224, v78
v_mul_f32 v225, v225, v78
v_mul_f32 v226, v226, v78
v_mul_f32 v227, v227, v78
v_mul_f32 v232, v232, v78
v_mul_f32 v233, v233, v78
v_mul_f32 v234, v234, v78
v_mul_f32 v235, v235, v78
v_mul_f32 v240, v240, v78
v_mul_f32 v241, v241, v78
v_mul_f32 v242, v242, v78
v_mul_f32 v243, v243, v78
v_mul_f32 v248, v248, v78
v_mul_f32 v249, v249, v78
v_mul_f32 v250, v250, v78
v_mul_f32 v251, v251, v78
v_max3_f32 v76, v36, v37, v38
v_max3_f32 v77, v39, v44, v45
v_max3_f32 v76, v76, v46, v47
v_max_f32 v76, v76, v77
v_mov_b32 v77, v76
s_nop 1
v_permlane32_swap_b32 v76, v77
s_nop 1
v_max_f32 v76, v76, v77
v_mov_b32 v77, v76
s_nop 1
v_permlane16_swap_b32 v76, v77
s_nop 1
v_max_f32 v76, v76, v77
v_max_f32 v76, 0, v76
v_exp_f32 v78, -v76
v_sub_f32 v36, v36, v76
v_sub_f32 v37, v37, v76
v_sub_f32 v38, v38, v76
v_sub_f32 v39, v39, v76
v_sub_f32 v44, v44, v76
v_sub_f32 v45, v45, v76
v_sub_f32 v46, v46, v76
v_sub_f32 v47, v47, v76
v_sub_f32 v60, v60, v76
v_sub_f32 v61, v61, v76
v_sub_f32 v62, v62, v76
v_sub_f32 v63, v63, v76
v_mul_f32 v68, v68, v78
v_mul_f32 v69, v69, v78
v_mul_f32 v70, v70, v78
v_mul_f32 v71, v71, v78
v_mul_f32 v132, v132, v78
v_mul_f32 v133, v133, v78
v_mul_f32 v134, v134, v78
v_mul_f32 v135, v135, v78
v_mul_f32 v140, v140, v78
v_mul_f32 v141, v141, v78
v_mul_f32 v142, v142, v78
v_mul_f32 v143, v143, v78
v_mul_f32 v148, v148, v78
v_mul_f32 v149, v149, v78
v_mul_f32 v150, v150, v78
v_mul_f32 v151, v151, v78
v_mul_f32 v156, v156, v78
v_mul_f32 v157, v157, v78
v_mul_f32 v158, v158, v78
v_mul_f32 v159, v159, v78
v_mul_f32 v164, v164, v78
v_mul_f32 v165, v165, v78
v_mul_f32 v166, v166, v78
v_mul_f32 v167, v167, v78
v_mul_f32 v172, v172, v78
v_mul_f32 v173, v173, v78
v_mul_f32 v174, v174, v78
v_mul_f32 v175, v175, v78
v_mul_f32 v180, v180, v78
v_mul_f32 v181, v181, v78
v_mul_f32 v182, v182, v78
v_mul_f32 v183, v183, v78
v_mul_f32 v188, v188, v78
v_mul_f32 v189, v189, v78
v_mul_f32 v190, v190, v78
v_mul_f32 v191, v191, v78
v_mul_f32 v196, v196, v78
v_mul_f32 v197, v197, v78
v_mul_f32 v198, v198, v78
v_mul_f32 v199, v199, v78
v_mul_f32 v204, v204, v78
v_mul_f32 v205, v205, v78
v_mul_f32 v206, v206, v78
v_mul_f32 v207, v207, v78
v_mul_f32 v212, v212, v78
v_mul_f32 v213, v213, v78
v_mul_f32 v214, v214, v78
v_mul_f32 v215, v215, v78
v_mul_f32 v220, v220, v78
v_mul_f32 v221, v221, v78
v_mul_f32 v222, v222, v78
v_mul_f32 v223, v223, v78
v_mul_f32 v228, v228, v78
v_mul_f32 v229, v229, v78
v_mul_f32 v230, v230, v78
v_mul_f32 v231, v231, v78
v_mul_f32 v236, v236, v78
v_mul_f32 v237, v237, v78
v_mul_f32 v238, v238, v78
v_mul_f32 v239, v239, v78
v_mul_f32 v244, v244, v78
v_mul_f32 v245, v245, v78
v_mul_f32 v246, v246, v78
v_mul_f32 v247, v247, v78
v_mul_f32 v252, v252, v78
v_mul_f32 v253, v253, v78
v_mul_f32 v254, v254, v78
v_mul_f32 v255, v255, v78
s_nop 1
s_branch L_k2_rescret0_2
L_k2_mask1_2:
s_lshl_b32 s63, s27, 5
s_sub_u32 s63, s66, s63
v_add_u32 v76, s63, v7
v_add_u32 v77, s63, v8
v_mov_b32 v78, 0xff800000
s_nop 4
v_cmp_gt_i32 s[72:73], 0, v76
v_cmp_gt_i32 s[74:75], 1, v76
v_cmp_gt_i32 s[76:77], 2, v76
v_cmp_gt_i32 s[78:79], 3, v76
s_nop 0
v_cndmask_b32 v16, v16, v78, s[72:73]
v_cndmask_b32 v17, v17, v78, s[74:75]
v_cndmask_b32 v18, v18, v78, s[76:77]
v_cndmask_b32 v19, v19, v78, s[78:79]
v_cmp_gt_i32 s[72:73], 16, v76
v_cmp_gt_i32 s[74:75], 17, v76
v_cmp_gt_i32 s[76:77], 18, v76
v_cmp_gt_i32 s[78:79], 19, v76
v_cndmask_b32 v24, v24, v78, s[72:73]
v_cndmask_b32 v25, v25, v78, s[74:75]
v_cndmask_b32 v26, v26, v78, s[76:77]
v_cndmask_b32 v27, v27, v78, s[78:79]
v_cmp_gt_i32 s[72:73], 0, v77
v_cmp_gt_i32 s[74:75], 1, v77
v_cmp_gt_i32 s[76:77], 2, v77
v_cmp_gt_i32 s[78:79], 3, v77
v_cndmask_b32 v20, v20, v78, s[72:73]
v_cndmask_b32 v21, v21, v78, s[74:75]
v_cndmask_b32 v22, v22, v78, s[76:77]
v_cndmask_b32 v23, v23, v78, s[78:79]
v_cmp_gt_i32 s[72:73], 16, v77
v_cmp_gt_i32 s[74:75], 17, v77
v_cmp_gt_i32 s[76:77], 18, v77
v_cmp_gt_i32 s[78:79], 19, v77
v_cndmask_b32 v28, v28, v78, s[72:73]
v_cndmask_b32 v29, v29, v78, s[74:75]
v_cndmask_b32 v30, v30, v78, s[76:77]
v_cndmask_b32 v31, v31, v78, s[78:79]
s_nop 0
s_branch L_k2_maskret1_2
L_k2_resc1_2:
s_nop 7
s_nop 1
v_max3_f32 v76, v16, v17, v18
v_max3_f32 v77, v19, v24, v25
v_max3_f32 v76, v76, v26, v27
v_max_f32 v76, v76, v77
v_mov_b32 v77, v76
s_nop 1
v_permlane32_swap_b32 v76, v77
s_nop 1
v_max_f32 v76, v76, v77
v_mov_b32 v77, v76
s_nop 1
v_permlane16_swap_b32 v76, v77
s_nop 1
v_max_f32 v76, v76, v77
v_max_f32 v76, 0, v76
v_exp_f32 v78, -v76
v_sub_f32 v16, v16, v76
v_sub_f32 v17, v17, v76
v_sub_f32 v18, v18, v76
v_sub_f32 v19, v19, v76
v_sub_f32 v24, v24, v76
v_sub_f32 v25, v25, v76
v_sub_f32 v26, v26, v76
v_sub_f32 v27, v27, v76
v_sub_f32 v56, v56, v76
v_sub_f32 v57, v57, v76
v_sub_f32 v58, v58, v76
v_sub_f32 v59, v59, v76
v_mul_f32 v64, v64, v78
v_mul_f32 v65, v65, v78
v_mul_f32 v66, v66, v78
v_mul_f32 v67, v67, v78
v_mul_f32 v128, v128, v78
v_mul_f32 v129, v129, v78
v_mul_f32 v130, v130, v78
v_mul_f32 v131, v131, v78
v_mul_f32 v136, v136, v78
v_mul_f32 v137, v137, v78
v_mul_f32 v138, v138, v78
v_mul_f32 v139, v139, v78
v_mul_f32 v144, v144, v78
v_mul_f32 v145, v145, v78
v_mul_f32 v146, v146, v78
v_mul_f32 v147, v147, v78
v_mul_f32 v152, v152, v78
v_mul_f32 v153, v153, v78
v_mul_f32 v154, v154, v78
v_mul_f32 v155, v155, v78
v_mul_f32 v160, v160, v78
v_mul_f32 v161, v161, v78
v_mul_f32 v162, v162, v78
v_mul_f32 v163, v163, v78
v_mul_f32 v168, v168, v78
v_mul_f32 v169, v169, v78
v_mul_f32 v170, v170, v78
v_mul_f32 v171, v171, v78
v_mul_f32 v176, v176, v78
v_mul_f32 v177, v177, v78
v_mul_f32 v178, v178, v78
v_mul_f32 v179, v179, v78
v_mul_f32 v184, v184, v78
v_mul_f32 v185, v185, v78
v_mul_f32 v186, v186, v78
v_mul_f32 v187, v187, v78
v_mul_f32 v192, v192, v78
v_mul_f32 v193, v193, v78
v_mul_f32 v194, v194, v78
v_mul_f32 v195, v195, v78
v_mul_f32 v200, v200, v78
v_mul_f32 v201, v201, v78
v_mul_f32 v202, v202, v78
v_mul_f32 v203, v203, v78
v_mul_f32 v208, v208, v78
v_mul_f32 v209, v209, v78
v_mul_f32 v210, v210, v78
v_mul_f32 v211, v211, v78
v_mul_f32 v216, v216, v78
v_mul_f32 v217, v217, v78
v_mul_f32 v218, v218, v78
v_mul_f32 v219, v219, v78
v_mul_f32 v224, v224, v78
v_mul_f32 v225, v225, v78
v_mul_f32 v226, v226, v78
v_mul_f32 v227, v227, v78
v_mul_f32 v232, v232, v78
v_mul_f32 v233, v233, v78
v_mul_f32 v234, v234, v78
v_mul_f32 v235, v235, v78
v_mul_f32 v240, v240, v78
v_mul_f32 v241, v241, v78
v_mul_f32 v242, v242, v78
v_mul_f32 v243, v243, v78
v_mul_f32 v248, v248, v78
v_mul_f32 v249, v249, v78
v_mul_f32 v250, v250, v78
v_mul_f32 v251, v251, v78
v_max3_f32 v76, v20, v21, v22
v_max3_f32 v77, v23, v28, v29
v_max3_f32 v76, v76, v30, v31
v_max_f32 v76, v76, v77
v_mov_b32 v77, v76
s_nop 1
v_permlane32_swap_b32 v76, v77
s_nop 1
v_max_f32 v76, v76, v77
v_mov_b32 v77, v76
s_nop 1
v_permlane16_swap_b32 v76, v77
s_nop 1
v_max_f32 v76, v76, v77
v_max_f32 v76, 0, v76
v_exp_f32 v78, -v76
v_sub_f32 v20, v20, v76
v_sub_f32 v21, v21, v76
v_sub_f32 v22, v22, v76
v_sub_f32 v23, v23, v76
v_sub_f32 v28, v28, v76
v_sub_f32 v29, v29, v76
v_sub_f32 v30, v30, v76
v_sub_f32 v31, v31, v76
v_sub_f32 v60, v60, v76
v_sub_f32 v61, v61, v76
v_sub_f32 v62, v62, v76
v_sub_f32 v63, v63, v76
v_mul_f32 v68, v68, v78
v_mul_f32 v69, v69, v78
v_mul_f32 v70, v70, v78
v_mul_f32 v71, v71, v78
v_mul_f32 v132, v132, v78
v_mul_f32 v133, v133, v78
v_mul_f32 v134, v134, v78
v_mul_f32 v135, v135, v78
v_mul_f32 v140, v140, v78
v_mul_f32 v141, v141, v78
v_mul_f32 v142, v142, v78
v_mul_f32 v143, v143, v78
v_mul_f32 v148, v148, v78
v_mul_f32 v149, v149, v78
v_mul_f32 v150, v150, v78
v_mul_f32 v151, v151, v78
v_mul_f32 v156, v156, v78
v_mul_f32 v157, v157, v78
v_mul_f32 v158, v158, v78
v_mul_f32 v159, v159, v78
v_mul_f32 v164, v164, v78
v_mul_f32 v165, v165, v78
v_mul_f32 v166, v166, v78
v_mul_f32 v167, v167, v78
v_mul_f32 v172, v172, v78
v_mul_f32 v173, v173, v78
v_mul_f32 v174, v174, v78
v_mul_f32 v175, v175, v78
v_mul_f32 v180, v180, v78
v_mul_f32 v181, v181, v78
v_mul_f32 v182, v182, v78
v_mul_f32 v183, v183, v78
v_mul_f32 v188, v188, v78
v_mul_f32 v189, v189, v78
v_mul_f32 v190, v190, v78
v_mul_f32 v191, v191, v78
v_mul_f32 v196, v196, v78
v_mul_f32 v197, v197, v78
v_mul_f32 v198, v198, v78
v_mul_f32 v199, v199, v78
v_mul_f32 v204, v204, v78
v_mul_f32 v205, v205, v78
v_mul_f32 v206, v206, v78
v_mul_f32 v207, v207, v78
v_mul_f32 v212, v212, v78
v_mul_f32 v213, v213, v78
v_mul_f32 v214, v214, v78
v_mul_f32 v215, v215, v78
v_mul_f32 v220, v220, v78
v_mul_f32 v221, v221, v78
v_mul_f32 v222, v222, v78
v_mul_f32 v223, v223, v78
v_mul_f32 v228, v228, v78
v_mul_f32 v229, v229, v78
v_mul_f32 v230, v230, v78
v_mul_f32 v231, v231, v78
v_mul_f32 v236, v236, v78
v_mul_f32 v237, v237, v78
v_mul_f32 v238, v238, v78
v_mul_f32 v239, v239, v78
v_mul_f32 v244, v244, v78
v_mul_f32 v245, v245, v78
v_mul_f32 v246, v246, v78
v_mul_f32 v247, v247, v78
v_mul_f32 v252, v252, v78
v_mul_f32 v253, v253, v78
v_mul_f32 v254, v254, v78
v_mul_f32 v255, v255, v78
s_nop 1
s_branch L_k2_rescret1_2
L_k2_mask0_3:
s_lshl_b32 s63, s27, 5
s_sub_u32 s63, s66, s63
v_add_u32 v76, s63, v7
v_add_u32 v77, s63, v8
v_mov_b32 v78, 0xff800000
s_nop 4
v_cmp_gt_i32 s[72:73], 0, v76
v_cmp_gt_i32 s[74:75], 1, v76
v_cmp_gt_i32 s[76:77], 2, v76
v_cmp_gt_i32 s[78:79], 3, v76
s_nop 0
v_cndmask_b32 v32, v32, v78, s[72:73]
v_cndmask_b32 v33, v33, v78, s[74:75]
v_cndmask_b32 v34, v34, v78, s[76:77]
v_cndmask_b32 v35, v35, v78, s[78:79]
v_cmp_gt_i32 s[72:73], 16, v76
v_cmp_gt_i32 s[74:75], 17, v76
v_cmp_gt_i32 s[76:77], 18, v76
v_cmp_gt_i32 s[78:79], 19, v76
v_cndmask_b32 v40, v40, v78, s[72:73]
v_cndmask_b32 v41, v41, v78, s[74:75]
v_cndmask_b32 v42, v42, v78, s[76:77]
v_cndmask_b32 v43, v43, v78, s[78:79]
v_cmp_gt_i32 s[72:73], 0, v77
v_cmp_gt_i32 s[74:75], 1, v77
v_cmp_gt_i32 s[76:77], 2, v77
v_cmp_gt_i32 s[78:79], 3, v77
v_cndmask_b32 v36, v36, v78, s[72:73]
v_cndmask_b32 v37, v37, v78, s[74:75]
v_cndmask_b32 v38, v38, v78, s[76:77]
v_cndmask_b32 v39, v39, v78, s[78:79]
v_cmp_gt_i32 s[72:73], 16, v77
v_cmp_gt_i32 s[74:75], 17, v77
v_cmp_gt_i32 s[76:77], 18, v77
v_cmp_gt_i32 s[78:79], 19, v77
v_cndmask_b32 v44, v44, v78, s[72:73]
v_cndmask_b32 v45, v45, v78, s[74:75]
v_cndmask_b32 v46, v46, v78, s[76:77]
v_cndmask_b32 v47, v47, v78, s[78:79]
s_nop 0
s_branch L_k2_maskret0_3
L_k2_resc0_3:
s_nop 7
s_nop 1
v_max3_f32 v76, v32, v33, v34
v_max3_f32 v77, v35, v40, v41
v_max3_f32 v76, v76, v42, v43
v_max_f32 v76, v76, v77
v_mov_b32 v77, v76
s_nop 1
v_permlane32_swap_b32 v76, v77
s_nop 1
v_max_f32 v76, v76, v77
v_mov_b32 v77, v76
s_nop 1
v_permlane16_swap_b32 v76, v77
s_nop 1
v_max_f32 v76, v76, v77
v_max_f32 v76, 0, v76
v_exp_f32 v78, -v76
v_sub_f32 v32, v32, v76
v_sub_f32 v33, v33, v76
v_sub_f32 v34, v34, v76
v_sub_f32 v35, v35, v76
v_sub_f32 v40, v40, v76
v_sub_f32 v41, v41, v76
v_sub_f32 v42, v42, v76
v_sub_f32 v43, v43, v76
v_sub_f32 v56, v56, v76
v_sub_f32 v57, v57, v76
v_sub_f32 v58, v58, v76
v_sub_f32 v59, v59, v76
v_mul_f32 v64, v64, v78
v_mul_f32 v65, v65, v78
v_mul_f32 v66, v66, v78
v_mul_f32 v67, v67, v78
v_mul_f32 v128, v128, v78
v_mul_f32 v129, v129, v78
v_mul_f32 v130, v130, v78
v_mul_f32 v131, v131, v78
v_mul_f32 v136, v136, v78
v_mul_f32 v137, v137, v78
v_mul_f32 v138, v138, v78
v_mul_f32 v139, v139, v78
v_mul_f32 v144, v144, v78
v_mul_f32 v145, v145, v78
v_mul_f32 v146, v146, v78
v_mul_f32 v147, v147, v78
v_mul_f32 v152, v152, v78
v_mul_f32 v153, v153, v78
v_mul_f32 v154, v154, v78
v_mul_f32 v155, v155, v78
v_mul_f32 v160, v160, v78
v_mul_f32 v161, v161, v78
v_mul_f32 v162, v162, v78
v_mul_f32 v163, v163, v78
v_mul_f32 v168, v168, v78
v_mul_f32 v169, v169, v78
v_mul_f32 v170, v170, v78
v_mul_f32 v171, v171, v78
v_mul_f32 v176, v176, v78
v_mul_f32 v177, v177, v78
v_mul_f32 v178, v178, v78
v_mul_f32 v179, v179, v78
v_mul_f32 v184, v184, v78
v_mul_f32 v185, v185, v78
v_mul_f32 v186, v186, v78
v_mul_f32 v187, v187, v78
v_mul_f32 v192, v192, v78
v_mul_f32 v193, v193, v78
v_mul_f32 v194, v194, v78
v_mul_f32 v195, v195, v78
v_mul_f32 v200, v200, v78
v_mul_f32 v201, v201, v78
v_mul_f32 v202, v202, v78
v_mul_f32 v203, v203, v78
v_mul_f32 v208, v208, v78
v_mul_f32 v209, v209, v78
v_mul_f32 v210, v210, v78
v_mul_f32 v211, v211, v78
v_mul_f32 v216, v216, v78
v_mul_f32 v217, v217, v78
v_mul_f32 v218, v218, v78
v_mul_f32 v219, v219, v78
v_mul_f32 v224, v224, v78
v_mul_f32 v225, v225, v78
v_mul_f32 v226, v226, v78
v_mul_f32 v227, v227, v78
v_mul_f32 v232, v232, v78
v_mul_f32 v233, v233, v78
v_mul_f32 v234, v234, v78
v_mul_f32 v235, v235, v78
v_mul_f32 v240, v240, v78
v_mul_f32 v241, v241, v78
v_mul_f32 v242, v242, v78
v_mul_f32 v243, v243, v78
v_mul_f32 v248, v248, v78
v_mul_f32 v249, v249, v78
v_mul_f32 v250, v250, v78
v_mul_f32 v251, v251, v78
v_max3_f32 v76, v36, v37, v38
v_max3_f32 v77, v39, v44, v45
v_max3_f32 v76, v76, v46, v47
v_max_f32 v76, v76, v77
v_mov_b32 v77, v76
s_nop 1
v_permlane32_swap_b32 v76, v77
s_nop 1
v_max_f32 v76, v76, v77
v_mov_b32 v77, v76
s_nop 1
v_permlane16_swap_b32 v76, v77
s_nop 1
v_max_f32 v76, v76, v77
v_max_f32 v76, 0, v76
v_exp_f32 v78, -v76
v_sub_f32 v36, v36, v76
v_sub_f32 v37, v37, v76
v_sub_f32 v38, v38, v76
v_sub_f32 v39, v39, v76
v_sub_f32 v44, v44, v76
v_sub_f32 v45, v45, v76
v_sub_f32 v46, v46, v76
v_sub_f32 v47, v47, v76
v_sub_f32 v60, v60, v76
v_sub_f32 v61, v61, v76
v_sub_f32 v62, v62, v76
v_sub_f32 v63, v63, v76
v_mul_f32 v68, v68, v78
v_mul_f32 v69, v69, v78
v_mul_f32 v70, v70, v78
v_mul_f32 v71, v71, v78
v_mul_f32 v132, v132, v78
v_mul_f32 v133, v133, v78
v_mul_f32 v134, v134, v78
v_mul_f32 v135, v135, v78
v_mul_f32 v140, v140, v78
v_mul_f32 v141, v141, v78
v_mul_f32 v142, v142, v78
v_mul_f32 v143, v143, v78
v_mul_f32 v148, v148, v78
v_mul_f32 v149, v149, v78
v_mul_f32 v150, v150, v78
v_mul_f32 v151, v151, v78
v_mul_f32 v156, v156, v78
v_mul_f32 v157, v157, v78
v_mul_f32 v158, v158, v78
v_mul_f32 v159, v159, v78
v_mul_f32 v164, v164, v78
v_mul_f32 v165, v165, v78
v_mul_f32 v166, v166, v78
v_mul_f32 v167, v167, v78
v_mul_f32 v172, v172, v78
v_mul_f32 v173, v173, v78
v_mul_f32 v174, v174, v78
v_mul_f32 v175, v175, v78
v_mul_f32 v180, v180, v78
v_mul_f32 v181, v181, v78
v_mul_f32 v182, v182, v78
v_mul_f32 v183, v183, v78
v_mul_f32 v188, v188, v78
v_mul_f32 v189, v189, v78
v_mul_f32 v190, v190, v78
v_mul_f32 v191, v191, v78
v_mul_f32 v196, v196, v78
v_mul_f32 v197, v197, v78
v_mul_f32 v198, v198, v78
v_mul_f32 v199, v199, v78
v_mul_f32 v204, v204, v78
v_mul_f32 v205, v205, v78
v_mul_f32 v206, v206, v78
v_mul_f32 v207, v207, v78
v_mul_f32 v212, v212, v78
v_mul_f32 v213, v213, v78
v_mul_f32 v214, v214, v78
v_mul_f32 v215, v215, v78
v_mul_f32 v220, v220, v78
v_mul_f32 v221, v221, v78
v_mul_f32 v222, v222, v78
v_mul_f32 v223, v223, v78
v_mul_f32 v228, v228, v78
v_mul_f32 v229, v229, v78
v_mul_f32 v230, v230, v78
v_mul_f32 v231, v231, v78
v_mul_f32 v236, v236, v78
v_mul_f32 v237, v237, v78
v_mul_f32 v238, v238, v78
v_mul_f32 v239, v239, v78
v_mul_f32 v244, v244, v78
v_mul_f32 v245, v245, v78
v_mul_f32 v246, v246, v78
v_mul_f32 v247, v247, v78
v_mul_f32 v252, v252, v78
v_mul_f32 v253, v253, v78
v_mul_f32 v254, v254, v78
v_mul_f32 v255, v255, v78
s_nop 1
s_branch L_k2_rescret0_3
L_k2_mask1_3:
s_lshl_b32 s63, s27, 5
s_sub_u32 s63, s66, s63
v_add_u32 v76, s63, v7
v_add_u32 v77, s63, v8
v_mov_b32 v78, 0xff800000
s_nop 4
v_cmp_gt_i32 s[72:73], 0, v76
v_cmp_gt_i32 s[74:75], 1, v76
v_cmp_gt_i32 s[76:77], 2, v76
v_cmp_gt_i32 s[78:79], 3, v76
s_nop 0
v_cndmask_b32 v16, v16, v78, s[72:73]
v_cndmask_b32 v17, v17, v78, s[74:75]
v_cndmask_b32 v18, v18, v78, s[76:77]
v_cndmask_b32 v19, v19, v78, s[78:79]
v_cmp_gt_i32 s[72:73], 16, v76
v_cmp_gt_i32 s[74:75], 17, v76
v_cmp_gt_i32 s[76:77], 18, v76
v_cmp_gt_i32 s[78:79], 19, v76
v_cndmask_b32 v24, v24, v78, s[72:73]
v_cndmask_b32 v25, v25, v78, s[74:75]
v_cndmask_b32 v26, v26, v78, s[76:77]
v_cndmask_b32 v27, v27, v78, s[78:79]
v_cmp_gt_i32 s[72:73], 0, v77
v_cmp_gt_i32 s[74:75], 1, v77
v_cmp_gt_i32 s[76:77], 2, v77
v_cmp_gt_i32 s[78:79], 3, v77
v_cndmask_b32 v20, v20, v78, s[72:73]
v_cndmask_b32 v21, v21, v78, s[74:75]
v_cndmask_b32 v22, v22, v78, s[76:77]
v_cndmask_b32 v23, v23, v78, s[78:79]
v_cmp_gt_i32 s[72:73], 16, v77
v_cmp_gt_i32 s[74:75], 17, v77
v_cmp_gt_i32 s[76:77], 18, v77
v_cmp_gt_i32 s[78:79], 19, v77
v_cndmask_b32 v28, v28, v78, s[72:73]
v_cndmask_b32 v29, v29, v78, s[74:75]
v_cndmask_b32 v30, v30, v78, s[76:77]
v_cndmask_b32 v31, v31, v78, s[78:79]
s_nop 0
s_branch L_k2_maskret1_3
L_k2_resc1_3:
s_nop 7
s_nop 1
v_max3_f32 v76, v16, v17, v18
v_max3_f32 v77, v19, v24, v25
v_max3_f32 v76, v76, v26, v27
v_max_f32 v76, v76, v77
v_mov_b32 v77, v76
s_nop 1
v_permlane32_swap_b32 v76, v77
s_nop 1
v_max_f32 v76, v76, v77
v_mov_b32 v77, v76
s_nop 1
v_permlane16_swap_b32 v76, v77
s_nop 1
v_max_f32 v76, v76, v77
v_max_f32 v76, 0, v76
v_exp_f32 v78, -v76
v_sub_f32 v16, v16, v76
v_sub_f32 v17, v17, v76
v_sub_f32 v18, v18, v76
v_sub_f32 v19, v19, v76
v_sub_f32 v24, v24, v76
v_sub_f32 v25, v25, v76
v_sub_f32 v26, v26, v76
v_sub_f32 v27, v27, v76
v_sub_f32 v56, v56, v76
v_sub_f32 v57, v57, v76
v_sub_f32 v58, v58, v76
v_sub_f32 v59, v59, v76
v_mul_f32 v64, v64, v78
v_mul_f32 v65, v65, v78
v_mul_f32 v66, v66, v78
v_mul_f32 v67, v67, v78
v_mul_f32 v128, v128, v78
v_mul_f32 v129, v129, v78
v_mul_f32 v130, v130, v78
v_mul_f32 v131, v131, v78
v_mul_f32 v136, v136, v78
v_mul_f32 v137, v137, v78
v_mul_f32 v138, v138, v78
v_mul_f32 v139, v139, v78
v_mul_f32 v144, v144, v78
v_mul_f32 v145, v145, v78
v_mul_f32 v146, v146, v78
v_mul_f32 v147, v147, v78
v_mul_f32 v152, v152, v78
v_mul_f32 v153, v153, v78
v_mul_f32 v154, v154, v78
v_mul_f32 v155, v155, v78
v_mul_f32 v160, v160, v78
v_mul_f32 v161, v161, v78
v_mul_f32 v162, v162, v78
v_mul_f32 v163, v163, v78
v_mul_f32 v168, v168, v78
v_mul_f32 v169, v169, v78
v_mul_f32 v170, v170, v78
v_mul_f32 v171, v171, v78
v_mul_f32 v176, v176, v78
v_mul_f32 v177, v177, v78
v_mul_f32 v178, v178, v78
v_mul_f32 v179, v179, v78
v_mul_f32 v184, v184, v78
v_mul_f32 v185, v185, v78
v_mul_f32 v186, v186, v78
v_mul_f32 v187, v187, v78
v_mul_f32 v192, v192, v78
v_mul_f32 v193, v193, v78
v_mul_f32 v194, v194, v78
v_mul_f32 v195, v195, v78
v_mul_f32 v200, v200, v78
v_mul_f32 v201, v201, v78
v_mul_f32 v202, v202, v78
v_mul_f32 v203, v203, v78
v_mul_f32 v208, v208, v78
v_mul_f32 v209, v209, v78
v_mul_f32 v210, v210, v78
v_mul_f32 v211, v211, v78
v_mul_f32 v216, v216, v78
v_mul_f32 v217, v217, v78
v_mul_f32 v218, v218, v78
v_mul_f32 v219, v219, v78
v_mul_f32 v224, v224, v78
v_mul_f32 v225, v225, v78
v_mul_f32 v226, v226, v78
v_mul_f32 v227, v227, v78
v_mul_f32 v232, v232, v78
v_mul_f32 v233, v233, v78
v_mul_f32 v234, v234, v78
v_mul_f32 v235, v235, v78
v_mul_f32 v240, v240, v78
v_mul_f32 v241, v241, v78
v_mul_f32 v242, v242, v78
v_mul_f32 v243, v243, v78
v_mul_f32 v248, v248, v78
v_mul_f32 v249, v249, v78
v_mul_f32 v250, v250, v78
v_mul_f32 v251, v251, v78
v_max3_f32 v76, v20, v21, v22
v_max3_f32 v77, v23, v28, v29
v_max3_f32 v76, v76, v30, v31
v_max_f32 v76, v76, v77
v_mov_b32 v77, v76
s_nop 1
v_permlane32_swap_b32 v76, v77
s_nop 1
v_max_f32 v76, v76, v77
v_mov_b32 v77, v76
s_nop 1
v_permlane16_swap_b32 v76, v77
s_nop 1
v_max_f32 v76, v76, v77
v_max_f32 v76, 0, v76
v_exp_f32 v78, -v76
v_sub_f32 v20, v20, v76
v_sub_f32 v21, v21, v76
v_sub_f32 v22, v22, v76
v_sub_f32 v23, v23, v76
v_sub_f32 v28, v28, v76
v_sub_f32 v29, v29, v76
v_sub_f32 v30, v30, v76
v_sub_f32 v31, v31, v76
v_sub_f32 v60, v60, v76
v_sub_f32 v61, v61, v76
v_sub_f32 v62, v62, v76
v_sub_f32 v63, v63, v76
v_mul_f32 v68, v68, v78
v_mul_f32 v69, v69, v78
v_mul_f32 v70, v70, v78
v_mul_f32 v71, v71, v78
v_mul_f32 v132, v132, v78
v_mul_f32 v133, v133, v78
v_mul_f32 v134, v134, v78
v_mul_f32 v135, v135, v78
v_mul_f32 v140, v140, v78
v_mul_f32 v141, v141, v78
v_mul_f32 v142, v142, v78
v_mul_f32 v143, v143, v78
v_mul_f32 v148, v148, v78
v_mul_f32 v149, v149, v78
v_mul_f32 v150, v150, v78
v_mul_f32 v151, v151, v78
v_mul_f32 v156, v156, v78
v_mul_f32 v157, v157, v78
v_mul_f32 v158, v158, v78
v_mul_f32 v159, v159, v78
v_mul_f32 v164, v164, v78
v_mul_f32 v165, v165, v78
v_mul_f32 v166, v166, v78
v_mul_f32 v167, v167, v78
v_mul_f32 v172, v172, v78
v_mul_f32 v173, v173, v78
v_mul_f32 v174, v174, v78
v_mul_f32 v175, v175, v78
v_mul_f32 v180, v180, v78
v_mul_f32 v181, v181, v78
v_mul_f32 v182, v182, v78
v_mul_f32 v183, v183, v78
v_mul_f32 v188, v188, v78
v_mul_f32 v189, v189, v78
v_mul_f32 v190, v190, v78
v_mul_f32 v191, v191, v78
v_mul_f32 v196, v196, v78
v_mul_f32 v197, v197, v78
v_mul_f32 v198, v198, v78
v_mul_f32 v199, v199, v78
v_mul_f32 v204, v204, v78
v_mul_f32 v205, v205, v78
v_mul_f32 v206, v206, v78
v_mul_f32 v207, v207, v78
v_mul_f32 v212, v212, v78
v_mul_f32 v213, v213, v78
v_mul_f32 v214, v214, v78
v_mul_f32 v215, v215, v78
v_mul_f32 v220, v220, v78
v_mul_f32 v221, v221, v78
v_mul_f32 v222, v222, v78
v_mul_f32 v223, v223, v78
v_mul_f32 v228, v228, v78
v_mul_f32 v229, v229, v78
v_mul_f32 v230, v230, v78
v_mul_f32 v231, v231, v78
v_mul_f32 v236, v236, v78
v_mul_f32 v237, v237, v78
v_mul_f32 v238, v238, v78
v_mul_f32 v239, v239, v78
v_mul_f32 v244, v244, v78
v_mul_f32 v245, v245, v78
v_mul_f32 v246, v246, v78
v_mul_f32 v247, v247, v78
v_mul_f32 v252, v252, v78
v_mul_f32 v253, v253, v78
v_mul_f32 v254, v254, v78
v_mul_f32 v255, v255, v78
s_nop 1
s_branch L_k2_rescret1_3
L_k2_fl_0:
buffer_load_dword v113, v114, s[12:15], s97 offen sc1
s_branch L_k2_flret_0
L_k2_ec_0:
s_waitcnt vmcnt(7)
v_readfirstlane_b32 s57, v113
s_cmp_eq_u32 s57, s3
s_cbranch_scc0 L_k2_ecret_0
s_lshl_b32 s56, s17, 3
s_add_u32 s56, s56, s19
s_mul_i32 s56, s56, 69632
s_mul_i32 s57, s16, 17408
s_add_u32 s56, s56, s57
s_add_u32 s56, s56, 83886080
s_add_u32 s57, s56, 16384
buffer_load_dwordx4 v[84:87], v1, s[12:15], s57 offen sc1
s_add_u32 s57, s56, 0
buffer_load_dwordx4 a[64:67], v1, s[12:15], s57 offen offset:0 sc1
buffer_load_dwordx4 a[68:71], v1, s[12:15], s57 offen offset:1024 sc1
buffer_load_dwordx4 a[72:75], v1, s[12:15], s57 offen offset:2048 sc1
buffer_load_dwordx4 a[76:79], v1, s[12:15], s57 offen offset:3072 sc1
s_add_u32 s57, s56, 4096
buffer_load_dwordx4 a[80:83], v1, s[12:15], s57 offen offset:0 sc1
buffer_load_dwordx4 a[84:87], v1, s[12:15], s57 offen offset:1024 sc1
buffer_load_dwordx4 a[88:91], v1, s[12:15], s57 offen offset:2048 sc1
buffer_load_dwordx4 a[92:95], v1, s[12:15], s57 offen offset:3072 sc1
s_add_u32 s57, s56, 8192
buffer_load_dwordx4 a[96:99], v1, s[12:15], s57 offen offset:0 sc1
buffer_load_dwordx4 a[100:103], v1, s[12:15], s57 offen offset:1024 sc1
buffer_load_dwordx4 a[104:107], v1, s[12:15], s57 offen offset:2048 sc1
buffer_load_dwordx4 a[108:111], v1, s[12:15], s57 offen offset:3072 sc1
s_add_u32 s57, s56, 12288
buffer_load_dwordx4 a[112:115], v1, s[12:15], s57 offen offset:0 sc1
buffer_load_dwordx4 a[116:119], v1, s[12:15], s57 offen offset:1024 sc1
buffer_load_dwordx4 a[120:123], v1, s[12:15], s57 offen offset:2048 sc1
buffer_load_dwordx4 a[124:127], v1, s[12:15], s57 offen offset:3072 sc1
s_mov_b32 s89, 1
s_branch L_k2_ecret_0
L_k2_fl_1:
buffer_load_dword v113, v114, s[12:15], s97 offen sc1
s_branch L_k2_flret_1
L_k2_ec_1:
s_waitcnt vmcnt(7)
v_readfirstlane_b32 s57, v113
s_cmp_eq_u32 s57, s3
s_cbranch_scc0 L_k2_ecret_1
s_lshl_b32 s56, s17, 3
s_add_u32 s56, s56, s19
s_mul_i32 s56, s56, 69632
s_mul_i32 s57, s16, 17408
s_add_u32 s56, s56, s57
s_add_u32 s56, s56, 83886080
s_add_u32 s57, s56, 16384
buffer_load_dwordx4 v[84:87], v1, s[12:15], s57 offen sc1
s_add_u32 s57, s56, 0
buffer_load_dwordx4 a[64:67], v1, s[12:15], s57 offen offset:0 sc1
buffer_load_dwordx4 a[68:71], v1, s[12:15], s57 offen offset:1024 sc1
buffer_load_dwordx4 a[72:75], v1, s[12:15], s57 offen offset:2048 sc1
buffer_load_dwordx4 a[76:79], v1, s[12:15], s57 offen offset:3072 sc1
s_add_u32 s57, s56, 4096
buffer_load_dwordx4 a[80:83], v1, s[12:15], s57 offen offset:0 sc1
buffer_load_dwordx4 a[84:87], v1, s[12:15], s57 offen offset:1024 sc1
buffer_load_dwordx4 a[88:91], v1, s[12:15], s57 offen offset:2048 sc1
buffer_load_dwordx4 a[92:95], v1, s[12:15], s57 offen offset:3072 sc1
s_add_u32 s57, s56, 8192
buffer_load_dwordx4 a[96:99], v1, s[12:15], s57 offen offset:0 sc1
buffer_load_dwordx4 a[100:103], v1, s[12:15], s57 offen offset:1024 sc1
buffer_load_dwordx4 a[104:107], v1, s[12:15], s57 offen offset:2048 sc1
buffer_load_dwordx4 a[108:111], v1, s[12:15], s57 offen offset:3072 sc1
s_add_u32 s57, s56, 12288
buffer_load_dwordx4 a[112:115], v1, s[12:15], s57 offen offset:0 sc1
buffer_load_dwordx4 a[116:119], v1, s[12:15], s57 offen offset:1024 sc1
buffer_load_dwordx4 a[120:123], v1, s[12:15], s57 offen offset:2048 sc1
buffer_load_dwordx4 a[124:127], v1, s[12:15], s57 offen offset:3072 sc1
s_mov_b32 s89, 1
s_branch L_k2_ecret_1
L_k2_fl_2:
buffer_load_dword v113, v114, s[12:15], s97 offen sc1
s_branch L_k2_flret_2
L_k2_ec_2:
s_waitcnt vmcnt(7)
v_readfirstlane_b32 s57, v113
s_cmp_eq_u32 s57, s3
s_cbranch_scc0 L_k2_ecret_2
s_lshl_b32 s56, s17, 3
s_add_u32 s56, s56, s19
s_mul_i32 s56, s56, 69632
s_mul_i32 s57, s16, 17408
s_add_u32 s56, s56, s57
s_add_u32 s56, s56, 83886080
s_add_u32 s57, s56, 16384
buffer_load_dwordx4 v[84:87], v1, s[12:15], s57 offen sc1
s_add_u32 s57, s56, 0
buffer_load_dwordx4 a[64:67], v1, s[12:15], s57 offen offset:0 sc1
buffer_load_dwordx4 a[68:71], v1, s[12:15], s57 offen offset:1024 sc1
buffer_load_dwordx4 a[72:75], v1, s[12:15], s57 offen offset:2048 sc1
buffer_load_dwordx4 a[76:79], v1, s[12:15], s57 offen offset:3072 sc1
s_add_u32 s57, s56, 4096
buffer_load_dwordx4 a[80:83], v1, s[12:15], s57 offen offset:0 sc1
buffer_load_dwordx4 a[84:87], v1, s[12:15], s57 offen offset:1024 sc1
buffer_load_dwordx4 a[88:91], v1, s[12:15], s57 offen offset:2048 sc1
buffer_load_dwordx4 a[92:95], v1, s[12:15], s57 offen offset:3072 sc1
s_add_u32 s57, s56, 8192
buffer_load_dwordx4 a[96:99], v1, s[12:15], s57 offen offset:0 sc1
buffer_load_dwordx4 a[100:103], v1, s[12:15], s57 offen offset:1024 sc1
buffer_load_dwordx4 a[104:107], v1, s[12:15], s57 offen offset:2048 sc1
buffer_load_dwordx4 a[108:111], v1, s[12:15], s57 offen offset:3072 sc1
s_add_u32 s57, s56, 12288
buffer_load_dwordx4 a[112:115], v1, s[12:15], s57 offen offset:0 sc1
buffer_load_dwordx4 a[116:119], v1, s[12:15], s57 offen offset:1024 sc1
buffer_load_dwordx4 a[120:123], v1, s[12:15], s57 offen offset:2048 sc1
buffer_load_dwordx4 a[124:127], v1, s[12:15], s57 offen offset:3072 sc1
s_mov_b32 s89, 1
s_branch L_k2_ecret_2
L_k2_fl_3:
buffer_load_dword v113, v114, s[12:15], s97 offen sc1
s_branch L_k2_flret_3
L_k2_ec_3:
s_waitcnt vmcnt(7)
v_readfirstlane_b32 s57, v113
s_cmp_eq_u32 s57, s3
s_cbranch_scc0 L_k2_ecret_3
s_lshl_b32 s56, s17, 3
s_add_u32 s56, s56, s19
s_mul_i32 s56, s56, 69632
s_mul_i32 s57, s16, 17408
s_add_u32 s56, s56, s57
s_add_u32 s56, s56, 83886080
s_add_u32 s57, s56, 16384
buffer_load_dwordx4 v[84:87], v1, s[12:15], s57 offen sc1
s_add_u32 s57, s56, 0
buffer_load_dwordx4 a[64:67], v1, s[12:15], s57 offen offset:0 sc1
buffer_load_dwordx4 a[68:71], v1, s[12:15], s57 offen offset:1024 sc1
buffer_load_dwordx4 a[72:75], v1, s[12:15], s57 offen offset:2048 sc1
buffer_load_dwordx4 a[76:79], v1, s[12:15], s57 offen offset:3072 sc1
s_add_u32 s57, s56, 4096
buffer_load_dwordx4 a[80:83], v1, s[12:15], s57 offen offset:0 sc1
buffer_load_dwordx4 a[84:87], v1, s[12:15], s57 offen offset:1024 sc1
buffer_load_dwordx4 a[88:91], v1, s[12:15], s57 offen offset:2048 sc1
buffer_load_dwordx4 a[92:95], v1, s[12:15], s57 offen offset:3072 sc1
s_add_u32 s57, s56, 8192
buffer_load_dwordx4 a[96:99], v1, s[12:15], s57 offen offset:0 sc1
buffer_load_dwordx4 a[100:103], v1, s[12:15], s57 offen offset:1024 sc1
buffer_load_dwordx4 a[104:107], v1, s[12:15], s57 offen offset:2048 sc1
buffer_load_dwordx4 a[108:111], v1, s[12:15], s57 offen offset:3072 sc1
s_add_u32 s57, s56, 12288
buffer_load_dwordx4 a[112:115], v1, s[12:15], s57 offen offset:0 sc1
buffer_load_dwordx4 a[116:119], v1, s[12:15], s57 offen offset:1024 sc1
buffer_load_dwordx4 a[120:123], v1, s[12:15], s57 offen offset:2048 sc1
buffer_load_dwordx4 a[124:127], v1, s[12:15], s57 offen offset:3072 sc1
s_mov_b32 s89, 1
s_branch L_k2_ecret_3
L_k2_maskP:
s_lshl_b32 s63, s27, 5
s_sub_u32 s63, s66, s63
v_add_u32 v76, s63, v7
v_add_u32 v77, s63, v8
v_mov_b32 v78, 0xff800000
s_nop 4
v_cmp_gt_i32 s[72:73], 0, v76
v_cmp_gt_i32 s[74:75], 1, v76
v_cmp_gt_i32 s[76:77], 2, v76
v_cmp_gt_i32 s[78:79], 3, v76
s_nop 0
v_cndmask_b32 v16, v16, v78, s[72:73]
v_cndmask_b32 v17, v17, v78, s[74:75]
v_cndmask_b32 v18, v18, v78, s[76:77]
v_cndmask_b32 v19, v19, v78, s[78:79]
v_cmp_gt_i32 s[72:73], 16, v76
v_cmp_gt_i32 s[74:75], 17, v76
v_cmp_gt_i32 s[76:77], 18, v76
v_cmp_gt_i32 s[78:79], 19, v76
v_cndmask_b32 v24, v24, v78, s[72:73]
v_cndmask_b32 v25, v25, v78, s[74:75]
v_cndmask_b32 v26, v26, v78, s[76:77]
v_cndmask_b32 v27, v27, v78, s[78:79]
v_cmp_gt_i32 s[72:73], 0, v77
v_cmp_gt_i32 s[74:75], 1, v77
v_cmp_gt_i32 s[76:77], 2, v77
v_cmp_gt_i32 s[78:79], 3, v77
v_cndmask_b32 v20, v20, v78, s[72:73]
v_cndmask_b32 v21, v21, v78, s[74:75]
v_cndmask_b32 v22, v22, v78, s[76:77]
v_cndmask_b32 v23, v23, v78, s[78:79]
v_cmp_gt_i32 s[72:73], 16, v77
v_cmp_gt_i32 s[74:75], 17, v77
v_cmp_gt_i32 s[76:77], 18, v77
v_cmp_gt_i32 s[78:79], 19, v77
v_cndmask_b32 v28, v28, v78, s[72:73]
v_cndmask_b32 v29, v29, v78, s[74:75]
v_cndmask_b32 v30, v30, v78, s[76:77]
v_cndmask_b32 v31, v31, v78, s[78:79]
s_nop 0
s_branch L_k2_maskPret
L_f_loc_1_2_0:
v_and_b32 v28, 63, v0
v_lshlrev_b32 v28, 7, v28
s_lshr_b32 s61, s2, 3
s_lshl_b32 s61, s61, 1
s_add_u32 s61, s61, 0
s_sub_u32 s62, s61, 147
s_min_u32 s62, s62, 27
s_and_b32 s63, s2, 7
s_mul_i32 s63, s63, 28
s_add_u32 s62, s62, s63
s_cmp_lt_u32 s61, 147
s_cselect_b32 s61, s61, s62
s_cselect_b32 s62, s46, s44
s_cselect_b32 s63, s47, s45
s_lshl_b32 s61, s61, 13
s_add_u32 s62, s62, s61
s_addc_u32 s63, s63, 0
v_add_co_u32 v242, vcc, s62, v28
v_mov_b32 v243, s63
s_nop 0
v_addc_co_u32 v243, vcc, 0, v243, vcc
s_lshr_b32 s61, s2, 3
s_lshl_b32 s61, s61, 1
s_add_u32 s61, s61, 64
s_sub_u32 s62, s61, 147
s_min_u32 s62, s62, 27
s_and_b32 s63, s2, 7
s_mul_i32 s63, s63, 28
s_add_u32 s62, s62, s63
s_cmp_lt_u32 s61, 147
s_cselect_b32 s61, s61, s62
s_cselect_b32 s62, s46, s44
s_cselect_b32 s63, s47, s45
s_lshl_b32 s61, s61, 13
s_add_u32 s62, s62, s61
s_addc_u32 s63, s63, 0
v_add_co_u32 v244, vcc, s62, v28
v_mov_b32 v245, s63
s_nop 0
v_addc_co_u32 v245, vcc, 0, v245, vcc
s_lshr_b32 s61, s2, 3
s_lshl_b32 s61, s61, 1
s_add_u32 s61, s61, 128
s_sub_u32 s62, s61, 147
s_min_u32 s62, s62, 27
s_and_b32 s63, s2, 7
s_mul_i32 s63, s63, 28
s_add_u32 s62, s62, s63
s_cmp_lt_u32 s61, 147
s_cselect_b32 s61, s61, s62
s_cselect_b32 s62, s46, s44
s_cselect_b32 s63, s47, s45
s_lshl_b32 s61, s61, 13
s_add_u32 s62, s62, s61
s_addc_u32 s63, s63, 0
v_add_co_u32 v246, vcc, s62, v28
v_mov_b32 v247, s63
s_nop 0
v_addc_co_u32 v247, vcc, 0, v247, vcc
s_branch L_f_locret_1_2_0
L_f_loc_1_3_0:
v_and_b32 v28, 63, v0
v_lshlrev_b32 v28, 7, v28
s_lshr_b32 s61, s2, 3
s_lshl_b32 s61, s61, 1
s_add_u32 s61, s61, 1
s_sub_u32 s62, s61, 147
s_min_u32 s62, s62, 27
s_and_b32 s63, s2, 7
s_mul_i32 s63, s63, 28
s_add_u32 s62, s62, s63
s_cmp_lt_u32 s61, 147
s_cselect_b32 s61, s61, s62
s_cselect_b32 s62, s46, s44
s_cselect_b32 s63, s47, s45
s_lshl_b32 s61, s61, 13
s_add_u32 s62, s62, s61
s_addc_u32 s63, s63, 0
v_add_co_u32 v242, vcc, s62, v28
v_mov_b32 v243, s63
s_nop 0
v_addc_co_u32 v243, vcc, 0, v243, vcc
s_lshr_b32 s61, s2, 3
s_lshl_b32 s61, s61, 1
s_add_u32 s61, s61, 65
s_sub_u32 s62, s61, 147
s_min_u32 s62, s62, 27
s_and_b32 s63, s2, 7
s_mul_i32 s63, s63, 28
s_add_u32 s62, s62, s63
s_cmp_lt_u32 s61, 147
s_cselect_b32 s61, s61, s62
s_cselect_b32 s62, s46, s44
s_cselect_b32 s63, s47, s45
s_lshl_b32 s61, s61, 13
s_add_u32 s62, s62, s61
s_addc_u32 s63, s63, 0
v_add_co_u32 v244, vcc, s62, v28
v_mov_b32 v245, s63
s_nop 0
v_addc_co_u32 v245, vcc, 0, v245, vcc
s_lshr_b32 s61, s2, 3
s_lshl_b32 s61, s61, 1
s_add_u32 s61, s61, 129
s_sub_u32 s62, s61, 147
s_min_u32 s62, s62, 27
s_and_b32 s63, s2, 7
s_mul_i32 s63, s63, 28
s_add_u32 s62, s62, s63
s_cmp_lt_u32 s61, 147
s_cselect_b32 s61, s61, s62
s_cselect_b32 s62, s46, s44
s_cselect_b32 s63, s47, s45
s_lshl_b32 s61, s61, 13
s_add_u32 s62, s62, s61
s_addc_u32 s63, s63, 0
v_add_co_u32 v246, vcc, s62, v28
v_mov_b32 v247, s63
s_nop 0
v_addc_co_u32 v247, vcc, 0, v247, vcc
s_branch L_f_locret_1_3_0
L_f_loc_0_2_0:
v_and_b32 v28, 63, v0
v_lshlrev_b32 v28, 7, v28
s_lshr_b32 s61, s2, 3
s_lshl_b32 s61, s61, 1
s_add_u32 s61, s61, 0
s_sub_u32 s62, s61, 147
s_min_u32 s62, s62, 27
s_and_b32 s63, s2, 7
s_mul_i32 s63, s63, 28
s_add_u32 s62, s62, s63
s_cmp_lt_u32 s61, 147
s_cselect_b32 s61, s61, s62
s_cselect_b32 s62, s46, s44
s_cselect_b32 s63, s47, s45
s_lshl_b32 s61, s61, 13
s_add_u32 s62, s62, s61
s_addc_u32 s63, s63, 0
v_add_co_u32 v242, vcc, s62, v28
v_mov_b32 v243, s63
s_nop 0
v_addc_co_u32 v243, vcc, 0, v243, vcc
s_lshr_b32 s61, s2, 3
s_lshl_b32 s61, s61, 1
s_add_u32 s61, s61, 64
s_sub_u32 s62, s61, 147
s_min_u32 s62, s62, 27
s_and_b32 s63, s2, 7
s_mul_i32 s63, s63, 28
s_add_u32 s62, s62, s63
s_cmp_lt_u32 s61, 147
s_cselect_b32 s61, s61, s62
s_cselect_b32 s62, s46, s44
s_cselect_b32 s63, s47, s45
s_lshl_b32 s61, s61, 13
s_add_u32 s62, s62, s61
s_addc_u32 s63, s63, 0
v_add_co_u32 v244, vcc, s62, v28
v_mov_b32 v245, s63
s_nop 0
v_addc_co_u32 v245, vcc, 0, v245, vcc
s_lshr_b32 s61, s2, 3
s_lshl_b32 s61, s61, 1
s_add_u32 s61, s61, 128
s_sub_u32 s62, s61, 147
s_min_u32 s62, s62, 27
s_and_b32 s63, s2, 7
s_mul_i32 s63, s63, 28
s_add_u32 s62, s62, s63
s_cmp_lt_u32 s61, 147
s_cselect_b32 s61, s61, s62
s_cselect_b32 s62, s46, s44
s_cselect_b32 s63, s47, s45
s_lshl_b32 s61, s61, 13
s_add_u32 s62, s62, s61
s_addc_u32 s63, s63, 0
v_add_co_u32 v246, vcc, s62, v28
v_mov_b32 v247, s63
s_nop 0
v_addc_co_u32 v247, vcc, 0, v247, vcc
s_branch L_f_locret_0_2_0
L_f_loc_0_3_0:
v_and_b32 v28, 63, v0
v_lshlrev_b32 v28, 7, v28
s_lshr_b32 s61, s2, 3
s_lshl_b32 s61, s61, 1
s_add_u32 s61, s61, 1
s_sub_u32 s62, s61, 147
s_min_u32 s62, s62, 27
s_and_b32 s63, s2, 7
s_mul_i32 s63, s63, 28
s_add_u32 s62, s62, s63
s_cmp_lt_u32 s61, 147
s_cselect_b32 s61, s61, s62
s_cselect_b32 s62, s46, s44
s_cselect_b32 s63, s47, s45
s_lshl_b32 s61, s61, 13
s_add_u32 s62, s62, s61
s_addc_u32 s63, s63, 0
v_add_co_u32 v242, vcc, s62, v28
v_mov_b32 v243, s63
s_nop 0
v_addc_co_u32 v243, vcc, 0, v243, vcc
s_lshr_b32 s61, s2, 3
s_lshl_b32 s61, s61, 1
s_add_u32 s61, s61, 65
s_sub_u32 s62, s61, 147
s_min_u32 s62, s62, 27
s_and_b32 s63, s2, 7
s_mul_i32 s63, s63, 28
s_add_u32 s62, s62, s63
s_cmp_lt_u32 s61, 147
s_cselect_b32 s61, s61, s62
s_cselect_b32 s62, s46, s44
s_cselect_b32 s63, s47, s45
s_lshl_b32 s61, s61, 13
s_add_u32 s62, s62, s61
s_addc_u32 s63, s63, 0
v_add_co_u32 v244, vcc, s62, v28
v_mov_b32 v245, s63
s_nop 0
v_addc_co_u32 v245, vcc, 0, v245, vcc
s_lshr_b32 s61, s2, 3
s_lshl_b32 s61, s61, 1
s_add_u32 s61, s61, 129
s_sub_u32 s62, s61, 147
s_min_u32 s62, s62, 27
s_and_b32 s63, s2, 7
s_mul_i32 s63, s63, 28
s_add_u32 s62, s62, s63
s_cmp_lt_u32 s61, 147
s_cselect_b32 s61, s61, s62
s_cselect_b32 s62, s46, s44
s_cselect_b32 s63, s47, s45
s_lshl_b32 s61, s61, 13
s_add_u32 s62, s62, s61
s_addc_u32 s63, s63, 0
v_add_co_u32 v246, vcc, s62, v28
v_mov_b32 v247, s63
s_nop 0
v_addc_co_u32 v247, vcc, 0, v247, vcc
s_branch L_f_locret_0_3_0
L_f_codeend:
s_endpgm
.section .rodata,"a"
.p2align 6
.amdhsa_kernel concat_heads__compressed_kv_cla__sliding_block__prompt_kernel
  .amdhsa_next_free_vgpr 512
  .amdhsa_next_free_sgpr 102
  .amdhsa_accum_offset 256
  .amdhsa_group_segment_fixed_size 0
  .amdhsa_kernarg_size 96
  .amdhsa_user_sgpr_count 2
  .amdhsa_user_sgpr_kernarg_segment_ptr 1
  .amdhsa_system_sgpr_workgroup_id_x 1
.end_amdhsa_kernel
```
